```python
import torch

def _softmax(x, axis=-1):
    return torch.softmax(x, dim=axis)

def _gelu(x):
    return torch.nn.functional.gelu(x, approximate='tanh')

def _silu(x):
    return torch.nn.functional.silu(x)

def _sigmoid(x):
    return torch.sigmoid(x)

def _layernorm(x, axis=-1, eps=1e-05):
    m = x.mean(dim=axis, keepdim=True)
    v = x.var(dim=axis, keepdim=True, unbiased=False)
    return (x - m) / torch.sqrt(v + eps)

def _scatter_add(tgt, idx, src, axis=0):
    return tgt.clone().index_add_(axis, idx, src)

def _segment_sum(src, seg, n):
    out = torch.zeros((n,) + src.shape[1:], dtype=src.dtype)
    return out.index_add_(0, seg, src)

def _pad(x, pw):
    flat = tuple((v for pair in reversed(pw) for v in pair))
    return torch.nn.functional.pad(x, flat)
kernel_name = 'adaLN_cond__memory_aug_recurrent_mem_tr__mixer_channel_mlp__prompt'

def setup_inputs():

    _w = lambda a: (lambda t: t.to(torch.bfloat16) if t.is_floating_point() else t)(torch.as_tensor(a))

    def _A_setup():
        B, S, Dm = (1, 2048, 640)
        H, Dh = (32, 192)
        M, seg = (8, 32)
        seg = min(seg, S)
        S = S // seg * seg
        return {'x': _w((lambda *s: torch.randn(*s, dtype=torch.bfloat16) * 0.05)(B, S, Dm)), 'mem0': _w((lambda *s: torch.randn(*s, dtype=torch.bfloat16) * 0.4)(B, M, Dm)), 'Wq': _w((lambda *s: torch.randn(*s, dtype=torch.bfloat16) * 1.6)(Dm, H, Dh) * Dm ** (-0.5)), 'Wk': _w((lambda *s: torch.randn(*s, dtype=torch.bfloat16) * 1.6)(Dm, H, Dh) * Dm ** (-0.5)), 'Wv': _w((lambda *s: torch.randn(*s, dtype=torch.bfloat16) * 0.4)(Dm, H, Dh) * Dm ** (-0.5)), 'Wo': _w((lambda *s: torch.randn(*s, dtype=torch.bfloat16) * 0.4)(H, Dh, Dm) * (H * Dh) ** (-0.5)), 'seg_len': seg}
    _A_in = _A_setup()

    def _B_setup():
        B, S, D, F = (1, 2048, 640, 1536)
        return {'x': _w((lambda *s: torch.randn(*s, dtype=torch.bfloat16) * 0.05)(B, S, D)), 'w1': _w((lambda *s: torch.randn(*s, dtype=torch.bfloat16) * 1.6)(D, F) * D ** (-0.5)), 'b1': _w((lambda *s: torch.randn(*s, dtype=torch.bfloat16) * 0.4)(F)), 'w2': _w((lambda *s: torch.randn(*s, dtype=torch.bfloat16) * 0.1)(F, D) * F ** (-0.5)), 'b2': _w((lambda *s: torch.randn(*s, dtype=torch.bfloat16) * 0.1)(D))}
    _B_in = _B_setup()
    return {'A_x': _A_in['x'], 'A_mem0': _A_in['mem0'], 'A_Wq': _A_in['Wq'], 'A_Wk': _A_in['Wk'], 'A_Wv': _A_in['Wv'], 'A_Wo': _A_in['Wo'], 'A_seg_len': _A_in['seg_len'], 'B_x': _B_in['x'], 'B_w1': _B_in['w1'], 'B_b1': _B_in['b1'], 'B_w2': _B_in['w2'], 'B_b2': _B_in['b2'], 'c': _w((lambda *s: torch.randn(*s, dtype=torch.bfloat16) * 0.1)(1, 640) * 8.0), 'w_mod': _w((lambda *s: torch.randn(*s, dtype=torch.bfloat16) * 0.1)(640, 6 * 640) * 640 ** (-0.5) * 8.0)}

def reference(A_x, A_mem0, A_Wq, A_Wk, A_Wv, A_Wo, A_seg_len, B_x, B_w1, B_b1, B_w2, B_b2, c, w_mod):

    def _A_ref(x, mem0, Wq, Wk, Wv, Wo, seg_len):
        B, S, Dm = x.shape
        H, Dh = (Wq.shape[1], Wq.shape[2])
        M = mem0.shape[1]
        scale = Dh ** (-0.5)
        n_seg = S // seg_len
        L = M + seg_len
        idx = torch.arange(L)
        mask = (idx[:, None] < M) | (idx[:, None] >= idx[None, :])
        mem = mem0
        outs = []
        for s in range(n_seg):
            xs = x[:, s * seg_len:(s + 1) * seg_len, :].clone()
            h = torch.concatenate([mem, xs], axis=1)
            q = torch.einsum('btd,dhe->bhte', h, Wq)
            k = torch.einsum('btd,dhe->bhte', h, Wk)
            v = torch.einsum('btd,dhe->bhte', h, Wv)
            scores = torch.einsum('bhqe,bhke->bhqk', q, k) * scale
            scores = torch.where(mask[None, None], scores, -1000000000.0)
            p = _softmax(scores, axis=-1)
            o = torch.einsum('bhqk,bhke->bhqe', p, v)
            o = torch.einsum('bhte,hed->btd', o, Wo)
            mem = o[:, :M, :].clone()
            outs.append(o[:, M:, :])
        return torch.concatenate(outs, axis=1)

    def _B_ref(x, w1, b1, w2, b2):
        y = _layernorm(x, axis=-1)
        h = _gelu(torch.einsum('bsd,df->bsf', y, w1) + b1)
        return torch.einsum('bsf,fd->bsd', h, w2) + b2
    x = A_x
    mod = (_silu(c) @ w_mod).reshape(c.shape[0], 6, 1, -1)
    sa, ca, ga, sb, cb, gb = (mod[:, 0].clone(), mod[:, 1].clone(), mod[:, 2].clone(), mod[:, 3].clone(), mod[:, 4].clone(), mod[:, 5].clone())
    h = _layernorm(x, axis=-1) * (1 + ca) + sa
    x = x + ga * _A_ref(h, A_mem0, A_Wq, A_Wk, A_Wv, A_Wo, A_seg_len)
    h = _layernorm(x, axis=-1) * (1 + cb) + sb
    x = x + gb * _B_ref(h, B_w1, B_b1, B_w2, B_b2)
    return x
```

```asm
; @launch grid=(256,1,1) block=(256,1,1) lds=163840
.amdgcn_target "amdgcn-amd-amdhsa--gfx950"
.text
.globl adaLN_cond__memory_aug_recurrent_mem_tr__mixer_channel_mlp__prompt_kernel
.p2align 8
.type adaLN_cond__memory_aug_recurrent_mem_tr__mixer_channel_mlp__prompt_kernel,@function
adaLN_cond__memory_aug_recurrent_mem_tr__mixer_channel_mlp__prompt_kernel:
  s_cmp_ge_u32 s2, 256
  s_cbranch_scc1 Lmain_end
  s_load_dwordx16 s[32:47], s[0:1], 0
  s_load_dwordx16 s[48:63], s[0:1], 64
  s_load_dwordx2 s[64:65], s[0:1], 128
  v_and_b32 v1, 63, v0
  v_lshrrev_b32 v2, 6, v0
  s_getreg_b32 s26, hwreg(HW_REG_XCC_ID)
  v_readfirstlane_b32 s21, v2
  s_and_b32 s26, s26, 7
  s_mov_b32 s24, 0
  s_mov_b32 s22, 0
  s_mov_b32 s83, 0
  s_waitcnt lgkmcnt(0)
  s_mov_b32 s4, s64
  s_and_b32 s5, s65, 0xffff
  s_mov_b32 s6, 0x10000000
  s_mov_b32 s7, 0x20000
  s_mov_b32 s12, s62
  s_and_b32 s13, s63, 0xffff
  s_mov_b32 s14, 0x100
  s_mov_b32 s15, 0x20000
  s_mov_b32 s8, s64
  s_and_b32 s9, s65, 0xffff
  s_mov_b32 s10, 0x10000000
  s_mov_b32 s11, 0x20000
  s_mov_b32 s16, s64
  s_and_b32 s17, s65, 0xffff
  s_mov_b32 s18, 0x10000000
  s_mov_b32 s19, 0x20000
  v_mov_b32 v4, 0
  s_cmp_lg_u32 s21, 0
  s_cbranch_scc1 Lw0_1
  s_lshl_b32 s27, s26, 2
  v_mov_b32 v2, s27
  v_mov_b32 v3, 1
  s_mov_b64 exec, 1
  buffer_atomic_add v3, v2, s[12:15], 0 offen sc0 sc1
  s_waitcnt vmcnt(0)
  s_mov_b64 exec, -1
  v_readfirstlane_b32 s27, v3
  s_cmp_lt_u32 s27, 32
  s_cbranch_scc1 Lgot_2
  v_mov_b32 v2, 32
  v_mov_b32 v3, 1
  s_mov_b64 exec, 1
  buffer_atomic_add v3, v2, s[12:15], 0 offen sc0 sc1
  s_waitcnt vmcnt(0)
  s_mov_b64 exec, -1
  v_readfirstlane_b32 s28, v3
  v_and_b32 v2, 7, v1
  v_lshlrev_b32 v2, 2, v2
Lovsp_4:
  s_add_u32 s24, s24, 1
  s_cmp_gt_u32 s24, 300000
  s_cbranch_scc1 Lbadrole_3
  buffer_load_dword v3, v2, s[12:15], 0 offen sc1
  s_waitcnt vmcnt(0)
  s_mov_b32 s29, 0
  v_readlane_b32 s30, v3, 0
  s_add_u32 s29, s29, s30
  v_readlane_b32 s30, v3, 1
  s_add_u32 s29, s29, s30
  v_readlane_b32 s30, v3, 2
  s_add_u32 s29, s29, s30
  v_readlane_b32 s30, v3, 3
  s_add_u32 s29, s29, s30
  v_readlane_b32 s30, v3, 4
  s_add_u32 s29, s29, s30
  v_readlane_b32 s30, v3, 5
  s_add_u32 s29, s29, s30
  v_readlane_b32 s30, v3, 6
  s_add_u32 s29, s29, s30
  v_readlane_b32 s30, v3, 7
  s_add_u32 s29, s29, s30
  s_cmp_lt_u32 s29, 256
  s_cbranch_scc1 Lovsp_4
  v_readlane_b32 s30, v3, 0
  s_min_u32 s30, s30, 32
  s_sub_u32 s31, 32, s30
  s_cmp_lt_u32 s28, s31
  s_cbranch_scc0 Lovn_5
  s_mov_b32 s26, 0
  s_add_u32 s27, s30, s28
  s_branch Lgot_2
Lovn_5:
  s_sub_u32 s28, s28, s31
  v_readlane_b32 s30, v3, 1
  s_min_u32 s30, s30, 32
  s_sub_u32 s31, 32, s30
  s_cmp_lt_u32 s28, s31
  s_cbranch_scc0 Lovn_6
  s_mov_b32 s26, 1
  s_add_u32 s27, s30, s28
  s_branch Lgot_2
Lovn_6:
  s_sub_u32 s28, s28, s31
  v_readlane_b32 s30, v3, 2
  s_min_u32 s30, s30, 32
  s_sub_u32 s31, 32, s30
  s_cmp_lt_u32 s28, s31
  s_cbranch_scc0 Lovn_7
  s_mov_b32 s26, 2
  s_add_u32 s27, s30, s28
  s_branch Lgot_2
Lovn_7:
  s_sub_u32 s28, s28, s31
  v_readlane_b32 s30, v3, 3
  s_min_u32 s30, s30, 32
  s_sub_u32 s31, 32, s30
  s_cmp_lt_u32 s28, s31
  s_cbranch_scc0 Lovn_8
  s_mov_b32 s26, 3
  s_add_u32 s27, s30, s28
  s_branch Lgot_2
Lovn_8:
  s_sub_u32 s28, s28, s31
  v_readlane_b32 s30, v3, 4
  s_min_u32 s30, s30, 32
  s_sub_u32 s31, 32, s30
  s_cmp_lt_u32 s28, s31
  s_cbranch_scc0 Lovn_9
  s_mov_b32 s26, 4
  s_add_u32 s27, s30, s28
  s_branch Lgot_2
Lovn_9:
  s_sub_u32 s28, s28, s31
  v_readlane_b32 s30, v3, 5
  s_min_u32 s30, s30, 32
  s_sub_u32 s31, 32, s30
  s_cmp_lt_u32 s28, s31
  s_cbranch_scc0 Lovn_10
  s_mov_b32 s26, 5
  s_add_u32 s27, s30, s28
  s_branch Lgot_2
Lovn_10:
  s_sub_u32 s28, s28, s31
  v_readlane_b32 s30, v3, 6
  s_min_u32 s30, s30, 32
  s_sub_u32 s31, 32, s30
  s_cmp_lt_u32 s28, s31
  s_cbranch_scc0 Lovn_11
  s_mov_b32 s26, 6
  s_add_u32 s27, s30, s28
  s_branch Lgot_2
Lovn_11:
  s_sub_u32 s28, s28, s31
  v_readlane_b32 s30, v3, 7
  s_min_u32 s30, s30, 32
  s_sub_u32 s31, 32, s30
  s_cmp_lt_u32 s28, s31
  s_cbranch_scc0 Lovn_12
  s_mov_b32 s26, 7
  s_add_u32 s27, s30, s28
  s_branch Lgot_2
Lovn_12:
  s_sub_u32 s28, s28, s31
Lbadrole_3:
  s_mov_b32 s26, 0x100
  s_mov_b32 s27, 0
Lgot_2:
  s_lshl_b32 s26, s26, 5
  s_add_u32 s26, s26, s27
  v_mov_b32 v3, s26
  ds_write_b32 v4, v3
  s_waitcnt lgkmcnt(0)
Lw0_1:
  s_barrier
  ds_read_b32 v3, v4
  s_waitcnt lgkmcnt(0) vmcnt(0)
  v_readfirstlane_b32 s26, v3
  s_mov_b32 s23, 0
  s_barrier
  s_cmp_ge_u32 s26, 256
  s_cbranch_scc1 Lmain_end
  s_and_b32 s26, s26, 255
  s_lshr_b32 s27, s26, 5
  s_and_b32 s28, s26, 31
  s_lshl_b32 s70, s26, 2
  s_add_u32 s70, s70, s21
  s_lshl_b32 s70, s70, 11
  s_add_u32 s70, s70, 0xd000000
  s_cmp_lt_u32 s27, 4
  s_cbranch_scc1 Llo_14
  s_lshl_b32 s29, s28, 2
  s_add_u32 s29, s29, s27
  s_sub_u32 s29, s29, 4
  s_branch Loth_13
Llo_14:
  s_cmp_lt_u32 s28, 26
  s_cbranch_scc1 Llo2_16
  s_mul_i32 s29, s27, 6
  s_add_u32 s29, s29, s28
  s_add_u32 s29, s29, 102
  s_branch Loth_13
Llo2_16:
  s_lshl_b32 s29, s28, 2
  s_add_u32 s29, s29, s27
  s_cmp_ge_u32 s29, 32
  s_cbranch_scc1 Ld_17
  s_sub_u32 s20, s29, 0
  s_branch Lrole_S
Ld_17:
  s_cmp_ge_u32 s29, 72
  s_cbranch_scc1 Ld_18
  s_sub_u32 s20, s29, 32
  s_add_u32 s71, s20, 0
  s_branch Lprep
Ld_18:
  s_cmp_ge_u32 s29, 104
  s_cbranch_scc1 Ld_19
  s_sub_u32 s20, s29, 72
  s_branch Lrole_V
Ld_19:
  s_branch Lmain_end
Loth_13:
  s_cmp_ge_u32 s29, 20
  s_cbranch_scc1 Ld_20
  s_sub_u32 s20, s29, 0
  s_add_u32 s71, s20, 40
  s_branch Lprep
Ld_20:
  s_cmp_ge_u32 s29, 92
  s_cbranch_scc1 Ld_21
  s_sub_u32 s20, s29, 20
  s_branch Lrole_QKV
Ld_21:
  s_cmp_ge_u32 s29, 124
  s_cbranch_scc1 Ld_22
  s_sub_u32 s20, s29, 92
  s_branch Lrole_U
Ld_22:
  s_cmp_ge_u32 s29, 128
  s_cbranch_scc1 Ld_23
  s_sub_u32 s20, s29, 124
  s_add_u32 s71, s20, 60
  s_branch Lprep
Ld_23:
  s_cmp_ge_u32 s29, 136
  s_cbranch_scc1 Ld_24
  s_sub_u32 s20, s29, 128
  s_add_u32 s71, s20, 64
  s_branch Lprep
Ld_24:
  s_cmp_ge_u32 s29, 142
  s_cbranch_scc1 Ld_25
  s_sub_u32 s20, s29, 136
  s_branch Lrole_M1
Ld_25:
  s_cmp_ge_u32 s29, 152
  s_cbranch_scc1 Ld_26
  s_sub_u32 s20, s29, 142
  s_branch Lrole_M2
Ld_26:
  s_branch Lmain_end
Lprep:
  v_lshrrev_b32 v2, 6, v0
  s_cmp_eq_u32 s71, 71
  s_cbranch_scc1 Lpcal_30
  s_cmp_lt_u32 s71, 18
  s_cbranch_scc1 Lpwork_31
  s_sub_u32 s28, s71, 18
  s_cmp_eq_u32 s28, 43
  s_cbranch_scc1 Lpmem_28
  s_cmp_eq_u32 s28, 47
  s_cselect_b32 s27, 0, -1
  v_mov_b32 v16, s27
  v_mov_b32 v17, s27
  v_mov_b32 v18, s27
  v_mov_b32 v19, s27
  v_lshlrev_b32 v5, 4, v0
  s_lshl_b32 s26, s28, 15
  buffer_store_dwordx4 v[16:19], v5, s[4:7], s26 offen sc1
  s_add_u32 s26, s26, 4096
  buffer_store_dwordx4 v[16:19], v5, s[4:7], s26 offen sc1
  s_add_u32 s26, s26, 4096
  buffer_store_dwordx4 v[16:19], v5, s[4:7], s26 offen sc1
  s_add_u32 s26, s26, 4096
  buffer_store_dwordx4 v[16:19], v5, s[4:7], s26 offen sc1
  s_add_u32 s26, s26, 4096
  buffer_store_dwordx4 v[16:19], v5, s[4:7], s26 offen sc1
  s_add_u32 s26, s26, 4096
  buffer_store_dwordx4 v[16:19], v5, s[4:7], s26 offen sc1
  s_add_u32 s26, s26, 4096
  buffer_store_dwordx4 v[16:19], v5, s[4:7], s26 offen sc1
  s_add_u32 s26, s26, 4096
  buffer_store_dwordx4 v[16:19], v5, s[4:7], s26 offen sc1
  s_sub_u32 s28, s71, 62
  s_cmp_ge_u32 s28, 6
  s_cbranch_scc1 Lpwork_31
  v_mov_b32 v16, 0
  v_lshlrev_b32 v5, 7, v0
  s_lshl_b32 s26, s28, 16
  s_add_u32 s26, s26, 0x200000
  s_add_u32 s27, s26, 32768
  buffer_store_dword v16, v5, s[4:7], s26 offen sc1
  buffer_store_dword v16, v5, s[4:7], s27 offen sc1
  s_branch Lpwork_31
Lpmem_28:
  s_mov_b32 s16, s34
  s_and_b32 s17, s35, 0xffff
  s_mov_b32 s18, 0x2800
  s_mov_b32 s19, 0x20000
  v_add_u32 v5, 0, v0
  v_min_u32 v5, 639, v5
  v_lshrrev_b32 v6, 4, v5
  v_bfe_u32 v7, v5, 1, 3
  v_and_b32 v8, 1, v5
  v_mul_u32_u24 v7, 1280, v7
  v_lshl_add_u32 v7, v6, 5, v7
  v_lshl_add_u32 v7, v8, 4, v7
  v_lshlrev_b32 v9, 4, v5
  buffer_load_dwordx4 v[16:19], v7, s[16:19], 0 offen
  v_add_u32 v5, 256, v0
  v_min_u32 v5, 639, v5
  v_lshrrev_b32 v6, 4, v5
  v_bfe_u32 v7, v5, 1, 3
  v_and_b32 v8, 1, v5
  v_mul_u32_u24 v7, 1280, v7
  v_lshl_add_u32 v7, v6, 5, v7
  v_lshl_add_u32 v7, v8, 4, v7
  v_lshlrev_b32 v10, 4, v5
  buffer_load_dwordx4 v[20:23], v7, s[16:19], 0 offen
  v_add_u32 v5, 512, v0
  v_min_u32 v5, 639, v5
  v_lshrrev_b32 v6, 4, v5
  v_bfe_u32 v7, v5, 1, 3
  v_and_b32 v8, 1, v5
  v_mul_u32_u24 v7, 1280, v7
  v_lshl_add_u32 v7, v6, 5, v7
  v_lshl_add_u32 v7, v8, 4, v7
  v_lshlrev_b32 v11, 4, v5
  buffer_load_dwordx4 v[24:27], v7, s[16:19], 0 offen
  s_waitcnt vmcnt(0)
  v_min_u32 v16, -2, v16
  v_min_u32 v17, -2, v17
  v_min_u32 v18, -2, v18
  v_min_u32 v19, -2, v19
  v_min_u32 v20, -2, v20
  v_min_u32 v21, -2, v21
  v_min_u32 v22, -2, v22
  v_min_u32 v23, -2, v23
  v_min_u32 v24, -2, v24
  v_min_u32 v25, -2, v25
  v_min_u32 v26, -2, v26
  v_min_u32 v27, -2, v27
  s_mov_b32 s26, 0x158000
  s_mov_b32 s27, 0x15a000
  buffer_store_dwordx4 v[16:19], v9, s[4:7], s26 offen sc1
  buffer_store_dwordx4 v[16:19], v9, s[4:7], s27 offen sc1
  s_mov_b32 s26, 0x158000
  s_mov_b32 s27, 0x15a000
  buffer_store_dwordx4 v[20:23], v10, s[4:7], s26 offen sc1
  buffer_store_dwordx4 v[20:23], v10, s[4:7], s27 offen sc1
  s_mov_b32 s26, 0x15a000
  s_mov_b32 s27, 0x15c000
  buffer_store_dwordx4 v[24:27], v11, s[4:7], s26 offen sc1
  buffer_store_dwordx4 v[24:27], v11, s[4:7], s27 offen sc1
  s_branch Lpwork_31
Lpcal_30:
  s_cmp_lg_u32 s21, 0
  s_cbranch_scc1 Lcend_32
  s_mov_b64 exec, 1
  v_mov_b32 v5, 0
  v_mov_b32 v6, 7
  s_mov_b32 s30, 0x7fffffff
  s_mov_b32 s31, 0x7fffffff
  s_mov_b32 s37, 0
  s_mov_b32 s39, 0
  s_mov_b32 exec_lo, -1
  v_lshlrev_b32 v8, 8, v1
  v_mov_b32 v6, 7
  s_mov_b32 s34, 0x1fc000
  buffer_store_dword v6, v8, s[4:7], s34 offen sc1
  s_mov_b32 s34, 0x1fe000
  buffer_store_dword v6, v8, s[4:7], s34 offen sc1
  s_mov_b64 exec, 1
  s_waitcnt vmcnt(0)
  s_mov_b32 s36, 0
Lcl_33:
  s_add_u32 s34, s36, 0x1fc000
  s_memtime s[26:27]
  s_waitcnt lgkmcnt(0)
  buffer_load_dword v7, v5, s[4:7], s34 offen sc1
  s_waitcnt vmcnt(0)
  s_memtime s[28:29]
  s_waitcnt lgkmcnt(0)
  s_sub_u32 s28, s28, s26
  s_min_u32 s30, s30, s28
  s_mov_b32 s38, s28
  s_add_u32 s34, s36, 0x1fe000
  s_memtime s[26:27]
  s_waitcnt lgkmcnt(0)
  buffer_load_dword v7, v5, s[4:7], s34 offen sc1
  s_waitcnt vmcnt(0)
  s_memtime s[28:29]
  s_waitcnt lgkmcnt(0)
  s_sub_u32 s28, s28, s26
  s_min_u32 s31, s31, s28
  s_cmp_lt_u32 s28, s38
  s_cselect_b32 s28, 1, -1
  s_add_i32 s39, s39, s28
  s_add_u32 s36, s36, 1280
  s_and_b32 s36, s36, 0x1f00
  s_add_u32 s37, s37, 1
  s_min_u32 s28, s30, s31
  s_max_u32 s29, s30, s31
  s_cmp_ge_u32 s37, 12
  s_cbranch_scc1 Lcd_34
  s_cmp_lt_u32 s37, 2
  s_cbranch_scc1 Lcl_33
  s_cmp_ge_u32 s28, 520
  s_cbranch_scc1 Lcl_33
  s_sub_u32 s29, s29, s28
  s_cmp_lt_u32 s29, 100
  s_cbranch_scc1 Lcl_33
Lcd_34:
  s_cmp_lt_u32 s31, s30
  s_cselect_b32 s34, 1, 0
  s_cmp_gt_i32 s39, 0
  s_cselect_b32 s38, 1, 0
  s_min_u32 s28, s30, s31
  s_max_u32 s29, s30, s31
  s_sub_u32 s29, s29, s28
  s_cmp_lt_u32 s29, 120
  s_cselect_b32 s34, s38, s34
  s_getreg_b32 s35, hwreg(HW_REG_XCC_ID)
  s_lshr_b32 s35, s35, 2
  s_and_b32 s35, s35, 1
  s_xor_b32 s34, s34, s35
  s_lshl_b32 s34, s34, 13
  v_mov_b32 v6, s34
  v_mov_b32 v7, s30
  v_mov_b32 v8, s31
  v_mov_b32 v9, s37
  s_mov_b32 s26, 0x260000
  buffer_store_dwordx4 v[6:9], v5, s[4:7], s26 offen sc1
  v_or_b32 v10, 1, v6
  v_mov_b32 v2, 140
  buffer_store_dword v10, v2, s[12:15], 0 offen sc1
  s_mov_b64 exec, -1
Lcend_32:
  s_barrier
  s_branch Lpdone_27
Lpwork_31:
  s_mov_b32 s72, s71
  s_sub_u32 s28, s71, 62
  s_cmp_lt_u32 s28, 6
  s_cselect_b32 s73, 0x1000001, 1
  s_mov_b32 s8, s32
  s_and_b32 s9, s33, 0xffff
  s_mov_b32 s10, 0x280000
  s_mov_b32 s11, 0x20000
  v_lshrrev_b32 v3, 4, v1
  v_lshl_add_u32 v3, v2, 2, v3
  v_and_b32 v4, 15, v1
  v_mul_u32_u24 v5, 1280, v3
  v_lshl_add_u32 v5, v4, 4, v5
  s_mul_i32 s27, s72, 20480
  s_add_u32 s28, s27, 1454080
  buffer_load_dwordx4 v[180:183], v5, s[8:11], s27 offen offset:0
  buffer_load_dwordx4 v[184:187], v5, s[8:11], s27 offen offset:256
  buffer_load_dwordx4 v[188:191], v5, s[8:11], s27 offen offset:512
  buffer_load_dwordx4 v[192:195], v5, s[8:11], s27 offen offset:768
  buffer_load_dwordx4 v[196:199], v5, s[8:11], s27 offen offset:1024
  buffer_load_dwordx4 v[200:203], v5, s[8:11], s28 offen offset:0
  buffer_load_dwordx4 v[204:207], v5, s[8:11], s28 offen offset:256
  buffer_load_dwordx4 v[208:211], v5, s[8:11], s28 offen offset:512
  buffer_load_dwordx4 v[212:215], v5, s[8:11], s28 offen offset:768
  buffer_load_dwordx4 v[216:219], v5, s[8:11], s28 offen offset:1024
  s_cmp_ge_u32 s72, 60
  s_cbranch_scc1 Lnomod_35
  s_mov_b32 s16, s56
  s_and_b32 s17, s57, 0xffff
  s_mov_b32 s18, 0x500
  s_mov_b32 s19, 0x20000
  s_mov_b32 s8, s58
  s_and_b32 s9, s59, 0xffff
  s_mov_b32 s10, 0x4b0000
  s_mov_b32 s11, 0x20000
  v_lshrrev_b32 v3, 3, v1
  v_and_b32 v4, 7, v1
  v_mul_u32_u24 v5, 160, v2
  v_add_u32 v5, v5, v3
  v_mul_u32_u24 v6, 7680, v5
  v_lshl_add_u32 v6, v4, 4, v6
  v_lshlrev_b32 v7, 1, v5
  s_lshl_b32 s26, s72, 7
  buffer_load_ushort v20, v7, s[16:19], 0 offen offset:0
  buffer_load_ushort v21, v7, s[16:19], 0 offen offset:16
  buffer_load_ushort v22, v7, s[16:19], 0 offen offset:32
  buffer_load_ushort v23, v7, s[16:19], 0 offen offset:48
  buffer_load_ushort v24, v7, s[16:19], 0 offen offset:64
  buffer_load_ushort v25, v7, s[16:19], 0 offen offset:80
  buffer_load_ushort v26, v7, s[16:19], 0 offen offset:96
  buffer_load_ushort v27, v7, s[16:19], 0 offen offset:112
  buffer_load_ushort v28, v7, s[16:19], 0 offen offset:128
  buffer_load_ushort v29, v7, s[16:19], 0 offen offset:144
  buffer_load_ushort v30, v7, s[16:19], 0 offen offset:160
  buffer_load_ushort v31, v7, s[16:19], 0 offen offset:176
  buffer_load_ushort v32, v7, s[16:19], 0 offen offset:192
  buffer_load_ushort v33, v7, s[16:19], 0 offen offset:208
  buffer_load_ushort v34, v7, s[16:19], 0 offen offset:224
  buffer_load_ushort v35, v7, s[16:19], 0 offen offset:240
  buffer_load_ushort v36, v7, s[16:19], 0 offen offset:256
  buffer_load_ushort v37, v7, s[16:19], 0 offen offset:272
  buffer_load_ushort v38, v7, s[16:19], 0 offen offset:288
  buffer_load_ushort v39, v7, s[16:19], 0 offen offset:304
  buffer_load_dwordx4 v[40:43], v6, s[8:11], s26 offen
  s_add_u32 s26, s26, 61440
  buffer_load_dwordx4 v[44:47], v6, s[8:11], s26 offen
  s_add_u32 s26, s26, 61440
  buffer_load_dwordx4 v[48:51], v6, s[8:11], s26 offen
  s_add_u32 s26, s26, 61440
  buffer_load_dwordx4 v[52:55], v6, s[8:11], s26 offen
  s_add_u32 s26, s26, 61440
  buffer_load_dwordx4 v[56:59], v6, s[8:11], s26 offen
  s_add_u32 s26, s26, 61440
  buffer_load_dwordx4 v[60:63], v6, s[8:11], s26 offen
  s_add_u32 s26, s26, 61440
  buffer_load_dwordx4 v[64:67], v6, s[8:11], s26 offen
  s_add_u32 s26, s26, 61440
  buffer_load_dwordx4 v[68:71], v6, s[8:11], s26 offen
  s_add_u32 s26, s26, 61440
  buffer_load_dwordx4 v[72:75], v6, s[8:11], s26 offen
  s_add_u32 s26, s26, 61440
  buffer_load_dwordx4 v[76:79], v6, s[8:11], s26 offen
  s_add_u32 s26, s26, 61440
  buffer_load_dwordx4 v[80:83], v6, s[8:11], s26 offen
  s_add_u32 s26, s26, 61440
  buffer_load_dwordx4 v[84:87], v6, s[8:11], s26 offen
  s_add_u32 s26, s26, 61440
  buffer_load_dwordx4 v[88:91], v6, s[8:11], s26 offen
  s_add_u32 s26, s26, 61440
  buffer_load_dwordx4 v[92:95], v6, s[8:11], s26 offen
  s_add_u32 s26, s26, 61440
  buffer_load_dwordx4 v[96:99], v6, s[8:11], s26 offen
  s_add_u32 s26, s26, 61440
  buffer_load_dwordx4 v[100:103], v6, s[8:11], s26 offen
  s_add_u32 s26, s26, 61440
  buffer_load_dwordx4 v[104:107], v6, s[8:11], s26 offen
  s_add_u32 s26, s26, 61440
  buffer_load_dwordx4 v[108:111], v6, s[8:11], s26 offen
  s_add_u32 s26, s26, 61440
  buffer_load_dwordx4 v[112:115], v6, s[8:11], s26 offen
  s_add_u32 s26, s26, 61440
  buffer_load_dwordx4 v[116:119], v6, s[8:11], s26 offen
  s_waitcnt vmcnt(20)
  v_lshlrev_b32 v20, 16, v20
  v_mul_f32 v8, 0xbfb8aa3b, v20
  v_exp_f32 v8, v8
  s_nop 0
  v_add_f32 v8, 1.0, v8
  v_rcp_f32 v8, v8
  s_nop 0
  v_mul_f32 v20, v20, v8
  v_cvt_pk_bf16_f32 v8, v20, v20
  v_lshlrev_b32 v20, 16, v8
  v_lshlrev_b32 v21, 16, v21
  v_mul_f32 v8, 0xbfb8aa3b, v21
  v_exp_f32 v8, v8
  s_nop 0
  v_add_f32 v8, 1.0, v8
  v_rcp_f32 v8, v8
  s_nop 0
  v_mul_f32 v21, v21, v8
  v_cvt_pk_bf16_f32 v8, v21, v21
  v_lshlrev_b32 v21, 16, v8
  v_lshlrev_b32 v22, 16, v22
  v_mul_f32 v8, 0xbfb8aa3b, v22
  v_exp_f32 v8, v8
  s_nop 0
  v_add_f32 v8, 1.0, v8
  v_rcp_f32 v8, v8
  s_nop 0
  v_mul_f32 v22, v22, v8
  v_cvt_pk_bf16_f32 v8, v22, v22
  v_lshlrev_b32 v22, 16, v8
  v_lshlrev_b32 v23, 16, v23
  v_mul_f32 v8, 0xbfb8aa3b, v23
  v_exp_f32 v8, v8
  s_nop 0
  v_add_f32 v8, 1.0, v8
  v_rcp_f32 v8, v8
  s_nop 0
  v_mul_f32 v23, v23, v8
  v_cvt_pk_bf16_f32 v8, v23, v23
  v_lshlrev_b32 v23, 16, v8
  v_lshlrev_b32 v24, 16, v24
  v_mul_f32 v8, 0xbfb8aa3b, v24
  v_exp_f32 v8, v8
  s_nop 0
  v_add_f32 v8, 1.0, v8
  v_rcp_f32 v8, v8
  s_nop 0
  v_mul_f32 v24, v24, v8
  v_cvt_pk_bf16_f32 v8, v24, v24
  v_lshlrev_b32 v24, 16, v8
  v_lshlrev_b32 v25, 16, v25
  v_mul_f32 v8, 0xbfb8aa3b, v25
  v_exp_f32 v8, v8
  s_nop 0
  v_add_f32 v8, 1.0, v8
  v_rcp_f32 v8, v8
  s_nop 0
  v_mul_f32 v25, v25, v8
  v_cvt_pk_bf16_f32 v8, v25, v25
  v_lshlrev_b32 v25, 16, v8
  v_lshlrev_b32 v26, 16, v26
  v_mul_f32 v8, 0xbfb8aa3b, v26
  v_exp_f32 v8, v8
  s_nop 0
  v_add_f32 v8, 1.0, v8
  v_rcp_f32 v8, v8
  s_nop 0
  v_mul_f32 v26, v26, v8
  v_cvt_pk_bf16_f32 v8, v26, v26
  v_lshlrev_b32 v26, 16, v8
  v_lshlrev_b32 v27, 16, v27
  v_mul_f32 v8, 0xbfb8aa3b, v27
  v_exp_f32 v8, v8
  s_nop 0
  v_add_f32 v8, 1.0, v8
  v_rcp_f32 v8, v8
  s_nop 0
  v_mul_f32 v27, v27, v8
  v_cvt_pk_bf16_f32 v8, v27, v27
  v_lshlrev_b32 v27, 16, v8
  v_lshlrev_b32 v28, 16, v28
  v_mul_f32 v8, 0xbfb8aa3b, v28
  v_exp_f32 v8, v8
  s_nop 0
  v_add_f32 v8, 1.0, v8
  v_rcp_f32 v8, v8
  s_nop 0
  v_mul_f32 v28, v28, v8
  v_cvt_pk_bf16_f32 v8, v28, v28
  v_lshlrev_b32 v28, 16, v8
  v_lshlrev_b32 v29, 16, v29
  v_mul_f32 v8, 0xbfb8aa3b, v29
  v_exp_f32 v8, v8
  s_nop 0
  v_add_f32 v8, 1.0, v8
  v_rcp_f32 v8, v8
  s_nop 0
  v_mul_f32 v29, v29, v8
  v_cvt_pk_bf16_f32 v8, v29, v29
  v_lshlrev_b32 v29, 16, v8
  v_lshlrev_b32 v30, 16, v30
  v_mul_f32 v8, 0xbfb8aa3b, v30
  v_exp_f32 v8, v8
  s_nop 0
  v_add_f32 v8, 1.0, v8
  v_rcp_f32 v8, v8
  s_nop 0
  v_mul_f32 v30, v30, v8
  v_cvt_pk_bf16_f32 v8, v30, v30
  v_lshlrev_b32 v30, 16, v8
  v_lshlrev_b32 v31, 16, v31
  v_mul_f32 v8, 0xbfb8aa3b, v31
  v_exp_f32 v8, v8
  s_nop 0
  v_add_f32 v8, 1.0, v8
  v_rcp_f32 v8, v8
  s_nop 0
  v_mul_f32 v31, v31, v8
  v_cvt_pk_bf16_f32 v8, v31, v31
  v_lshlrev_b32 v31, 16, v8
  v_lshlrev_b32 v32, 16, v32
  v_mul_f32 v8, 0xbfb8aa3b, v32
  v_exp_f32 v8, v8
  s_nop 0
  v_add_f32 v8, 1.0, v8
  v_rcp_f32 v8, v8
  s_nop 0
  v_mul_f32 v32, v32, v8
  v_cvt_pk_bf16_f32 v8, v32, v32
  v_lshlrev_b32 v32, 16, v8
  v_lshlrev_b32 v33, 16, v33
  v_mul_f32 v8, 0xbfb8aa3b, v33
  v_exp_f32 v8, v8
  s_nop 0
  v_add_f32 v8, 1.0, v8
  v_rcp_f32 v8, v8
  s_nop 0
  v_mul_f32 v33, v33, v8
  v_cvt_pk_bf16_f32 v8, v33, v33
  v_lshlrev_b32 v33, 16, v8
  v_lshlrev_b32 v34, 16, v34
  v_mul_f32 v8, 0xbfb8aa3b, v34
  v_exp_f32 v8, v8
  s_nop 0
  v_add_f32 v8, 1.0, v8
  v_rcp_f32 v8, v8
  s_nop 0
  v_mul_f32 v34, v34, v8
  v_cvt_pk_bf16_f32 v8, v34, v34
  v_lshlrev_b32 v34, 16, v8
  v_lshlrev_b32 v35, 16, v35
  v_mul_f32 v8, 0xbfb8aa3b, v35
  v_exp_f32 v8, v8
  s_nop 0
  v_add_f32 v8, 1.0, v8
  v_rcp_f32 v8, v8
  s_nop 0
  v_mul_f32 v35, v35, v8
  v_cvt_pk_bf16_f32 v8, v35, v35
  v_lshlrev_b32 v35, 16, v8
  v_lshlrev_b32 v36, 16, v36
  v_mul_f32 v8, 0xbfb8aa3b, v36
  v_exp_f32 v8, v8
  s_nop 0
  v_add_f32 v8, 1.0, v8
  v_rcp_f32 v8, v8
  s_nop 0
  v_mul_f32 v36, v36, v8
  v_cvt_pk_bf16_f32 v8, v36, v36
  v_lshlrev_b32 v36, 16, v8
  v_lshlrev_b32 v37, 16, v37
  v_mul_f32 v8, 0xbfb8aa3b, v37
  v_exp_f32 v8, v8
  s_nop 0
  v_add_f32 v8, 1.0, v8
  v_rcp_f32 v8, v8
  s_nop 0
  v_mul_f32 v37, v37, v8
  v_cvt_pk_bf16_f32 v8, v37, v37
  v_lshlrev_b32 v37, 16, v8
  v_lshlrev_b32 v38, 16, v38
  v_mul_f32 v8, 0xbfb8aa3b, v38
  v_exp_f32 v8, v8
  s_nop 0
  v_add_f32 v8, 1.0, v8
  v_rcp_f32 v8, v8
  s_nop 0
  v_mul_f32 v38, v38, v8
  v_cvt_pk_bf16_f32 v8, v38, v38
  v_lshlrev_b32 v38, 16, v8
  v_lshlrev_b32 v39, 16, v39
  v_mul_f32 v8, 0xbfb8aa3b, v39
  v_exp_f32 v8, v8
  s_nop 0
  v_add_f32 v8, 1.0, v8
  v_rcp_f32 v8, v8
  s_nop 0
  v_mul_f32 v39, v39, v8
  v_cvt_pk_bf16_f32 v8, v39, v39
  v_lshlrev_b32 v39, 16, v8
  v_mov_b32 v10, 0
  v_mov_b32 v11, 0
  v_mov_b32 v12, 0
  v_mov_b32 v13, 0
  v_mov_b32 v14, 0
  v_mov_b32 v15, 0
  v_mov_b32 v16, 0
  v_mov_b32 v17, 0
  s_waitcnt vmcnt(19)
  v_lshlrev_b32 v8, 16, v40
  v_and_b32 v9, 0xffff0000, v40
  v_fmac_f32 v10, v8, v20
  v_fmac_f32 v11, v9, v20
  v_lshlrev_b32 v8, 16, v41
  v_and_b32 v9, 0xffff0000, v41
  v_fmac_f32 v12, v8, v20
  v_fmac_f32 v13, v9, v20
  v_lshlrev_b32 v8, 16, v42
  v_and_b32 v9, 0xffff0000, v42
  v_fmac_f32 v14, v8, v20
  v_fmac_f32 v15, v9, v20
  v_lshlrev_b32 v8, 16, v43
  v_and_b32 v9, 0xffff0000, v43
  v_fmac_f32 v16, v8, v20
  v_fmac_f32 v17, v9, v20
  s_waitcnt vmcnt(18)
  v_lshlrev_b32 v8, 16, v44
  v_and_b32 v9, 0xffff0000, v44
  v_fmac_f32 v10, v8, v21
  v_fmac_f32 v11, v9, v21
  v_lshlrev_b32 v8, 16, v45
  v_and_b32 v9, 0xffff0000, v45
  v_fmac_f32 v12, v8, v21
  v_fmac_f32 v13, v9, v21
  v_lshlrev_b32 v8, 16, v46
  v_and_b32 v9, 0xffff0000, v46
  v_fmac_f32 v14, v8, v21
  v_fmac_f32 v15, v9, v21
  v_lshlrev_b32 v8, 16, v47
  v_and_b32 v9, 0xffff0000, v47
  v_fmac_f32 v16, v8, v21
  v_fmac_f32 v17, v9, v21
  s_waitcnt vmcnt(17)
  v_lshlrev_b32 v8, 16, v48
  v_and_b32 v9, 0xffff0000, v48
  v_fmac_f32 v10, v8, v22
  v_fmac_f32 v11, v9, v22
  v_lshlrev_b32 v8, 16, v49
  v_and_b32 v9, 0xffff0000, v49
  v_fmac_f32 v12, v8, v22
  v_fmac_f32 v13, v9, v22
  v_lshlrev_b32 v8, 16, v50
  v_and_b32 v9, 0xffff0000, v50
  v_fmac_f32 v14, v8, v22
  v_fmac_f32 v15, v9, v22
  v_lshlrev_b32 v8, 16, v51
  v_and_b32 v9, 0xffff0000, v51
  v_fmac_f32 v16, v8, v22
  v_fmac_f32 v17, v9, v22
  s_waitcnt vmcnt(16)
  v_lshlrev_b32 v8, 16, v52
  v_and_b32 v9, 0xffff0000, v52
  v_fmac_f32 v10, v8, v23
  v_fmac_f32 v11, v9, v23
  v_lshlrev_b32 v8, 16, v53
  v_and_b32 v9, 0xffff0000, v53
  v_fmac_f32 v12, v8, v23
  v_fmac_f32 v13, v9, v23
  v_lshlrev_b32 v8, 16, v54
  v_and_b32 v9, 0xffff0000, v54
  v_fmac_f32 v14, v8, v23
  v_fmac_f32 v15, v9, v23
  v_lshlrev_b32 v8, 16, v55
  v_and_b32 v9, 0xffff0000, v55
  v_fmac_f32 v16, v8, v23
  v_fmac_f32 v17, v9, v23
  s_waitcnt vmcnt(15)
  v_lshlrev_b32 v8, 16, v56
  v_and_b32 v9, 0xffff0000, v56
  v_fmac_f32 v10, v8, v24
  v_fmac_f32 v11, v9, v24
  v_lshlrev_b32 v8, 16, v57
  v_and_b32 v9, 0xffff0000, v57
  v_fmac_f32 v12, v8, v24
  v_fmac_f32 v13, v9, v24
  v_lshlrev_b32 v8, 16, v58
  v_and_b32 v9, 0xffff0000, v58
  v_fmac_f32 v14, v8, v24
  v_fmac_f32 v15, v9, v24
  v_lshlrev_b32 v8, 16, v59
  v_and_b32 v9, 0xffff0000, v59
  v_fmac_f32 v16, v8, v24
  v_fmac_f32 v17, v9, v24
  s_waitcnt vmcnt(14)
  v_lshlrev_b32 v8, 16, v60
  v_and_b32 v9, 0xffff0000, v60
  v_fmac_f32 v10, v8, v25
  v_fmac_f32 v11, v9, v25
  v_lshlrev_b32 v8, 16, v61
  v_and_b32 v9, 0xffff0000, v61
  v_fmac_f32 v12, v8, v25
  v_fmac_f32 v13, v9, v25
  v_lshlrev_b32 v8, 16, v62
  v_and_b32 v9, 0xffff0000, v62
  v_fmac_f32 v14, v8, v25
  v_fmac_f32 v15, v9, v25
  v_lshlrev_b32 v8, 16, v63
  v_and_b32 v9, 0xffff0000, v63
  v_fmac_f32 v16, v8, v25
  v_fmac_f32 v17, v9, v25
  s_waitcnt vmcnt(13)
  v_lshlrev_b32 v8, 16, v64
  v_and_b32 v9, 0xffff0000, v64
  v_fmac_f32 v10, v8, v26
  v_fmac_f32 v11, v9, v26
  v_lshlrev_b32 v8, 16, v65
  v_and_b32 v9, 0xffff0000, v65
  v_fmac_f32 v12, v8, v26
  v_fmac_f32 v13, v9, v26
  v_lshlrev_b32 v8, 16, v66
  v_and_b32 v9, 0xffff0000, v66
  v_fmac_f32 v14, v8, v26
  v_fmac_f32 v15, v9, v26
  v_lshlrev_b32 v8, 16, v67
  v_and_b32 v9, 0xffff0000, v67
  v_fmac_f32 v16, v8, v26
  v_fmac_f32 v17, v9, v26
  s_waitcnt vmcnt(12)
  v_lshlrev_b32 v8, 16, v68
  v_and_b32 v9, 0xffff0000, v68
  v_fmac_f32 v10, v8, v27
  v_fmac_f32 v11, v9, v27
  v_lshlrev_b32 v8, 16, v69
  v_and_b32 v9, 0xffff0000, v69
  v_fmac_f32 v12, v8, v27
  v_fmac_f32 v13, v9, v27
  v_lshlrev_b32 v8, 16, v70
  v_and_b32 v9, 0xffff0000, v70
  v_fmac_f32 v14, v8, v27
  v_fmac_f32 v15, v9, v27
  v_lshlrev_b32 v8, 16, v71
  v_and_b32 v9, 0xffff0000, v71
  v_fmac_f32 v16, v8, v27
  v_fmac_f32 v17, v9, v27
  s_waitcnt vmcnt(11)
  v_lshlrev_b32 v8, 16, v72
  v_and_b32 v9, 0xffff0000, v72
  v_fmac_f32 v10, v8, v28
  v_fmac_f32 v11, v9, v28
  v_lshlrev_b32 v8, 16, v73
  v_and_b32 v9, 0xffff0000, v73
  v_fmac_f32 v12, v8, v28
  v_fmac_f32 v13, v9, v28
  v_lshlrev_b32 v8, 16, v74
  v_and_b32 v9, 0xffff0000, v74
  v_fmac_f32 v14, v8, v28
  v_fmac_f32 v15, v9, v28
  v_lshlrev_b32 v8, 16, v75
  v_and_b32 v9, 0xffff0000, v75
  v_fmac_f32 v16, v8, v28
  v_fmac_f32 v17, v9, v28
  s_waitcnt vmcnt(10)
  v_lshlrev_b32 v8, 16, v76
  v_and_b32 v9, 0xffff0000, v76
  v_fmac_f32 v10, v8, v29
  v_fmac_f32 v11, v9, v29
  v_lshlrev_b32 v8, 16, v77
  v_and_b32 v9, 0xffff0000, v77
  v_fmac_f32 v12, v8, v29
  v_fmac_f32 v13, v9, v29
  v_lshlrev_b32 v8, 16, v78
  v_and_b32 v9, 0xffff0000, v78
  v_fmac_f32 v14, v8, v29
  v_fmac_f32 v15, v9, v29
  v_lshlrev_b32 v8, 16, v79
  v_and_b32 v9, 0xffff0000, v79
  v_fmac_f32 v16, v8, v29
  v_fmac_f32 v17, v9, v29
  s_waitcnt vmcnt(9)
  v_lshlrev_b32 v8, 16, v80
  v_and_b32 v9, 0xffff0000, v80
  v_fmac_f32 v10, v8, v30
  v_fmac_f32 v11, v9, v30
  v_lshlrev_b32 v8, 16, v81
  v_and_b32 v9, 0xffff0000, v81
  v_fmac_f32 v12, v8, v30
  v_fmac_f32 v13, v9, v30
  v_lshlrev_b32 v8, 16, v82
  v_and_b32 v9, 0xffff0000, v82
  v_fmac_f32 v14, v8, v30
  v_fmac_f32 v15, v9, v30
  v_lshlrev_b32 v8, 16, v83
  v_and_b32 v9, 0xffff0000, v83
  v_fmac_f32 v16, v8, v30
  v_fmac_f32 v17, v9, v30
  s_waitcnt vmcnt(8)
  v_lshlrev_b32 v8, 16, v84
  v_and_b32 v9, 0xffff0000, v84
  v_fmac_f32 v10, v8, v31
  v_fmac_f32 v11, v9, v31
  v_lshlrev_b32 v8, 16, v85
  v_and_b32 v9, 0xffff0000, v85
  v_fmac_f32 v12, v8, v31
  v_fmac_f32 v13, v9, v31
  v_lshlrev_b32 v8, 16, v86
  v_and_b32 v9, 0xffff0000, v86
  v_fmac_f32 v14, v8, v31
  v_fmac_f32 v15, v9, v31
  v_lshlrev_b32 v8, 16, v87
  v_and_b32 v9, 0xffff0000, v87
  v_fmac_f32 v16, v8, v31
  v_fmac_f32 v17, v9, v31
  s_waitcnt vmcnt(7)
  v_lshlrev_b32 v8, 16, v88
  v_and_b32 v9, 0xffff0000, v88
  v_fmac_f32 v10, v8, v32
  v_fmac_f32 v11, v9, v32
  v_lshlrev_b32 v8, 16, v89
  v_and_b32 v9, 0xffff0000, v89
  v_fmac_f32 v12, v8, v32
  v_fmac_f32 v13, v9, v32
  v_lshlrev_b32 v8, 16, v90
  v_and_b32 v9, 0xffff0000, v90
  v_fmac_f32 v14, v8, v32
  v_fmac_f32 v15, v9, v32
  v_lshlrev_b32 v8, 16, v91
  v_and_b32 v9, 0xffff0000, v91
  v_fmac_f32 v16, v8, v32
  v_fmac_f32 v17, v9, v32
  s_waitcnt vmcnt(6)
  v_lshlrev_b32 v8, 16, v92
  v_and_b32 v9, 0xffff0000, v92
  v_fmac_f32 v10, v8, v33
  v_fmac_f32 v11, v9, v33
  v_lshlrev_b32 v8, 16, v93
  v_and_b32 v9, 0xffff0000, v93
  v_fmac_f32 v12, v8, v33
  v_fmac_f32 v13, v9, v33
  v_lshlrev_b32 v8, 16, v94
  v_and_b32 v9, 0xffff0000, v94
  v_fmac_f32 v14, v8, v33
  v_fmac_f32 v15, v9, v33
  v_lshlrev_b32 v8, 16, v95
  v_and_b32 v9, 0xffff0000, v95
  v_fmac_f32 v16, v8, v33
  v_fmac_f32 v17, v9, v33
  s_waitcnt vmcnt(5)
  v_lshlrev_b32 v8, 16, v96
  v_and_b32 v9, 0xffff0000, v96
  v_fmac_f32 v10, v8, v34
  v_fmac_f32 v11, v9, v34
  v_lshlrev_b32 v8, 16, v97
  v_and_b32 v9, 0xffff0000, v97
  v_fmac_f32 v12, v8, v34
  v_fmac_f32 v13, v9, v34
  v_lshlrev_b32 v8, 16, v98
  v_and_b32 v9, 0xffff0000, v98
  v_fmac_f32 v14, v8, v34
  v_fmac_f32 v15, v9, v34
  v_lshlrev_b32 v8, 16, v99
  v_and_b32 v9, 0xffff0000, v99
  v_fmac_f32 v16, v8, v34
  v_fmac_f32 v17, v9, v34
  s_waitcnt vmcnt(4)
  v_lshlrev_b32 v8, 16, v100
  v_and_b32 v9, 0xffff0000, v100
  v_fmac_f32 v10, v8, v35
  v_fmac_f32 v11, v9, v35
  v_lshlrev_b32 v8, 16, v101
  v_and_b32 v9, 0xffff0000, v101
  v_fmac_f32 v12, v8, v35
  v_fmac_f32 v13, v9, v35
  v_lshlrev_b32 v8, 16, v102
  v_and_b32 v9, 0xffff0000, v102
  v_fmac_f32 v14, v8, v35
  v_fmac_f32 v15, v9, v35
  v_lshlrev_b32 v8, 16, v103
  v_and_b32 v9, 0xffff0000, v103
  v_fmac_f32 v16, v8, v35
  v_fmac_f32 v17, v9, v35
  s_waitcnt vmcnt(3)
  v_lshlrev_b32 v8, 16, v104
  v_and_b32 v9, 0xffff0000, v104
  v_fmac_f32 v10, v8, v36
  v_fmac_f32 v11, v9, v36
  v_lshlrev_b32 v8, 16, v105
  v_and_b32 v9, 0xffff0000, v105
  v_fmac_f32 v12, v8, v36
  v_fmac_f32 v13, v9, v36
  v_lshlrev_b32 v8, 16, v106
  v_and_b32 v9, 0xffff0000, v106
  v_fmac_f32 v14, v8, v36
  v_fmac_f32 v15, v9, v36
  v_lshlrev_b32 v8, 16, v107
  v_and_b32 v9, 0xffff0000, v107
  v_fmac_f32 v16, v8, v36
  v_fmac_f32 v17, v9, v36
  s_waitcnt vmcnt(2)
  v_lshlrev_b32 v8, 16, v108
  v_and_b32 v9, 0xffff0000, v108
  v_fmac_f32 v10, v8, v37
  v_fmac_f32 v11, v9, v37
  v_lshlrev_b32 v8, 16, v109
  v_and_b32 v9, 0xffff0000, v109
  v_fmac_f32 v12, v8, v37
  v_fmac_f32 v13, v9, v37
  v_lshlrev_b32 v8, 16, v110
  v_and_b32 v9, 0xffff0000, v110
  v_fmac_f32 v14, v8, v37
  v_fmac_f32 v15, v9, v37
  v_lshlrev_b32 v8, 16, v111
  v_and_b32 v9, 0xffff0000, v111
  v_fmac_f32 v16, v8, v37
  v_fmac_f32 v17, v9, v37
  s_waitcnt vmcnt(1)
  v_lshlrev_b32 v8, 16, v112
  v_and_b32 v9, 0xffff0000, v112
  v_fmac_f32 v10, v8, v38
  v_fmac_f32 v11, v9, v38
  v_lshlrev_b32 v8, 16, v113
  v_and_b32 v9, 0xffff0000, v113
  v_fmac_f32 v12, v8, v38
  v_fmac_f32 v13, v9, v38
  v_lshlrev_b32 v8, 16, v114
  v_and_b32 v9, 0xffff0000, v114
  v_fmac_f32 v14, v8, v38
  v_fmac_f32 v15, v9, v38
  v_lshlrev_b32 v8, 16, v115
  v_and_b32 v9, 0xffff0000, v115
  v_fmac_f32 v16, v8, v38
  v_fmac_f32 v17, v9, v38
  s_waitcnt vmcnt(0)
  v_lshlrev_b32 v8, 16, v116
  v_and_b32 v9, 0xffff0000, v116
  v_fmac_f32 v10, v8, v39
  v_fmac_f32 v11, v9, v39
  v_lshlrev_b32 v8, 16, v117
  v_and_b32 v9, 0xffff0000, v117
  v_fmac_f32 v12, v8, v39
  v_fmac_f32 v13, v9, v39
  v_lshlrev_b32 v8, 16, v118
  v_and_b32 v9, 0xffff0000, v118
  v_fmac_f32 v14, v8, v39
  v_fmac_f32 v15, v9, v39
  v_lshlrev_b32 v8, 16, v119
  v_and_b32 v9, 0xffff0000, v119
  v_fmac_f32 v16, v8, v39
  v_fmac_f32 v17, v9, v39
  v_lshl_add_u32 v8, v2, 3, v3
  v_lshlrev_b32 v8, 8, v8
  v_lshl_add_u32 v8, v4, 5, v8
  ds_write_b128 v8, v[10:13]
  ds_write_b128 v8, v[14:17] offset:16
  s_waitcnt lgkmcnt(0)
  s_barrier
  s_cmp_lg_u32 s21, 0
  s_cbranch_scc1 Lmend_36
  v_lshlrev_b32 v8, 2, v0
  ds_read_b32 v40, v8 offset:0
  ds_read_b32 v41, v8 offset:256
  ds_read_b32 v42, v8 offset:512
  ds_read_b32 v43, v8 offset:768
  ds_read_b32 v44, v8 offset:1024
  ds_read_b32 v45, v8 offset:1280
  ds_read_b32 v46, v8 offset:1536
  ds_read_b32 v47, v8 offset:1792
  ds_read_b32 v48, v8 offset:2048
  ds_read_b32 v49, v8 offset:2304
  ds_read_b32 v50, v8 offset:2560
  ds_read_b32 v51, v8 offset:2816
  ds_read_b32 v52, v8 offset:3072
  ds_read_b32 v53, v8 offset:3328
  ds_read_b32 v54, v8 offset:3584
  ds_read_b32 v55, v8 offset:3840
  ds_read_b32 v56, v8 offset:4096
  ds_read_b32 v57, v8 offset:4352
  ds_read_b32 v58, v8 offset:4608
  ds_read_b32 v59, v8 offset:4864
  ds_read_b32 v60, v8 offset:5120
  ds_read_b32 v61, v8 offset:5376
  ds_read_b32 v62, v8 offset:5632
  ds_read_b32 v63, v8 offset:5888
  ds_read_b32 v64, v8 offset:6144
  ds_read_b32 v65, v8 offset:6400
  ds_read_b32 v66, v8 offset:6656
  ds_read_b32 v67, v8 offset:6912
  ds_read_b32 v68, v8 offset:7168
  ds_read_b32 v69, v8 offset:7424
  ds_read_b32 v70, v8 offset:7680
  ds_read_b32 v71, v8 offset:7936
  s_waitcnt lgkmcnt(0)
  v_add_f32 v40, v40, v41
  v_add_f32 v40, v40, v42
  v_add_f32 v40, v40, v43
  v_add_f32 v40, v40, v44
  v_add_f32 v40, v40, v45
  v_add_f32 v40, v40, v46
  v_add_f32 v40, v40, v47
  v_add_f32 v40, v40, v48
  v_add_f32 v40, v40, v49
  v_add_f32 v40, v40, v50
  v_add_f32 v40, v40, v51
  v_add_f32 v40, v40, v52
  v_add_f32 v40, v40, v53
  v_add_f32 v40, v40, v54
  v_add_f32 v40, v40, v55
  v_add_f32 v40, v40, v56
  v_add_f32 v40, v40, v57
  v_add_f32 v40, v40, v58
  v_add_f32 v40, v40, v59
  v_add_f32 v40, v40, v60
  v_add_f32 v40, v40, v61
  v_add_f32 v40, v40, v62
  v_add_f32 v40, v40, v63
  v_add_f32 v40, v40, v64
  v_add_f32 v40, v40, v65
  v_add_f32 v40, v40, v66
  v_add_f32 v40, v40, v67
  v_add_f32 v40, v40, v68
  v_add_f32 v40, v40, v69
  v_add_f32 v40, v40, v70
  v_add_f32 v40, v40, v71
  v_cvt_pk_bf16_f32 v9, v40, v40
  v_lshlrev_b32 v40, 16, v9
  s_sub_u32 s27, s72, 10
  s_cmp_lt_u32 s27, 10
  s_cselect_b32 s26, 1, 0
  s_sub_u32 s27, s72, 40
  s_cmp_lt_u32 s27, 10
  s_cselect_b32 s27, 1, 0
  s_or_b32 s26, s26, s27
  s_cmp_eq_u32 s26, 0
  s_cbranch_scc1 Lno1_37
  v_add_f32 v40, 1.0, v40
  v_cvt_pk_bf16_f32 v9, v40, v40
  v_lshlrev_b32 v40, 16, v9
Lno1_37:
  s_lshl_b32 s26, s72, 8
  s_add_u32 s26, s26, 0x280000
  buffer_store_dword v40, v8, s[4:7], s26 offen sc1
Lmend_36:
  s_mov_b32 s73, 0x10001
  s_cmp_lt_u32 s72, 20
  s_cselect_b32 s73, 0x101, s73
Lnomod_35:
  s_waitcnt vmcnt(0)
  s_barrier
  s_cmp_lg_u32 s21, 0
  s_cbranch_scc1 Lca_38
  v_mov_b32 v2, 40
  v_mov_b32 v3, s73
  s_mov_b64 exec, 1
  buffer_atomic_add v3, v2, s[12:15], 0 offen sc0 sc1
  s_waitcnt vmcnt(0)
  v_readfirstlane_b32 s26, v3
  s_add_u32 s26, s26, s73
  v_mov_b32 v3, 1
  s_bfe_u32 s27, s26, 0x80008
  s_cmp_lg_u32 s27, 20
  s_cbranch_scc1 Lca1_39
  s_bitcmp1_b32 s73, 8
  s_cbranch_scc0 Lca1_39
  v_mov_b32 v2, 128
  buffer_store_dword v3, v2, s[12:15], 0 offen sc1
Lca1_39:
  s_lshr_b32 s27, s26, 24
  s_cmp_lg_u32 s27, 6
  s_cbranch_scc1 Lca4_41
  s_bitcmp1_b32 s73, 24
  s_cbranch_scc0 Lca4_41
  v_mov_b32 v2, 136
  buffer_store_dword v3, v2, s[12:15], 0 offen sc1
Lca4_41:
  s_cmp_lg_u32 s26, 0x6281447
  s_cbranch_scc1 Lca2_40
  v_mov_b32 v2, 132
  buffer_store_dword v3, v2, s[12:15], 0 offen sc1
Lca2_40:
  s_mov_b64 exec, -1
Lca_38:
  v_lshrrev_b32 v2, 6, v0
  v_lshrrev_b32 v3, 4, v1
  v_lshl_add_u32 v11, v2, 2, v3
  v_and_b32 v4, 15, v1
  v_mul_u32_u24 v5, 1280, v11
  v_lshl_add_u32 v5, v4, 4, v5
  v_lshlrev_b32 v6, 5, v4
  v_lshrrev_b32 v10, 2, v4
  v_lshlrev_b32 v10, 11, v10
  v_and_b32 v12, 3, v4
  v_lshl_add_u32 v10, v12, 8, v10
  v_lshl_add_u32 v10, v11, 4, v10
  s_mov_b32 s74, 0
Lhl_42:
  v_lshlrev_b32 v40, 16, v180
  v_and_b32 v41, 0xffff0000, v180
  v_mov_b32 v180, v200
  v_lshlrev_b32 v42, 16, v181
  v_and_b32 v43, 0xffff0000, v181
  v_mov_b32 v181, v201
  v_lshlrev_b32 v44, 16, v182
  v_and_b32 v45, 0xffff0000, v182
  v_mov_b32 v182, v202
  v_lshlrev_b32 v46, 16, v183
  v_and_b32 v47, 0xffff0000, v183
  v_mov_b32 v183, v203
  v_lshlrev_b32 v48, 16, v184
  v_and_b32 v49, 0xffff0000, v184
  v_mov_b32 v184, v204
  v_lshlrev_b32 v50, 16, v185
  v_and_b32 v51, 0xffff0000, v185
  v_mov_b32 v185, v205
  v_lshlrev_b32 v52, 16, v186
  v_and_b32 v53, 0xffff0000, v186
  v_mov_b32 v186, v206
  v_lshlrev_b32 v54, 16, v187
  v_and_b32 v55, 0xffff0000, v187
  v_mov_b32 v187, v207
  v_lshlrev_b32 v56, 16, v188
  v_and_b32 v57, 0xffff0000, v188
  v_mov_b32 v188, v208
  v_lshlrev_b32 v58, 16, v189
  v_and_b32 v59, 0xffff0000, v189
  v_mov_b32 v189, v209
  v_lshlrev_b32 v60, 16, v190
  v_and_b32 v61, 0xffff0000, v190
  v_mov_b32 v190, v210
  v_lshlrev_b32 v62, 16, v191
  v_and_b32 v63, 0xffff0000, v191
  v_mov_b32 v191, v211
  v_lshlrev_b32 v64, 16, v192
  v_and_b32 v65, 0xffff0000, v192
  v_mov_b32 v192, v212
  v_lshlrev_b32 v66, 16, v193
  v_and_b32 v67, 0xffff0000, v193
  v_mov_b32 v193, v213
  v_lshlrev_b32 v68, 16, v194
  v_and_b32 v69, 0xffff0000, v194
  v_mov_b32 v194, v214
  v_lshlrev_b32 v70, 16, v195
  v_and_b32 v71, 0xffff0000, v195
  v_mov_b32 v195, v215
  v_lshlrev_b32 v72, 16, v196
  v_and_b32 v73, 0xffff0000, v196
  v_mov_b32 v196, v216
  v_lshlrev_b32 v74, 16, v197
  v_and_b32 v75, 0xffff0000, v197
  v_mov_b32 v197, v217
  v_lshlrev_b32 v76, 16, v198
  v_and_b32 v77, 0xffff0000, v198
  v_mov_b32 v198, v218
  v_lshlrev_b32 v78, 16, v199
  v_and_b32 v79, 0xffff0000, v199
  v_mov_b32 v199, v219
  v_pk_add_f32 v[16:17], v[40:41], v[42:43]
  v_pk_add_f32 v[18:19], v[44:45], v[46:47]
  v_pk_add_f32 v[16:17], v[16:17], v[48:49]
  v_pk_add_f32 v[18:19], v[18:19], v[50:51]
  v_pk_add_f32 v[16:17], v[16:17], v[52:53]
  v_pk_add_f32 v[18:19], v[18:19], v[54:55]
  v_pk_add_f32 v[16:17], v[16:17], v[56:57]
  v_pk_add_f32 v[18:19], v[18:19], v[58:59]
  v_pk_add_f32 v[16:17], v[16:17], v[60:61]
  v_pk_add_f32 v[18:19], v[18:19], v[62:63]
  v_pk_add_f32 v[16:17], v[16:17], v[64:65]
  v_pk_add_f32 v[18:19], v[18:19], v[66:67]
  v_pk_add_f32 v[16:17], v[16:17], v[68:69]
  v_pk_add_f32 v[18:19], v[18:19], v[70:71]
  v_pk_add_f32 v[16:17], v[16:17], v[72:73]
  v_pk_add_f32 v[18:19], v[18:19], v[74:75]
  v_pk_add_f32 v[16:17], v[16:17], v[76:77]
  v_pk_add_f32 v[18:19], v[18:19], v[78:79]
  v_pk_add_f32 v[16:17], v[16:17], v[18:19]
  v_add_f32 v7, v16, v17
  s_nop 1
  v_add_f32_dpp v7, v7, v7 row_ror:8 row_mask:0xf bank_mask:0xf
  s_nop 1
  v_add_f32_dpp v7, v7, v7 row_ror:4 row_mask:0xf bank_mask:0xf
  s_nop 1
  v_add_f32_dpp v7, v7, v7 row_ror:2 row_mask:0xf bank_mask:0xf
  s_nop 1
  v_add_f32_dpp v7, v7, v7 row_ror:1 row_mask:0xf bank_mask:0xf
  v_mul_f32 v16, 0xbacccccd, v7
  v_pk_add_f32 v[40:41], v[40:41], v[16:17] op_sel_hi:[1,0]
  v_pk_add_f32 v[42:43], v[42:43], v[16:17] op_sel_hi:[1,0]
  v_pk_add_f32 v[44:45], v[44:45], v[16:17] op_sel_hi:[1,0]
  v_pk_add_f32 v[46:47], v[46:47], v[16:17] op_sel_hi:[1,0]
  v_pk_add_f32 v[48:49], v[48:49], v[16:17] op_sel_hi:[1,0]
  v_pk_add_f32 v[50:51], v[50:51], v[16:17] op_sel_hi:[1,0]
  v_pk_add_f32 v[52:53], v[52:53], v[16:17] op_sel_hi:[1,0]
  v_pk_add_f32 v[54:55], v[54:55], v[16:17] op_sel_hi:[1,0]
  v_pk_add_f32 v[56:57], v[56:57], v[16:17] op_sel_hi:[1,0]
  v_pk_add_f32 v[58:59], v[58:59], v[16:17] op_sel_hi:[1,0]
  v_pk_add_f32 v[60:61], v[60:61], v[16:17] op_sel_hi:[1,0]
  v_pk_add_f32 v[62:63], v[62:63], v[16:17] op_sel_hi:[1,0]
  v_pk_add_f32 v[64:65], v[64:65], v[16:17] op_sel_hi:[1,0]
  v_pk_add_f32 v[66:67], v[66:67], v[16:17] op_sel_hi:[1,0]
  v_pk_add_f32 v[68:69], v[68:69], v[16:17] op_sel_hi:[1,0]
  v_pk_add_f32 v[70:71], v[70:71], v[16:17] op_sel_hi:[1,0]
  v_pk_add_f32 v[72:73], v[72:73], v[16:17] op_sel_hi:[1,0]
  v_pk_add_f32 v[74:75], v[74:75], v[16:17] op_sel_hi:[1,0]
  v_pk_add_f32 v[76:77], v[76:77], v[16:17] op_sel_hi:[1,0]
  v_pk_add_f32 v[78:79], v[78:79], v[16:17] op_sel_hi:[1,0]
  v_pk_mul_f32 v[16:17], v[40:41], v[40:41]
  v_pk_mul_f32 v[18:19], v[42:43], v[42:43]
  v_pk_fma_f32 v[16:17], v[44:45], v[44:45], v[16:17]
  v_pk_fma_f32 v[18:19], v[46:47], v[46:47], v[18:19]
  v_pk_fma_f32 v[16:17], v[48:49], v[48:49], v[16:17]
  v_pk_fma_f32 v[18:19], v[50:51], v[50:51], v[18:19]
  v_pk_fma_f32 v[16:17], v[52:53], v[52:53], v[16:17]
  v_pk_fma_f32 v[18:19], v[54:55], v[54:55], v[18:19]
  v_pk_fma_f32 v[16:17], v[56:57], v[56:57], v[16:17]
  v_pk_fma_f32 v[18:19], v[58:59], v[58:59], v[18:19]
  v_pk_fma_f32 v[16:17], v[60:61], v[60:61], v[16:17]
  v_pk_fma_f32 v[18:19], v[62:63], v[62:63], v[18:19]
  v_pk_fma_f32 v[16:17], v[64:65], v[64:65], v[16:17]
  v_pk_fma_f32 v[18:19], v[66:67], v[66:67], v[18:19]
  v_pk_fma_f32 v[16:17], v[68:69], v[68:69], v[16:17]
  v_pk_fma_f32 v[18:19], v[70:71], v[70:71], v[18:19]
  v_pk_fma_f32 v[16:17], v[72:73], v[72:73], v[16:17]
  v_pk_fma_f32 v[18:19], v[74:75], v[74:75], v[18:19]
  v_pk_fma_f32 v[16:17], v[76:77], v[76:77], v[16:17]
  v_pk_fma_f32 v[18:19], v[78:79], v[78:79], v[18:19]
  v_pk_add_f32 v[16:17], v[16:17], v[18:19]
  v_add_f32 v8, v16, v17
  s_nop 1
  v_add_f32_dpp v8, v8, v8 row_ror:8 row_mask:0xf bank_mask:0xf
  s_nop 1
  v_add_f32_dpp v8, v8, v8 row_ror:4 row_mask:0xf bank_mask:0xf
  s_nop 1
  v_add_f32_dpp v8, v8, v8 row_ror:2 row_mask:0xf bank_mask:0xf
  s_nop 1
  v_add_f32_dpp v8, v8, v8 row_ror:1 row_mask:0xf bank_mask:0xf
  v_mov_b32 v9, 0x3727c5ac
  v_fmac_f32 v9, 0x3acccccd, v8
  v_rsq_f32 v8, v9
  s_nop 0
  s_cmp_lg_u32 s74, 0
  s_cbranch_scc1 Lhm_43
  v_and_b32 v2, 3, v1
  v_lshlrev_b32 v2, 2, v2
Lcw_45:
  s_add_u32 s24, s24, 1
  s_cmp_gt_u32 s24, 300000
  s_cbranch_scc1 Lfail_44
  buffer_load_dword v3, v2, s[12:15], 0 offen offset:128 sc1
  s_waitcnt vmcnt(0)
  v_cmp_eq_u32 vcc, 0, v3
  s_and_b32 s26, vcc_lo, 5
  s_cmp_eq_u32 s26, 0
  s_cbranch_scc1 Lcok_46
  s_sleep 6
  s_branch Lcw_45
Lcok_46:
  s_mov_b32 s27, 0x280000
  s_mov_b32 s28, 0x280a00
  buffer_load_dwordx4 v[80:83], v6, s[4:7], s27 offen offset:0 sc1
  buffer_load_dwordx4 v[120:123], v6, s[4:7], s28 offen offset:0 sc1
  buffer_load_dwordx4 v[84:87], v6, s[4:7], s27 offen offset:16 sc1
  buffer_load_dwordx4 v[124:127], v6, s[4:7], s28 offen offset:16 sc1
  buffer_load_dwordx4 v[88:91], v6, s[4:7], s27 offen offset:512 sc1
  buffer_load_dwordx4 v[128:131], v6, s[4:7], s28 offen offset:512 sc1
  buffer_load_dwordx4 v[92:95], v6, s[4:7], s27 offen offset:528 sc1
  buffer_load_dwordx4 v[132:135], v6, s[4:7], s28 offen offset:528 sc1
  buffer_load_dwordx4 v[96:99], v6, s[4:7], s27 offen offset:1024 sc1
  buffer_load_dwordx4 v[136:139], v6, s[4:7], s28 offen offset:1024 sc1
  buffer_load_dwordx4 v[100:103], v6, s[4:7], s27 offen offset:1040 sc1
  buffer_load_dwordx4 v[140:143], v6, s[4:7], s28 offen offset:1040 sc1
  buffer_load_dwordx4 v[104:107], v6, s[4:7], s27 offen offset:1536 sc1
  buffer_load_dwordx4 v[144:147], v6, s[4:7], s28 offen offset:1536 sc1
  buffer_load_dwordx4 v[108:111], v6, s[4:7], s27 offen offset:1552 sc1
  buffer_load_dwordx4 v[148:151], v6, s[4:7], s28 offen offset:1552 sc1
  buffer_load_dwordx4 v[112:115], v6, s[4:7], s27 offen offset:2048 sc1
  buffer_load_dwordx4 v[152:155], v6, s[4:7], s28 offen offset:2048 sc1
  buffer_load_dwordx4 v[116:119], v6, s[4:7], s27 offen offset:2064 sc1
  buffer_load_dwordx4 v[156:159], v6, s[4:7], s28 offen offset:2064 sc1
  s_waitcnt vmcnt(0)
Lhm_43:
  v_pk_mul_f32 v[40:41], v[40:41], v[8:9] op_sel_hi:[1,0]
  v_pk_fma_f32 v[40:41], v[40:41], v[120:121], v[80:81]
  v_pk_mul_f32 v[42:43], v[42:43], v[8:9] op_sel_hi:[1,0]
  v_pk_fma_f32 v[42:43], v[42:43], v[122:123], v[82:83]
  v_pk_mul_f32 v[44:45], v[44:45], v[8:9] op_sel_hi:[1,0]
  v_pk_fma_f32 v[44:45], v[44:45], v[124:125], v[84:85]
  v_pk_mul_f32 v[46:47], v[46:47], v[8:9] op_sel_hi:[1,0]
  v_pk_fma_f32 v[46:47], v[46:47], v[126:127], v[86:87]
  v_pk_mul_f32 v[48:49], v[48:49], v[8:9] op_sel_hi:[1,0]
  v_pk_fma_f32 v[48:49], v[48:49], v[128:129], v[88:89]
  v_pk_mul_f32 v[50:51], v[50:51], v[8:9] op_sel_hi:[1,0]
  v_pk_fma_f32 v[50:51], v[50:51], v[130:131], v[90:91]
  v_pk_mul_f32 v[52:53], v[52:53], v[8:9] op_sel_hi:[1,0]
  v_pk_fma_f32 v[52:53], v[52:53], v[132:133], v[92:93]
  v_pk_mul_f32 v[54:55], v[54:55], v[8:9] op_sel_hi:[1,0]
  v_pk_fma_f32 v[54:55], v[54:55], v[134:135], v[94:95]
  v_pk_mul_f32 v[56:57], v[56:57], v[8:9] op_sel_hi:[1,0]
  v_pk_fma_f32 v[56:57], v[56:57], v[136:137], v[96:97]
  v_pk_mul_f32 v[58:59], v[58:59], v[8:9] op_sel_hi:[1,0]
  v_pk_fma_f32 v[58:59], v[58:59], v[138:139], v[98:99]
  v_pk_mul_f32 v[60:61], v[60:61], v[8:9] op_sel_hi:[1,0]
  v_pk_fma_f32 v[60:61], v[60:61], v[140:141], v[100:101]
  v_pk_mul_f32 v[62:63], v[62:63], v[8:9] op_sel_hi:[1,0]
  v_pk_fma_f32 v[62:63], v[62:63], v[142:143], v[102:103]
  v_pk_mul_f32 v[64:65], v[64:65], v[8:9] op_sel_hi:[1,0]
  v_pk_fma_f32 v[64:65], v[64:65], v[144:145], v[104:105]
  v_pk_mul_f32 v[66:67], v[66:67], v[8:9] op_sel_hi:[1,0]
  v_pk_fma_f32 v[66:67], v[66:67], v[146:147], v[106:107]
  v_pk_mul_f32 v[68:69], v[68:69], v[8:9] op_sel_hi:[1,0]
  v_pk_fma_f32 v[68:69], v[68:69], v[148:149], v[108:109]
  v_pk_mul_f32 v[70:71], v[70:71], v[8:9] op_sel_hi:[1,0]
  v_pk_fma_f32 v[70:71], v[70:71], v[150:151], v[110:111]
  v_pk_mul_f32 v[72:73], v[72:73], v[8:9] op_sel_hi:[1,0]
  v_pk_fma_f32 v[72:73], v[72:73], v[152:153], v[112:113]
  v_pk_mul_f32 v[74:75], v[74:75], v[8:9] op_sel_hi:[1,0]
  v_pk_fma_f32 v[74:75], v[74:75], v[154:155], v[114:115]
  v_pk_mul_f32 v[76:77], v[76:77], v[8:9] op_sel_hi:[1,0]
  v_pk_fma_f32 v[76:77], v[76:77], v[156:157], v[116:117]
  v_pk_mul_f32 v[78:79], v[78:79], v[8:9] op_sel_hi:[1,0]
  v_pk_fma_f32 v[78:79], v[78:79], v[158:159], v[118:119]
  v_cvt_pk_bf16_f32 v160, v40, v41
  v_cvt_pk_bf16_f32 v161, v42, v43
  v_cvt_pk_bf16_f32 v162, v44, v45
  v_cvt_pk_bf16_f32 v163, v46, v47
  v_cvt_pk_bf16_f32 v164, v48, v49
  v_cvt_pk_bf16_f32 v165, v50, v51
  v_cvt_pk_bf16_f32 v166, v52, v53
  v_cvt_pk_bf16_f32 v167, v54, v55
  v_cvt_pk_bf16_f32 v168, v56, v57
  v_cvt_pk_bf16_f32 v169, v58, v59
  v_cvt_pk_bf16_f32 v170, v60, v61
  v_cvt_pk_bf16_f32 v171, v62, v63
  v_cvt_pk_bf16_f32 v172, v64, v65
  v_cvt_pk_bf16_f32 v173, v66, v67
  v_cvt_pk_bf16_f32 v174, v68, v69
  v_cvt_pk_bf16_f32 v175, v70, v71
  v_cvt_pk_bf16_f32 v176, v72, v73
  v_cvt_pk_bf16_f32 v177, v74, v75
  v_cvt_pk_bf16_f32 v178, v76, v77
  v_cvt_pk_bf16_f32 v179, v78, v79
  s_lshr_b32 s26, s72, 1
  s_mul_i32 s26, s26, 40960
  s_and_b32 s27, s72, 1
  s_lshl_b32 s27, s27, 10
  s_add_u32 s26, s26, s27
  s_add_u32 s26, s26, 0x300000
  buffer_store_dwordx4 v[160:163], v10, s[4:7], s26 offen sc1
  s_add_u32 s26, s26, 8192
  buffer_store_dwordx4 v[164:167], v10, s[4:7], s26 offen sc1
  s_add_u32 s26, s26, 8192
  buffer_store_dwordx4 v[168:171], v10, s[4:7], s26 offen sc1
  s_add_u32 s26, s26, 8192
  buffer_store_dwordx4 v[172:175], v10, s[4:7], s26 offen sc1
  s_add_u32 s26, s26, 8192
  buffer_store_dwordx4 v[176:179], v10, s[4:7], s26 offen sc1
  s_waitcnt vmcnt(0)
  s_barrier
  s_cmp_lg_u32 s21, 0
  s_cbranch_scc1 Lhs_47
  s_lshl_b32 s75, s72, 7
  s_add_u32 s75, s75, 0x250000
  v_mov_b32 v3, 0
  s_mov_b32 s26, 1
  v_mov_b32 v2, s26
  s_mov_b64 exec, 1
  buffer_store_dword v2, v3, s[4:7], s75 offen sc1
  s_mov_b64 exec, -1
Lhs_47:
  s_add_u32 s74, s74, 1
  s_add_u32 s72, s72, 71
  s_cmp_lt_u32 s72, 128
  s_cbranch_scc1 Lhl_42
Lpdone_27:
  v_and_b32 v2, 3, v1
  v_lshlrev_b32 v2, 2, v2
Lcw_49:
  s_add_u32 s24, s24, 1
  s_cmp_gt_u32 s24, 300000
  s_cbranch_scc1 Lfail_48
  buffer_load_dword v3, v2, s[12:15], 0 offen offset:128 sc1
  s_waitcnt vmcnt(0)
  v_cmp_eq_u32 vcc, 0, v3
  s_and_b32 s26, vcc_lo, 10
  s_cmp_eq_u32 s26, 0
  s_cbranch_scc1 Lcok_50
  s_sleep 6
  s_branch Lcw_49
Lcok_50:
  v_readlane_b32 s23, v3, 3
  s_and_b32 s23, s23, 0x2000
  s_barrier
  s_cmp_lt_u32 s71, 64
  s_cbranch_scc1 Lpd_51
  s_branch Lrole_ATT
Lpd_51:
  s_cmp_lt_u32 s71, 60
  s_cbranch_scc1 Lpd_52
  s_branch Lrole_LN
Lpd_52:
  s_cmp_lt_u32 s71, 40
  s_cbranch_scc1 Lpd_53
  s_branch Lrole_PZ
Lpd_53:
  s_cmp_lt_u32 s71, 0
  s_cbranch_scc1 Lpd_54
  s_branch Lrole_F
Lpd_54:
  s_branch Lmain_end
.p2align 6
Lrole_QKV:
  s_cmp_ge_u32 s20, 24
  s_cselect_b32 s26, 1, 0
  s_cmp_ge_u32 s20, 48
  s_cselect_b32 s27, 1, 0
  s_add_u32 s26, s26, s27
  s_mul_i32 s27, s26, 24
  s_sub_u32 s27, s20, s27
  s_cmp_eq_u32 s26, 1
  s_cselect_b64 s[66:67], s[40:41], s[38:39]
  s_cselect_b32 s30, 0x3600000, 0x0
  s_cselect_b32 s33, 0x800, 0
  s_cmp_eq_u32 s26, 0
  s_cselect_b32 s30, 0x1e00000, s30
  s_cselect_b32 s33, 0x400, s33
  s_cmp_eq_u32 s26, 2
  s_cselect_b64 s[66:67], s[36:37], s[66:67]
  s_cselect_b32 s30, 0x600000, s30
  s_cselect_b32 s33, 0x0, s33
  s_mov_b32 s8, s66
  s_and_b32 s9, s67, 0xffff
  s_mov_b32 s10, 0x780000
  s_mov_b32 s11, 0x20000
  s_lshl_b32 s27, s27, 2
  s_add_u32 s27, s27, s21
  s_lshl_b32 s28, s27, 7
  s_lshl_b32 s26, s27, 12
  s_add_u32 s30, s30, s26
  s_lshl_b32 s26, s27, 2
  s_add_u32 s33, s33, s26
  s_mov_b32 s29, 0x300000
  s_mov_b32 s31, 393216
  s_cmp_lt_u32 s20, 48
  s_cbranch_scc1 Lnodelay_55
  v_and_b32 v2, 3, v1
  v_lshlrev_b32 v2, 2, v2
Lcw_57:
  s_add_u32 s24, s24, 1
  s_cmp_gt_u32 s24, 300000
  s_cbranch_scc1 Lfail_56
  buffer_load_dword v3, v2, s[12:15], 0 offen offset:128 sc1
  s_waitcnt vmcnt(0)
  v_cmp_eq_u32 vcc, 0, v3
  s_and_b32 s26, vcc_lo, 1
  s_cmp_eq_u32 s26, 0
  s_cbranch_scc1 Lcok_58
  s_sleep 6
  s_branch Lcw_57
Lcok_58:
Lnodelay_55:
  v_lshrrev_b32 v2, 3, v1
  v_and_b32 v3, 7, v1
  v_mul_u32_u24 v2, 12288, v2
  v_lshl_add_u32 v2, v3, 4, v2
  v_add_u32 v16, 0, v2
  v_add_u32 v17, 97280, v2
  v_add_u32 v18, 194560, v2
  v_add_u32 v19, 291840, v2
  v_add_u32 v20, 393216, v2
  v_add_u32 v21, 490496, v2
  v_add_u32 v22, 587776, v2
  v_add_u32 v23, 685056, v2
  v_lshrrev_b32 v2, 4, v1
  v_bfe_u32 v3, v1, 2, 2
  v_lshl_add_u32 v2, v2, 3, v3
  v_lshlrev_b32 v2, 7, v2
  v_bfe_u32 v3, v1, 1, 1
  v_lshl_add_u32 v2, v3, 6, v2
  v_and_b32 v3, 1, v1
  v_lshl_add_u32 v2, v3, 4, v2
  s_lshl_b32 s34, s21, 15
  v_add_u32 v4, s34, v2
  s_add_u32 s27, s28, 0x0
  s_add_u32 m0, s34, 0
  s_nop 0
  buffer_load_dwordx4 v16, s[8:11], s27 offen offset:0 nt lds
  buffer_load_dwordx4 v17, s[8:11], s27 offen offset:1024 nt lds
  buffer_load_dwordx4 v18, s[8:11], s27 offen offset:2048 nt lds
  buffer_load_dwordx4 v19, s[8:11], s27 offen offset:3072 nt lds
  s_add_u32 m0, s34, 4096
  s_nop 0
  buffer_load_dwordx4 v20, s[8:11], s27 offen offset:0 nt lds
  buffer_load_dwordx4 v21, s[8:11], s27 offen offset:1024 nt lds
  buffer_load_dwordx4 v22, s[8:11], s27 offen offset:2048 nt lds
  buffer_load_dwordx4 v23, s[8:11], s27 offen offset:3072 nt lds
  s_add_u32 s27, s28, 0xc0000
  s_add_u32 m0, s34, 8192
  s_nop 0
  buffer_load_dwordx4 v16, s[8:11], s27 offen offset:0 nt lds
  buffer_load_dwordx4 v17, s[8:11], s27 offen offset:1024 nt lds
  buffer_load_dwordx4 v18, s[8:11], s27 offen offset:2048 nt lds
  buffer_load_dwordx4 v19, s[8:11], s27 offen offset:3072 nt lds
  s_add_u32 m0, s34, 12288
  s_nop 0
  buffer_load_dwordx4 v20, s[8:11], s27 offen offset:0 nt lds
  buffer_load_dwordx4 v21, s[8:11], s27 offen offset:1024 nt lds
  buffer_load_dwordx4 v22, s[8:11], s27 offen offset:2048 nt lds
  buffer_load_dwordx4 v23, s[8:11], s27 offen offset:3072 nt lds
  s_add_u32 s27, s28, 0x180000
  s_add_u32 m0, s34, 16384
  s_nop 0
  buffer_load_dwordx4 v16, s[8:11], s27 offen offset:0 nt lds
  buffer_load_dwordx4 v17, s[8:11], s27 offen offset:1024 nt lds
  buffer_load_dwordx4 v18, s[8:11], s27 offen offset:2048 nt lds
  buffer_load_dwordx4 v19, s[8:11], s27 offen offset:3072 nt lds
  s_add_u32 m0, s34, 20480
  s_nop 0
  buffer_load_dwordx4 v20, s[8:11], s27 offen offset:0 nt lds
  buffer_load_dwordx4 v21, s[8:11], s27 offen offset:1024 nt lds
  buffer_load_dwordx4 v22, s[8:11], s27 offen offset:2048 nt lds
  buffer_load_dwordx4 v23, s[8:11], s27 offen offset:3072 nt lds
  s_waitcnt vmcnt(16)
  s_waitcnt lgkmcnt(0)
  s_add_u32 s27, s28, 0x240000
  s_add_u32 m0, s34, 24576
  s_nop 0
  buffer_load_dwordx4 v16, s[8:11], s27 offen offset:0 nt lds
  buffer_load_dwordx4 v17, s[8:11], s27 offen offset:1024 nt lds
  buffer_load_dwordx4 v18, s[8:11], s27 offen offset:2048 nt lds
  buffer_load_dwordx4 v19, s[8:11], s27 offen offset:3072 nt lds
  s_add_u32 m0, s34, 28672
  s_nop 0
  buffer_load_dwordx4 v20, s[8:11], s27 offen offset:0 nt lds
  buffer_load_dwordx4 v21, s[8:11], s27 offen offset:1024 nt lds
  buffer_load_dwordx4 v22, s[8:11], s27 offen offset:2048 nt lds
  buffer_load_dwordx4 v23, s[8:11], s27 offen offset:3072 nt lds
  ds_read_b64_tr_b16 a[0:1], v4 offset:0
  ds_read_b64_tr_b16 a[2:3], v4 offset:512
  ds_read_b64_tr_b16 a[4:5], v4 offset:8
  ds_read_b64_tr_b16 a[6:7], v4 offset:520
  ds_read_b64_tr_b16 a[8:9], v4 offset:32
  ds_read_b64_tr_b16 a[10:11], v4 offset:544
  ds_read_b64_tr_b16 a[12:13], v4 offset:40
  ds_read_b64_tr_b16 a[14:15], v4 offset:552
  ds_read_b64_tr_b16 a[16:17], v4 offset:4096
  ds_read_b64_tr_b16 a[18:19], v4 offset:4608
  ds_read_b64_tr_b16 a[20:21], v4 offset:4104
  ds_read_b64_tr_b16 a[22:23], v4 offset:4616
  ds_read_b64_tr_b16 a[24:25], v4 offset:4128
  ds_read_b64_tr_b16 a[26:27], v4 offset:4640
  ds_read_b64_tr_b16 a[28:29], v4 offset:4136
  ds_read_b64_tr_b16 a[30:31], v4 offset:4648
  s_waitcnt vmcnt(16)
  s_waitcnt lgkmcnt(0)
  s_add_u32 s27, s28, 0x300000
  s_add_u32 m0, s34, 0
  s_nop 0
  buffer_load_dwordx4 v16, s[8:11], s27 offen offset:0 nt lds
  buffer_load_dwordx4 v17, s[8:11], s27 offen offset:1024 nt lds
  buffer_load_dwordx4 v18, s[8:11], s27 offen offset:2048 nt lds
  buffer_load_dwordx4 v19, s[8:11], s27 offen offset:3072 nt lds
  s_add_u32 m0, s34, 4096
  s_nop 0
  buffer_load_dwordx4 v20, s[8:11], s27 offen offset:0 nt lds
  buffer_load_dwordx4 v21, s[8:11], s27 offen offset:1024 nt lds
  buffer_load_dwordx4 v22, s[8:11], s27 offen offset:2048 nt lds
  buffer_load_dwordx4 v23, s[8:11], s27 offen offset:3072 nt lds
  ds_read_b64_tr_b16 a[32:33], v4 offset:8192
  ds_read_b64_tr_b16 a[34:35], v4 offset:8704
  ds_read_b64_tr_b16 a[36:37], v4 offset:8200
  ds_read_b64_tr_b16 a[38:39], v4 offset:8712
  ds_read_b64_tr_b16 a[40:41], v4 offset:8224
  ds_read_b64_tr_b16 a[42:43], v4 offset:8736
  ds_read_b64_tr_b16 a[44:45], v4 offset:8232
  ds_read_b64_tr_b16 a[46:47], v4 offset:8744
  ds_read_b64_tr_b16 a[48:49], v4 offset:12288
  ds_read_b64_tr_b16 a[50:51], v4 offset:12800
  ds_read_b64_tr_b16 a[52:53], v4 offset:12296
  ds_read_b64_tr_b16 a[54:55], v4 offset:12808
  ds_read_b64_tr_b16 a[56:57], v4 offset:12320
  ds_read_b64_tr_b16 a[58:59], v4 offset:12832
  ds_read_b64_tr_b16 a[60:61], v4 offset:12328
  ds_read_b64_tr_b16 a[62:63], v4 offset:12840
  s_waitcnt vmcnt(16)
  s_waitcnt lgkmcnt(0)
  s_add_u32 s27, s28, 0x3c0000
  s_add_u32 m0, s34, 8192
  s_nop 0
  buffer_load_dwordx4 v16, s[8:11], s27 offen offset:0 nt lds
  buffer_load_dwordx4 v17, s[8:11], s27 offen offset:1024 nt lds
  buffer_load_dwordx4 v18, s[8:11], s27 offen offset:2048 nt lds
  buffer_load_dwordx4 v19, s[8:11], s27 offen offset:3072 nt lds
  s_add_u32 m0, s34, 12288
  s_nop 0
  buffer_load_dwordx4 v20, s[8:11], s27 offen offset:0 nt lds
  buffer_load_dwordx4 v21, s[8:11], s27 offen offset:1024 nt lds
  buffer_load_dwordx4 v22, s[8:11], s27 offen offset:2048 nt lds
  buffer_load_dwordx4 v23, s[8:11], s27 offen offset:3072 nt lds
  ds_read_b64_tr_b16 a[64:65], v4 offset:16384
  ds_read_b64_tr_b16 a[66:67], v4 offset:16896
  ds_read_b64_tr_b16 a[68:69], v4 offset:16392
  ds_read_b64_tr_b16 a[70:71], v4 offset:16904
  ds_read_b64_tr_b16 a[72:73], v4 offset:16416
  ds_read_b64_tr_b16 a[74:75], v4 offset:16928
  ds_read_b64_tr_b16 a[76:77], v4 offset:16424
  ds_read_b64_tr_b16 a[78:79], v4 offset:16936
  ds_read_b64_tr_b16 a[80:81], v4 offset:20480
  ds_read_b64_tr_b16 a[82:83], v4 offset:20992
  ds_read_b64_tr_b16 a[84:85], v4 offset:20488
  ds_read_b64_tr_b16 a[86:87], v4 offset:21000
  ds_read_b64_tr_b16 a[88:89], v4 offset:20512
  ds_read_b64_tr_b16 a[90:91], v4 offset:21024
  ds_read_b64_tr_b16 a[92:93], v4 offset:20520
  ds_read_b64_tr_b16 a[94:95], v4 offset:21032
  s_waitcnt vmcnt(16)
  s_waitcnt lgkmcnt(0)
  s_add_u32 s27, s28, 0x480000
  s_add_u32 m0, s34, 16384
  s_nop 0
  buffer_load_dwordx4 v16, s[8:11], s27 offen offset:0 nt lds
  buffer_load_dwordx4 v17, s[8:11], s27 offen offset:1024 nt lds
  buffer_load_dwordx4 v18, s[8:11], s27 offen offset:2048 nt lds
  buffer_load_dwordx4 v19, s[8:11], s27 offen offset:3072 nt lds
  s_add_u32 m0, s34, 20480
  s_nop 0
  buffer_load_dwordx4 v20, s[8:11], s27 offen offset:0 nt lds
  buffer_load_dwordx4 v21, s[8:11], s27 offen offset:1024 nt lds
  buffer_load_dwordx4 v22, s[8:11], s27 offen offset:2048 nt lds
  buffer_load_dwordx4 v23, s[8:11], s27 offen offset:3072 nt lds
  ds_read_b64_tr_b16 a[96:97], v4 offset:24576
  ds_read_b64_tr_b16 a[98:99], v4 offset:25088
  ds_read_b64_tr_b16 a[100:101], v4 offset:24584
  ds_read_b64_tr_b16 a[102:103], v4 offset:25096
  ds_read_b64_tr_b16 a[104:105], v4 offset:24608
  ds_read_b64_tr_b16 a[106:107], v4 offset:25120
  ds_read_b64_tr_b16 a[108:109], v4 offset:24616
  ds_read_b64_tr_b16 a[110:111], v4 offset:25128
  ds_read_b64_tr_b16 a[112:113], v4 offset:28672
  ds_read_b64_tr_b16 a[114:115], v4 offset:29184
  ds_read_b64_tr_b16 a[116:117], v4 offset:28680
  ds_read_b64_tr_b16 a[118:119], v4 offset:29192
  ds_read_b64_tr_b16 a[120:121], v4 offset:28704
  ds_read_b64_tr_b16 a[122:123], v4 offset:29216
  ds_read_b64_tr_b16 a[124:125], v4 offset:28712
  ds_read_b64_tr_b16 a[126:127], v4 offset:29224
  s_waitcnt vmcnt(16)
  s_waitcnt lgkmcnt(0)
  s_add_u32 s27, s28, 0x540000
  s_add_u32 m0, s34, 24576
  s_nop 0
  buffer_load_dwordx4 v16, s[8:11], s27 offen offset:0 nt lds
  buffer_load_dwordx4 v17, s[8:11], s27 offen offset:1024 nt lds
  buffer_load_dwordx4 v18, s[8:11], s27 offen offset:2048 nt lds
  buffer_load_dwordx4 v19, s[8:11], s27 offen offset:3072 nt lds
  s_add_u32 m0, s34, 28672
  s_nop 0
  buffer_load_dwordx4 v20, s[8:11], s27 offen offset:0 nt lds
  buffer_load_dwordx4 v21, s[8:11], s27 offen offset:1024 nt lds
  buffer_load_dwordx4 v22, s[8:11], s27 offen offset:2048 nt lds
  buffer_load_dwordx4 v23, s[8:11], s27 offen offset:3072 nt lds
  ds_read_b64_tr_b16 a[128:129], v4 offset:0
  ds_read_b64_tr_b16 a[130:131], v4 offset:512
  ds_read_b64_tr_b16 a[132:133], v4 offset:8
  ds_read_b64_tr_b16 a[134:135], v4 offset:520
  ds_read_b64_tr_b16 a[136:137], v4 offset:32
  ds_read_b64_tr_b16 a[138:139], v4 offset:544
  ds_read_b64_tr_b16 a[140:141], v4 offset:40
  ds_read_b64_tr_b16 a[142:143], v4 offset:552
  ds_read_b64_tr_b16 a[144:145], v4 offset:4096
  ds_read_b64_tr_b16 a[146:147], v4 offset:4608
  ds_read_b64_tr_b16 a[148:149], v4 offset:4104
  ds_read_b64_tr_b16 a[150:151], v4 offset:4616
  ds_read_b64_tr_b16 a[152:153], v4 offset:4128
  ds_read_b64_tr_b16 a[154:155], v4 offset:4640
  ds_read_b64_tr_b16 a[156:157], v4 offset:4136
  ds_read_b64_tr_b16 a[158:159], v4 offset:4648
  s_waitcnt vmcnt(16)
  s_waitcnt lgkmcnt(0)
  s_add_u32 s27, s28, 0x600000
  s_add_u32 m0, s34, 0
  s_nop 0
  buffer_load_dwordx4 v16, s[8:11], s27 offen offset:0 nt lds
  buffer_load_dwordx4 v17, s[8:11], s27 offen offset:1024 nt lds
  buffer_load_dwordx4 v18, s[8:11], s27 offen offset:2048 nt lds
  buffer_load_dwordx4 v19, s[8:11], s27 offen offset:3072 nt lds
  s_add_u32 m0, s34, 4096
  s_nop 0
  buffer_load_dwordx4 v20, s[8:11], s27 offen offset:0 nt lds
  buffer_load_dwordx4 v21, s[8:11], s27 offen offset:1024 nt lds
  buffer_load_dwordx4 v22, s[8:11], s27 offen offset:2048 nt lds
  buffer_load_dwordx4 v23, s[8:11], s27 offen offset:3072 nt lds
  ds_read_b64_tr_b16 a[160:161], v4 offset:8192
  ds_read_b64_tr_b16 a[162:163], v4 offset:8704
  ds_read_b64_tr_b16 a[164:165], v4 offset:8200
  ds_read_b64_tr_b16 a[166:167], v4 offset:8712
  ds_read_b64_tr_b16 a[168:169], v4 offset:8224
  ds_read_b64_tr_b16 a[170:171], v4 offset:8736
  ds_read_b64_tr_b16 a[172:173], v4 offset:8232
  ds_read_b64_tr_b16 a[174:175], v4 offset:8744
  ds_read_b64_tr_b16 a[176:177], v4 offset:12288
  ds_read_b64_tr_b16 a[178:179], v4 offset:12800
  ds_read_b64_tr_b16 a[180:181], v4 offset:12296
  ds_read_b64_tr_b16 a[182:183], v4 offset:12808
  ds_read_b64_tr_b16 a[184:185], v4 offset:12320
  ds_read_b64_tr_b16 a[186:187], v4 offset:12832
  ds_read_b64_tr_b16 a[188:189], v4 offset:12328
  ds_read_b64_tr_b16 a[190:191], v4 offset:12840
  s_waitcnt vmcnt(16)
  s_waitcnt lgkmcnt(0)
  s_add_u32 s27, s28, 0x6c0000
  s_add_u32 m0, s34, 8192
  s_nop 0
  buffer_load_dwordx4 v16, s[8:11], s27 offen offset:0 nt lds
  buffer_load_dwordx4 v17, s[8:11], s27 offen offset:1024 nt lds
  buffer_load_dwordx4 v18, s[8:11], s27 offen offset:2048 nt lds
  buffer_load_dwordx4 v19, s[8:11], s27 offen offset:3072 nt lds
  s_add_u32 m0, s34, 12288
  s_nop 0
  buffer_load_dwordx4 v20, s[8:11], s27 offen offset:0 nt lds
  buffer_load_dwordx4 v21, s[8:11], s27 offen offset:1024 nt lds
  buffer_load_dwordx4 v22, s[8:11], s27 offen offset:2048 nt lds
  buffer_load_dwordx4 v23, s[8:11], s27 offen offset:3072 nt lds
  ds_read_b64_tr_b16 a[192:193], v4 offset:16384
  ds_read_b64_tr_b16 a[194:195], v4 offset:16896
  ds_read_b64_tr_b16 a[196:197], v4 offset:16392
  ds_read_b64_tr_b16 a[198:199], v4 offset:16904
  ds_read_b64_tr_b16 a[200:201], v4 offset:16416
  ds_read_b64_tr_b16 a[202:203], v4 offset:16928
  ds_read_b64_tr_b16 a[204:205], v4 offset:16424
  ds_read_b64_tr_b16 a[206:207], v4 offset:16936
  ds_read_b64_tr_b16 a[208:209], v4 offset:20480
  ds_read_b64_tr_b16 a[210:211], v4 offset:20992
  ds_read_b64_tr_b16 a[212:213], v4 offset:20488
  ds_read_b64_tr_b16 a[214:215], v4 offset:21000
  ds_read_b64_tr_b16 a[216:217], v4 offset:20512
  ds_read_b64_tr_b16 a[218:219], v4 offset:21024
  ds_read_b64_tr_b16 a[220:221], v4 offset:20520
  ds_read_b64_tr_b16 a[222:223], v4 offset:21032
  s_waitcnt vmcnt(16)
  ds_read_b64_tr_b16 a[224:225], v4 offset:24576
  ds_read_b64_tr_b16 a[226:227], v4 offset:25088
  ds_read_b64_tr_b16 a[228:229], v4 offset:24584
  ds_read_b64_tr_b16 a[230:231], v4 offset:25096
  ds_read_b64_tr_b16 a[232:233], v4 offset:24608
  ds_read_b64_tr_b16 a[234:235], v4 offset:25120
  ds_read_b64_tr_b16 a[236:237], v4 offset:24616
  ds_read_b64_tr_b16 a[238:239], v4 offset:25128
  ds_read_b64_tr_b16 a[240:241], v4 offset:28672
  ds_read_b64_tr_b16 a[242:243], v4 offset:29184
  ds_read_b64_tr_b16 a[244:245], v4 offset:28680
  ds_read_b64_tr_b16 a[246:247], v4 offset:29192
  ds_read_b64_tr_b16 a[248:249], v4 offset:28704
  ds_read_b64_tr_b16 a[250:251], v4 offset:29216
  ds_read_b64_tr_b16 a[252:253], v4 offset:28712
  ds_read_b64_tr_b16 a[254:255], v4 offset:29224
  s_waitcnt vmcnt(8)
  ds_read_b64_tr_b16 v[192:193], v4 offset:0
  ds_read_b64_tr_b16 v[194:195], v4 offset:512
  ds_read_b64_tr_b16 v[196:197], v4 offset:8
  ds_read_b64_tr_b16 v[198:199], v4 offset:520
  ds_read_b64_tr_b16 v[200:201], v4 offset:32
  ds_read_b64_tr_b16 v[202:203], v4 offset:544
  ds_read_b64_tr_b16 v[204:205], v4 offset:40
  ds_read_b64_tr_b16 v[206:207], v4 offset:552
  ds_read_b64_tr_b16 v[208:209], v4 offset:4096
  ds_read_b64_tr_b16 v[210:211], v4 offset:4608
  ds_read_b64_tr_b16 v[212:213], v4 offset:4104
  ds_read_b64_tr_b16 v[214:215], v4 offset:4616
  ds_read_b64_tr_b16 v[216:217], v4 offset:4128
  ds_read_b64_tr_b16 v[218:219], v4 offset:4640
  ds_read_b64_tr_b16 v[220:221], v4 offset:4136
  ds_read_b64_tr_b16 v[222:223], v4 offset:4648
  s_waitcnt vmcnt(0)
  ds_read_b64_tr_b16 v[224:225], v4 offset:8192
  ds_read_b64_tr_b16 v[226:227], v4 offset:8704
  ds_read_b64_tr_b16 v[228:229], v4 offset:8200
  ds_read_b64_tr_b16 v[230:231], v4 offset:8712
  ds_read_b64_tr_b16 v[232:233], v4 offset:8224
  ds_read_b64_tr_b16 v[234:235], v4 offset:8736
  ds_read_b64_tr_b16 v[236:237], v4 offset:8232
  ds_read_b64_tr_b16 v[238:239], v4 offset:8744
  ds_read_b64_tr_b16 v[240:241], v4 offset:12288
  ds_read_b64_tr_b16 v[242:243], v4 offset:12800
  ds_read_b64_tr_b16 v[244:245], v4 offset:12296
  ds_read_b64_tr_b16 v[246:247], v4 offset:12808
  ds_read_b64_tr_b16 v[248:249], v4 offset:12320
  ds_read_b64_tr_b16 v[250:251], v4 offset:12832
  ds_read_b64_tr_b16 v[252:253], v4 offset:12328
  ds_read_b64_tr_b16 v[254:255], v4 offset:12840
  s_waitcnt vmcnt(0) lgkmcnt(0)
  v_and_b32 v2, 3, v1
  v_lshlrev_b32 v2, 2, v2
Lcw_60:
  s_add_u32 s24, s24, 1
  s_cmp_gt_u32 s24, 300000
  s_cbranch_scc1 Lfail_59
  buffer_load_dword v3, v2, s[12:15], 0 offen offset:128 sc1
  s_waitcnt vmcnt(0)
  v_cmp_eq_u32 vcc, 0, v3
  s_and_b32 s26, vcc_lo, 4
  s_cmp_eq_u32 s26, 0
  s_cbranch_scc1 Lcok_61
  s_sleep 6
  s_branch Lcw_60
Lcok_61:
  v_readlane_b32 s23, v3, 3
  s_and_b32 s23, s23, 0x2000
  v_lshlrev_b32 v5, 4, v1
  v_mov_b32 v8, 0
  v_lshrrev_b32 v2, 5, v1
  v_lshlrev_b32 v2, 11, v2
  v_bfe_u32 v3, v1, 4, 1
  v_lshl_add_u32 v2, v3, 9, v2
  v_and_b32 v3, 15, v1
  v_lshl_add_u32 v7, v3, 4, v2
  v_mov_b32 v11, 1
  v_and_b32 v14, 1, v1
  v_lshlrev_b32 v14, 7, v14
  v_add_u32 v14, 0x50000, v14
  s_and_b32 s47, s20, 31
  s_lshl_b32 s47, s47, 7
  s_add_u32 s47, s47, 0x20000
  s_lshl_b32 s33, s33, 5
  s_add_u32 s33, s33, 0x200000
  s_mul_i32 s35, s21, 10240
  s_mov_b32 s22, 0
  s_mov_b32 s25, 0
  s_mov_b32 s45, 0
  s_mov_b32 s46, 0
  s_barrier
  s_branch Lslow_62
Lslowep_65:
  s_nop 7
  v_cvt_pk_bf16_f32 v88, v48, v56
  v_cvt_pk_bf16_f32 v89, v49, v57
  v_cvt_pk_bf16_f32 v90, v50, v58
  v_cvt_pk_bf16_f32 v91, v51, v59
  v_cvt_pk_bf16_f32 v92, v52, v60
  v_cvt_pk_bf16_f32 v93, v53, v61
  v_cvt_pk_bf16_f32 v94, v54, v62
  v_cvt_pk_bf16_f32 v95, v55, v63
  buffer_store_dwordx4 v[88:91], v7, s[4:7], s40 offen offset:0 sc1
  buffer_store_dwordx4 v[92:95], v7, s[4:7], s40 offen offset:256 sc1
  s_waitcnt vmcnt(0)
  s_mov_b32 s26, s46
  v_mov_b32 v2, s26
  s_mov_b64 exec, 1
  buffer_store_dword v2, v8, s[4:7], s33 offen sc1
  s_mov_b64 exec, -1
  s_cmp_ge_u32 s22, 64
  s_cbranch_scc1 Lfin_64
Lslow_62:
  s_cmp_eq_u32 s25, 1
  s_cbranch_scc1 Lhv_66
  s_min_u32 s26, s22, 63
  s_lshl_b32 s26, s26, 8
  v_add_u32 v9, s26, v14
  v_writelane_b32 v9, s47, 0
  s_mov_b32 s37, 0x200000
  s_add_i32 s38, s22, -15
  s_max_i32 s38, s38, 0
  v_writelane_b32 v11, s38, 0
Lsp_68:
  s_add_u32 s24, s24, 1
  s_cmp_gt_u32 s24, 300000
  s_cbranch_scc1 Lfail_67
  buffer_load_dword v10, v9, s[4:7], s37 offen sc1
  s_waitcnt vmcnt(0)
  v_cmp_gt_u32 vcc, v11, v10
  s_cbranch_vccz Lrok_69
  s_sleep 2
  s_branch Lsp_68
Lrok_69:
  s_mul_i32 s42, s22, 40960
  s_add_u32 s42, s42, s29
  s_mov_b32 s43, s45
  s_add_u32 s42, s42, s35
  s_add_u32 s43, s43, s35
  s_add_u32 m0, s43, 0
  s_nop 0
  buffer_load_dwordx4 v5, s[4:7], s42 offen offset:0 sc1 lds
  buffer_load_dwordx4 v5, s[4:7], s42 offen offset:1024 sc1 lds
  buffer_load_dwordx4 v5, s[4:7], s42 offen offset:2048 sc1 lds
  buffer_load_dwordx4 v5, s[4:7], s42 offen offset:3072 sc1 lds
  s_add_u32 m0, s43, 4096
  s_add_u32 s42, s42, 4096
  buffer_load_dwordx4 v5, s[4:7], s42 offen offset:0 sc1 lds
  buffer_load_dwordx4 v5, s[4:7], s42 offen offset:1024 sc1 lds
  buffer_load_dwordx4 v5, s[4:7], s42 offen offset:2048 sc1 lds
  buffer_load_dwordx4 v5, s[4:7], s42 offen offset:3072 sc1 lds
  s_add_u32 m0, s43, 8192
  s_add_u32 s42, s42, 4096
  buffer_load_dwordx4 v5, s[4:7], s42 offen offset:0 sc1 lds
  buffer_load_dwordx4 v5, s[4:7], s42 offen offset:1024 sc1 lds
  s_waitcnt vmcnt(0)
Lhv_66:
  s_barrier
  v_add_u32 v6, s45, v5
  ds_read_b128 v[64:67], v6 offset:0
  ds_read_b128 v[68:71], v6 offset:2048
  ds_read_b128 v[72:75], v6 offset:4096
  s_add_u32 s44, s22, 1
  s_min_u32 s26, s44, 63
  s_lshl_b32 s26, s26, 8
  v_add_u32 v9, s26, v14
  v_writelane_b32 v9, s47, 0
  s_mov_b32 s37, 0x200000
  buffer_load_dword v10, v9, s[4:7], s37 offen sc1
  s_mul_i32 s39, s22, 393216
  s_add_u32 s39, s39, s30
  ds_read_b128 v[76:79], v6 offset:6144
  s_waitcnt lgkmcnt(3)
  v_mfma_f32_16x16x32_bf16 v[32:35], a[0:3], v[64:67], 0
  v_mfma_f32_16x16x32_bf16 v[36:39], a[4:7], v[64:67], 0
  v_mfma_f32_16x16x32_bf16 v[40:43], a[8:11], v[64:67], 0
  v_mfma_f32_16x16x32_bf16 v[44:47], a[12:15], v[64:67], 0
  ds_read_b128 v[64:67], v6 offset:8192
  s_waitcnt lgkmcnt(3)
  v_mfma_f32_16x16x32_bf16 v[32:35], a[16:19], v[68:71], v[32:35]
  v_mfma_f32_16x16x32_bf16 v[36:39], a[20:23], v[68:71], v[36:39]
  v_mfma_f32_16x16x32_bf16 v[40:43], a[24:27], v[68:71], v[40:43]
  v_mfma_f32_16x16x32_bf16 v[44:47], a[28:31], v[68:71], v[44:47]
  ds_read_b128 v[68:71], v6 offset:10240
  s_waitcnt lgkmcnt(3)
  v_mfma_f32_16x16x32_bf16 v[32:35], a[32:35], v[72:75], v[32:35]
  v_mfma_f32_16x16x32_bf16 v[36:39], a[36:39], v[72:75], v[36:39]
  v_mfma_f32_16x16x32_bf16 v[40:43], a[40:43], v[72:75], v[40:43]
  v_mfma_f32_16x16x32_bf16 v[44:47], a[44:47], v[72:75], v[44:47]
  ds_read_b128 v[72:75], v6 offset:12288
  s_waitcnt lgkmcnt(3)
  v_mfma_f32_16x16x32_bf16 v[32:35], a[48:51], v[76:79], v[32:35]
  v_mfma_f32_16x16x32_bf16 v[36:39], a[52:55], v[76:79], v[36:39]
  v_mfma_f32_16x16x32_bf16 v[40:43], a[56:59], v[76:79], v[40:43]
  v_mfma_f32_16x16x32_bf16 v[44:47], a[60:63], v[76:79], v[44:47]
  ds_read_b128 v[76:79], v6 offset:14336
  s_waitcnt lgkmcnt(3)
  v_mfma_f32_16x16x32_bf16 v[32:35], a[64:67], v[64:67], v[32:35]
  v_mfma_f32_16x16x32_bf16 v[36:39], a[68:71], v[64:67], v[36:39]
  v_mfma_f32_16x16x32_bf16 v[40:43], a[72:75], v[64:67], v[40:43]
  v_mfma_f32_16x16x32_bf16 v[44:47], a[76:79], v[64:67], v[44:47]
  ds_read_b128 v[64:67], v6 offset:16384
  s_waitcnt lgkmcnt(3)
  v_mfma_f32_16x16x32_bf16 v[32:35], a[80:83], v[68:71], v[32:35]
  v_mfma_f32_16x16x32_bf16 v[36:39], a[84:87], v[68:71], v[36:39]
  v_mfma_f32_16x16x32_bf16 v[40:43], a[88:91], v[68:71], v[40:43]
  v_mfma_f32_16x16x32_bf16 v[44:47], a[92:95], v[68:71], v[44:47]
  s_waitcnt vmcnt(0)
  s_branch Lmid_63
Lfast_70:
  s_waitcnt vmcnt(3)
  s_barrier
  v_add_u32 v6, s45, v5
  ds_read_b128 v[64:67], v6 offset:0
  ds_read_b128 v[68:71], v6 offset:2048
  ds_read_b128 v[72:75], v6 offset:4096
  s_add_u32 s44, s22, 1
  s_min_u32 s26, s44, 63
  s_lshl_b32 s26, s26, 8
  v_add_u32 v9, s26, v14
  v_writelane_b32 v9, s47, 0
  s_mov_b32 s37, 0x200000
  buffer_load_dword v10, v9, s[4:7], s37 offen sc1
  s_mul_i32 s39, s22, 393216
  s_add_u32 s39, s39, s30
  ds_read_b128 v[76:79], v6 offset:6144
  s_waitcnt lgkmcnt(3)
  v_mfma_f32_16x16x32_bf16 v[32:35], a[0:3], v[64:67], 0
  v_cvt_pk_bf16_f32 v88, v48, v56
  v_mfma_f32_16x16x32_bf16 v[36:39], a[4:7], v[64:67], 0
  v_cvt_pk_bf16_f32 v89, v49, v57
  v_mfma_f32_16x16x32_bf16 v[40:43], a[8:11], v[64:67], 0
  v_cvt_pk_bf16_f32 v90, v50, v58
  v_mfma_f32_16x16x32_bf16 v[44:47], a[12:15], v[64:67], 0
  v_cvt_pk_bf16_f32 v91, v51, v59
  ds_read_b128 v[64:67], v6 offset:8192
  v_cvt_pk_bf16_f32 v92, v52, v60
  s_waitcnt lgkmcnt(3)
  v_cvt_pk_bf16_f32 v93, v53, v61
  v_mfma_f32_16x16x32_bf16 v[32:35], a[16:19], v[68:71], v[32:35]
  v_cvt_pk_bf16_f32 v94, v54, v62
  v_mfma_f32_16x16x32_bf16 v[36:39], a[20:23], v[68:71], v[36:39]
  v_cvt_pk_bf16_f32 v95, v55, v63
  v_mfma_f32_16x16x32_bf16 v[40:43], a[24:27], v[68:71], v[40:43]
  buffer_store_dwordx4 v[88:91], v7, s[4:7], s40 offen offset:0 sc1
  v_mfma_f32_16x16x32_bf16 v[44:47], a[28:31], v[68:71], v[44:47]
  buffer_store_dwordx4 v[92:95], v7, s[4:7], s40 offen offset:256 sc1
  ds_read_b128 v[68:71], v6 offset:10240
  s_waitcnt lgkmcnt(3)
  v_mfma_f32_16x16x32_bf16 v[32:35], a[32:35], v[72:75], v[32:35]
  v_mfma_f32_16x16x32_bf16 v[36:39], a[36:39], v[72:75], v[36:39]
  v_mfma_f32_16x16x32_bf16 v[40:43], a[40:43], v[72:75], v[40:43]
  v_mfma_f32_16x16x32_bf16 v[44:47], a[44:47], v[72:75], v[44:47]
  ds_read_b128 v[72:75], v6 offset:12288
  s_waitcnt lgkmcnt(3)
  v_mfma_f32_16x16x32_bf16 v[32:35], a[48:51], v[76:79], v[32:35]
  v_mfma_f32_16x16x32_bf16 v[36:39], a[52:55], v[76:79], v[36:39]
  v_mfma_f32_16x16x32_bf16 v[40:43], a[56:59], v[76:79], v[40:43]
  v_mfma_f32_16x16x32_bf16 v[44:47], a[60:63], v[76:79], v[44:47]
  ds_read_b128 v[76:79], v6 offset:14336
  s_waitcnt lgkmcnt(3)
  v_mfma_f32_16x16x32_bf16 v[32:35], a[64:67], v[64:67], v[32:35]
  v_mfma_f32_16x16x32_bf16 v[36:39], a[68:71], v[64:67], v[36:39]
  v_mfma_f32_16x16x32_bf16 v[40:43], a[72:75], v[64:67], v[40:43]
  v_mfma_f32_16x16x32_bf16 v[44:47], a[76:79], v[64:67], v[44:47]
  ds_read_b128 v[64:67], v6 offset:16384
  s_waitcnt lgkmcnt(3)
  v_mfma_f32_16x16x32_bf16 v[32:35], a[80:83], v[68:71], v[32:35]
  v_mfma_f32_16x16x32_bf16 v[36:39], a[84:87], v[68:71], v[36:39]
  v_mfma_f32_16x16x32_bf16 v[40:43], a[88:91], v[68:71], v[40:43]
  v_mfma_f32_16x16x32_bf16 v[44:47], a[92:95], v[68:71], v[44:47]
  s_waitcnt vmcnt(2)
Lmid_63:
  s_add_u32 s40, s39, 1024
  s_mul_i32 s42, s44, 40960
  s_add_u32 s42, s42, s29
  s_sub_u32 s43, 40960, s45
  s_add_u32 s42, s42, s35
  s_add_u32 s43, s43, s35
  s_mov_b32 s25, 1
  s_cmp_ge_u32 s44, 64
  s_cselect_b32 s25, 0, s25
  s_add_i32 s38, s44, -15
  s_max_i32 s38, s38, 0
  v_writelane_b32 v11, s38, 0
  s_nop 0
  v_cmp_gt_u32 vcc, v11, v10
  s_cmp_lg_u64 vcc, 0
  s_cselect_b32 s25, 0, s25
  s_cmp_eq_u32 s25, 0
  s_cselect_b32 s42, 0x7ff00000, s42
  ds_read_b128 v[68:71], v6 offset:18432
  s_waitcnt lgkmcnt(3)
  v_mfma_f32_16x16x32_bf16 v[32:35], a[96:99], v[72:75], v[32:35]
  s_add_u32 m0, s43, 0
  s_nop 0
  buffer_load_dwordx4 v5, s[4:7], s42 offen offset:0 sc1 lds
  v_mfma_f32_16x16x32_bf16 v[36:39], a[100:103], v[72:75], v[36:39]
  v_mfma_f32_16x16x32_bf16 v[40:43], a[104:107], v[72:75], v[40:43]
  v_mfma_f32_16x16x32_bf16 v[44:47], a[108:111], v[72:75], v[44:47]
  ds_read_b128 v[72:75], v6 offset:20480
  s_waitcnt lgkmcnt(3)
  v_mfma_f32_16x16x32_bf16 v[32:35], a[112:115], v[76:79], v[32:35]
  buffer_load_dwordx4 v5, s[4:7], s42 offen offset:1024 sc1 lds
  v_mfma_f32_16x16x32_bf16 v[36:39], a[116:119], v[76:79], v[36:39]
  v_mfma_f32_16x16x32_bf16 v[40:43], a[120:123], v[76:79], v[40:43]
  v_mfma_f32_16x16x32_bf16 v[44:47], a[124:127], v[76:79], v[44:47]
  ds_read_b128 v[76:79], v6 offset:22528
  s_waitcnt lgkmcnt(3)
  v_mfma_f32_16x16x32_bf16 v[32:35], a[128:131], v[64:67], v[32:35]
  buffer_load_dwordx4 v5, s[4:7], s42 offen offset:2048 sc1 lds
  v_mfma_f32_16x16x32_bf16 v[36:39], a[132:135], v[64:67], v[36:39]
  v_mfma_f32_16x16x32_bf16 v[40:43], a[136:139], v[64:67], v[40:43]
  v_mfma_f32_16x16x32_bf16 v[44:47], a[140:143], v[64:67], v[44:47]
  ds_read_b128 v[64:67], v6 offset:24576
  s_waitcnt lgkmcnt(3)
  v_mfma_f32_16x16x32_bf16 v[32:35], a[144:147], v[68:71], v[32:35]
  buffer_load_dwordx4 v5, s[4:7], s42 offen offset:3072 sc1 lds
  v_mfma_f32_16x16x32_bf16 v[36:39], a[148:151], v[68:71], v[36:39]
  v_mfma_f32_16x16x32_bf16 v[40:43], a[152:155], v[68:71], v[40:43]
  v_mfma_f32_16x16x32_bf16 v[44:47], a[156:159], v[68:71], v[44:47]
  ds_read_b128 v[68:71], v6 offset:26624
  s_waitcnt lgkmcnt(3)
  v_mfma_f32_16x16x32_bf16 v[32:35], a[160:163], v[72:75], v[32:35]
  s_add_u32 m0, s43, 4096
  s_add_u32 s42, s42, 4096
  buffer_load_dwordx4 v5, s[4:7], s42 offen offset:0 sc1 lds
  v_mfma_f32_16x16x32_bf16 v[36:39], a[164:167], v[72:75], v[36:39]
  v_mfma_f32_16x16x32_bf16 v[40:43], a[168:171], v[72:75], v[40:43]
  v_mfma_f32_16x16x32_bf16 v[44:47], a[172:175], v[72:75], v[44:47]
  ds_read_b128 v[72:75], v6 offset:28672
  s_waitcnt lgkmcnt(3)
  v_mfma_f32_16x16x32_bf16 v[32:35], a[176:179], v[76:79], v[32:35]
  buffer_load_dwordx4 v5, s[4:7], s42 offen offset:1024 sc1 lds
  v_mfma_f32_16x16x32_bf16 v[36:39], a[180:183], v[76:79], v[36:39]
  v_mfma_f32_16x16x32_bf16 v[40:43], a[184:187], v[76:79], v[40:43]
  v_mfma_f32_16x16x32_bf16 v[44:47], a[188:191], v[76:79], v[44:47]
  ds_read_b128 v[76:79], v6 offset:30720
  s_waitcnt lgkmcnt(3)
  v_mfma_f32_16x16x32_bf16 v[32:35], a[192:195], v[64:67], v[32:35]
  buffer_load_dwordx4 v5, s[4:7], s42 offen offset:2048 sc1 lds
  v_mfma_f32_16x16x32_bf16 v[36:39], a[196:199], v[64:67], v[36:39]
  v_mfma_f32_16x16x32_bf16 v[40:43], a[200:203], v[64:67], v[40:43]
  v_mfma_f32_16x16x32_bf16 v[44:47], a[204:207], v[64:67], v[44:47]
  ds_read_b128 v[64:67], v6 offset:32768
  s_waitcnt lgkmcnt(3)
  v_mfma_f32_16x16x32_bf16 v[32:35], a[208:211], v[68:71], v[32:35]
  buffer_load_dwordx4 v5, s[4:7], s42 offen offset:3072 sc1 lds
  v_mfma_f32_16x16x32_bf16 v[36:39], a[212:215], v[68:71], v[36:39]
  v_mfma_f32_16x16x32_bf16 v[40:43], a[216:219], v[68:71], v[40:43]
  v_mfma_f32_16x16x32_bf16 v[44:47], a[220:223], v[68:71], v[44:47]
  ds_read_b128 v[68:71], v6 offset:34816
  s_waitcnt lgkmcnt(3)
  v_mfma_f32_16x16x32_bf16 v[32:35], a[224:227], v[72:75], v[32:35]
  s_add_u32 m0, s43, 8192
  s_add_u32 s42, s42, 4096
  buffer_load_dwordx4 v5, s[4:7], s42 offen offset:0 sc1 lds
  v_mfma_f32_16x16x32_bf16 v[36:39], a[228:231], v[72:75], v[36:39]
  v_mfma_f32_16x16x32_bf16 v[40:43], a[232:235], v[72:75], v[40:43]
  v_mfma_f32_16x16x32_bf16 v[44:47], a[236:239], v[72:75], v[44:47]
  ds_read_b128 v[72:75], v6 offset:36864
  s_waitcnt lgkmcnt(3)
  v_mfma_f32_16x16x32_bf16 v[32:35], a[240:243], v[76:79], v[32:35]
  buffer_load_dwordx4 v5, s[4:7], s42 offen offset:1024 sc1 lds
  v_mfma_f32_16x16x32_bf16 v[36:39], a[244:247], v[76:79], v[36:39]
  v_mfma_f32_16x16x32_bf16 v[40:43], a[248:251], v[76:79], v[40:43]
  v_mfma_f32_16x16x32_bf16 v[44:47], a[252:255], v[76:79], v[44:47]
  s_waitcnt vmcnt(10)
  s_mov_b32 s26, s46
  v_mov_b32 v2, s26
  s_mov_b64 exec, 1
  buffer_store_dword v2, v8, s[4:7], s33 offen sc1
  s_mov_b64 exec, -1
  ds_read_b128 v[76:79], v6 offset:38912
  s_waitcnt lgkmcnt(3)
  v_mfma_f32_16x16x32_bf16 v[32:35], v[192:195], v[64:67], v[32:35]
  v_mfma_f32_16x16x32_bf16 v[36:39], v[196:199], v[64:67], v[36:39]
  v_mfma_f32_16x16x32_bf16 v[40:43], v[200:203], v[64:67], v[40:43]
  v_mfma_f32_16x16x32_bf16 v[44:47], v[204:207], v[64:67], v[44:47]
  ds_read_b128 v[64:67], v6 offset:1024
  s_waitcnt lgkmcnt(3)
  v_mfma_f32_16x16x32_bf16 v[32:35], v[208:211], v[68:71], v[32:35]
  v_mfma_f32_16x16x32_bf16 v[36:39], v[212:215], v[68:71], v[36:39]
  v_mfma_f32_16x16x32_bf16 v[40:43], v[216:219], v[68:71], v[40:43]
  v_mfma_f32_16x16x32_bf16 v[44:47], v[220:223], v[68:71], v[44:47]
  ds_read_b128 v[68:71], v6 offset:3072
  s_waitcnt lgkmcnt(3)
  v_mfma_f32_16x16x32_bf16 v[32:35], v[224:227], v[72:75], v[32:35]
  v_mfma_f32_16x16x32_bf16 v[36:39], v[228:231], v[72:75], v[36:39]
  v_mfma_f32_16x16x32_bf16 v[40:43], v[232:235], v[72:75], v[40:43]
  v_mfma_f32_16x16x32_bf16 v[44:47], v[236:239], v[72:75], v[44:47]
  ds_read_b128 v[72:75], v6 offset:5120
  s_waitcnt lgkmcnt(3)
  v_mfma_f32_16x16x32_bf16 v[32:35], v[240:243], v[76:79], v[32:35]
  v_mfma_f32_16x16x32_bf16 v[36:39], v[244:247], v[76:79], v[36:39]
  v_mfma_f32_16x16x32_bf16 v[40:43], v[248:251], v[76:79], v[40:43]
  v_mfma_f32_16x16x32_bf16 v[44:47], v[252:255], v[76:79], v[44:47]
  ds_read_b128 v[76:79], v6 offset:7168
  s_waitcnt lgkmcnt(3)
  v_mfma_f32_16x16x32_bf16 v[48:51], a[0:3], v[64:67], 0
  v_mfma_f32_16x16x32_bf16 v[52:55], a[4:7], v[64:67], 0
  v_mfma_f32_16x16x32_bf16 v[56:59], a[8:11], v[64:67], 0
  v_mfma_f32_16x16x32_bf16 v[60:63], a[12:15], v[64:67], 0
  ds_read_b128 v[64:67], v6 offset:9216
  s_waitcnt lgkmcnt(3)
  v_mfma_f32_16x16x32_bf16 v[48:51], a[16:19], v[68:71], v[48:51]
  v_mfma_f32_16x16x32_bf16 v[52:55], a[20:23], v[68:71], v[52:55]
  v_mfma_f32_16x16x32_bf16 v[56:59], a[24:27], v[68:71], v[56:59]
  v_cvt_pk_bf16_f32 v80, v32, v40
  v_mfma_f32_16x16x32_bf16 v[60:63], a[28:31], v[68:71], v[60:63]
  v_cvt_pk_bf16_f32 v81, v33, v41
  ds_read_b128 v[68:71], v6 offset:11264
  v_cvt_pk_bf16_f32 v82, v34, v42
  s_waitcnt lgkmcnt(3)
  v_cvt_pk_bf16_f32 v83, v35, v43
  v_mfma_f32_16x16x32_bf16 v[48:51], a[32:35], v[72:75], v[48:51]
  v_cvt_pk_bf16_f32 v84, v36, v44
  v_mfma_f32_16x16x32_bf16 v[52:55], a[36:39], v[72:75], v[52:55]
  v_cvt_pk_bf16_f32 v85, v37, v45
  v_mfma_f32_16x16x32_bf16 v[56:59], a[40:43], v[72:75], v[56:59]
  v_cvt_pk_bf16_f32 v86, v38, v46
  v_mfma_f32_16x16x32_bf16 v[60:63], a[44:47], v[72:75], v[60:63]
  v_cvt_pk_bf16_f32 v87, v39, v47
  ds_read_b128 v[72:75], v6 offset:13312
  buffer_store_dwordx4 v[80:83], v7, s[4:7], s39 offen offset:0 sc1
  s_waitcnt lgkmcnt(3)
  buffer_store_dwordx4 v[84:87], v7, s[4:7], s39 offen offset:256 sc1
  v_mfma_f32_16x16x32_bf16 v[48:51], a[48:51], v[76:79], v[48:51]
  v_mfma_f32_16x16x32_bf16 v[52:55], a[52:55], v[76:79], v[52:55]
  v_mfma_f32_16x16x32_bf16 v[56:59], a[56:59], v[76:79], v[56:59]
  v_mfma_f32_16x16x32_bf16 v[60:63], a[60:63], v[76:79], v[60:63]
  ds_read_b128 v[76:79], v6 offset:15360
  s_waitcnt lgkmcnt(3)
  v_mfma_f32_16x16x32_bf16 v[48:51], a[64:67], v[64:67], v[48:51]
  v_mfma_f32_16x16x32_bf16 v[52:55], a[68:71], v[64:67], v[52:55]
  v_mfma_f32_16x16x32_bf16 v[56:59], a[72:75], v[64:67], v[56:59]
  v_mfma_f32_16x16x32_bf16 v[60:63], a[76:79], v[64:67], v[60:63]
  ds_read_b128 v[64:67], v6 offset:17408
  s_waitcnt lgkmcnt(3)
  v_mfma_f32_16x16x32_bf16 v[48:51], a[80:83], v[68:71], v[48:51]
  v_mfma_f32_16x16x32_bf16 v[52:55], a[84:87], v[68:71], v[52:55]
  v_mfma_f32_16x16x32_bf16 v[56:59], a[88:91], v[68:71], v[56:59]
  v_mfma_f32_16x16x32_bf16 v[60:63], a[92:95], v[68:71], v[60:63]
  ds_read_b128 v[68:71], v6 offset:19456
  s_waitcnt lgkmcnt(3)
  v_mfma_f32_16x16x32_bf16 v[48:51], a[96:99], v[72:75], v[48:51]
  v_mfma_f32_16x16x32_bf16 v[52:55], a[100:103], v[72:75], v[52:55]
  v_mfma_f32_16x16x32_bf16 v[56:59], a[104:107], v[72:75], v[56:59]
  v_mfma_f32_16x16x32_bf16 v[60:63], a[108:111], v[72:75], v[60:63]
  ds_read_b128 v[72:75], v6 offset:21504
  s_waitcnt lgkmcnt(3)
  v_mfma_f32_16x16x32_bf16 v[48:51], a[112:115], v[76:79], v[48:51]
  v_mfma_f32_16x16x32_bf16 v[52:55], a[116:119], v[76:79], v[52:55]
  v_mfma_f32_16x16x32_bf16 v[56:59], a[120:123], v[76:79], v[56:59]
  v_mfma_f32_16x16x32_bf16 v[60:63], a[124:127], v[76:79], v[60:63]
  ds_read_b128 v[76:79], v6 offset:23552
  s_waitcnt lgkmcnt(3)
  v_mfma_f32_16x16x32_bf16 v[48:51], a[128:131], v[64:67], v[48:51]
  v_mfma_f32_16x16x32_bf16 v[52:55], a[132:135], v[64:67], v[52:55]
  v_mfma_f32_16x16x32_bf16 v[56:59], a[136:139], v[64:67], v[56:59]
  v_mfma_f32_16x16x32_bf16 v[60:63], a[140:143], v[64:67], v[60:63]
  ds_read_b128 v[64:67], v6 offset:25600
  s_waitcnt lgkmcnt(3)
  v_mfma_f32_16x16x32_bf16 v[48:51], a[144:147], v[68:71], v[48:51]
  v_mfma_f32_16x16x32_bf16 v[52:55], a[148:151], v[68:71], v[52:55]
  v_mfma_f32_16x16x32_bf16 v[56:59], a[152:155], v[68:71], v[56:59]
  v_mfma_f32_16x16x32_bf16 v[60:63], a[156:159], v[68:71], v[60:63]
  ds_read_b128 v[68:71], v6 offset:27648
  s_waitcnt lgkmcnt(3)
  v_mfma_f32_16x16x32_bf16 v[48:51], a[160:163], v[72:75], v[48:51]
  v_mfma_f32_16x16x32_bf16 v[52:55], a[164:167], v[72:75], v[52:55]
  v_mfma_f32_16x16x32_bf16 v[56:59], a[168:171], v[72:75], v[56:59]
  v_mfma_f32_16x16x32_bf16 v[60:63], a[172:175], v[72:75], v[60:63]
  ds_read_b128 v[72:75], v6 offset:29696
  s_waitcnt lgkmcnt(3)
  v_mfma_f32_16x16x32_bf16 v[48:51], a[176:179], v[76:79], v[48:51]
  v_mfma_f32_16x16x32_bf16 v[52:55], a[180:183], v[76:79], v[52:55]
  v_mfma_f32_16x16x32_bf16 v[56:59], a[184:187], v[76:79], v[56:59]
  v_mfma_f32_16x16x32_bf16 v[60:63], a[188:191], v[76:79], v[60:63]
  ds_read_b128 v[76:79], v6 offset:31744
  s_waitcnt lgkmcnt(3)
  v_mfma_f32_16x16x32_bf16 v[48:51], a[192:195], v[64:67], v[48:51]
  v_mfma_f32_16x16x32_bf16 v[52:55], a[196:199], v[64:67], v[52:55]
  v_mfma_f32_16x16x32_bf16 v[56:59], a[200:203], v[64:67], v[56:59]
  v_mfma_f32_16x16x32_bf16 v[60:63], a[204:207], v[64:67], v[60:63]
  ds_read_b128 v[64:67], v6 offset:33792
  s_waitcnt lgkmcnt(3)
  v_mfma_f32_16x16x32_bf16 v[48:51], a[208:211], v[68:71], v[48:51]
  v_mfma_f32_16x16x32_bf16 v[52:55], a[212:215], v[68:71], v[52:55]
  v_mfma_f32_16x16x32_bf16 v[56:59], a[216:219], v[68:71], v[56:59]
  v_mfma_f32_16x16x32_bf16 v[60:63], a[220:223], v[68:71], v[60:63]
  ds_read_b128 v[68:71], v6 offset:35840
  s_waitcnt lgkmcnt(3)
  v_mfma_f32_16x16x32_bf16 v[48:51], a[224:227], v[72:75], v[48:51]
  v_mfma_f32_16x16x32_bf16 v[52:55], a[228:231], v[72:75], v[52:55]
  v_mfma_f32_16x16x32_bf16 v[56:59], a[232:235], v[72:75], v[56:59]
  v_mfma_f32_16x16x32_bf16 v[60:63], a[236:239], v[72:75], v[60:63]
  ds_read_b128 v[72:75], v6 offset:37888
  s_waitcnt lgkmcnt(3)
  v_mfma_f32_16x16x32_bf16 v[48:51], a[240:243], v[76:79], v[48:51]
  v_mfma_f32_16x16x32_bf16 v[52:55], a[244:247], v[76:79], v[52:55]
  v_mfma_f32_16x16x32_bf16 v[56:59], a[248:251], v[76:79], v[56:59]
  v_mfma_f32_16x16x32_bf16 v[60:63], a[252:255], v[76:79], v[60:63]
  ds_read_b128 v[76:79], v6 offset:39936
  s_waitcnt lgkmcnt(3)
  v_mfma_f32_16x16x32_bf16 v[48:51], v[192:195], v[64:67], v[48:51]
  v_mfma_f32_16x16x32_bf16 v[52:55], v[196:199], v[64:67], v[52:55]
  v_mfma_f32_16x16x32_bf16 v[56:59], v[200:203], v[64:67], v[56:59]
  v_mfma_f32_16x16x32_bf16 v[60:63], v[204:207], v[64:67], v[60:63]
  s_waitcnt lgkmcnt(2)
  v_mfma_f32_16x16x32_bf16 v[48:51], v[208:211], v[68:71], v[48:51]
  v_mfma_f32_16x16x32_bf16 v[52:55], v[212:215], v[68:71], v[52:55]
  v_mfma_f32_16x16x32_bf16 v[56:59], v[216:219], v[68:71], v[56:59]
  v_mfma_f32_16x16x32_bf16 v[60:63], v[220:223], v[68:71], v[60:63]
  s_waitcnt lgkmcnt(1)
  v_mfma_f32_16x16x32_bf16 v[48:51], v[224:227], v[72:75], v[48:51]
  v_mfma_f32_16x16x32_bf16 v[52:55], v[228:231], v[72:75], v[52:55]
  v_mfma_f32_16x16x32_bf16 v[56:59], v[232:235], v[72:75], v[56:59]
  v_mfma_f32_16x16x32_bf16 v[60:63], v[236:239], v[72:75], v[60:63]
  s_waitcnt lgkmcnt(0)
  v_mfma_f32_16x16x32_bf16 v[48:51], v[240:243], v[76:79], v[48:51]
  v_mfma_f32_16x16x32_bf16 v[52:55], v[244:247], v[76:79], v[52:55]
  v_mfma_f32_16x16x32_bf16 v[56:59], v[248:251], v[76:79], v[56:59]
  v_mfma_f32_16x16x32_bf16 v[60:63], v[252:255], v[76:79], v[60:63]
  s_add_u32 s46, s22, 1
  s_mov_b32 s22, s44
  s_sub_u32 s45, 40960, s45
  s_cmp_lt_u32 s22, 4
  s_cbranch_scc1 Lslowep_65
  s_cmp_eq_u32 s25, 1
  s_cbranch_scc1 Lfast_70
  s_branch Lslowep_65
Lfin_64:
  s_cmp_ge_u32 s20, 18
  s_cbranch_scc1 Lmain_end
  s_mul_i32 s26, s20, 10923
  s_lshr_b32 s26, s26, 16
  s_add_u32 s83, s26, 1
  s_mul_i32 s26, s26, 6
  s_sub_u32 s20, s20, s26
  s_barrier
  s_branch Lrole_M1
  s_branch Lmain_end
.p2align 6
Lrole_U:
  s_mov_b32 s8, s42
  s_and_b32 s9, s43, 0xffff
  s_mov_b32 s10, 0x780000
  s_mov_b32 s11, 0x20000
  v_add_u32 v2, 0, v1
  v_mul_u32_u24 v3, 3277, v2
  v_lshrrev_b32 v3, 16, v3
  v_mul_u32_u24 v4, 20, v3
  v_sub_u32 v2, v2, v4
  v_mul_u32_u24 v3, 1280, v3
  v_lshl_add_u32 v3, v2, 4, v3
  v_subrev_u32 v16, 0, v3
  v_add_u32 v2, 64, v1
  v_mul_u32_u24 v3, 3277, v2
  v_lshrrev_b32 v3, 16, v3
  v_mul_u32_u24 v4, 20, v3
  v_sub_u32 v2, v2, v4
  v_mul_u32_u24 v3, 1280, v3
  v_lshl_add_u32 v3, v2, 4, v3
  v_subrev_u32 v17, 1024, v3
  v_add_u32 v2, 128, v1
  v_mul_u32_u24 v3, 3277, v2
  v_lshrrev_b32 v3, 16, v3
  v_mul_u32_u24 v4, 20, v3
  v_sub_u32 v2, v2, v4
  v_mul_u32_u24 v3, 1280, v3
  v_lshl_add_u32 v3, v2, 4, v3
  v_subrev_u32 v18, 2048, v3
  v_add_u32 v2, 192, v1
  v_mul_u32_u24 v3, 3277, v2
  v_lshrrev_b32 v3, 16, v3
  v_mul_u32_u24 v4, 20, v3
  v_sub_u32 v2, v2, v4
  v_mul_u32_u24 v3, 1280, v3
  v_lshl_add_u32 v3, v2, 4, v3
  v_subrev_u32 v19, 3072, v3
  v_add_u32 v2, 256, v1
  v_mul_u32_u24 v3, 3277, v2
  v_lshrrev_b32 v3, 16, v3
  v_mul_u32_u24 v4, 20, v3
  v_sub_u32 v2, v2, v4
  v_mul_u32_u24 v3, 1280, v3
  v_lshl_add_u32 v3, v2, 4, v3
  v_subrev_u32 v20, 0, v3
  v_add_u32 v2, 320, v1
  v_mul_u32_u24 v3, 3277, v2
  v_lshrrev_b32 v3, 16, v3
  v_mul_u32_u24 v4, 20, v3
  v_sub_u32 v2, v2, v4
  v_mul_u32_u24 v3, 1280, v3
  v_lshl_add_u32 v3, v2, 4, v3
  v_subrev_u32 v21, 1024, v3
  v_add_u32 v2, 384, v1
  v_mul_u32_u24 v3, 3277, v2
  v_lshrrev_b32 v3, 16, v3
  v_mul_u32_u24 v4, 20, v3
  v_sub_u32 v2, v2, v4
  v_mul_u32_u24 v3, 1280, v3
  v_lshl_add_u32 v3, v2, 4, v3
  v_subrev_u32 v22, 2048, v3
  v_add_u32 v2, 448, v1
  v_mul_u32_u24 v3, 3277, v2
  v_lshrrev_b32 v3, 16, v3
  v_mul_u32_u24 v4, 20, v3
  v_sub_u32 v2, v2, v4
  v_mul_u32_u24 v3, 1280, v3
  v_lshl_add_u32 v3, v2, 4, v3
  v_subrev_u32 v23, 3072, v3
  v_add_u32 v2, 512, v1
  v_mul_u32_u24 v3, 3277, v2
  v_lshrrev_b32 v3, 16, v3
  v_mul_u32_u24 v4, 20, v3
  v_sub_u32 v2, v2, v4
  v_mul_u32_u24 v3, 1280, v3
  v_lshl_add_u32 v3, v2, 4, v3
  v_subrev_u32 v24, 0, v3
  v_add_u32 v2, 576, v1
  v_mul_u32_u24 v3, 3277, v2
  v_lshrrev_b32 v3, 16, v3
  v_mul_u32_u24 v4, 20, v3
  v_sub_u32 v2, v2, v4
  v_mul_u32_u24 v3, 1280, v3
  v_lshl_add_u32 v3, v2, 4, v3
  v_subrev_u32 v25, 1024, v3
  s_mul_i32 s28, s20, 245760
  s_mul_i32 s26, s21, 320
  s_add_u32 s28, s28, s26
  s_mul_i32 s34, s21, 40960
  v_lshrrev_b32 v2, 4, v1
  v_lshlrev_b32 v2, 2, v2
  v_bfe_u32 v3, v1, 2, 1
  v_lshl_add_u32 v2, v3, 4, v2
  v_bfe_u32 v3, v1, 3, 1
  v_add_u32 v2, v2, v3
  v_mul_u32_u24 v2, 320, v2
  v_and_b32 v3, 3, v1
  v_lshl_add_u32 v2, v3, 3, v2
  v_add_u32 v4, s34, v2
  s_add_u32 s27, s28, 0x0
  s_add_u32 m0, s34, 0
  s_nop 0
  buffer_load_dwordx4 v16, s[8:11], s27 offen offset:0 nt lds
  buffer_load_dwordx4 v17, s[8:11], s27 offen offset:1024 nt lds
  buffer_load_dwordx4 v18, s[8:11], s27 offen offset:2048 nt lds
  buffer_load_dwordx4 v19, s[8:11], s27 offen offset:3072 nt lds
  s_add_u32 m0, s34, 4096
  s_nop 0
  buffer_load_dwordx4 v20, s[8:11], s27 offen offset:0 nt lds
  buffer_load_dwordx4 v21, s[8:11], s27 offen offset:1024 nt lds
  buffer_load_dwordx4 v22, s[8:11], s27 offen offset:2048 nt lds
  buffer_load_dwordx4 v23, s[8:11], s27 offen offset:3072 nt lds
  s_add_u32 m0, s34, 8192
  s_nop 0
  buffer_load_dwordx4 v24, s[8:11], s27 offen offset:0 nt lds
  buffer_load_dwordx4 v25, s[8:11], s27 offen offset:1024 nt lds
  s_add_u32 s27, s28, 0xa000
  s_add_u32 m0, s34, 10240
  s_nop 0
  buffer_load_dwordx4 v16, s[8:11], s27 offen offset:0 nt lds
  buffer_load_dwordx4 v17, s[8:11], s27 offen offset:1024 nt lds
  buffer_load_dwordx4 v18, s[8:11], s27 offen offset:2048 nt lds
  buffer_load_dwordx4 v19, s[8:11], s27 offen offset:3072 nt lds
  s_add_u32 m0, s34, 14336
  s_nop 0
  buffer_load_dwordx4 v20, s[8:11], s27 offen offset:0 nt lds
  buffer_load_dwordx4 v21, s[8:11], s27 offen offset:1024 nt lds
  buffer_load_dwordx4 v22, s[8:11], s27 offen offset:2048 nt lds
  buffer_load_dwordx4 v23, s[8:11], s27 offen offset:3072 nt lds
  s_add_u32 m0, s34, 18432
  s_nop 0
  buffer_load_dwordx4 v24, s[8:11], s27 offen offset:0 nt lds
  buffer_load_dwordx4 v25, s[8:11], s27 offen offset:1024 nt lds
  s_waitcnt vmcnt(10)
  s_waitcnt lgkmcnt(0)
  s_add_u32 s27, s28, 0x14000
  s_add_u32 m0, s34, 20480
  s_nop 0
  buffer_load_dwordx4 v16, s[8:11], s27 offen offset:0 nt lds
  buffer_load_dwordx4 v17, s[8:11], s27 offen offset:1024 nt lds
  buffer_load_dwordx4 v18, s[8:11], s27 offen offset:2048 nt lds
  buffer_load_dwordx4 v19, s[8:11], s27 offen offset:3072 nt lds
  s_add_u32 m0, s34, 24576
  s_nop 0
  buffer_load_dwordx4 v20, s[8:11], s27 offen offset:0 nt lds
  buffer_load_dwordx4 v21, s[8:11], s27 offen offset:1024 nt lds
  buffer_load_dwordx4 v22, s[8:11], s27 offen offset:2048 nt lds
  buffer_load_dwordx4 v23, s[8:11], s27 offen offset:3072 nt lds
  s_add_u32 m0, s34, 28672
  s_nop 0
  buffer_load_dwordx4 v24, s[8:11], s27 offen offset:0 nt lds
  buffer_load_dwordx4 v25, s[8:11], s27 offen offset:1024 nt lds
  ds_read_b64_tr_b16 a[0:1], v4 offset:0
  ds_read_b64_tr_b16 a[2:3], v4 offset:640
  ds_read_b64_tr_b16 a[24:25], v4 offset:32
  ds_read_b64_tr_b16 a[26:27], v4 offset:672
  ds_read_b64_tr_b16 a[48:49], v4 offset:64
  ds_read_b64_tr_b16 a[50:51], v4 offset:704
  ds_read_b64_tr_b16 a[72:73], v4 offset:96
  ds_read_b64_tr_b16 a[74:75], v4 offset:736
  ds_read_b64_tr_b16 a[96:97], v4 offset:128
  ds_read_b64_tr_b16 a[98:99], v4 offset:768
  ds_read_b64_tr_b16 a[120:121], v4 offset:160
  ds_read_b64_tr_b16 a[122:123], v4 offset:800
  ds_read_b64_tr_b16 a[144:145], v4 offset:192
  ds_read_b64_tr_b16 a[146:147], v4 offset:832
  ds_read_b64_tr_b16 a[168:169], v4 offset:224
  ds_read_b64_tr_b16 a[170:171], v4 offset:864
  ds_read_b64_tr_b16 a[192:193], v4 offset:256
  ds_read_b64_tr_b16 a[194:195], v4 offset:896
  ds_read_b64_tr_b16 a[216:217], v4 offset:288
  ds_read_b64_tr_b16 a[218:219], v4 offset:928
  s_waitcnt vmcnt(10)
  s_waitcnt lgkmcnt(0)
  s_add_u32 s27, s28, 0x1e000
  s_add_u32 m0, s34, 30720
  s_nop 0
  buffer_load_dwordx4 v16, s[8:11], s27 offen offset:0 nt lds
  buffer_load_dwordx4 v17, s[8:11], s27 offen offset:1024 nt lds
  buffer_load_dwordx4 v18, s[8:11], s27 offen offset:2048 nt lds
  buffer_load_dwordx4 v19, s[8:11], s27 offen offset:3072 nt lds
  s_add_u32 m0, s34, 34816
  s_nop 0
  buffer_load_dwordx4 v20, s[8:11], s27 offen offset:0 nt lds
  buffer_load_dwordx4 v21, s[8:11], s27 offen offset:1024 nt lds
  buffer_load_dwordx4 v22, s[8:11], s27 offen offset:2048 nt lds
  buffer_load_dwordx4 v23, s[8:11], s27 offen offset:3072 nt lds
  s_add_u32 m0, s34, 38912
  s_nop 0
  buffer_load_dwordx4 v24, s[8:11], s27 offen offset:0 nt lds
  buffer_load_dwordx4 v25, s[8:11], s27 offen offset:1024 nt lds
  ds_read_b64_tr_b16 a[4:5], v4 offset:10240
  ds_read_b64_tr_b16 a[6:7], v4 offset:10880
  ds_read_b64_tr_b16 a[28:29], v4 offset:10272
  ds_read_b64_tr_b16 a[30:31], v4 offset:10912
  ds_read_b64_tr_b16 a[52:53], v4 offset:10304
  ds_read_b64_tr_b16 a[54:55], v4 offset:10944
  ds_read_b64_tr_b16 a[76:77], v4 offset:10336
  ds_read_b64_tr_b16 a[78:79], v4 offset:10976
  ds_read_b64_tr_b16 a[100:101], v4 offset:10368
  ds_read_b64_tr_b16 a[102:103], v4 offset:11008
  ds_read_b64_tr_b16 a[124:125], v4 offset:10400
  ds_read_b64_tr_b16 a[126:127], v4 offset:11040
  ds_read_b64_tr_b16 a[148:149], v4 offset:10432
  ds_read_b64_tr_b16 a[150:151], v4 offset:11072
  ds_read_b64_tr_b16 a[172:173], v4 offset:10464
  ds_read_b64_tr_b16 a[174:175], v4 offset:11104
  ds_read_b64_tr_b16 a[196:197], v4 offset:10496
  ds_read_b64_tr_b16 a[198:199], v4 offset:11136
  ds_read_b64_tr_b16 a[220:221], v4 offset:10528
  ds_read_b64_tr_b16 a[222:223], v4 offset:11168
  s_waitcnt vmcnt(10)
  s_waitcnt lgkmcnt(0)
  s_add_u32 s27, s28, 0x28000
  s_add_u32 m0, s34, 0
  s_nop 0
  buffer_load_dwordx4 v16, s[8:11], s27 offen offset:0 nt lds
  buffer_load_dwordx4 v17, s[8:11], s27 offen offset:1024 nt lds
  buffer_load_dwordx4 v18, s[8:11], s27 offen offset:2048 nt lds
  buffer_load_dwordx4 v19, s[8:11], s27 offen offset:3072 nt lds
  s_add_u32 m0, s34, 4096
  s_nop 0
  buffer_load_dwordx4 v20, s[8:11], s27 offen offset:0 nt lds
  buffer_load_dwordx4 v21, s[8:11], s27 offen offset:1024 nt lds
  buffer_load_dwordx4 v22, s[8:11], s27 offen offset:2048 nt lds
  buffer_load_dwordx4 v23, s[8:11], s27 offen offset:3072 nt lds
  s_add_u32 m0, s34, 8192
  s_nop 0
  buffer_load_dwordx4 v24, s[8:11], s27 offen offset:0 nt lds
  buffer_load_dwordx4 v25, s[8:11], s27 offen offset:1024 nt lds
  ds_read_b64_tr_b16 a[8:9], v4 offset:20480
  ds_read_b64_tr_b16 a[10:11], v4 offset:21120
  ds_read_b64_tr_b16 a[32:33], v4 offset:20512
  ds_read_b64_tr_b16 a[34:35], v4 offset:21152
  ds_read_b64_tr_b16 a[56:57], v4 offset:20544
  ds_read_b64_tr_b16 a[58:59], v4 offset:21184
  ds_read_b64_tr_b16 a[80:81], v4 offset:20576
  ds_read_b64_tr_b16 a[82:83], v4 offset:21216
  ds_read_b64_tr_b16 a[104:105], v4 offset:20608
  ds_read_b64_tr_b16 a[106:107], v4 offset:21248
  ds_read_b64_tr_b16 a[128:129], v4 offset:20640
  ds_read_b64_tr_b16 a[130:131], v4 offset:21280
  ds_read_b64_tr_b16 a[152:153], v4 offset:20672
  ds_read_b64_tr_b16 a[154:155], v4 offset:21312
  ds_read_b64_tr_b16 a[176:177], v4 offset:20704
  ds_read_b64_tr_b16 a[178:179], v4 offset:21344
  ds_read_b64_tr_b16 a[200:201], v4 offset:20736
  ds_read_b64_tr_b16 a[202:203], v4 offset:21376
  ds_read_b64_tr_b16 a[224:225], v4 offset:20768
  ds_read_b64_tr_b16 a[226:227], v4 offset:21408
  s_waitcnt vmcnt(10)
  s_waitcnt lgkmcnt(0)
  s_add_u32 s27, s28, 0x32000
  s_add_u32 m0, s34, 10240
  s_nop 0
  buffer_load_dwordx4 v16, s[8:11], s27 offen offset:0 nt lds
  buffer_load_dwordx4 v17, s[8:11], s27 offen offset:1024 nt lds
  buffer_load_dwordx4 v18, s[8:11], s27 offen offset:2048 nt lds
  buffer_load_dwordx4 v19, s[8:11], s27 offen offset:3072 nt lds
  s_add_u32 m0, s34, 14336
  s_nop 0
  buffer_load_dwordx4 v20, s[8:11], s27 offen offset:0 nt lds
  buffer_load_dwordx4 v21, s[8:11], s27 offen offset:1024 nt lds
  buffer_load_dwordx4 v22, s[8:11], s27 offen offset:2048 nt lds
  buffer_load_dwordx4 v23, s[8:11], s27 offen offset:3072 nt lds
  s_add_u32 m0, s34, 18432
  s_nop 0
  buffer_load_dwordx4 v24, s[8:11], s27 offen offset:0 nt lds
  buffer_load_dwordx4 v25, s[8:11], s27 offen offset:1024 nt lds
  ds_read_b64_tr_b16 a[12:13], v4 offset:30720
  ds_read_b64_tr_b16 a[14:15], v4 offset:31360
  ds_read_b64_tr_b16 a[36:37], v4 offset:30752
  ds_read_b64_tr_b16 a[38:39], v4 offset:31392
  ds_read_b64_tr_b16 a[60:61], v4 offset:30784
  ds_read_b64_tr_b16 a[62:63], v4 offset:31424
  ds_read_b64_tr_b16 a[84:85], v4 offset:30816
  ds_read_b64_tr_b16 a[86:87], v4 offset:31456
  ds_read_b64_tr_b16 a[108:109], v4 offset:30848
  ds_read_b64_tr_b16 a[110:111], v4 offset:31488
  ds_read_b64_tr_b16 a[132:133], v4 offset:30880
  ds_read_b64_tr_b16 a[134:135], v4 offset:31520
  ds_read_b64_tr_b16 a[156:157], v4 offset:30912
  ds_read_b64_tr_b16 a[158:159], v4 offset:31552
  ds_read_b64_tr_b16 a[180:181], v4 offset:30944
  ds_read_b64_tr_b16 a[182:183], v4 offset:31584
  ds_read_b64_tr_b16 a[204:205], v4 offset:30976
  ds_read_b64_tr_b16 a[206:207], v4 offset:31616
  ds_read_b64_tr_b16 a[228:229], v4 offset:31008
  ds_read_b64_tr_b16 a[230:231], v4 offset:31648
  s_waitcnt vmcnt(10)
  ds_read_b64_tr_b16 a[16:17], v4 offset:0
  ds_read_b64_tr_b16 a[18:19], v4 offset:640
  ds_read_b64_tr_b16 a[40:41], v4 offset:32
  ds_read_b64_tr_b16 a[42:43], v4 offset:672
  ds_read_b64_tr_b16 a[64:65], v4 offset:64
  ds_read_b64_tr_b16 a[66:67], v4 offset:704
  ds_read_b64_tr_b16 a[88:89], v4 offset:96
  ds_read_b64_tr_b16 a[90:91], v4 offset:736
  ds_read_b64_tr_b16 a[112:113], v4 offset:128
  ds_read_b64_tr_b16 a[114:115], v4 offset:768
  ds_read_b64_tr_b16 a[136:137], v4 offset:160
  ds_read_b64_tr_b16 a[138:139], v4 offset:800
  ds_read_b64_tr_b16 a[160:161], v4 offset:192
  ds_read_b64_tr_b16 a[162:163], v4 offset:832
  ds_read_b64_tr_b16 a[184:185], v4 offset:224
  ds_read_b64_tr_b16 a[186:187], v4 offset:864
  ds_read_b64_tr_b16 a[208:209], v4 offset:256
  ds_read_b64_tr_b16 a[210:211], v4 offset:896
  ds_read_b64_tr_b16 a[232:233], v4 offset:288
  ds_read_b64_tr_b16 a[234:235], v4 offset:928
  s_waitcnt vmcnt(0)
  ds_read_b64_tr_b16 a[20:21], v4 offset:10240
  ds_read_b64_tr_b16 a[22:23], v4 offset:10880
  ds_read_b64_tr_b16 a[44:45], v4 offset:10272
  ds_read_b64_tr_b16 a[46:47], v4 offset:10912
  ds_read_b64_tr_b16 a[68:69], v4 offset:10304
  ds_read_b64_tr_b16 a[70:71], v4 offset:10944
  ds_read_b64_tr_b16 a[92:93], v4 offset:10336
  ds_read_b64_tr_b16 a[94:95], v4 offset:10976
  ds_read_b64_tr_b16 a[116:117], v4 offset:10368
  ds_read_b64_tr_b16 a[118:119], v4 offset:11008
  ds_read_b64_tr_b16 a[140:141], v4 offset:10400
  ds_read_b64_tr_b16 a[142:143], v4 offset:11040
  ds_read_b64_tr_b16 a[164:165], v4 offset:10432
  ds_read_b64_tr_b16 a[166:167], v4 offset:11072
  ds_read_b64_tr_b16 a[188:189], v4 offset:10464
  ds_read_b64_tr_b16 a[190:191], v4 offset:11104
  ds_read_b64_tr_b16 a[212:213], v4 offset:10496
  ds_read_b64_tr_b16 a[214:215], v4 offset:11136
  ds_read_b64_tr_b16 a[236:237], v4 offset:10528
  ds_read_b64_tr_b16 a[238:239], v4 offset:11168
  s_waitcnt vmcnt(0) lgkmcnt(0)
  v_and_b32 v2, 3, v1
  v_lshlrev_b32 v2, 2, v2
Lcw_72:
  s_add_u32 s24, s24, 1
  s_cmp_gt_u32 s24, 300000
  s_cbranch_scc1 Lfail_71
  buffer_load_dword v3, v2, s[12:15], 0 offen offset:128 sc1
  s_waitcnt vmcnt(0)
  v_cmp_eq_u32 vcc, 0, v3
  s_and_b32 s26, vcc_lo, 4
  s_cmp_eq_u32 s26, 0
  s_cbranch_scc1 Lcok_73
  s_sleep 6
  s_branch Lcw_72
Lcok_73:
  v_readlane_b32 s23, v3, 3
  s_and_b32 s23, s23, 0x2000
  v_lshlrev_b32 v5, 4, v1
  v_mov_b32 v8, 0
  v_min_u32 v2, 2, v1
  v_lshlrev_b32 v9, 2, v2
  s_mul_i32 s29, s20, 12
  s_add_u32 s29, s29, 0x800
  s_lshl_b32 s33, s21, 7
  s_lshl_b32 s26, s20, 2
  s_add_u32 s33, s33, s26
  s_add_u32 s33, s33, 0xc00
  s_mul_i32 s30, s20, 12288
  s_add_u32 s30, s30, 0x3600000
  s_mul_i32 s31, s21, 327680
  s_lshl_b32 s26, s20, 10
  s_add_u32 s31, s31, s26
  s_add_u32 s31, s31, 0x4e00000
  s_mov_b32 s22, 0
  s_mov_b32 s25, 0
  s_lshl_b32 s29, s29, 5
  s_add_u32 s29, s29, 0x200000
  s_lshl_b32 s33, s33, 5
  s_add_u32 s33, s33, 0x200000
  v_lshlrev_b32 v9, 5, v9
  v_mov_b32 v11, 0
Lul_75:
  s_cmp_eq_u32 s25, 1
  s_cbranch_scc1 Lpre_79
  s_add_u32 s38, s22, 1
  s_waitcnt vmcnt(2)
  v_cmp_gt_u32 vcc, s38, v11
  s_cbranch_vccnz Lun2_80
  s_add_u32 s26, s22, 0
  s_mul_i32 s42, s26, 393216
  s_add_u32 s42, s42, s30
  buffer_load_dwordx4 v[32:35], v5, s[4:7], s42 offen offset:0 sc1
  buffer_load_dwordx4 v[36:39], v5, s[4:7], s42 offen offset:1024 sc1
  buffer_load_dwordx4 v[40:43], v5, s[4:7], s42 offen offset:2048 sc1
  buffer_load_dwordx4 v[44:47], v5, s[4:7], s42 offen offset:3072 sc1
  s_add_u32 s42, s42, 4096
  buffer_load_dwordx4 v[48:51], v5, s[4:7], s42 offen offset:0 sc1
  buffer_load_dwordx4 v[52:55], v5, s[4:7], s42 offen offset:1024 sc1
  buffer_load_dwordx4 v[56:59], v5, s[4:7], s42 offen offset:2048 sc1
  buffer_load_dwordx4 v[60:63], v5, s[4:7], s42 offen offset:3072 sc1
  s_add_u32 s42, s42, 4096
  buffer_load_dwordx4 v[64:67], v5, s[4:7], s42 offen offset:0 sc1
  buffer_load_dwordx4 v[68:71], v5, s[4:7], s42 offen offset:1024 sc1
  buffer_load_dwordx4 v[72:75], v5, s[4:7], s42 offen offset:2048 sc1
  buffer_load_dwordx4 v[76:79], v5, s[4:7], s42 offen offset:3072 sc1
  s_waitcnt vmcnt(12)
  s_mov_b32 s26, s22
  v_mov_b32 v2, s26
  s_mov_b64 exec, 1
  buffer_store_dword v2, v8, s[4:7], s33 offen sc1
  s_mov_b64 exec, -1
  s_waitcnt vmcnt(1)
  s_branch Lhave_78
Lun2_80:
  s_waitcnt vmcnt(0)
  s_mov_b32 s26, s22
  v_mov_b32 v2, s26
  s_mov_b64 exec, 1
  buffer_store_dword v2, v8, s[4:7], s33 offen sc1
  s_mov_b64 exec, -1
  s_cmp_ge_u32 s22, 64
  s_cbranch_scc1 Lufin_76
Lsp_77:
  s_add_u32 s24, s24, 1
  s_cmp_gt_u32 s24, 300000
  s_cbranch_scc1 Lfail_74
  buffer_load_dword v10, v9, s[4:7], s29 offen sc1
  s_waitcnt vmcnt(0)
  v_cmp_gt_u32 vcc, s38, v10
  s_cbranch_vccz Lrok_81
  s_sleep 2
  s_branch Lsp_77
Lrok_81:
  s_add_u32 s26, s22, 0
  s_mul_i32 s42, s26, 393216
  s_add_u32 s42, s42, s30
  buffer_load_dwordx4 v[32:35], v5, s[4:7], s42 offen offset:0 sc1
  buffer_load_dwordx4 v[36:39], v5, s[4:7], s42 offen offset:1024 sc1
  buffer_load_dwordx4 v[40:43], v5, s[4:7], s42 offen offset:2048 sc1
  buffer_load_dwordx4 v[44:47], v5, s[4:7], s42 offen offset:3072 sc1
  s_add_u32 s42, s42, 4096
  buffer_load_dwordx4 v[48:51], v5, s[4:7], s42 offen offset:0 sc1
  buffer_load_dwordx4 v[52:55], v5, s[4:7], s42 offen offset:1024 sc1
  buffer_load_dwordx4 v[56:59], v5, s[4:7], s42 offen offset:2048 sc1
  buffer_load_dwordx4 v[60:63], v5, s[4:7], s42 offen offset:3072 sc1
  s_add_u32 s42, s42, 4096
  buffer_load_dwordx4 v[64:67], v5, s[4:7], s42 offen offset:0 sc1
  buffer_load_dwordx4 v[68:71], v5, s[4:7], s42 offen offset:1024 sc1
  buffer_load_dwordx4 v[72:75], v5, s[4:7], s42 offen offset:2048 sc1
  buffer_load_dwordx4 v[76:79], v5, s[4:7], s42 offen offset:3072 sc1
  s_waitcnt vmcnt(0)
  s_branch Lhave_78
Lpre_79:
  s_waitcnt vmcnt(4)
Lhave_78:
  buffer_load_dword v10, v9, s[4:7], s29 offen sc1
  s_mul_i32 s40, s22, 1310720
  s_add_u32 s40, s40, s31
  s_add_u32 s39, s22, 2
  v_mfma_f32_16x16x32_bf16 v[128:131], v[32:35], a[0:3], 0
  v_mfma_f32_16x16x32_bf16 v[132:135], v[36:39], a[0:3], 0
  v_mfma_f32_16x16x32_bf16 v[128:131], v[40:43], a[4:7], v[128:131]
  v_mfma_f32_16x16x32_bf16 v[132:135], v[44:47], a[4:7], v[132:135]
  v_mfma_f32_16x16x32_bf16 v[128:131], v[48:51], a[8:11], v[128:131]
  v_mfma_f32_16x16x32_bf16 v[132:135], v[52:55], a[8:11], v[132:135]
  v_mfma_f32_16x16x32_bf16 v[128:131], v[56:59], a[12:15], v[128:131]
  v_mfma_f32_16x16x32_bf16 v[132:135], v[60:63], a[12:15], v[132:135]
  v_mfma_f32_16x16x32_bf16 v[128:131], v[64:67], a[16:19], v[128:131]
  v_mfma_f32_16x16x32_bf16 v[132:135], v[68:71], a[16:19], v[132:135]
  v_mfma_f32_16x16x32_bf16 v[128:131], v[72:75], a[20:23], v[128:131]
  v_mfma_f32_16x16x32_bf16 v[132:135], v[76:79], a[20:23], v[132:135]
  v_mfma_f32_16x16x32_bf16 v[136:139], v[32:35], a[24:27], 0
  v_mfma_f32_16x16x32_bf16 v[140:143], v[36:39], a[24:27], 0
  v_mfma_f32_16x16x32_bf16 v[136:139], v[40:43], a[28:31], v[136:139]
  v_mfma_f32_16x16x32_bf16 v[140:143], v[44:47], a[28:31], v[140:143]
  v_mfma_f32_16x16x32_bf16 v[136:139], v[48:51], a[32:35], v[136:139]
  v_mfma_f32_16x16x32_bf16 v[140:143], v[52:55], a[32:35], v[140:143]
  v_mfma_f32_16x16x32_bf16 v[136:139], v[56:59], a[36:39], v[136:139]
  v_mfma_f32_16x16x32_bf16 v[140:143], v[60:63], a[36:39], v[140:143]
  v_mfma_f32_16x16x32_bf16 v[136:139], v[64:67], a[40:43], v[136:139]
  v_cvt_pk_bf16_f32 v144, v128, v132
  v_cvt_pk_bf16_f32 v145, v129, v133
  v_mfma_f32_16x16x32_bf16 v[140:143], v[68:71], a[40:43], v[140:143]
  v_cvt_pk_bf16_f32 v146, v130, v134
  v_cvt_pk_bf16_f32 v147, v131, v135
  v_mfma_f32_16x16x32_bf16 v[136:139], v[72:75], a[44:47], v[136:139]
  buffer_store_dwordx4 v[144:147], v5, s[4:7], s40 offen sc1
  s_add_u32 s40, s40, 32768
  v_mfma_f32_16x16x32_bf16 v[140:143], v[76:79], a[44:47], v[140:143]
  v_mfma_f32_16x16x32_bf16 v[128:131], v[32:35], a[48:51], 0
  v_mfma_f32_16x16x32_bf16 v[132:135], v[36:39], a[48:51], 0
  v_mfma_f32_16x16x32_bf16 v[128:131], v[40:43], a[52:55], v[128:131]
  v_mfma_f32_16x16x32_bf16 v[132:135], v[44:47], a[52:55], v[132:135]
  v_mfma_f32_16x16x32_bf16 v[128:131], v[48:51], a[56:59], v[128:131]
  v_mfma_f32_16x16x32_bf16 v[132:135], v[52:55], a[56:59], v[132:135]
  v_mfma_f32_16x16x32_bf16 v[128:131], v[56:59], a[60:63], v[128:131]
  v_mfma_f32_16x16x32_bf16 v[132:135], v[60:63], a[60:63], v[132:135]
  v_mfma_f32_16x16x32_bf16 v[128:131], v[64:67], a[64:67], v[128:131]
  v_cvt_pk_bf16_f32 v148, v136, v140
  v_cvt_pk_bf16_f32 v149, v137, v141
  v_mfma_f32_16x16x32_bf16 v[132:135], v[68:71], a[64:67], v[132:135]
  v_cvt_pk_bf16_f32 v150, v138, v142
  v_cvt_pk_bf16_f32 v151, v139, v143
  v_mfma_f32_16x16x32_bf16 v[128:131], v[72:75], a[68:71], v[128:131]
  buffer_store_dwordx4 v[148:151], v5, s[4:7], s40 offen sc1
  s_add_u32 s40, s40, 32768
  v_mfma_f32_16x16x32_bf16 v[132:135], v[76:79], a[68:71], v[132:135]
  s_waitcnt vmcnt(2)
  s_mov_b32 s26, s22
  v_mov_b32 v2, s26
  s_mov_b64 exec, 1
  buffer_store_dword v2, v8, s[4:7], s33 offen sc1
  s_mov_b64 exec, -1
  s_add_u32 s26, s22, 1
  s_mul_i32 s42, s26, 393216
  s_add_u32 s42, s42, s30
  v_cmp_gt_u32 vcc, s39, v10
  s_cmp_eq_u64 vcc, 0
  s_cselect_b32 s25, 1, 0
  s_cselect_b32 s42, s42, 0x7ff00000
  v_mfma_f32_16x16x32_bf16 v[136:139], v[32:35], a[72:75], 0
  v_mfma_f32_16x16x32_bf16 v[140:143], v[36:39], a[72:75], 0
  buffer_load_dwordx4 v[80:83], v5, s[4:7], s42 offen offset:0 sc1
  v_mfma_f32_16x16x32_bf16 v[136:139], v[40:43], a[76:79], v[136:139]
  v_mfma_f32_16x16x32_bf16 v[140:143], v[44:47], a[76:79], v[140:143]
  v_mfma_f32_16x16x32_bf16 v[136:139], v[48:51], a[80:83], v[136:139]
  v_mfma_f32_16x16x32_bf16 v[140:143], v[52:55], a[80:83], v[140:143]
  buffer_load_dwordx4 v[84:87], v5, s[4:7], s42 offen offset:1024 sc1
  v_mfma_f32_16x16x32_bf16 v[136:139], v[56:59], a[84:87], v[136:139]
  v_mfma_f32_16x16x32_bf16 v[140:143], v[60:63], a[84:87], v[140:143]
  v_mfma_f32_16x16x32_bf16 v[136:139], v[64:67], a[88:91], v[136:139]
  v_cvt_pk_bf16_f32 v144, v128, v132
  v_cvt_pk_bf16_f32 v145, v129, v133
  v_mfma_f32_16x16x32_bf16 v[140:143], v[68:71], a[88:91], v[140:143]
  v_cvt_pk_bf16_f32 v146, v130, v134
  v_cvt_pk_bf16_f32 v147, v131, v135
  v_mfma_f32_16x16x32_bf16 v[136:139], v[72:75], a[92:95], v[136:139]
  buffer_store_dwordx4 v[144:147], v5, s[4:7], s40 offen sc1
  s_add_u32 s40, s40, 32768
  v_mfma_f32_16x16x32_bf16 v[140:143], v[76:79], a[92:95], v[140:143]
  v_mfma_f32_16x16x32_bf16 v[128:131], v[32:35], a[96:99], 0
  v_mfma_f32_16x16x32_bf16 v[132:135], v[36:39], a[96:99], 0
  buffer_load_dwordx4 v[88:91], v5, s[4:7], s42 offen offset:2048 sc1
  v_mfma_f32_16x16x32_bf16 v[128:131], v[40:43], a[100:103], v[128:131]
  v_mfma_f32_16x16x32_bf16 v[132:135], v[44:47], a[100:103], v[132:135]
  v_mfma_f32_16x16x32_bf16 v[128:131], v[48:51], a[104:107], v[128:131]
  v_mfma_f32_16x16x32_bf16 v[132:135], v[52:55], a[104:107], v[132:135]
  buffer_load_dwordx4 v[92:95], v5, s[4:7], s42 offen offset:3072 sc1
  v_mfma_f32_16x16x32_bf16 v[128:131], v[56:59], a[108:111], v[128:131]
  v_mfma_f32_16x16x32_bf16 v[132:135], v[60:63], a[108:111], v[132:135]
  v_mfma_f32_16x16x32_bf16 v[128:131], v[64:67], a[112:115], v[128:131]
  v_cvt_pk_bf16_f32 v148, v136, v140
  v_cvt_pk_bf16_f32 v149, v137, v141
  v_mfma_f32_16x16x32_bf16 v[132:135], v[68:71], a[112:115], v[132:135]
  v_cvt_pk_bf16_f32 v150, v138, v142
  v_cvt_pk_bf16_f32 v151, v139, v143
  v_mfma_f32_16x16x32_bf16 v[128:131], v[72:75], a[116:119], v[128:131]
  buffer_store_dwordx4 v[148:151], v5, s[4:7], s40 offen sc1
  s_add_u32 s40, s40, 32768
  v_mfma_f32_16x16x32_bf16 v[132:135], v[76:79], a[116:119], v[132:135]
  v_mfma_f32_16x16x32_bf16 v[136:139], v[32:35], a[120:123], 0
  v_mfma_f32_16x16x32_bf16 v[140:143], v[36:39], a[120:123], 0
  s_add_u32 s42, s42, 4096
  buffer_load_dwordx4 v[96:99], v5, s[4:7], s42 offen offset:0 sc1
  v_mfma_f32_16x16x32_bf16 v[136:139], v[40:43], a[124:127], v[136:139]
  v_mfma_f32_16x16x32_bf16 v[140:143], v[44:47], a[124:127], v[140:143]
  v_mfma_f32_16x16x32_bf16 v[136:139], v[48:51], a[128:131], v[136:139]
  v_mfma_f32_16x16x32_bf16 v[140:143], v[52:55], a[128:131], v[140:143]
  buffer_load_dwordx4 v[100:103], v5, s[4:7], s42 offen offset:1024 sc1
  v_mfma_f32_16x16x32_bf16 v[136:139], v[56:59], a[132:135], v[136:139]
  v_mfma_f32_16x16x32_bf16 v[140:143], v[60:63], a[132:135], v[140:143]
  v_mfma_f32_16x16x32_bf16 v[136:139], v[64:67], a[136:139], v[136:139]
  v_cvt_pk_bf16_f32 v144, v128, v132
  v_cvt_pk_bf16_f32 v145, v129, v133
  v_mfma_f32_16x16x32_bf16 v[140:143], v[68:71], a[136:139], v[140:143]
  v_cvt_pk_bf16_f32 v146, v130, v134
  v_cvt_pk_bf16_f32 v147, v131, v135
  v_mfma_f32_16x16x32_bf16 v[136:139], v[72:75], a[140:143], v[136:139]
  buffer_store_dwordx4 v[144:147], v5, s[4:7], s40 offen sc1
  s_add_u32 s40, s40, 32768
  v_mfma_f32_16x16x32_bf16 v[140:143], v[76:79], a[140:143], v[140:143]
  v_mfma_f32_16x16x32_bf16 v[128:131], v[32:35], a[144:147], 0
  v_mfma_f32_16x16x32_bf16 v[132:135], v[36:39], a[144:147], 0
  buffer_load_dwordx4 v[104:107], v5, s[4:7], s42 offen offset:2048 sc1
  v_mfma_f32_16x16x32_bf16 v[128:131], v[40:43], a[148:151], v[128:131]
  v_mfma_f32_16x16x32_bf16 v[132:135], v[44:47], a[148:151], v[132:135]
  v_mfma_f32_16x16x32_bf16 v[128:131], v[48:51], a[152:155], v[128:131]
  v_mfma_f32_16x16x32_bf16 v[132:135], v[52:55], a[152:155], v[132:135]
  buffer_load_dwordx4 v[108:111], v5, s[4:7], s42 offen offset:3072 sc1
  v_mfma_f32_16x16x32_bf16 v[128:131], v[56:59], a[156:159], v[128:131]
  v_mfma_f32_16x16x32_bf16 v[132:135], v[60:63], a[156:159], v[132:135]
  v_mfma_f32_16x16x32_bf16 v[128:131], v[64:67], a[160:163], v[128:131]
  v_cvt_pk_bf16_f32 v148, v136, v140
  v_cvt_pk_bf16_f32 v149, v137, v141
  v_mfma_f32_16x16x32_bf16 v[132:135], v[68:71], a[160:163], v[132:135]
  v_cvt_pk_bf16_f32 v150, v138, v142
  v_cvt_pk_bf16_f32 v151, v139, v143
  v_mfma_f32_16x16x32_bf16 v[128:131], v[72:75], a[164:167], v[128:131]
  buffer_store_dwordx4 v[148:151], v5, s[4:7], s40 offen sc1
  s_add_u32 s40, s40, 32768
  v_mfma_f32_16x16x32_bf16 v[132:135], v[76:79], a[164:167], v[132:135]
  v_mfma_f32_16x16x32_bf16 v[136:139], v[32:35], a[168:171], 0
  v_mfma_f32_16x16x32_bf16 v[140:143], v[36:39], a[168:171], 0
  s_add_u32 s42, s42, 4096
  buffer_load_dwordx4 v[112:115], v5, s[4:7], s42 offen offset:0 sc1
  v_mfma_f32_16x16x32_bf16 v[136:139], v[40:43], a[172:175], v[136:139]
  v_mfma_f32_16x16x32_bf16 v[140:143], v[44:47], a[172:175], v[140:143]
  v_mfma_f32_16x16x32_bf16 v[136:139], v[48:51], a[176:179], v[136:139]
  v_mfma_f32_16x16x32_bf16 v[140:143], v[52:55], a[176:179], v[140:143]
  buffer_load_dwordx4 v[116:119], v5, s[4:7], s42 offen offset:1024 sc1
  v_mfma_f32_16x16x32_bf16 v[136:139], v[56:59], a[180:183], v[136:139]
  v_mfma_f32_16x16x32_bf16 v[140:143], v[60:63], a[180:183], v[140:143]
  v_mfma_f32_16x16x32_bf16 v[136:139], v[64:67], a[184:187], v[136:139]
  v_cvt_pk_bf16_f32 v144, v128, v132
  v_cvt_pk_bf16_f32 v145, v129, v133
  v_mfma_f32_16x16x32_bf16 v[140:143], v[68:71], a[184:187], v[140:143]
  v_cvt_pk_bf16_f32 v146, v130, v134
  v_cvt_pk_bf16_f32 v147, v131, v135
  v_mfma_f32_16x16x32_bf16 v[136:139], v[72:75], a[188:191], v[136:139]
  buffer_store_dwordx4 v[144:147], v5, s[4:7], s40 offen sc1
  s_add_u32 s40, s40, 32768
  v_mfma_f32_16x16x32_bf16 v[140:143], v[76:79], a[188:191], v[140:143]
  v_mfma_f32_16x16x32_bf16 v[128:131], v[32:35], a[192:195], 0
  v_mfma_f32_16x16x32_bf16 v[132:135], v[36:39], a[192:195], 0
  buffer_load_dwordx4 v[120:123], v5, s[4:7], s42 offen offset:2048 sc1
  v_mfma_f32_16x16x32_bf16 v[128:131], v[40:43], a[196:199], v[128:131]
  v_mfma_f32_16x16x32_bf16 v[132:135], v[44:47], a[196:199], v[132:135]
  v_mfma_f32_16x16x32_bf16 v[128:131], v[48:51], a[200:203], v[128:131]
  v_mfma_f32_16x16x32_bf16 v[132:135], v[52:55], a[200:203], v[132:135]
  buffer_load_dwordx4 v[124:127], v5, s[4:7], s42 offen offset:3072 sc1
  v_mfma_f32_16x16x32_bf16 v[128:131], v[56:59], a[204:207], v[128:131]
  v_mfma_f32_16x16x32_bf16 v[132:135], v[60:63], a[204:207], v[132:135]
  v_mfma_f32_16x16x32_bf16 v[128:131], v[64:67], a[208:211], v[128:131]
  v_cvt_pk_bf16_f32 v148, v136, v140
  v_cvt_pk_bf16_f32 v149, v137, v141
  v_mfma_f32_16x16x32_bf16 v[132:135], v[68:71], a[208:211], v[132:135]
  v_cvt_pk_bf16_f32 v150, v138, v142
  v_cvt_pk_bf16_f32 v151, v139, v143
  v_mfma_f32_16x16x32_bf16 v[128:131], v[72:75], a[212:215], v[128:131]
  buffer_store_dwordx4 v[148:151], v5, s[4:7], s40 offen sc1
  s_add_u32 s40, s40, 32768
  v_mfma_f32_16x16x32_bf16 v[132:135], v[76:79], a[212:215], v[132:135]
  buffer_load_dword v11, v9, s[4:7], s29 offen sc1
  v_mfma_f32_16x16x32_bf16 v[136:139], v[32:35], a[216:219], 0
  v_mfma_f32_16x16x32_bf16 v[140:143], v[36:39], a[216:219], 0
  v_mfma_f32_16x16x32_bf16 v[136:139], v[40:43], a[220:223], v[136:139]
  v_mfma_f32_16x16x32_bf16 v[140:143], v[44:47], a[220:223], v[140:143]
  v_mfma_f32_16x16x32_bf16 v[136:139], v[48:51], a[224:227], v[136:139]
  v_mfma_f32_16x16x32_bf16 v[140:143], v[52:55], a[224:227], v[140:143]
  v_mfma_f32_16x16x32_bf16 v[136:139], v[56:59], a[228:231], v[136:139]
  v_mfma_f32_16x16x32_bf16 v[140:143], v[60:63], a[228:231], v[140:143]
  v_mfma_f32_16x16x32_bf16 v[136:139], v[64:67], a[232:235], v[136:139]
  v_cvt_pk_bf16_f32 v144, v128, v132
  v_cvt_pk_bf16_f32 v145, v129, v133
  v_mfma_f32_16x16x32_bf16 v[140:143], v[68:71], a[232:235], v[140:143]
  v_cvt_pk_bf16_f32 v146, v130, v134
  v_cvt_pk_bf16_f32 v147, v131, v135
  v_mfma_f32_16x16x32_bf16 v[136:139], v[72:75], a[236:239], v[136:139]
  buffer_store_dwordx4 v[144:147], v5, s[4:7], s40 offen sc1
  s_add_u32 s40, s40, 32768
  v_mfma_f32_16x16x32_bf16 v[140:143], v[76:79], a[236:239], v[140:143]
  s_nop 7
  v_cvt_pk_bf16_f32 v148, v136, v140
  v_cvt_pk_bf16_f32 v149, v137, v141
  v_cvt_pk_bf16_f32 v150, v138, v142
  v_cvt_pk_bf16_f32 v151, v139, v143
  buffer_store_dwordx4 v[148:151], v5, s[4:7], s40 offen sc1
  s_add_u32 s40, s40, 32768
  s_add_u32 s22, s22, 1
  s_cmp_eq_u32 s25, 1
  s_cbranch_scc1 Lpre_84
  s_add_u32 s38, s22, 1
  s_waitcnt vmcnt(2)
  v_cmp_gt_u32 vcc, s38, v11
  s_cbranch_vccnz Lun2_85
  s_add_u32 s26, s22, 0
  s_mul_i32 s42, s26, 393216
  s_add_u32 s42, s42, s30
  buffer_load_dwordx4 v[80:83], v5, s[4:7], s42 offen offset:0 sc1
  buffer_load_dwordx4 v[84:87], v5, s[4:7], s42 offen offset:1024 sc1
  buffer_load_dwordx4 v[88:91], v5, s[4:7], s42 offen offset:2048 sc1
  buffer_load_dwordx4 v[92:95], v5, s[4:7], s42 offen offset:3072 sc1
  s_add_u32 s42, s42, 4096
  buffer_load_dwordx4 v[96:99], v5, s[4:7], s42 offen offset:0 sc1
  buffer_load_dwordx4 v[100:103], v5, s[4:7], s42 offen offset:1024 sc1
  buffer_load_dwordx4 v[104:107], v5, s[4:7], s42 offen offset:2048 sc1
  buffer_load_dwordx4 v[108:111], v5, s[4:7], s42 offen offset:3072 sc1
  s_add_u32 s42, s42, 4096
  buffer_load_dwordx4 v[112:115], v5, s[4:7], s42 offen offset:0 sc1
  buffer_load_dwordx4 v[116:119], v5, s[4:7], s42 offen offset:1024 sc1
  buffer_load_dwordx4 v[120:123], v5, s[4:7], s42 offen offset:2048 sc1
  buffer_load_dwordx4 v[124:127], v5, s[4:7], s42 offen offset:3072 sc1
  s_waitcnt vmcnt(12)
  s_mov_b32 s26, s22
  v_mov_b32 v2, s26
  s_mov_b64 exec, 1
  buffer_store_dword v2, v8, s[4:7], s33 offen sc1
  s_mov_b64 exec, -1
  s_waitcnt vmcnt(1)
  s_branch Lhave_83
Lun2_85:
  s_waitcnt vmcnt(0)
  s_mov_b32 s26, s22
  v_mov_b32 v2, s26
  s_mov_b64 exec, 1
  buffer_store_dword v2, v8, s[4:7], s33 offen sc1
  s_mov_b64 exec, -1
  s_cmp_ge_u32 s22, 64
  s_cbranch_scc1 Lufin_76
Lsp_82:
  s_add_u32 s24, s24, 1
  s_cmp_gt_u32 s24, 300000
  s_cbranch_scc1 Lfail_74
  buffer_load_dword v10, v9, s[4:7], s29 offen sc1
  s_waitcnt vmcnt(0)
  v_cmp_gt_u32 vcc, s38, v10
  s_cbranch_vccz Lrok_86
  s_sleep 2
  s_branch Lsp_82
Lrok_86:
  s_add_u32 s26, s22, 0
  s_mul_i32 s42, s26, 393216
  s_add_u32 s42, s42, s30
  buffer_load_dwordx4 v[80:83], v5, s[4:7], s42 offen offset:0 sc1
  buffer_load_dwordx4 v[84:87], v5, s[4:7], s42 offen offset:1024 sc1
  buffer_load_dwordx4 v[88:91], v5, s[4:7], s42 offen offset:2048 sc1
  buffer_load_dwordx4 v[92:95], v5, s[4:7], s42 offen offset:3072 sc1
  s_add_u32 s42, s42, 4096
  buffer_load_dwordx4 v[96:99], v5, s[4:7], s42 offen offset:0 sc1
  buffer_load_dwordx4 v[100:103], v5, s[4:7], s42 offen offset:1024 sc1
  buffer_load_dwordx4 v[104:107], v5, s[4:7], s42 offen offset:2048 sc1
  buffer_load_dwordx4 v[108:111], v5, s[4:7], s42 offen offset:3072 sc1
  s_add_u32 s42, s42, 4096
  buffer_load_dwordx4 v[112:115], v5, s[4:7], s42 offen offset:0 sc1
  buffer_load_dwordx4 v[116:119], v5, s[4:7], s42 offen offset:1024 sc1
  buffer_load_dwordx4 v[120:123], v5, s[4:7], s42 offen offset:2048 sc1
  buffer_load_dwordx4 v[124:127], v5, s[4:7], s42 offen offset:3072 sc1
  s_waitcnt vmcnt(0)
  s_branch Lhave_83
Lpre_84:
  s_waitcnt vmcnt(4)
Lhave_83:
  buffer_load_dword v10, v9, s[4:7], s29 offen sc1
  s_mul_i32 s40, s22, 1310720
  s_add_u32 s40, s40, s31
  s_add_u32 s39, s22, 2
  v_mfma_f32_16x16x32_bf16 v[128:131], v[80:83], a[0:3], 0
  v_mfma_f32_16x16x32_bf16 v[132:135], v[84:87], a[0:3], 0
  v_mfma_f32_16x16x32_bf16 v[128:131], v[88:91], a[4:7], v[128:131]
  v_mfma_f32_16x16x32_bf16 v[132:135], v[92:95], a[4:7], v[132:135]
  v_mfma_f32_16x16x32_bf16 v[128:131], v[96:99], a[8:11], v[128:131]
  v_mfma_f32_16x16x32_bf16 v[132:135], v[100:103], a[8:11], v[132:135]
  v_mfma_f32_16x16x32_bf16 v[128:131], v[104:107], a[12:15], v[128:131]
  v_mfma_f32_16x16x32_bf16 v[132:135], v[108:111], a[12:15], v[132:135]
  v_mfma_f32_16x16x32_bf16 v[128:131], v[112:115], a[16:19], v[128:131]
  v_mfma_f32_16x16x32_bf16 v[132:135], v[116:119], a[16:19], v[132:135]
  v_mfma_f32_16x16x32_bf16 v[128:131], v[120:123], a[20:23], v[128:131]
  v_mfma_f32_16x16x32_bf16 v[132:135], v[124:127], a[20:23], v[132:135]
  v_mfma_f32_16x16x32_bf16 v[136:139], v[80:83], a[24:27], 0
  v_mfma_f32_16x16x32_bf16 v[140:143], v[84:87], a[24:27], 0
  v_mfma_f32_16x16x32_bf16 v[136:139], v[88:91], a[28:31], v[136:139]
  v_mfma_f32_16x16x32_bf16 v[140:143], v[92:95], a[28:31], v[140:143]
  v_mfma_f32_16x16x32_bf16 v[136:139], v[96:99], a[32:35], v[136:139]
  v_mfma_f32_16x16x32_bf16 v[140:143], v[100:103], a[32:35], v[140:143]
  v_mfma_f32_16x16x32_bf16 v[136:139], v[104:107], a[36:39], v[136:139]
  v_mfma_f32_16x16x32_bf16 v[140:143], v[108:111], a[36:39], v[140:143]
  v_mfma_f32_16x16x32_bf16 v[136:139], v[112:115], a[40:43], v[136:139]
  v_cvt_pk_bf16_f32 v144, v128, v132
  v_cvt_pk_bf16_f32 v145, v129, v133
  v_mfma_f32_16x16x32_bf16 v[140:143], v[116:119], a[40:43], v[140:143]
  v_cvt_pk_bf16_f32 v146, v130, v134
  v_cvt_pk_bf16_f32 v147, v131, v135
  v_mfma_f32_16x16x32_bf16 v[136:139], v[120:123], a[44:47], v[136:139]
  buffer_store_dwordx4 v[144:147], v5, s[4:7], s40 offen sc1
  s_add_u32 s40, s40, 32768
  v_mfma_f32_16x16x32_bf16 v[140:143], v[124:127], a[44:47], v[140:143]
  v_mfma_f32_16x16x32_bf16 v[128:131], v[80:83], a[48:51], 0
  v_mfma_f32_16x16x32_bf16 v[132:135], v[84:87], a[48:51], 0
  v_mfma_f32_16x16x32_bf16 v[128:131], v[88:91], a[52:55], v[128:131]
  v_mfma_f32_16x16x32_bf16 v[132:135], v[92:95], a[52:55], v[132:135]
  v_mfma_f32_16x16x32_bf16 v[128:131], v[96:99], a[56:59], v[128:131]
  v_mfma_f32_16x16x32_bf16 v[132:135], v[100:103], a[56:59], v[132:135]
  v_mfma_f32_16x16x32_bf16 v[128:131], v[104:107], a[60:63], v[128:131]
  v_mfma_f32_16x16x32_bf16 v[132:135], v[108:111], a[60:63], v[132:135]
  v_mfma_f32_16x16x32_bf16 v[128:131], v[112:115], a[64:67], v[128:131]
  v_cvt_pk_bf16_f32 v148, v136, v140
  v_cvt_pk_bf16_f32 v149, v137, v141
  v_mfma_f32_16x16x32_bf16 v[132:135], v[116:119], a[64:67], v[132:135]
  v_cvt_pk_bf16_f32 v150, v138, v142
  v_cvt_pk_bf16_f32 v151, v139, v143
  v_mfma_f32_16x16x32_bf16 v[128:131], v[120:123], a[68:71], v[128:131]
  buffer_store_dwordx4 v[148:151], v5, s[4:7], s40 offen sc1
  s_add_u32 s40, s40, 32768
  v_mfma_f32_16x16x32_bf16 v[132:135], v[124:127], a[68:71], v[132:135]
  s_waitcnt vmcnt(2)
  s_mov_b32 s26, s22
  v_mov_b32 v2, s26
  s_mov_b64 exec, 1
  buffer_store_dword v2, v8, s[4:7], s33 offen sc1
  s_mov_b64 exec, -1
  s_add_u32 s26, s22, 1
  s_mul_i32 s42, s26, 393216
  s_add_u32 s42, s42, s30
  v_cmp_gt_u32 vcc, s39, v10
  s_cmp_eq_u64 vcc, 0
  s_cselect_b32 s25, 1, 0
  s_cselect_b32 s42, s42, 0x7ff00000
  v_mfma_f32_16x16x32_bf16 v[136:139], v[80:83], a[72:75], 0
  v_mfma_f32_16x16x32_bf16 v[140:143], v[84:87], a[72:75], 0
  buffer_load_dwordx4 v[32:35], v5, s[4:7], s42 offen offset:0 sc1
  v_mfma_f32_16x16x32_bf16 v[136:139], v[88:91], a[76:79], v[136:139]
  v_mfma_f32_16x16x32_bf16 v[140:143], v[92:95], a[76:79], v[140:143]
  v_mfma_f32_16x16x32_bf16 v[136:139], v[96:99], a[80:83], v[136:139]
  v_mfma_f32_16x16x32_bf16 v[140:143], v[100:103], a[80:83], v[140:143]
  buffer_load_dwordx4 v[36:39], v5, s[4:7], s42 offen offset:1024 sc1
  v_mfma_f32_16x16x32_bf16 v[136:139], v[104:107], a[84:87], v[136:139]
  v_mfma_f32_16x16x32_bf16 v[140:143], v[108:111], a[84:87], v[140:143]
  v_mfma_f32_16x16x32_bf16 v[136:139], v[112:115], a[88:91], v[136:139]
  v_cvt_pk_bf16_f32 v144, v128, v132
  v_cvt_pk_bf16_f32 v145, v129, v133
  v_mfma_f32_16x16x32_bf16 v[140:143], v[116:119], a[88:91], v[140:143]
  v_cvt_pk_bf16_f32 v146, v130, v134
  v_cvt_pk_bf16_f32 v147, v131, v135
  v_mfma_f32_16x16x32_bf16 v[136:139], v[120:123], a[92:95], v[136:139]
  buffer_store_dwordx4 v[144:147], v5, s[4:7], s40 offen sc1
  s_add_u32 s40, s40, 32768
  v_mfma_f32_16x16x32_bf16 v[140:143], v[124:127], a[92:95], v[140:143]
  v_mfma_f32_16x16x32_bf16 v[128:131], v[80:83], a[96:99], 0
  v_mfma_f32_16x16x32_bf16 v[132:135], v[84:87], a[96:99], 0
  buffer_load_dwordx4 v[40:43], v5, s[4:7], s42 offen offset:2048 sc1
  v_mfma_f32_16x16x32_bf16 v[128:131], v[88:91], a[100:103], v[128:131]
  v_mfma_f32_16x16x32_bf16 v[132:135], v[92:95], a[100:103], v[132:135]
  v_mfma_f32_16x16x32_bf16 v[128:131], v[96:99], a[104:107], v[128:131]
  v_mfma_f32_16x16x32_bf16 v[132:135], v[100:103], a[104:107], v[132:135]
  buffer_load_dwordx4 v[44:47], v5, s[4:7], s42 offen offset:3072 sc1
  v_mfma_f32_16x16x32_bf16 v[128:131], v[104:107], a[108:111], v[128:131]
  v_mfma_f32_16x16x32_bf16 v[132:135], v[108:111], a[108:111], v[132:135]
  v_mfma_f32_16x16x32_bf16 v[128:131], v[112:115], a[112:115], v[128:131]
  v_cvt_pk_bf16_f32 v148, v136, v140
  v_cvt_pk_bf16_f32 v149, v137, v141
  v_mfma_f32_16x16x32_bf16 v[132:135], v[116:119], a[112:115], v[132:135]
  v_cvt_pk_bf16_f32 v150, v138, v142
  v_cvt_pk_bf16_f32 v151, v139, v143
  v_mfma_f32_16x16x32_bf16 v[128:131], v[120:123], a[116:119], v[128:131]
  buffer_store_dwordx4 v[148:151], v5, s[4:7], s40 offen sc1
  s_add_u32 s40, s40, 32768
  v_mfma_f32_16x16x32_bf16 v[132:135], v[124:127], a[116:119], v[132:135]
  v_mfma_f32_16x16x32_bf16 v[136:139], v[80:83], a[120:123], 0
  v_mfma_f32_16x16x32_bf16 v[140:143], v[84:87], a[120:123], 0
  s_add_u32 s42, s42, 4096
  buffer_load_dwordx4 v[48:51], v5, s[4:7], s42 offen offset:0 sc1
  v_mfma_f32_16x16x32_bf16 v[136:139], v[88:91], a[124:127], v[136:139]
  v_mfma_f32_16x16x32_bf16 v[140:143], v[92:95], a[124:127], v[140:143]
  v_mfma_f32_16x16x32_bf16 v[136:139], v[96:99], a[128:131], v[136:139]
  v_mfma_f32_16x16x32_bf16 v[140:143], v[100:103], a[128:131], v[140:143]
  buffer_load_dwordx4 v[52:55], v5, s[4:7], s42 offen offset:1024 sc1
  v_mfma_f32_16x16x32_bf16 v[136:139], v[104:107], a[132:135], v[136:139]
  v_mfma_f32_16x16x32_bf16 v[140:143], v[108:111], a[132:135], v[140:143]
  v_mfma_f32_16x16x32_bf16 v[136:139], v[112:115], a[136:139], v[136:139]
  v_cvt_pk_bf16_f32 v144, v128, v132
  v_cvt_pk_bf16_f32 v145, v129, v133
  v_mfma_f32_16x16x32_bf16 v[140:143], v[116:119], a[136:139], v[140:143]
  v_cvt_pk_bf16_f32 v146, v130, v134
  v_cvt_pk_bf16_f32 v147, v131, v135
  v_mfma_f32_16x16x32_bf16 v[136:139], v[120:123], a[140:143], v[136:139]
  buffer_store_dwordx4 v[144:147], v5, s[4:7], s40 offen sc1
  s_add_u32 s40, s40, 32768
  v_mfma_f32_16x16x32_bf16 v[140:143], v[124:127], a[140:143], v[140:143]
  v_mfma_f32_16x16x32_bf16 v[128:131], v[80:83], a[144:147], 0
  v_mfma_f32_16x16x32_bf16 v[132:135], v[84:87], a[144:147], 0
  buffer_load_dwordx4 v[56:59], v5, s[4:7], s42 offen offset:2048 sc1
  v_mfma_f32_16x16x32_bf16 v[128:131], v[88:91], a[148:151], v[128:131]
  v_mfma_f32_16x16x32_bf16 v[132:135], v[92:95], a[148:151], v[132:135]
  v_mfma_f32_16x16x32_bf16 v[128:131], v[96:99], a[152:155], v[128:131]
  v_mfma_f32_16x16x32_bf16 v[132:135], v[100:103], a[152:155], v[132:135]
  buffer_load_dwordx4 v[60:63], v5, s[4:7], s42 offen offset:3072 sc1
  v_mfma_f32_16x16x32_bf16 v[128:131], v[104:107], a[156:159], v[128:131]
  v_mfma_f32_16x16x32_bf16 v[132:135], v[108:111], a[156:159], v[132:135]
  v_mfma_f32_16x16x32_bf16 v[128:131], v[112:115], a[160:163], v[128:131]
  v_cvt_pk_bf16_f32 v148, v136, v140
  v_cvt_pk_bf16_f32 v149, v137, v141
  v_mfma_f32_16x16x32_bf16 v[132:135], v[116:119], a[160:163], v[132:135]
  v_cvt_pk_bf16_f32 v150, v138, v142
  v_cvt_pk_bf16_f32 v151, v139, v143
  v_mfma_f32_16x16x32_bf16 v[128:131], v[120:123], a[164:167], v[128:131]
  buffer_store_dwordx4 v[148:151], v5, s[4:7], s40 offen sc1
  s_add_u32 s40, s40, 32768
  v_mfma_f32_16x16x32_bf16 v[132:135], v[124:127], a[164:167], v[132:135]
  v_mfma_f32_16x16x32_bf16 v[136:139], v[80:83], a[168:171], 0
  v_mfma_f32_16x16x32_bf16 v[140:143], v[84:87], a[168:171], 0
  s_add_u32 s42, s42, 4096
  buffer_load_dwordx4 v[64:67], v5, s[4:7], s42 offen offset:0 sc1
  v_mfma_f32_16x16x32_bf16 v[136:139], v[88:91], a[172:175], v[136:139]
  v_mfma_f32_16x16x32_bf16 v[140:143], v[92:95], a[172:175], v[140:143]
  v_mfma_f32_16x16x32_bf16 v[136:139], v[96:99], a[176:179], v[136:139]
  v_mfma_f32_16x16x32_bf16 v[140:143], v[100:103], a[176:179], v[140:143]
  buffer_load_dwordx4 v[68:71], v5, s[4:7], s42 offen offset:1024 sc1
  v_mfma_f32_16x16x32_bf16 v[136:139], v[104:107], a[180:183], v[136:139]
  v_mfma_f32_16x16x32_bf16 v[140:143], v[108:111], a[180:183], v[140:143]
  v_mfma_f32_16x16x32_bf16 v[136:139], v[112:115], a[184:187], v[136:139]
  v_cvt_pk_bf16_f32 v144, v128, v132
  v_cvt_pk_bf16_f32 v145, v129, v133
  v_mfma_f32_16x16x32_bf16 v[140:143], v[116:119], a[184:187], v[140:143]
  v_cvt_pk_bf16_f32 v146, v130, v134
  v_cvt_pk_bf16_f32 v147, v131, v135
  v_mfma_f32_16x16x32_bf16 v[136:139], v[120:123], a[188:191], v[136:139]
  buffer_store_dwordx4 v[144:147], v5, s[4:7], s40 offen sc1
  s_add_u32 s40, s40, 32768
  v_mfma_f32_16x16x32_bf16 v[140:143], v[124:127], a[188:191], v[140:143]
  v_mfma_f32_16x16x32_bf16 v[128:131], v[80:83], a[192:195], 0
  v_mfma_f32_16x16x32_bf16 v[132:135], v[84:87], a[192:195], 0
  buffer_load_dwordx4 v[72:75], v5, s[4:7], s42 offen offset:2048 sc1
  v_mfma_f32_16x16x32_bf16 v[128:131], v[88:91], a[196:199], v[128:131]
  v_mfma_f32_16x16x32_bf16 v[132:135], v[92:95], a[196:199], v[132:135]
  v_mfma_f32_16x16x32_bf16 v[128:131], v[96:99], a[200:203], v[128:131]
  v_mfma_f32_16x16x32_bf16 v[132:135], v[100:103], a[200:203], v[132:135]
  buffer_load_dwordx4 v[76:79], v5, s[4:7], s42 offen offset:3072 sc1
  v_mfma_f32_16x16x32_bf16 v[128:131], v[104:107], a[204:207], v[128:131]
  v_mfma_f32_16x16x32_bf16 v[132:135], v[108:111], a[204:207], v[132:135]
  v_mfma_f32_16x16x32_bf16 v[128:131], v[112:115], a[208:211], v[128:131]
  v_cvt_pk_bf16_f32 v148, v136, v140
  v_cvt_pk_bf16_f32 v149, v137, v141
  v_mfma_f32_16x16x32_bf16 v[132:135], v[116:119], a[208:211], v[132:135]
  v_cvt_pk_bf16_f32 v150, v138, v142
  v_cvt_pk_bf16_f32 v151, v139, v143
  v_mfma_f32_16x16x32_bf16 v[128:131], v[120:123], a[212:215], v[128:131]
  buffer_store_dwordx4 v[148:151], v5, s[4:7], s40 offen sc1
  s_add_u32 s40, s40, 32768
  v_mfma_f32_16x16x32_bf16 v[132:135], v[124:127], a[212:215], v[132:135]
  buffer_load_dword v11, v9, s[4:7], s29 offen sc1
  v_mfma_f32_16x16x32_bf16 v[136:139], v[80:83], a[216:219], 0
  v_mfma_f32_16x16x32_bf16 v[140:143], v[84:87], a[216:219], 0
  v_mfma_f32_16x16x32_bf16 v[136:139], v[88:91], a[220:223], v[136:139]
  v_mfma_f32_16x16x32_bf16 v[140:143], v[92:95], a[220:223], v[140:143]
  v_mfma_f32_16x16x32_bf16 v[136:139], v[96:99], a[224:227], v[136:139]
  v_mfma_f32_16x16x32_bf16 v[140:143], v[100:103], a[224:227], v[140:143]
  v_mfma_f32_16x16x32_bf16 v[136:139], v[104:107], a[228:231], v[136:139]
  v_mfma_f32_16x16x32_bf16 v[140:143], v[108:111], a[228:231], v[140:143]
  v_mfma_f32_16x16x32_bf16 v[136:139], v[112:115], a[232:235], v[136:139]
  v_cvt_pk_bf16_f32 v144, v128, v132
  v_cvt_pk_bf16_f32 v145, v129, v133
  v_mfma_f32_16x16x32_bf16 v[140:143], v[116:119], a[232:235], v[140:143]
  v_cvt_pk_bf16_f32 v146, v130, v134
  v_cvt_pk_bf16_f32 v147, v131, v135
  v_mfma_f32_16x16x32_bf16 v[136:139], v[120:123], a[236:239], v[136:139]
  buffer_store_dwordx4 v[144:147], v5, s[4:7], s40 offen sc1
  s_add_u32 s40, s40, 32768
  v_mfma_f32_16x16x32_bf16 v[140:143], v[124:127], a[236:239], v[140:143]
  s_nop 7
  v_cvt_pk_bf16_f32 v148, v136, v140
  v_cvt_pk_bf16_f32 v149, v137, v141
  v_cvt_pk_bf16_f32 v150, v138, v142
  v_cvt_pk_bf16_f32 v151, v139, v143
  buffer_store_dwordx4 v[148:151], v5, s[4:7], s40 offen sc1
  s_add_u32 s40, s40, 32768
  s_add_u32 s22, s22, 1
  s_branch Lul_75
Lufin_76:
  s_cmp_ge_u32 s20, 30
  s_cbranch_scc1 Lmain_end
  s_mul_i32 s26, s20, 6554
  s_lshr_b32 s26, s26, 16
  s_add_u32 s83, s26, 1
  s_mul_i32 s26, s26, 10
  s_sub_u32 s20, s20, s26
  s_branch Lrole_M2
  s_branch Lmain_end
.p2align 6
Lrole_S:
  s_mov_b32 s8, s36
  s_and_b32 s9, s37, 0xffff
  s_mov_b32 s10, 0x780000
  s_mov_b32 s11, 0x20000
  s_mov_b32 s16, s38
  s_and_b32 s17, s39, 0xffff
  s_mov_b32 s18, 0x780000
  s_mov_b32 s19, 0x20000
  s_sub_u32 s8, s8, 4096
  s_subb_u32 s9, s9, 0
  s_mov_b32 s10, 0x781000
  s_sub_u32 s16, s16, 4096
  s_subb_u32 s17, s17, 0
  s_mov_b32 s18, 0x781000
  s_mul_i32 s26, s21, 384
  v_add_u32 v2, 0, v1
  v_add_u32 v2, s26, v2
  v_mul_u32_u24 v3, 2731, v2
  v_lshrrev_b32 v3, 16, v3
  v_mul_u32_u24 v4, 24, v3
  v_sub_u32 v2, v2, v4
  v_bfe_u32 v4, v3, 1, 2
  v_lshlrev_b32 v4, 1, v4
  v_xor_b32 v2, v2, v4
  v_lshlrev_b32 v2, 4, v2
  v_and_b32 v4, 1, v3
  v_bfe_u32 v5, v3, 1, 3
  v_lshl_or_b32 v4, v5, 2, v4
  v_lshrrev_b32 v5, 4, v3
  v_lshl_or_b32 v5, v5, 6, v4
  v_mul_u32_u24 v5, 12288, v5
  v_add_u32 v5, v5, v2
  v_add_u32 v112, 4096, v5
  v_bfe_u32 v5, v3, 4, 1
  v_lshl_or_b32 v4, v5, 1, v4
  v_lshrrev_b32 v5, 5, v3
  v_lshl_or_b32 v4, v5, 6, v4
  v_mul_u32_u24 v4, 12288, v4
  v_add_u32 v4, v4, v2
  v_add_u32 v118, 4096, v4
  v_add_u32 v2, 64, v1
  v_add_u32 v2, s26, v2
  v_mul_u32_u24 v3, 2731, v2
  v_lshrrev_b32 v3, 16, v3
  v_mul_u32_u24 v4, 24, v3
  v_sub_u32 v2, v2, v4
  v_bfe_u32 v4, v3, 1, 2
  v_lshlrev_b32 v4, 1, v4
  v_xor_b32 v2, v2, v4
  v_lshlrev_b32 v2, 4, v2
  v_and_b32 v4, 1, v3
  v_bfe_u32 v5, v3, 1, 3
  v_lshl_or_b32 v4, v5, 2, v4
  v_lshrrev_b32 v5, 4, v3
  v_lshl_or_b32 v5, v5, 6, v4
  v_mul_u32_u24 v5, 12288, v5
  v_add_u32 v5, v5, v2
  v_add_u32 v113, 3072, v5
  v_bfe_u32 v5, v3, 4, 1
  v_lshl_or_b32 v4, v5, 1, v4
  v_lshrrev_b32 v5, 5, v3
  v_lshl_or_b32 v4, v5, 6, v4
  v_mul_u32_u24 v4, 12288, v4
  v_add_u32 v4, v4, v2
  v_add_u32 v119, 3072, v4
  v_add_u32 v2, 128, v1
  v_add_u32 v2, s26, v2
  v_mul_u32_u24 v3, 2731, v2
  v_lshrrev_b32 v3, 16, v3
  v_mul_u32_u24 v4, 24, v3
  v_sub_u32 v2, v2, v4
  v_bfe_u32 v4, v3, 1, 2
  v_lshlrev_b32 v4, 1, v4
  v_xor_b32 v2, v2, v4
  v_lshlrev_b32 v2, 4, v2
  v_and_b32 v4, 1, v3
  v_bfe_u32 v5, v3, 1, 3
  v_lshl_or_b32 v4, v5, 2, v4
  v_lshrrev_b32 v5, 4, v3
  v_lshl_or_b32 v5, v5, 6, v4
  v_mul_u32_u24 v5, 12288, v5
  v_add_u32 v5, v5, v2
  v_add_u32 v114, 2048, v5
  v_bfe_u32 v5, v3, 4, 1
  v_lshl_or_b32 v4, v5, 1, v4
  v_lshrrev_b32 v5, 5, v3
  v_lshl_or_b32 v4, v5, 6, v4
  v_mul_u32_u24 v4, 12288, v4
  v_add_u32 v4, v4, v2
  v_add_u32 v120, 2048, v4
  v_add_u32 v2, 192, v1
  v_add_u32 v2, s26, v2
  v_mul_u32_u24 v3, 2731, v2
  v_lshrrev_b32 v3, 16, v3
  v_mul_u32_u24 v4, 24, v3
  v_sub_u32 v2, v2, v4
  v_bfe_u32 v4, v3, 1, 2
  v_lshlrev_b32 v4, 1, v4
  v_xor_b32 v2, v2, v4
  v_lshlrev_b32 v2, 4, v2
  v_and_b32 v4, 1, v3
  v_bfe_u32 v5, v3, 1, 3
  v_lshl_or_b32 v4, v5, 2, v4
  v_lshrrev_b32 v5, 4, v3
  v_lshl_or_b32 v5, v5, 6, v4
  v_mul_u32_u24 v5, 12288, v5
  v_add_u32 v5, v5, v2
  v_add_u32 v115, 1024, v5
  v_bfe_u32 v5, v3, 4, 1
  v_lshl_or_b32 v4, v5, 1, v4
  v_lshrrev_b32 v5, 5, v3
  v_lshl_or_b32 v4, v5, 6, v4
  v_mul_u32_u24 v4, 12288, v4
  v_add_u32 v4, v4, v2
  v_add_u32 v121, 1024, v4
  v_add_u32 v2, 256, v1
  v_add_u32 v2, s26, v2
  v_mul_u32_u24 v3, 2731, v2
  v_lshrrev_b32 v3, 16, v3
  v_mul_u32_u24 v4, 24, v3
  v_sub_u32 v2, v2, v4
  v_bfe_u32 v4, v3, 1, 2
  v_lshlrev_b32 v4, 1, v4
  v_xor_b32 v2, v2, v4
  v_lshlrev_b32 v2, 4, v2
  v_and_b32 v4, 1, v3
  v_bfe_u32 v5, v3, 1, 3
  v_lshl_or_b32 v4, v5, 2, v4
  v_lshrrev_b32 v5, 4, v3
  v_lshl_or_b32 v5, v5, 6, v4
  v_mul_u32_u24 v5, 12288, v5
  v_add_u32 v5, v5, v2
  v_add_u32 v116, 4096, v5
  v_bfe_u32 v5, v3, 4, 1
  v_lshl_or_b32 v4, v5, 1, v4
  v_lshrrev_b32 v5, 5, v3
  v_lshl_or_b32 v4, v5, 6, v4
  v_mul_u32_u24 v4, 12288, v4
  v_add_u32 v4, v4, v2
  v_add_u32 v122, 4096, v4
  v_add_u32 v2, 320, v1
  v_add_u32 v2, s26, v2
  v_mul_u32_u24 v3, 2731, v2
  v_lshrrev_b32 v3, 16, v3
  v_mul_u32_u24 v4, 24, v3
  v_sub_u32 v2, v2, v4
  v_bfe_u32 v4, v3, 1, 2
  v_lshlrev_b32 v4, 1, v4
  v_xor_b32 v2, v2, v4
  v_lshlrev_b32 v2, 4, v2
  v_and_b32 v4, 1, v3
  v_bfe_u32 v5, v3, 1, 3
  v_lshl_or_b32 v4, v5, 2, v4
  v_lshrrev_b32 v5, 4, v3
  v_lshl_or_b32 v5, v5, 6, v4
  v_mul_u32_u24 v5, 12288, v5
  v_add_u32 v5, v5, v2
  v_add_u32 v117, 3072, v5
  v_bfe_u32 v5, v3, 4, 1
  v_lshl_or_b32 v4, v5, 1, v4
  v_lshrrev_b32 v5, 5, v3
  v_lshl_or_b32 v4, v5, 6, v4
  v_mul_u32_u24 v4, 12288, v4
  v_add_u32 v4, v4, v2
  v_add_u32 v123, 3072, v4
  v_bfe_u32 v2, v1, 2, 1
  v_bfe_u32 v3, v1, 4, 1
  v_lshl_or_b32 v2, v3, 1, v2
  v_bfe_u32 v3, v1, 3, 1
  v_lshl_or_b32 v2, v3, 2, v2
  v_bfe_u32 v3, v1, 5, 1
  v_lshl_or_b32 v2, v3, 3, v2
  v_bfe_u32 v3, v2, 1, 2
  v_mul_u32_u24 v2, 384, v2
  v_and_b32 v4, 3, v1
  v_lshl_add_u32 v2, v4, 3, v2
  s_mul_i32 s26, s21, 3
  s_and_b32 s27, s21, 1
  s_add_u32 s29, s27, 0
  s_cmp_eq_u32 s29, 3
  s_cselect_b32 s29, 0, s29
  s_add_u32 s29, s29, s26
  v_xor_b32 v4, s29, v3
  v_lshl_add_u32 v18, v4, 5, v2
  s_add_u32 s29, s27, 1
  s_cmp_eq_u32 s29, 3
  s_cselect_b32 s29, 0, s29
  s_add_u32 s29, s29, s26
  v_xor_b32 v4, s29, v3
  v_lshl_add_u32 v19, v4, 5, v2
  s_add_u32 s29, s27, 2
  s_cmp_eq_u32 s29, 3
  s_cselect_b32 s29, 0, s29
  s_add_u32 s29, s29, s26
  v_xor_b32 v4, s29, v3
  v_lshl_add_u32 v20, v4, 5, v2
  s_add_u32 s29, s21, 0
  s_and_b32 s29, s29, 3
  s_mul_i32 s29, s29, 6144
  v_add_u32 v6, s29, v18
  v_add_u32 v7, s29, v19
  v_add_u32 v8, s29, v20
  s_add_u32 s29, s21, 1
  s_and_b32 s29, s29, 3
  s_mul_i32 s29, s29, 6144
  v_add_u32 v9, s29, v18
  v_add_u32 v10, s29, v19
  v_add_u32 v11, s29, v20
  s_add_u32 s29, s21, 2
  s_and_b32 s29, s29, 3
  s_mul_i32 s29, s29, 6144
  v_add_u32 v12, s29, v18
  v_add_u32 v13, s29, v19
  v_add_u32 v14, s29, v20
  s_add_u32 s29, s21, 3
  s_and_b32 s29, s29, 3
  s_mul_i32 s29, s29, 6144
  v_add_u32 v15, s29, v18
  v_add_u32 v16, s29, v19
  v_add_u32 v17, s29, v20
  s_mul_i32 s28, s20, 384
  s_mul_i32 s35, s21, 6144
  s_add_u32 s27, s28, 0x0
  s_add_u32 m0, s35, 98304
  s_nop 0
  buffer_load_dwordx4 v112, s[8:11], s27 offen offset:0 lds
  buffer_load_dwordx4 v113, s[8:11], s27 offen offset:1024 lds
  buffer_load_dwordx4 v114, s[8:11], s27 offen offset:2048 lds
  buffer_load_dwordx4 v115, s[8:11], s27 offen offset:3072 lds
  s_add_u32 m0, s35, 102400
  s_nop 0
  buffer_load_dwordx4 v116, s[8:11], s27 offen offset:0 lds
  buffer_load_dwordx4 v117, s[8:11], s27 offen offset:1024 lds
  s_add_u32 m0, s35, 122880
  s_nop 0
  buffer_load_dwordx4 v112, s[16:19], s27 offen offset:0 lds
  buffer_load_dwordx4 v113, s[16:19], s27 offen offset:1024 lds
  buffer_load_dwordx4 v114, s[16:19], s27 offen offset:2048 lds
  buffer_load_dwordx4 v115, s[16:19], s27 offen offset:3072 lds
  s_add_u32 m0, s35, 126976
  s_nop 0
  buffer_load_dwordx4 v116, s[16:19], s27 offen offset:0 lds
  buffer_load_dwordx4 v117, s[16:19], s27 offen offset:1024 lds
  s_add_u32 s27, s28, 0x6000
  s_add_u32 m0, s35, 0
  s_nop 0
  buffer_load_dwordx4 v112, s[8:11], s27 offen offset:0 lds
  buffer_load_dwordx4 v113, s[8:11], s27 offen offset:1024 lds
  buffer_load_dwordx4 v114, s[8:11], s27 offen offset:2048 lds
  buffer_load_dwordx4 v115, s[8:11], s27 offen offset:3072 lds
  s_add_u32 m0, s35, 4096
  s_nop 0
  buffer_load_dwordx4 v116, s[8:11], s27 offen offset:0 lds
  buffer_load_dwordx4 v117, s[8:11], s27 offen offset:1024 lds
  s_add_u32 m0, s35, 24576
  s_nop 0
  buffer_load_dwordx4 v112, s[16:19], s27 offen offset:0 lds
  buffer_load_dwordx4 v113, s[16:19], s27 offen offset:1024 lds
  buffer_load_dwordx4 v114, s[16:19], s27 offen offset:2048 lds
  buffer_load_dwordx4 v115, s[16:19], s27 offen offset:3072 lds
  s_add_u32 m0, s35, 28672
  s_nop 0
  buffer_load_dwordx4 v116, s[16:19], s27 offen offset:0 lds
  buffer_load_dwordx4 v117, s[16:19], s27 offen offset:1024 lds
  s_waitcnt vmcnt(12) lgkmcnt(0)
  s_barrier
  s_add_u32 s27, s28, 0x60000
  s_add_u32 m0, s35, 49152
  s_nop 0
  buffer_load_dwordx4 v112, s[8:11], s27 offen offset:0 lds
  buffer_load_dwordx4 v113, s[8:11], s27 offen offset:1024 lds
  buffer_load_dwordx4 v114, s[8:11], s27 offen offset:2048 lds
  buffer_load_dwordx4 v115, s[8:11], s27 offen offset:3072 lds
  s_add_u32 m0, s35, 53248
  s_nop 0
  buffer_load_dwordx4 v116, s[8:11], s27 offen offset:0 lds
  buffer_load_dwordx4 v117, s[8:11], s27 offen offset:1024 lds
  s_add_u32 m0, s35, 73728
  s_nop 0
  buffer_load_dwordx4 v112, s[16:19], s27 offen offset:0 lds
  buffer_load_dwordx4 v113, s[16:19], s27 offen offset:1024 lds
  buffer_load_dwordx4 v114, s[16:19], s27 offen offset:2048 lds
  buffer_load_dwordx4 v115, s[16:19], s27 offen offset:3072 lds
  s_add_u32 m0, s35, 77824
  s_nop 0
  buffer_load_dwordx4 v116, s[16:19], s27 offen offset:0 lds
  buffer_load_dwordx4 v117, s[16:19], s27 offen offset:1024 lds
  v_add_u32 v2, 98304, v6
  ds_read_b64_tr_b16 a[0:1], v2 offset:0
  ds_read_b64_tr_b16 a[24:25], v2 offset:24576
  v_add_u32 v2, 98304, v7
  ds_read_b64_tr_b16 a[8:9], v2 offset:0
  ds_read_b64_tr_b16 a[32:33], v2 offset:24576
  v_add_u32 v2, 98304, v8
  ds_read_b64_tr_b16 a[16:17], v2 offset:0
  ds_read_b64_tr_b16 a[40:41], v2 offset:24576
  v_add_u32 v2, 98304, v9
  ds_read_b64_tr_b16 a[48:49], v2 offset:0
  ds_read_b64_tr_b16 a[72:73], v2 offset:24576
  v_add_u32 v2, 98304, v10
  ds_read_b64_tr_b16 a[56:57], v2 offset:0
  ds_read_b64_tr_b16 a[80:81], v2 offset:24576
  v_add_u32 v2, 98304, v11
  ds_read_b64_tr_b16 a[64:65], v2 offset:0
  ds_read_b64_tr_b16 a[88:89], v2 offset:24576
  v_add_u32 v2, 98304, v12
  ds_read_b64_tr_b16 a[96:97], v2 offset:0
  ds_read_b64_tr_b16 a[120:121], v2 offset:24576
  v_add_u32 v2, 98304, v13
  ds_read_b64_tr_b16 a[104:105], v2 offset:0
  ds_read_b64_tr_b16 a[128:129], v2 offset:24576
  v_add_u32 v2, 98304, v14
  ds_read_b64_tr_b16 a[112:113], v2 offset:0
  ds_read_b64_tr_b16 a[136:137], v2 offset:24576
  v_add_u32 v2, 98304, v15
  ds_read_b64_tr_b16 a[144:145], v2 offset:0
  ds_read_b64_tr_b16 a[168:169], v2 offset:24576
  v_add_u32 v2, 98304, v16
  ds_read_b64_tr_b16 a[152:153], v2 offset:0
  ds_read_b64_tr_b16 a[176:177], v2 offset:24576
  v_add_u32 v2, 98304, v17
  ds_read_b64_tr_b16 a[160:161], v2 offset:0
  ds_read_b64_tr_b16 a[184:185], v2 offset:24576
  s_waitcnt vmcnt(12) lgkmcnt(0)
  s_barrier
  s_add_u32 s27, s28, 0x66000
  s_add_u32 m0, s35, 98304
  s_nop 0
  buffer_load_dwordx4 v112, s[8:11], s27 offen offset:0 lds
  buffer_load_dwordx4 v113, s[8:11], s27 offen offset:1024 lds
  buffer_load_dwordx4 v114, s[8:11], s27 offen offset:2048 lds
  buffer_load_dwordx4 v115, s[8:11], s27 offen offset:3072 lds
  s_add_u32 m0, s35, 102400
  s_nop 0
  buffer_load_dwordx4 v116, s[8:11], s27 offen offset:0 lds
  buffer_load_dwordx4 v117, s[8:11], s27 offen offset:1024 lds
  s_add_u32 m0, s35, 122880
  s_nop 0
  buffer_load_dwordx4 v112, s[16:19], s27 offen offset:0 lds
  buffer_load_dwordx4 v113, s[16:19], s27 offen offset:1024 lds
  buffer_load_dwordx4 v114, s[16:19], s27 offen offset:2048 lds
  buffer_load_dwordx4 v115, s[16:19], s27 offen offset:3072 lds
  s_add_u32 m0, s35, 126976
  s_nop 0
  buffer_load_dwordx4 v116, s[16:19], s27 offen offset:0 lds
  buffer_load_dwordx4 v117, s[16:19], s27 offen offset:1024 lds
  ds_read_b64_tr_b16 a[2:3], v6 offset:0
  ds_read_b64_tr_b16 a[26:27], v6 offset:24576
  ds_read_b64_tr_b16 a[10:11], v7 offset:0
  ds_read_b64_tr_b16 a[34:35], v7 offset:24576
  ds_read_b64_tr_b16 a[18:19], v8 offset:0
  ds_read_b64_tr_b16 a[42:43], v8 offset:24576
  ds_read_b64_tr_b16 a[50:51], v9 offset:0
  ds_read_b64_tr_b16 a[74:75], v9 offset:24576
  ds_read_b64_tr_b16 a[58:59], v10 offset:0
  ds_read_b64_tr_b16 a[82:83], v10 offset:24576
  ds_read_b64_tr_b16 a[66:67], v11 offset:0
  ds_read_b64_tr_b16 a[90:91], v11 offset:24576
  ds_read_b64_tr_b16 a[98:99], v12 offset:0
  ds_read_b64_tr_b16 a[122:123], v12 offset:24576
  ds_read_b64_tr_b16 a[106:107], v13 offset:0
  ds_read_b64_tr_b16 a[130:131], v13 offset:24576
  ds_read_b64_tr_b16 a[114:115], v14 offset:0
  ds_read_b64_tr_b16 a[138:139], v14 offset:24576
  ds_read_b64_tr_b16 a[146:147], v15 offset:0
  ds_read_b64_tr_b16 a[170:171], v15 offset:24576
  ds_read_b64_tr_b16 a[154:155], v16 offset:0
  ds_read_b64_tr_b16 a[178:179], v16 offset:24576
  ds_read_b64_tr_b16 a[162:163], v17 offset:0
  ds_read_b64_tr_b16 a[186:187], v17 offset:24576
  s_waitcnt vmcnt(12) lgkmcnt(0)
  s_barrier
  s_add_u32 s27, s28, 0x300000
  s_add_u32 m0, s35, 0
  s_nop 0
  buffer_load_dwordx4 v112, s[8:11], s27 offen offset:0 lds
  buffer_load_dwordx4 v113, s[8:11], s27 offen offset:1024 lds
  buffer_load_dwordx4 v114, s[8:11], s27 offen offset:2048 lds
  buffer_load_dwordx4 v115, s[8:11], s27 offen offset:3072 lds
  s_add_u32 m0, s35, 4096
  s_nop 0
  buffer_load_dwordx4 v116, s[8:11], s27 offen offset:0 lds
  buffer_load_dwordx4 v117, s[8:11], s27 offen offset:1024 lds
  s_add_u32 m0, s35, 24576
  s_nop 0
  buffer_load_dwordx4 v112, s[16:19], s27 offen offset:0 lds
  buffer_load_dwordx4 v113, s[16:19], s27 offen offset:1024 lds
  buffer_load_dwordx4 v114, s[16:19], s27 offen offset:2048 lds
  buffer_load_dwordx4 v115, s[16:19], s27 offen offset:3072 lds
  s_add_u32 m0, s35, 28672
  s_nop 0
  buffer_load_dwordx4 v116, s[16:19], s27 offen offset:0 lds
  buffer_load_dwordx4 v117, s[16:19], s27 offen offset:1024 lds
  v_add_u32 v2, 49152, v6
  ds_read_b64_tr_b16 a[4:5], v2 offset:0
  ds_read_b64_tr_b16 a[28:29], v2 offset:24576
  v_add_u32 v2, 49152, v7
  ds_read_b64_tr_b16 a[12:13], v2 offset:0
  ds_read_b64_tr_b16 a[36:37], v2 offset:24576
  v_add_u32 v2, 49152, v8
  ds_read_b64_tr_b16 a[20:21], v2 offset:0
  ds_read_b64_tr_b16 a[44:45], v2 offset:24576
  v_add_u32 v2, 49152, v9
  ds_read_b64_tr_b16 a[52:53], v2 offset:0
  ds_read_b64_tr_b16 a[76:77], v2 offset:24576
  v_add_u32 v2, 49152, v10
  ds_read_b64_tr_b16 a[60:61], v2 offset:0
  ds_read_b64_tr_b16 a[84:85], v2 offset:24576
  v_add_u32 v2, 49152, v11
  ds_read_b64_tr_b16 a[68:69], v2 offset:0
  ds_read_b64_tr_b16 a[92:93], v2 offset:24576
  v_add_u32 v2, 49152, v12
  ds_read_b64_tr_b16 a[100:101], v2 offset:0
  ds_read_b64_tr_b16 a[124:125], v2 offset:24576
  v_add_u32 v2, 49152, v13
  ds_read_b64_tr_b16 a[108:109], v2 offset:0
  ds_read_b64_tr_b16 a[132:133], v2 offset:24576
  v_add_u32 v2, 49152, v14
  ds_read_b64_tr_b16 a[116:117], v2 offset:0
  ds_read_b64_tr_b16 a[140:141], v2 offset:24576
  v_add_u32 v2, 49152, v15
  ds_read_b64_tr_b16 a[148:149], v2 offset:0
  ds_read_b64_tr_b16 a[172:173], v2 offset:24576
  v_add_u32 v2, 49152, v16
  ds_read_b64_tr_b16 a[156:157], v2 offset:0
  ds_read_b64_tr_b16 a[180:181], v2 offset:24576
  v_add_u32 v2, 49152, v17
  ds_read_b64_tr_b16 a[164:165], v2 offset:0
  ds_read_b64_tr_b16 a[188:189], v2 offset:24576
  s_waitcnt vmcnt(12) lgkmcnt(0)
  s_barrier
  s_add_u32 s27, s28, 0x306000
  s_add_u32 m0, s35, 49152
  s_nop 0
  buffer_load_dwordx4 v112, s[8:11], s27 offen offset:0 lds
  buffer_load_dwordx4 v113, s[8:11], s27 offen offset:1024 lds
  buffer_load_dwordx4 v114, s[8:11], s27 offen offset:2048 lds
  buffer_load_dwordx4 v115, s[8:11], s27 offen offset:3072 lds
  s_add_u32 m0, s35, 53248
  s_nop 0
  buffer_load_dwordx4 v116, s[8:11], s27 offen offset:0 lds
  buffer_load_dwordx4 v117, s[8:11], s27 offen offset:1024 lds
  s_add_u32 m0, s35, 73728
  s_nop 0
  buffer_load_dwordx4 v112, s[16:19], s27 offen offset:0 lds
  buffer_load_dwordx4 v113, s[16:19], s27 offen offset:1024 lds
  buffer_load_dwordx4 v114, s[16:19], s27 offen offset:2048 lds
  buffer_load_dwordx4 v115, s[16:19], s27 offen offset:3072 lds
  s_add_u32 m0, s35, 77824
  s_nop 0
  buffer_load_dwordx4 v116, s[16:19], s27 offen offset:0 lds
  buffer_load_dwordx4 v117, s[16:19], s27 offen offset:1024 lds
  v_add_u32 v2, 98304, v6
  ds_read_b64_tr_b16 a[6:7], v2 offset:0
  ds_read_b64_tr_b16 a[30:31], v2 offset:24576
  v_add_u32 v2, 98304, v7
  ds_read_b64_tr_b16 a[14:15], v2 offset:0
  ds_read_b64_tr_b16 a[38:39], v2 offset:24576
  v_add_u32 v2, 98304, v8
  ds_read_b64_tr_b16 a[22:23], v2 offset:0
  ds_read_b64_tr_b16 a[46:47], v2 offset:24576
  v_add_u32 v2, 98304, v9
  ds_read_b64_tr_b16 a[54:55], v2 offset:0
  ds_read_b64_tr_b16 a[78:79], v2 offset:24576
  v_add_u32 v2, 98304, v10
  ds_read_b64_tr_b16 a[62:63], v2 offset:0
  ds_read_b64_tr_b16 a[86:87], v2 offset:24576
  v_add_u32 v2, 98304, v11
  ds_read_b64_tr_b16 a[70:71], v2 offset:0
  ds_read_b64_tr_b16 a[94:95], v2 offset:24576
  v_add_u32 v2, 98304, v12
  ds_read_b64_tr_b16 a[102:103], v2 offset:0
  ds_read_b64_tr_b16 a[126:127], v2 offset:24576
  v_add_u32 v2, 98304, v13
  ds_read_b64_tr_b16 a[110:111], v2 offset:0
  ds_read_b64_tr_b16 a[134:135], v2 offset:24576
  v_add_u32 v2, 98304, v14
  ds_read_b64_tr_b16 a[118:119], v2 offset:0
  ds_read_b64_tr_b16 a[142:143], v2 offset:24576
  v_add_u32 v2, 98304, v15
  ds_read_b64_tr_b16 a[150:151], v2 offset:0
  ds_read_b64_tr_b16 a[174:175], v2 offset:24576
  v_add_u32 v2, 98304, v16
  ds_read_b64_tr_b16 a[158:159], v2 offset:0
  ds_read_b64_tr_b16 a[182:183], v2 offset:24576
  v_add_u32 v2, 98304, v17
  ds_read_b64_tr_b16 a[166:167], v2 offset:0
  ds_read_b64_tr_b16 a[190:191], v2 offset:24576
  s_waitcnt vmcnt(12) lgkmcnt(0)
  s_barrier
  s_add_u32 s27, s28, 0x360000
  s_add_u32 m0, s35, 98304
  s_nop 0
  buffer_load_dwordx4 v112, s[8:11], s27 offen offset:0 lds
  buffer_load_dwordx4 v113, s[8:11], s27 offen offset:1024 lds
  buffer_load_dwordx4 v114, s[8:11], s27 offen offset:2048 lds
  buffer_load_dwordx4 v115, s[8:11], s27 offen offset:3072 lds
  s_add_u32 m0, s35, 102400
  s_nop 0
  buffer_load_dwordx4 v116, s[8:11], s27 offen offset:0 lds
  buffer_load_dwordx4 v117, s[8:11], s27 offen offset:1024 lds
  s_add_u32 m0, s35, 122880
  s_nop 0
  buffer_load_dwordx4 v112, s[16:19], s27 offen offset:0 lds
  buffer_load_dwordx4 v113, s[16:19], s27 offen offset:1024 lds
  buffer_load_dwordx4 v114, s[16:19], s27 offen offset:2048 lds
  buffer_load_dwordx4 v115, s[16:19], s27 offen offset:3072 lds
  s_add_u32 m0, s35, 126976
  s_nop 0
  buffer_load_dwordx4 v116, s[16:19], s27 offen offset:0 lds
  buffer_load_dwordx4 v117, s[16:19], s27 offen offset:1024 lds
  ds_read_b64_tr_b16 a[192:193], v6 offset:0
  ds_read_b64_tr_b16 a[216:217], v6 offset:24576
  ds_read_b64_tr_b16 a[200:201], v7 offset:0
  ds_read_b64_tr_b16 a[224:225], v7 offset:24576
  ds_read_b64_tr_b16 a[208:209], v8 offset:0
  ds_read_b64_tr_b16 a[232:233], v8 offset:24576
  ds_read_b64_tr_b16 a[240:241], v9 offset:0
  ds_read_b64_tr_b16 v[136:137], v9 offset:24576
  ds_read_b64_tr_b16 a[248:249], v10 offset:0
  ds_read_b64_tr_b16 v[144:145], v10 offset:24576
  ds_read_b64_tr_b16 v[128:129], v11 offset:0
  ds_read_b64_tr_b16 v[152:153], v11 offset:24576
  ds_read_b64_tr_b16 v[160:161], v12 offset:0
  ds_read_b64_tr_b16 v[184:185], v12 offset:24576
  ds_read_b64_tr_b16 v[168:169], v13 offset:0
  ds_read_b64_tr_b16 v[192:193], v13 offset:24576
  ds_read_b64_tr_b16 v[176:177], v14 offset:0
  ds_read_b64_tr_b16 v[200:201], v14 offset:24576
  ds_read_b64_tr_b16 v[208:209], v15 offset:0
  ds_read_b64_tr_b16 v[232:233], v15 offset:24576
  ds_read_b64_tr_b16 v[216:217], v16 offset:0
  ds_read_b64_tr_b16 v[240:241], v16 offset:24576
  ds_read_b64_tr_b16 v[224:225], v17 offset:0
  ds_read_b64_tr_b16 v[248:249], v17 offset:24576
  s_waitcnt vmcnt(12) lgkmcnt(0)
  s_barrier
  s_add_u32 s27, s28, 0x366000
  s_add_u32 m0, s35, 0
  s_nop 0
  buffer_load_dwordx4 v112, s[8:11], s27 offen offset:0 lds
  buffer_load_dwordx4 v113, s[8:11], s27 offen offset:1024 lds
  buffer_load_dwordx4 v114, s[8:11], s27 offen offset:2048 lds
  buffer_load_dwordx4 v115, s[8:11], s27 offen offset:3072 lds
  s_add_u32 m0, s35, 4096
  s_nop 0
  buffer_load_dwordx4 v116, s[8:11], s27 offen offset:0 lds
  buffer_load_dwordx4 v117, s[8:11], s27 offen offset:1024 lds
  s_add_u32 m0, s35, 24576
  s_nop 0
  buffer_load_dwordx4 v112, s[16:19], s27 offen offset:0 lds
  buffer_load_dwordx4 v113, s[16:19], s27 offen offset:1024 lds
  buffer_load_dwordx4 v114, s[16:19], s27 offen offset:2048 lds
  buffer_load_dwordx4 v115, s[16:19], s27 offen offset:3072 lds
  s_add_u32 m0, s35, 28672
  s_nop 0
  buffer_load_dwordx4 v116, s[16:19], s27 offen offset:0 lds
  buffer_load_dwordx4 v117, s[16:19], s27 offen offset:1024 lds
  v_add_u32 v2, 49152, v6
  ds_read_b64_tr_b16 a[194:195], v2 offset:0
  ds_read_b64_tr_b16 a[218:219], v2 offset:24576
  v_add_u32 v2, 49152, v7
  ds_read_b64_tr_b16 a[202:203], v2 offset:0
  ds_read_b64_tr_b16 a[226:227], v2 offset:24576
  v_add_u32 v2, 49152, v8
  ds_read_b64_tr_b16 a[210:211], v2 offset:0
  ds_read_b64_tr_b16 a[234:235], v2 offset:24576
  v_add_u32 v2, 49152, v9
  ds_read_b64_tr_b16 a[242:243], v2 offset:0
  ds_read_b64_tr_b16 v[138:139], v2 offset:24576
  v_add_u32 v2, 49152, v10
  ds_read_b64_tr_b16 a[250:251], v2 offset:0
  ds_read_b64_tr_b16 v[146:147], v2 offset:24576
  v_add_u32 v2, 49152, v11
  ds_read_b64_tr_b16 v[130:131], v2 offset:0
  ds_read_b64_tr_b16 v[154:155], v2 offset:24576
  v_add_u32 v2, 49152, v12
  ds_read_b64_tr_b16 v[162:163], v2 offset:0
  ds_read_b64_tr_b16 v[186:187], v2 offset:24576
  v_add_u32 v2, 49152, v13
  ds_read_b64_tr_b16 v[170:171], v2 offset:0
  ds_read_b64_tr_b16 v[194:195], v2 offset:24576
  v_add_u32 v2, 49152, v14
  ds_read_b64_tr_b16 v[178:179], v2 offset:0
  ds_read_b64_tr_b16 v[202:203], v2 offset:24576
  v_add_u32 v2, 49152, v15
  ds_read_b64_tr_b16 v[210:211], v2 offset:0
  ds_read_b64_tr_b16 v[234:235], v2 offset:24576
  v_add_u32 v2, 49152, v16
  ds_read_b64_tr_b16 v[218:219], v2 offset:0
  ds_read_b64_tr_b16 v[242:243], v2 offset:24576
  v_add_u32 v2, 49152, v17
  ds_read_b64_tr_b16 v[226:227], v2 offset:0
  ds_read_b64_tr_b16 v[250:251], v2 offset:24576
  s_waitcnt vmcnt(12) lgkmcnt(0)
  s_barrier
  s_add_u32 s27, s28, 0x600000
  s_add_u32 m0, s35, 49152
  s_nop 0
  buffer_load_dwordx4 v118, s[8:11], s27 offen offset:0 lds
  buffer_load_dwordx4 v119, s[8:11], s27 offen offset:1024 lds
  buffer_load_dwordx4 v120, s[8:11], s27 offen offset:2048 lds
  buffer_load_dwordx4 v121, s[8:11], s27 offen offset:3072 lds
  s_add_u32 m0, s35, 53248
  s_nop 0
  buffer_load_dwordx4 v122, s[8:11], s27 offen offset:0 lds
  buffer_load_dwordx4 v123, s[8:11], s27 offen offset:1024 lds
  s_add_u32 m0, s35, 73728
  s_nop 0
  buffer_load_dwordx4 v118, s[16:19], s27 offen offset:0 lds
  buffer_load_dwordx4 v119, s[16:19], s27 offen offset:1024 lds
  buffer_load_dwordx4 v120, s[16:19], s27 offen offset:2048 lds
  buffer_load_dwordx4 v121, s[16:19], s27 offen offset:3072 lds
  s_add_u32 m0, s35, 77824
  s_nop 0
  buffer_load_dwordx4 v122, s[16:19], s27 offen offset:0 lds
  buffer_load_dwordx4 v123, s[16:19], s27 offen offset:1024 lds
  v_add_u32 v2, 98304, v6
  ds_read_b64_tr_b16 a[196:197], v2 offset:0
  ds_read_b64_tr_b16 a[220:221], v2 offset:24576
  v_add_u32 v2, 98304, v7
  ds_read_b64_tr_b16 a[204:205], v2 offset:0
  ds_read_b64_tr_b16 a[228:229], v2 offset:24576
  v_add_u32 v2, 98304, v8
  ds_read_b64_tr_b16 a[212:213], v2 offset:0
  ds_read_b64_tr_b16 a[236:237], v2 offset:24576
  v_add_u32 v2, 98304, v9
  ds_read_b64_tr_b16 a[244:245], v2 offset:0
  ds_read_b64_tr_b16 v[140:141], v2 offset:24576
  v_add_u32 v2, 98304, v10
  ds_read_b64_tr_b16 a[252:253], v2 offset:0
  ds_read_b64_tr_b16 v[148:149], v2 offset:24576
  v_add_u32 v2, 98304, v11
  ds_read_b64_tr_b16 v[132:133], v2 offset:0
  ds_read_b64_tr_b16 v[156:157], v2 offset:24576
  v_add_u32 v2, 98304, v12
  ds_read_b64_tr_b16 v[164:165], v2 offset:0
  ds_read_b64_tr_b16 v[188:189], v2 offset:24576
  v_add_u32 v2, 98304, v13
  ds_read_b64_tr_b16 v[172:173], v2 offset:0
  ds_read_b64_tr_b16 v[196:197], v2 offset:24576
  v_add_u32 v2, 98304, v14
  ds_read_b64_tr_b16 v[180:181], v2 offset:0
  ds_read_b64_tr_b16 v[204:205], v2 offset:24576
  v_add_u32 v2, 98304, v15
  ds_read_b64_tr_b16 v[212:213], v2 offset:0
  ds_read_b64_tr_b16 v[236:237], v2 offset:24576
  v_add_u32 v2, 98304, v16
  ds_read_b64_tr_b16 v[220:221], v2 offset:0
  ds_read_b64_tr_b16 v[244:245], v2 offset:24576
  v_add_u32 v2, 98304, v17
  ds_read_b64_tr_b16 v[228:229], v2 offset:0
  ds_read_b64_tr_b16 v[252:253], v2 offset:24576
  s_waitcnt vmcnt(12) lgkmcnt(0)
  s_barrier
  s_add_u32 s27, s28, 0x660000
  s_add_u32 m0, s35, 98304
  s_nop 0
  buffer_load_dwordx4 v118, s[8:11], s27 offen offset:0 lds
  buffer_load_dwordx4 v119, s[8:11], s27 offen offset:1024 lds
  buffer_load_dwordx4 v120, s[8:11], s27 offen offset:2048 lds
  buffer_load_dwordx4 v121, s[8:11], s27 offen offset:3072 lds
  s_add_u32 m0, s35, 102400
  s_nop 0
  buffer_load_dwordx4 v122, s[8:11], s27 offen offset:0 lds
  buffer_load_dwordx4 v123, s[8:11], s27 offen offset:1024 lds
  s_add_u32 m0, s35, 122880
  s_nop 0
  buffer_load_dwordx4 v118, s[16:19], s27 offen offset:0 lds
  buffer_load_dwordx4 v119, s[16:19], s27 offen offset:1024 lds
  buffer_load_dwordx4 v120, s[16:19], s27 offen offset:2048 lds
  buffer_load_dwordx4 v121, s[16:19], s27 offen offset:3072 lds
  s_add_u32 m0, s35, 126976
  s_nop 0
  buffer_load_dwordx4 v122, s[16:19], s27 offen offset:0 lds
  buffer_load_dwordx4 v123, s[16:19], s27 offen offset:1024 lds
  ds_read_b64_tr_b16 a[198:199], v6 offset:0
  ds_read_b64_tr_b16 a[222:223], v6 offset:24576
  ds_read_b64_tr_b16 a[206:207], v7 offset:0
  ds_read_b64_tr_b16 a[230:231], v7 offset:24576
  ds_read_b64_tr_b16 a[214:215], v8 offset:0
  ds_read_b64_tr_b16 a[238:239], v8 offset:24576
  ds_read_b64_tr_b16 a[246:247], v9 offset:0
  ds_read_b64_tr_b16 v[142:143], v9 offset:24576
  ds_read_b64_tr_b16 a[254:255], v10 offset:0
  ds_read_b64_tr_b16 v[150:151], v10 offset:24576
  ds_read_b64_tr_b16 v[134:135], v11 offset:0
  ds_read_b64_tr_b16 v[158:159], v11 offset:24576
  ds_read_b64_tr_b16 v[166:167], v12 offset:0
  ds_read_b64_tr_b16 v[190:191], v12 offset:24576
  ds_read_b64_tr_b16 v[174:175], v13 offset:0
  ds_read_b64_tr_b16 v[198:199], v13 offset:24576
  ds_read_b64_tr_b16 v[182:183], v14 offset:0
  ds_read_b64_tr_b16 v[206:207], v14 offset:24576
  ds_read_b64_tr_b16 v[214:215], v15 offset:0
  ds_read_b64_tr_b16 v[238:239], v15 offset:24576
  ds_read_b64_tr_b16 v[222:223], v16 offset:0
  ds_read_b64_tr_b16 v[246:247], v16 offset:24576
  ds_read_b64_tr_b16 v[230:231], v17 offset:0
  ds_read_b64_tr_b16 v[254:255], v17 offset:24576
  s_waitcnt vmcnt(12) lgkmcnt(0)
  s_barrier
  s_waitcnt vmcnt(0) lgkmcnt(0)
  s_barrier
  s_waitcnt lgkmcnt(0)
  s_barrier
  v_add_u32 v2, 49152, v18
  ds_read_b64_tr_b16 v[24:25], v2 offset:0
  ds_read_b64_tr_b16 v[48:49], v2 offset:24576
  ds_read_b64_tr_b16 v[26:27], v2 offset:6144
  ds_read_b64_tr_b16 v[50:51], v2 offset:30720
  ds_read_b64_tr_b16 v[72:73], v2 offset:12288
  ds_read_b64_tr_b16 v[96:97], v2 offset:36864
  ds_read_b64_tr_b16 v[74:75], v2 offset:18432
  ds_read_b64_tr_b16 v[98:99], v2 offset:43008
  v_add_u32 v2, 49152, v19
  ds_read_b64_tr_b16 v[32:33], v2 offset:0
  ds_read_b64_tr_b16 v[56:57], v2 offset:24576
  ds_read_b64_tr_b16 v[34:35], v2 offset:6144
  ds_read_b64_tr_b16 v[58:59], v2 offset:30720
  ds_read_b64_tr_b16 v[80:81], v2 offset:12288
  ds_read_b64_tr_b16 v[104:105], v2 offset:36864
  ds_read_b64_tr_b16 v[82:83], v2 offset:18432
  ds_read_b64_tr_b16 v[106:107], v2 offset:43008
  v_add_u32 v2, 49152, v20
  ds_read_b64_tr_b16 v[40:41], v2 offset:0
  ds_read_b64_tr_b16 v[64:65], v2 offset:24576
  ds_read_b64_tr_b16 v[42:43], v2 offset:6144
  ds_read_b64_tr_b16 v[66:67], v2 offset:30720
  ds_read_b64_tr_b16 v[88:89], v2 offset:12288
  ds_read_b64_tr_b16 v[112:113], v2 offset:36864
  ds_read_b64_tr_b16 v[90:91], v2 offset:18432
  ds_read_b64_tr_b16 v[114:115], v2 offset:43008
  v_add_u32 v2, 98304, v18
  ds_read_b64_tr_b16 v[28:29], v2 offset:0
  ds_read_b64_tr_b16 v[52:53], v2 offset:24576
  ds_read_b64_tr_b16 v[30:31], v2 offset:6144
  ds_read_b64_tr_b16 v[54:55], v2 offset:30720
  ds_read_b64_tr_b16 v[76:77], v2 offset:12288
  ds_read_b64_tr_b16 v[100:101], v2 offset:36864
  ds_read_b64_tr_b16 v[78:79], v2 offset:18432
  ds_read_b64_tr_b16 v[102:103], v2 offset:43008
  v_add_u32 v2, 98304, v19
  ds_read_b64_tr_b16 v[36:37], v2 offset:0
  ds_read_b64_tr_b16 v[60:61], v2 offset:24576
  ds_read_b64_tr_b16 v[38:39], v2 offset:6144
  ds_read_b64_tr_b16 v[62:63], v2 offset:30720
  ds_read_b64_tr_b16 v[84:85], v2 offset:12288
  ds_read_b64_tr_b16 v[108:109], v2 offset:36864
  ds_read_b64_tr_b16 v[86:87], v2 offset:18432
  ds_read_b64_tr_b16 v[110:111], v2 offset:43008
  v_add_u32 v2, 98304, v20
  ds_read_b64_tr_b16 v[44:45], v2 offset:0
  ds_read_b64_tr_b16 v[68:69], v2 offset:24576
  ds_read_b64_tr_b16 v[46:47], v2 offset:6144
  ds_read_b64_tr_b16 v[70:71], v2 offset:30720
  ds_read_b64_tr_b16 v[92:93], v2 offset:12288
  ds_read_b64_tr_b16 v[116:117], v2 offset:36864
  ds_read_b64_tr_b16 v[94:95], v2 offset:18432
  ds_read_b64_tr_b16 v[118:119], v2 offset:43008
  s_mul_i32 s34, s21, 24576
  s_add_u32 s34, s34, 49152
  v_lshlrev_b32 v4, 4, v1
  v_add_u32 v4, s34, v4
  s_waitcnt lgkmcnt(0)
  s_barrier
  ds_write_b128 v4, v[24:27] offset:0
  ds_write_b128 v4, v[28:31] offset:1024
  ds_write_b128 v4, v[32:35] offset:2048
  ds_write_b128 v4, v[36:39] offset:3072
  ds_write_b128 v4, v[40:43] offset:4096
  ds_write_b128 v4, v[44:47] offset:5120
  ds_write_b128 v4, v[48:51] offset:6144
  ds_write_b128 v4, v[52:55] offset:7168
  ds_write_b128 v4, v[56:59] offset:8192
  ds_write_b128 v4, v[60:63] offset:9216
  ds_write_b128 v4, v[64:67] offset:10240
  ds_write_b128 v4, v[68:71] offset:11264
  ds_write_b128 v4, v[72:75] offset:12288
  ds_write_b128 v4, v[76:79] offset:13312
  ds_write_b128 v4, v[80:83] offset:14336
  ds_write_b128 v4, v[84:87] offset:15360
  ds_write_b128 v4, v[88:91] offset:16384
  ds_write_b128 v4, v[92:95] offset:17408
  ds_write_b128 v4, v[96:99] offset:18432
  ds_write_b128 v4, v[100:103] offset:19456
  ds_write_b128 v4, v[104:107] offset:20480
  ds_write_b128 v4, v[108:111] offset:21504
  ds_write_b128 v4, v[112:115] offset:22528
  ds_write_b128 v4, v[116:119] offset:23552
  s_waitcnt lgkmcnt(0)
  v_and_b32 v2, 3, v1
  v_lshlrev_b32 v2, 2, v2
Lcw_88:
  s_add_u32 s24, s24, 1
  s_cmp_gt_u32 s24, 300000
  s_cbranch_scc1 Lfail_87
  buffer_load_dword v3, v2, s[12:15], 0 offen offset:128 sc1
  s_waitcnt vmcnt(0)
  v_cmp_eq_u32 vcc, 0, v3
  s_and_b32 s26, vcc_lo, 10
  s_cmp_eq_u32 s26, 0
  s_cbranch_scc1 Lcok_89
  s_sleep 6
  s_branch Lcw_88
Lcok_89:
  v_readlane_b32 s23, v3, 3
  s_and_b32 s23, s23, 0x2000
  v_lshlrev_b32 v6, 4, v1
  s_lshl_b32 s26, s21, 10
  v_add_u32 v7, s26, v6
  v_lshrrev_b32 v8, 1, v7
  v_and_b32 v2, 1, v1
  v_mov_b32 v3, 0x4444
  v_mov_b32 v9, 0xeeee
  v_cmp_eq_u32 vcc, 0, v2
  s_nop 1
  v_cndmask_b32 v9, v9, v3, vcc
  v_mov_b32 v0, 0
  s_add_u32 s48, s23, 0x178000
  s_add_u32 s49, s48, 16384
  s_add_u32 s26, s21, 1
  s_and_b32 s26, s26, 3
  s_lshl_b32 s80, s26, 10
  s_add_u32 s26, s21, 2
  s_and_b32 s26, s26, 3
  s_lshl_b32 s81, s26, 10
  s_add_u32 s26, s21, 3
  s_and_b32 s26, s26, 3
  s_lshl_b32 s82, s26, 10
  v_lshrrev_b32 v3, 4, v1
  v_bfe_u32 v2, v1, 3, 1
  v_lshlrev_b32 v2, 8, v2
  v_lshl_add_u32 v2, v3, 6, v2
  v_bfe_u32 v12, v1, 0, 1
  v_lshl_add_u32 v2, v12, 4, v2
  v_bfe_u32 v12, v1, 1, 2
  v_lshl_add_u32 v11, v12, 2, v2
  v_bfe_u32 v2, v1, 2, 1
  v_lshlrev_b32 v2, 8, v2
  v_lshl_add_u32 v2, v3, 6, v2
  v_bfe_u32 v12, v1, 3, 1
  v_lshl_add_u32 v2, v12, 5, v2
  v_bfe_u32 v12, v1, 0, 1
  v_lshl_add_u32 v2, v12, 4, v2
  v_bfe_u32 v12, v1, 1, 1
  v_lshl_add_u32 v10, v12, 3, v2
  v_bfe_u32 v2, v1, 2, 2
  v_lshlrev_b32 v2, 8, v2
  v_lshl_add_u32 v2, v3, 5, v2
  v_and_b32 v12, 3, v1
  v_lshl_add_u32 v5, v12, 2, v2
  v_lshlrev_b32 v2, 5, v3
  v_bfe_u32 v12, v1, 3, 1
  v_lshl_add_u32 v2, v12, 4, v2
  v_bfe_u32 v12, v1, 1, 1
  v_lshl_add_u32 v2, v12, 3, v2
  v_bfe_u32 v12, v1, 2, 1
  v_lshl_add_u32 v14, v12, 2, v2
  v_lshlrev_b32 v2, 4, v3
  v_bfe_u32 v12, v1, 2, 1
  v_lshl_add_u32 v2, v12, 3, v2
  v_bfe_u32 v12, v1, 1, 1
  v_lshl_add_u32 v2, v12, 2, v2
  v_bfe_u32 v12, v1, 3, 1
  v_lshl_add_u32 v2, v12, 1, v2
  v_bfe_u32 v12, v1, 0, 1
  v_add_u32 v2, v2, v12
  v_lshlrev_b32 v15, 4, v2
  s_lshr_b32 s27, s21, 1
  s_mul_i32 s27, s27, 3
  s_and_b32 s28, s21, 1
  s_lshl_b32 s28, s28, 1
  s_add_u32 s26, s27, s28
  s_add_u32 s27, s27, 1
  s_lshl_b32 s88, s26, 9
  s_add_u32 s88, s88, 12288
  s_lshl_b32 s89, s27, 9
  s_add_u32 s89, s89, s28
  s_add_u32 s89, s89, 12288
  s_lshl_b32 s90, s26, 10
  s_add_u32 s90, s90, 16384
  s_lshl_b32 s91, s27, 10
  s_add_u32 s91, s91, s28
  s_add_u32 s91, s91, 16384
  s_lshr_b32 s26, s20, 4
  s_lshl_b32 s53, s26, 14
  s_and_b32 s26, s20, 15
  s_lshl_b32 s26, s26, 9
  s_add_u32 s53, s53, s26
  s_add_u32 s53, s53, 0x180000
  s_add_u32 s53, s53, s23
  s_lshl_b32 s54, s20, 7
  s_add_u32 s54, s54, 0x188000
  s_add_u32 s54, s54, s23
  s_mul_i32 s29, s20, 12
  s_add_u32 s29, s29, 0x400
  s_mul_i32 s30, s20, 12288
  s_add_u32 s30, s30, 0x1e00000
  s_mul_i32 s31, s20, 3072
  s_add_u32 s31, s31, 0x9e00000
  s_lshl_b32 s33, s20, 2
  s_add_u32 s33, s33, 0x1000
  s_mov_b32 s55, 0x3dd53b95
  s_mov_b32 s95, 0x42700000
  s_lshl_b32 s47, s20, 7
  s_add_u32 s47, s47, s48
  s_mov_b32 s56, 0x00ff00ff
  s_mov_b32 s57, 0x00ff00ff
  s_mov_b32 s58, 0x55555555
  s_mov_b32 s59, 0x55555555
  s_mov_b32 s92, 0
  s_mov_b32 s93, 98304
  s_mov_b32 s22, 0
  s_mov_b32 s46, 0
  s_barrier
  s_lshl_b32 s29, s29, 5
  s_add_u32 s29, s29, 0x200000
  s_lshl_b32 s33, s33, 5
  s_add_u32 s33, s33, 0x200000
  s_cmp_eq_u32 s21, 0
  s_cbranch_scc1 Lsk0_91
  s_add_u32 s38, s22, 1
  s_min_u32 s38, s38, 64
  s_cmp_ge_u32 s46, s38
  s_cbranch_scc1 Lkok_92
  v_min_u32 v3, 2, v1
  v_lshlrev_b32 v3, 7, v3
Lkp_93:
  s_add_u32 s24, s24, 1
  s_cmp_gt_u32 s24, 300000
  s_cbranch_scc1 Lfail_90
  buffer_load_dword v2, v3, s[4:7], s29 offen sc1
  s_waitcnt vmcnt(0)
  v_cmp_gt_u32 vcc, s38, v2
  s_cbranch_vccz Lrok_94
  s_sleep 2
  s_branch Lkp_93
Lrok_94:
  v_readlane_b32 s46, v2, 0
  v_readlane_b32 s26, v2, 1
  s_min_u32 s46, s46, s26
  v_readlane_b32 s26, v2, 2
  s_min_u32 s46, s46, s26
Lkok_92:
  s_add_u32 s26, s22, 0
  s_min_u32 s26, s26, 63
  s_mul_i32 s44, s26, 393216
  s_add_u32 s44, s44, s30
  s_add_u32 s26, s22, 0
  s_and_b32 s26, s26, 1
  s_mul_i32 s26, s26, 12288
  s_add_u32 s26, s26, 20480
  s_lshl_b32 s39, s21, 12
  s_add_u32 m0, s26, s39
  s_add_u32 s44, s44, s39
  s_sub_u32 s44, s44, 4096
  buffer_load_dwordx4 v6, s[4:7], s44 offen offset:0 sc1 lds
  buffer_load_dwordx4 v6, s[4:7], s44 offen offset:1024 sc1 lds
  buffer_load_dwordx4 v6, s[4:7], s44 offen offset:2048 sc1 lds
  buffer_load_dwordx4 v6, s[4:7], s44 offen offset:3072 sc1 lds
Lsk0_91:
Lsl_95:
  v_mov_b64 v[56:57], 0
  v_mov_b64 v[58:59], 0
  v_mov_b64 v[60:61], 0
  v_mov_b64 v[62:63], 0
  v_mov_b64 v[64:65], 0
  v_mov_b64 v[66:67], 0
  v_mov_b64 v[68:69], 0
  v_mov_b64 v[70:71], 0
  v_mov_b64 v[72:73], 0
  v_mov_b64 v[74:75], 0
  v_mov_b64 v[76:77], 0
  v_mov_b64 v[78:79], 0
  ds_read_b128 v[80:83], v4 offset:0
  ds_read_b128 v[84:87], v4 offset:1024
  ds_read_b128 v[88:91], v4 offset:2048
  ds_read_b128 v[92:95], v4 offset:3072
  ds_read_b128 v[96:99], v4 offset:4096
  ds_read_b128 v[100:103], v4 offset:5120
  ds_read_b128 v[104:107], v4 offset:12288
  ds_read_b128 v[108:111], v4 offset:13312
  ds_read_b128 v[112:115], v4 offset:14336
  ds_read_b128 v[116:119], v4 offset:15360
  ds_read_b128 v[120:123], v4 offset:16384
  ds_read_b128 v[124:127], v4 offset:17408
  s_cmp_eq_u32 s21, 0
  s_cbranch_scc1 Lsk1_96
  s_add_u32 s38, s22, 2
  s_min_u32 s38, s38, 64
  s_cmp_ge_u32 s46, s38
  s_cbranch_scc1 Lkok_97
  v_min_u32 v3, 2, v1
  v_lshlrev_b32 v3, 7, v3
Lkp_98:
  s_add_u32 s24, s24, 1
  s_cmp_gt_u32 s24, 300000
  s_cbranch_scc1 Lfail_90
  buffer_load_dword v2, v3, s[4:7], s29 offen sc1
  s_waitcnt vmcnt(0)
  v_cmp_gt_u32 vcc, s38, v2
  s_cbranch_vccz Lrok_99
  s_sleep 2
  s_branch Lkp_98
Lrok_99:
  v_readlane_b32 s46, v2, 0
  v_readlane_b32 s26, v2, 1
  s_min_u32 s46, s46, s26
  v_readlane_b32 s26, v2, 2
  s_min_u32 s46, s46, s26
Lkok_97:
  s_add_u32 s26, s22, 1
  s_min_u32 s26, s26, 63
  s_mul_i32 s44, s26, 393216
  s_add_u32 s44, s44, s30
  s_add_u32 s26, s22, 1
  s_and_b32 s26, s26, 1
  s_mul_i32 s26, s26, 12288
  s_add_u32 s26, s26, 20480
  s_lshl_b32 s39, s21, 12
  s_add_u32 m0, s26, s39
  s_add_u32 s44, s44, s39
  s_sub_u32 s44, s44, 4096
Lsk1_96:
  s_add_u32 s60, s53, s92
  s_add_u32 s61, s54, s92
  s_add_u32 s62, s53, s93
  s_add_u32 s63, s54, s93
  s_and_b32 s26, s22, 1
  s_mul_i32 s94, s26, 12288
  s_add_u32 s94, s94, 24576
  s_and_b32 s26, s22, 3
  s_lshl_b32 s26, s26, 15
  s_add_u32 s50, s26, s23
  s_add_u32 s50, s50, 0x158000
  s_add_u32 s51, s50, 4096
  s_add_u32 s52, s50, 16384
  s_mov_b32 s38, s22
  s_cmp_eq_u32 s22, 0
  s_cbranch_scc1 Lmp0_101
  v_and_b32 v2, 7, v1
  s_lshl_b32 s26, s21, 3
  v_add_u32 v2, s26, v2
  v_lshlrev_b32 v2, 7, v2
  v_bfe_u32 v3, v1, 3, 1
  v_lshl_add_u32 v3, v3, 12, v2
Ltf_102:
  buffer_load_dword v2, v3, s[4:7], s48 offen sc1
  s_memrealtime s[98:99]
  s_add_u32 s24, s24, 1
  s_cmp_gt_u32 s24, 300000
  s_cbranch_scc1 Lfail_100
  s_waitcnt vmcnt(0) lgkmcnt(0)
Ltk_105:
  v_and_b32 v12, 0xff, v2
  v_cmp_gt_u32 vcc, s38, v12
  s_cbranch_vccz Ltok_106
  s_sleep 1
  s_branch Ltf_102
Ltok_106:
  v_cmp_lt_u32 vcc, s38, v12
  s_cbranch_vccnz Ltg_103
  s_lshl_b32 s98, s98, 8
  v_subrev_u32 v2, s98, v2
  s_nop 1
  v_max_i32_dpp v2, v2, v2 row_ror:8 row_mask:0xf bank_mask:0xf
  s_nop 1
  v_max_i32_dpp v2, v2, v2 row_ror:4 row_mask:0xf bank_mask:0xf
  s_nop 1
  v_max_i32_dpp v2, v2, v2 row_ror:2 row_mask:0xf bank_mask:0xf
  s_nop 1
  v_max_i32_dpp v2, v2, v2 row_ror:1 row_mask:0xf bank_mask:0xf
  s_nop 0
  v_readlane_b32 s96, v2, 0
  s_min_i32 s96, s96, 0x6700
  s_add_u32 s96, s96, s98
  s_add_u32 s96, s96, 0x4d00
Ltc_107:
  s_memrealtime s[98:99]
  s_waitcnt lgkmcnt(0)
  s_lshl_b32 s98, s98, 8
  s_sub_u32 s98, s96, s98
  s_cmp_gt_i32 s98, 255
  s_cbranch_scc1 Ltc_107
Ltg_103:
Lmp0_101:
Lmp_108:
  buffer_load_dwordx4 v[16:19], v7, s[4:7], s50 offen sc1
  buffer_load_dwordx4 v[32:35], v7, s[4:7], s51 offen sc1
  buffer_load_dwordx2 v[52:53], v8, s[4:7], s52 offen sc1
  s_add_u32 s24, s24, 1
  s_cmp_gt_u32 s24, 300000
  s_cbranch_scc1 Lfail_100
  v_add_u32 v3, s81, v6
  v_add_u32 v12, s82, v6
  s_waitcnt vmcnt(0) lgkmcnt(0)
  v_max3_u32 v2, v16, v17, v18
  v_max3_u32 v2, v2, v19, v32
  v_max3_u32 v2, v2, v33, v34
  v_max3_u32 v2, v2, v35, v52
  v_max_u32 v2, v2, v53
  v_cmp_eq_u32 vcc, -1, v2
  s_cbranch_vccnz Lmp_108
  ds_write_b128 v7, v[16:19] offset:0
  ds_write_b128 v7, v[32:35] offset:4096
  ds_write_b64 v8, v[52:53] offset:8192
  v_add_u32 v2, s80, v6
  v_smfmac_f32_16x16x64_bf16 v[56:59], v[16:19], a[0:7], v9
  v_smfmac_f32_16x16x64_bf16 v[60:63], v[16:19], a[8:15], v9
  v_smfmac_f32_16x16x64_bf16 v[64:67], v[16:19], a[16:23], v9
  s_waitcnt lgkmcnt(0)
  s_barrier
  ds_read_b128 v[48:51], v6 offset:8192
  ds_read_b128 v[52:55], v6 offset:9216
  ds_read_b128 v[20:23], v2 offset:0
  ds_read_b128 v[24:27], v3 offset:0
  ds_read_b128 v[28:31], v12 offset:0
  ds_read_b128 v[36:39], v2 offset:4096
  ds_read_b128 v[40:43], v3 offset:4096
  ds_read_b128 v[44:47], v12 offset:4096
  s_memrealtime s[96:97]
  v_smfmac_f32_16x16x64_bf16 v[68:71], v[16:19], a[24:31], v9
  v_smfmac_f32_16x16x64_bf16 v[72:75], v[16:19], a[32:39], v9
  v_smfmac_f32_16x16x64_bf16 v[76:79], v[16:19], a[40:47], v9
  v_smfmac_f32_16x16x64_bf16 v[56:59], v[32:35], a[192:199], v9
  v_smfmac_f32_16x16x64_bf16 v[60:63], v[32:35], a[200:207], v9
  v_smfmac_f32_16x16x64_bf16 v[64:67], v[32:35], a[208:215], v9
  v_smfmac_f32_16x16x64_bf16 v[68:71], v[32:35], a[216:223], v9
  v_smfmac_f32_16x16x64_bf16 v[72:75], v[32:35], a[224:231], v9
  v_smfmac_f32_16x16x64_bf16 v[76:79], v[32:35], a[232:239], v9
  s_waitcnt lgkmcnt(7)
  v_smfmac_f32_16x16x64_bf16 v[56:59], v[48:51], v[80:87], v9
  v_smfmac_f32_16x16x64_bf16 v[60:63], v[48:51], v[88:95], v9
  v_smfmac_f32_16x16x64_bf16 v[64:67], v[48:51], v[96:103], v9
  s_waitcnt lgkmcnt(6)
  v_smfmac_f32_16x16x64_bf16 v[56:59], v[52:55], v[104:111], v9
  v_smfmac_f32_16x16x64_bf16 v[60:63], v[52:55], v[112:119], v9
  v_smfmac_f32_16x16x64_bf16 v[64:67], v[52:55], v[120:127], v9
  s_waitcnt lgkmcnt(0)
  s_cmp_eq_u32 s21, 0
  s_cbranch_scc1 Lsw0_109
  s_cmp_lg_u32 s21, 3
  s_cbranch_scc1 Lef3_112
  s_add_u32 s26, s96, 87
  s_lshl_b32 s26, s26, 8
  s_add_u32 s26, s26, s22
  s_add_u32 s26, s26, 1
  v_mov_b32 v13, s26
  s_mov_b64 exec, 1
  buffer_store_dword v13, v0, s[4:7], s47 offen sc1
  s_mov_b64 exec, -1
Lef3_112:
  v_smfmac_f32_16x16x64_bf16 v[56:59], v[20:23], a[48:55], v9
  ds_read_b128 v[80:83], v4 offset:6144
  v_smfmac_f32_16x16x64_bf16 v[60:63], v[20:23], a[56:63], v9
  ds_read_b128 v[84:87], v4 offset:7168
  buffer_load_dwordx4 v6, s[4:7], s44 offen offset:0 sc1 lds
  v_smfmac_f32_16x16x64_bf16 v[64:67], v[20:23], a[64:71], v9
  ds_read_b128 v[88:91], v4 offset:8192
  v_smfmac_f32_16x16x64_bf16 v[56:59], v[24:27], a[96:103], v9
  ds_read_b128 v[92:95], v4 offset:9216
  v_smfmac_f32_16x16x64_bf16 v[60:63], v[24:27], a[104:111], v9
  ds_read_b128 v[96:99], v4 offset:10240
  v_smfmac_f32_16x16x64_bf16 v[64:67], v[24:27], a[112:119], v9
  buffer_load_dwordx4 v6, s[4:7], s44 offen offset:1024 sc1 lds
  ds_read_b128 v[100:103], v4 offset:11264
  v_smfmac_f32_16x16x64_bf16 v[56:59], v[28:31], a[144:151], v9
  ds_read_b128 v[104:107], v4 offset:18432
  v_smfmac_f32_16x16x64_bf16 v[60:63], v[28:31], a[152:159], v9
  ds_read_b128 v[108:111], v4 offset:19456
  v_smfmac_f32_16x16x64_bf16 v[64:67], v[28:31], a[160:167], v9
  ds_read_b128 v[112:115], v4 offset:20480
  buffer_load_dwordx4 v6, s[4:7], s44 offen offset:2048 sc1 lds
  v_smfmac_f32_16x16x64_bf16 v[56:59], v[36:39], a[240:247], v9
  ds_read_b128 v[116:119], v4 offset:21504
  v_smfmac_f32_16x16x64_bf16 v[60:63], v[36:39], a[248:255], v9
  ds_read_b128 v[120:123], v4 offset:22528
  v_smfmac_f32_16x16x64_bf16 v[64:67], v[36:39], v[128:135], v9
  ds_read_b128 v[124:127], v4 offset:23552
  v_smfmac_f32_16x16x64_bf16 v[56:59], v[40:43], v[160:167], v9
  buffer_load_dwordx4 v6, s[4:7], s44 offen offset:3072 sc1 lds
  v_smfmac_f32_16x16x64_bf16 v[60:63], v[40:43], v[168:175], v9
  v_smfmac_f32_16x16x64_bf16 v[64:67], v[40:43], v[176:183], v9
  v_smfmac_f32_16x16x64_bf16 v[56:59], v[44:47], v[208:215], v9
  v_smfmac_f32_16x16x64_bf16 v[60:63], v[44:47], v[216:223], v9
  v_smfmac_f32_16x16x64_bf16 v[64:67], v[44:47], v[224:231], v9
  s_waitcnt lgkmcnt(0)
  v_smfmac_f32_16x16x64_bf16 v[68:71], v[48:51], v[80:87], v9
  v_add_u32 v2, s88, v11
  v_smfmac_f32_16x16x64_bf16 v[72:75], v[48:51], v[88:95], v9
  v_add_u32 v3, s89, v11
  v_smfmac_f32_16x16x64_bf16 v[76:79], v[48:51], v[96:103], v9
  s_nop 0
  v_smfmac_f32_16x16x64_bf16 v[68:71], v[52:55], v[104:111], v9
  s_nop 0
  v_smfmac_f32_16x16x64_bf16 v[72:75], v[52:55], v[112:119], v9
  s_nop 0
  v_smfmac_f32_16x16x64_bf16 v[76:79], v[52:55], v[120:127], v9
  v_smfmac_f32_16x16x64_bf16 v[68:71], v[20:23], a[72:79], v9
  v_add_f32 v56, v56, v57
  v_add_f32 v58, v58, v59
  v_add_f32 v60, v60, v61
  v_smfmac_f32_16x16x64_bf16 v[72:75], v[20:23], a[80:87], v9
  v_add_f32 v62, v62, v63
  v_cvt_pk_bf16_f32 v57, v56, v60
  v_cvt_pk_bf16_f32 v59, v58, v62
  v_smfmac_f32_16x16x64_bf16 v[76:79], v[20:23], a[88:95], v9
  ds_write_b32 v2, v57
  ds_write_b32 v2, v59 offset:32
  v_add_f32 v64, v64, v65
  v_smfmac_f32_16x16x64_bf16 v[68:71], v[24:27], a[120:127], v9
  v_add_f32 v66, v66, v67
  v_cvt_pk_bf16_f32 v65, v64, v66
  ds_write_b16 v3, v65
  v_smfmac_f32_16x16x64_bf16 v[72:75], v[24:27], a[128:135], v9
  ds_write_b16_d16_hi v3, v65 offset:32
  v_smfmac_f32_16x16x64_bf16 v[76:79], v[24:27], a[136:143], v9
  v_smfmac_f32_16x16x64_bf16 v[68:71], v[28:31], a[168:175], v9
  v_smfmac_f32_16x16x64_bf16 v[72:75], v[28:31], a[176:183], v9
  v_smfmac_f32_16x16x64_bf16 v[76:79], v[28:31], a[184:191], v9
  s_waitcnt lgkmcnt(0)
  s_barrier
  v_smfmac_f32_16x16x64_bf16 v[68:71], v[36:39], v[136:143], v9
  v_smfmac_f32_16x16x64_bf16 v[72:75], v[36:39], v[144:151], v9
  v_smfmac_f32_16x16x64_bf16 v[76:79], v[36:39], v[152:159], v9
  v_smfmac_f32_16x16x64_bf16 v[68:71], v[40:43], v[184:191], v9
  v_add_u32 v2, s90, v5
  v_add_u32 v3, s91, v5
  v_smfmac_f32_16x16x64_bf16 v[68:71], v[44:47], v[232:239], v9
  v_smfmac_f32_16x16x64_bf16 v[72:75], v[40:43], v[192:199], v9
  v_smfmac_f32_16x16x64_bf16 v[72:75], v[44:47], v[240:247], v9
  v_smfmac_f32_16x16x64_bf16 v[76:79], v[40:43], v[200:207], v9
  v_smfmac_f32_16x16x64_bf16 v[76:79], v[44:47], v[248:255], v9
  s_nop 3
  v_add_f32 v68, v68, v69
  v_add_f32 v70, v70, v71
  v_add_f32 v72, v72, v73
  v_add_f32 v74, v74, v75
  v_cvt_pk_bf16_f32 v69, v68, v72
  v_cvt_pk_bf16_f32 v71, v70, v74
  ds_write_b32 v2, v69
  ds_write_b32 v2, v71 offset:16
  v_add_f32 v76, v76, v77
  v_add_f32 v78, v78, v79
  v_cvt_pk_bf16_f32 v77, v76, v78
  ds_write_b16 v3, v77
  ds_write_b16_d16_hi v3, v77 offset:16
  s_waitcnt lgkmcnt(0)
  s_barrier
  s_branch Lso_110
Lsw0_109:
  v_smfmac_f32_16x16x64_bf16 v[56:59], v[20:23], a[48:55], v9
  ds_read_b128 v[80:83], v4 offset:6144
  v_smfmac_f32_16x16x64_bf16 v[60:63], v[20:23], a[56:63], v9
  ds_read_b128 v[84:87], v4 offset:7168
  v_smfmac_f32_16x16x64_bf16 v[64:67], v[20:23], a[64:71], v9
  ds_read_b128 v[88:91], v4 offset:8192
  v_smfmac_f32_16x16x64_bf16 v[56:59], v[24:27], a[96:103], v9
  ds_read_b128 v[92:95], v4 offset:9216
  v_smfmac_f32_16x16x64_bf16 v[60:63], v[24:27], a[104:111], v9
  ds_read_b128 v[96:99], v4 offset:10240
  v_smfmac_f32_16x16x64_bf16 v[64:67], v[24:27], a[112:119], v9
  ds_read_b128 v[100:103], v4 offset:11264
  v_smfmac_f32_16x16x64_bf16 v[56:59], v[28:31], a[144:151], v9
  ds_read_b128 v[104:107], v4 offset:18432
  v_smfmac_f32_16x16x64_bf16 v[60:63], v[28:31], a[152:159], v9
  ds_read_b128 v[108:111], v4 offset:19456
  v_smfmac_f32_16x16x64_bf16 v[64:67], v[28:31], a[160:167], v9
  ds_read_b128 v[112:115], v4 offset:20480
  v_smfmac_f32_16x16x64_bf16 v[56:59], v[36:39], a[240:247], v9
  ds_read_b128 v[116:119], v4 offset:21504
  v_smfmac_f32_16x16x64_bf16 v[60:63], v[36:39], a[248:255], v9
  ds_read_b128 v[120:123], v4 offset:22528
  v_smfmac_f32_16x16x64_bf16 v[64:67], v[36:39], v[128:135], v9
  ds_read_b128 v[124:127], v4 offset:23552
  v_smfmac_f32_16x16x64_bf16 v[56:59], v[40:43], v[160:167], v9
  v_smfmac_f32_16x16x64_bf16 v[60:63], v[40:43], v[168:175], v9
  v_smfmac_f32_16x16x64_bf16 v[64:67], v[40:43], v[176:183], v9
  v_smfmac_f32_16x16x64_bf16 v[56:59], v[44:47], v[208:215], v9
  v_smfmac_f32_16x16x64_bf16 v[60:63], v[44:47], v[216:223], v9
  v_smfmac_f32_16x16x64_bf16 v[64:67], v[44:47], v[224:231], v9
  s_waitcnt lgkmcnt(0)
  v_smfmac_f32_16x16x64_bf16 v[68:71], v[48:51], v[80:87], v9
  v_add_u32 v2, s88, v11
  v_smfmac_f32_16x16x64_bf16 v[72:75], v[48:51], v[88:95], v9
  v_add_u32 v3, s89, v11
  v_smfmac_f32_16x16x64_bf16 v[76:79], v[48:51], v[96:103], v9
  v_add_u32 v12, s94, v15
  v_smfmac_f32_16x16x64_bf16 v[68:71], v[52:55], v[104:111], v9
  s_mov_b64 vcc, s[56:57]
  v_smfmac_f32_16x16x64_bf16 v[72:75], v[52:55], v[112:119], v9
  s_nop 0
  v_smfmac_f32_16x16x64_bf16 v[76:79], v[52:55], v[120:127], v9
  v_smfmac_f32_16x16x64_bf16 v[68:71], v[20:23], a[72:79], v9
  v_add_f32 v56, v56, v57
  v_add_f32 v58, v58, v59
  v_add_f32 v60, v60, v61
  v_smfmac_f32_16x16x64_bf16 v[72:75], v[20:23], a[80:87], v9
  v_add_f32 v62, v62, v63
  v_cvt_pk_bf16_f32 v57, v56, v60
  v_cvt_pk_bf16_f32 v59, v58, v62
  v_smfmac_f32_16x16x64_bf16 v[76:79], v[20:23], a[88:95], v9
  ds_write_b32 v2, v57
  ds_write_b32 v2, v59 offset:32
  v_add_f32 v64, v64, v65
  v_smfmac_f32_16x16x64_bf16 v[68:71], v[24:27], a[120:127], v9
  v_add_f32 v66, v66, v67
  v_cvt_pk_bf16_f32 v65, v64, v66
  ds_write_b16 v3, v65
  v_smfmac_f32_16x16x64_bf16 v[72:75], v[24:27], a[128:135], v9
  ds_write_b16_d16_hi v3, v65 offset:32
  v_smfmac_f32_16x16x64_bf16 v[76:79], v[24:27], a[136:143], v9
  v_smfmac_f32_16x16x64_bf16 v[68:71], v[28:31], a[168:175], v9
  ds_read_b128 v[80:83], v12 offset:0
  ds_read_b128 v[84:87], v12 offset:2048
  v_smfmac_f32_16x16x64_bf16 v[72:75], v[28:31], a[176:183], v9
  ds_read_b128 v[104:107], v12 offset:1024
  ds_read_b128 v[108:111], v12 offset:3072
  v_smfmac_f32_16x16x64_bf16 v[76:79], v[28:31], a[184:191], v9
  s_waitcnt lgkmcnt(4)
  s_barrier
  ds_read_b128 v[16:19], v6 offset:12288
  ds_read_b128 v[48:51], v6 offset:13312
  ds_read_b128 v[52:55], v6 offset:14336
  v_smfmac_f32_16x16x64_bf16 v[68:71], v[36:39], v[136:143], v9
  ds_read_b128 v[88:91], v12 offset:4096
  ds_read_b128 v[92:95], v12 offset:6144
  ds_read_b128 v[112:115], v12 offset:5120
  v_smfmac_f32_16x16x64_bf16 v[72:75], v[36:39], v[144:151], v9
  ds_read_b128 v[116:119], v12 offset:7168
  ds_read_b128 v[96:99], v12 offset:8192
  ds_read_b128 v[100:103], v12 offset:10240
  v_smfmac_f32_16x16x64_bf16 v[76:79], v[36:39], v[152:159], v9
  ds_read_b128 v[120:123], v12 offset:9216
  ds_read_b128 v[124:127], v12 offset:11264
  v_mov_b64 v[56:57], 0
  v_smfmac_f32_16x16x64_bf16 v[68:71], v[40:43], v[184:191], v9
  v_mov_b64 v[58:59], 0
  v_mov_b64 v[60:61], 0
  v_mov_b64 v[62:63], 0
  v_smfmac_f32_16x16x64_bf16 v[68:71], v[44:47], v[232:239], v9
  v_mov_b64 v[64:65], 0
  v_mov_b64 v[66:67], 0
  s_waitcnt lgkmcnt(8)
  v_smfmac_f32_16x16x64_bf16 v[56:59], v[16:19], v[80:87], v9
  v_smfmac_f32_16x16x64_bf16 v[60:63], v[16:19], v[104:111], v9
  s_waitcnt lgkmcnt(4)
  v_smfmac_f32_16x16x64_bf16 v[56:59], v[48:51], v[88:95], v9
  v_smfmac_f32_16x16x64_bf16 v[60:63], v[48:51], v[112:119], v9
  s_waitcnt lgkmcnt(0)
  v_smfmac_f32_16x16x64_bf16 v[56:59], v[52:55], v[96:103], v9
  v_smfmac_f32_16x16x64_bf16 v[60:63], v[52:55], v[120:127], v9
  v_smfmac_f32_16x16x64_bf16 v[72:75], v[40:43], v[192:199], v9
  v_add_u32 v2, s90, v5
  v_add_u32 v3, s91, v5
  s_nop 0
  s_nop 0
  v_smfmac_f32_16x16x64_bf16 v[72:75], v[44:47], v[240:247], v9
  s_nop 1
  v_add_f32 v80, v56, v57
  v_add_f32 v82, v58, v59
  v_add_f32 v81, v60, v61
  v_smfmac_f32_16x16x64_bf16 v[76:79], v[40:43], v[200:207], v9
  v_add_f32 v83, v62, v63
  v_cndmask_b32_dpp v84, v82, v80, vcc row_ror:8 row_mask:0xf bank_mask:0xf
  s_nop 0
  v_cndmask_b32_dpp v85, v83, v81, vcc row_ror:8 row_mask:0xf bank_mask:0xf
  v_smfmac_f32_16x16x64_bf16 v[76:79], v[44:47], v[248:255], v9
  s_not_b64 vcc, vcc
  v_cndmask_b32_dpp v86, v80, v82, vcc row_ror:8 row_mask:0xf bank_mask:0xf
  v_cndmask_b32_dpp v87, v81, v83, vcc row_ror:8 row_mask:0xf bank_mask:0xf
  v_add_f32 v68, v68, v69
  v_add_f32 v70, v70, v71
  v_add_f32 v72, v72, v73
  v_add_f32 v74, v74, v75
  v_cvt_pk_bf16_f32 v69, v68, v72
  v_cvt_pk_bf16_f32 v71, v70, v74
  ds_write_b32 v2, v69
  ds_write_b32 v2, v71 offset:16
  v_add_f32 v76, v76, v77
  v_add_f32 v78, v78, v79
  v_cvt_pk_bf16_f32 v77, v76, v78
  ds_write_b16 v3, v77
  ds_write_b16_d16_hi v3, v77 offset:16
  s_not_b64 vcc, vcc
  s_waitcnt lgkmcnt(0)
  s_barrier
  s_cmp_ge_u32 s22, 63
  s_cbranch_scc1 Lsn_111
  ds_read_b128 v[20:23], v6 offset:16384
  ds_read_b128 v[24:27], v6 offset:17408
  ds_read_b128 v[28:31], v6 offset:18432
  ds_read_b128 v[32:35], v6 offset:19456
  ds_read_b128 v[36:39], v6 offset:20480
  ds_read_b128 v[40:43], v6 offset:21504
  v_max3_f32 v88, v84, v85, v86
  v_max_f32 v88, v88, v87
  s_nop 1
  v_max_f32_dpp v88, v88, v88 quad_perm:[1,0,3,2] row_mask:0xf bank_mask:0xf
  s_nop 1
  v_max_f32_dpp v88, v88, v88 quad_perm:[2,3,0,1] row_mask:0xf bank_mask:0xf
  s_nop 1
  v_max_f32_dpp v88, v88, v88 row_half_mirror row_mask:0xf bank_mask:0xf
  v_sub_f32 v84, v84, v88
  v_sub_f32 v85, v85, v88
  v_sub_f32 v86, v86, v88
  v_sub_f32 v87, v87, v88
  s_waitcnt lgkmcnt(4)
  v_smfmac_f32_16x16x64_bf16 v[64:67], v[16:19], v[20:27], v9
  v_mul_f32 v84, s55, v84
  v_mul_f32 v85, s55, v85
  s_waitcnt lgkmcnt(2)
  v_smfmac_f32_16x16x64_bf16 v[64:67], v[48:51], v[28:35], v9
  v_mul_f32 v86, s55, v86
  v_mul_f32 v87, s55, v87
  s_waitcnt lgkmcnt(0)
  v_smfmac_f32_16x16x64_bf16 v[64:67], v[52:55], v[36:43], v9
  v_exp_f32 v84, v84
  v_exp_f32 v85, v85
  v_exp_f32 v86, v86
  v_exp_f32 v87, v87
  v_add_f32 v90, v84, v85
  v_add_f32 v93, v86, v87
  v_add_f32 v90, v90, v93
  s_nop 0
  v_add_f32 v82, v66, v67
  v_add_f32 v80, v64, v65
  s_nop 0
  v_cndmask_b32_dpp v91, v82, v80, vcc row_ror:8 row_mask:0xf bank_mask:0xf
  v_sub_f32 v91, v91, v88
  v_mul_f32 v91, s55, v91
  v_cmp_lt_f32 vcc, s95, v91
  v_exp_f32 v92, v91
  s_cbranch_vccnz Lsslow_113
Lsback_114:
  v_add_f32 v90, v90, v92
  s_nop 1
  v_add_f32_dpp v90, v90, v90 quad_perm:[1,0,3,2] row_mask:0xf bank_mask:0xf
  s_nop 1
  v_add_f32_dpp v90, v90, v90 quad_perm:[2,3,0,1] row_mask:0xf bank_mask:0xf
  s_nop 1
  v_add_f32_dpp v90, v90, v90 row_half_mirror row_mask:0xf bank_mask:0xf
  v_rcp_f32 v90, v90
  s_nop 0
  v_mul_f32 v92, v92, v90
  v_mul_f32 v84, v84, v90
  v_mul_f32 v85, v85, v90
  v_mul_f32 v86, v86, v90
  v_mul_f32 v87, v87, v90
  v_mov_b32_dpp v93, v92 quad_perm:[1,0,3,2] row_mask:0xf bank_mask:0xf
  v_cvt_pk_bf16_f32 v94, v84, v85
  v_cvt_pk_bf16_f32 v95, v86, v87
  buffer_store_dwordx2 v[94:95], v10, s[4:7], s60 offen sc1
  v_cvt_pk_bf16_f32 v92, v92, v93
  s_mov_b64 exec, s[58:59]
  buffer_store_dword v92, v14, s[4:7], s61 offen sc1
  s_mov_b64 exec, -1
  s_branch Lsn_111
Lsslow_113:
  v_max_f32 v93, 0, v91
  s_nop 1
  v_max_f32_dpp v93, v93, v93 quad_perm:[1,0,3,2] row_mask:0xf bank_mask:0xf
  s_nop 1
  v_max_f32_dpp v93, v93, v93 quad_perm:[2,3,0,1] row_mask:0xf bank_mask:0xf
  s_nop 1
  v_max_f32_dpp v93, v93, v93 row_half_mirror row_mask:0xf bank_mask:0xf
  v_sub_f32 v91, v91, v93
  v_exp_f32 v93, -v93
  v_exp_f32 v92, v91
  s_nop 0
  v_mul_f32 v84, v84, v93
  v_mul_f32 v85, v85, v93
  v_mul_f32 v86, v86, v93
  v_mul_f32 v87, v87, v93
  v_mul_f32 v90, v90, v93
  s_branch Lsback_114
Lso_110:
  s_cmp_lg_u32 s21, 2
  s_cbranch_scc1 Lnk2_115
  v_mov_b32 v12, -1
  v_mov_b32 v13, -1
  v_lshlrev_b32 v2, 3, v1
  buffer_store_dwordx2 v[12:13], v2, s[4:7], s62 offen sc1
  s_mov_b64 exec, 0xffff
  buffer_store_dwordx2 v[12:13], v2, s[4:7], s63 offen sc1
  s_mov_b64 exec, -1
Lnk2_115:
  s_cmp_lg_u32 s21, 1
  s_cbranch_scc1 Lsn_111
  v_lshrrev_b32 v2, 3, v1
  v_lshlrev_b32 v2, 8, v2
  v_and_b32 v3, 7, v1
  v_lshl_add_u32 v2, v3, 4, v2
  ds_read_b128 v[20:23], v2 offset:16384
  ds_read_b128 v[24:27], v2 offset:18432
  ds_read_b128 v[28:31], v2 offset:20480
  s_mul_i32 s27, s22, 98304
  s_add_u32 s27, s27, s31
  s_waitcnt lgkmcnt(0)
  buffer_store_dwordx4 v[20:23], v6, s[4:7], s27 offen offset:0 sc1
  buffer_store_dwordx4 v[24:27], v6, s[4:7], s27 offen offset:1024 sc1
  buffer_store_dwordx4 v[28:31], v6, s[4:7], s27 offen offset:2048 sc1
  s_waitcnt vmcnt(0)
  s_add_u32 s26, s22, 1
  v_mov_b32 v2, s26
  s_mov_b64 exec, 1
  buffer_store_dword v2, v0, s[4:7], s33 offen sc1
  s_mov_b64 exec, -1
Lsn_111:
  s_mov_b32 s93, s92
  s_add_u32 s92, s92, 49152
  s_cmp_eq_u32 s92, 147456
  s_cselect_b32 s92, 0, s92
  s_add_u32 s22, s22, 1
  s_cmp_lt_u32 s22, 64
  s_cbranch_scc1 Lsl_95
  s_branch Lmain_end
.p2align 6
Lrole_V:
  s_mov_b32 s8, s40
  s_and_b32 s9, s41, 0xffff
  s_mov_b32 s10, 0x780000
  s_mov_b32 s11, 0x20000
  s_sub_u32 s8, s8, 4096
  s_subb_u32 s9, s9, 0
  s_mov_b32 s10, 0x781000
  s_mul_i32 s26, s21, 384
  v_add_u32 v2, 0, v1
  v_add_u32 v2, s26, v2
  v_mul_u32_u24 v3, 2731, v2
  v_lshrrev_b32 v3, 16, v3
  v_mul_u32_u24 v4, 24, v3
  v_sub_u32 v2, v2, v4
  v_bfe_u32 v4, v3, 1, 2
  v_lshlrev_b32 v4, 1, v4
  v_xor_b32 v2, v2, v4
  v_lshlrev_b32 v2, 4, v2
  v_and_b32 v4, 1, v3
  v_bfe_u32 v5, v3, 1, 3
  v_lshl_or_b32 v4, v5, 2, v4
  v_lshrrev_b32 v5, 4, v3
  v_lshl_or_b32 v5, v5, 6, v4
  v_mul_u32_u24 v5, 12288, v5
  v_add_u32 v5, v5, v2
  v_add_u32 v112, 4096, v5
  v_bfe_u32 v5, v3, 4, 1
  v_lshl_or_b32 v4, v5, 1, v4
  v_lshrrev_b32 v5, 5, v3
  v_lshl_or_b32 v4, v5, 6, v4
  v_mul_u32_u24 v4, 12288, v4
  v_add_u32 v4, v4, v2
  v_add_u32 v118, 4096, v4
  v_add_u32 v2, 64, v1
  v_add_u32 v2, s26, v2
  v_mul_u32_u24 v3, 2731, v2
  v_lshrrev_b32 v3, 16, v3
  v_mul_u32_u24 v4, 24, v3
  v_sub_u32 v2, v2, v4
  v_bfe_u32 v4, v3, 1, 2
  v_lshlrev_b32 v4, 1, v4
  v_xor_b32 v2, v2, v4
  v_lshlrev_b32 v2, 4, v2
  v_and_b32 v4, 1, v3
  v_bfe_u32 v5, v3, 1, 3
  v_lshl_or_b32 v4, v5, 2, v4
  v_lshrrev_b32 v5, 4, v3
  v_lshl_or_b32 v5, v5, 6, v4
  v_mul_u32_u24 v5, 12288, v5
  v_add_u32 v5, v5, v2
  v_add_u32 v113, 3072, v5
  v_bfe_u32 v5, v3, 4, 1
  v_lshl_or_b32 v4, v5, 1, v4
  v_lshrrev_b32 v5, 5, v3
  v_lshl_or_b32 v4, v5, 6, v4
  v_mul_u32_u24 v4, 12288, v4
  v_add_u32 v4, v4, v2
  v_add_u32 v119, 3072, v4
  v_add_u32 v2, 128, v1
  v_add_u32 v2, s26, v2
  v_mul_u32_u24 v3, 2731, v2
  v_lshrrev_b32 v3, 16, v3
  v_mul_u32_u24 v4, 24, v3
  v_sub_u32 v2, v2, v4
  v_bfe_u32 v4, v3, 1, 2
  v_lshlrev_b32 v4, 1, v4
  v_xor_b32 v2, v2, v4
  v_lshlrev_b32 v2, 4, v2
  v_and_b32 v4, 1, v3
  v_bfe_u32 v5, v3, 1, 3
  v_lshl_or_b32 v4, v5, 2, v4
  v_lshrrev_b32 v5, 4, v3
  v_lshl_or_b32 v5, v5, 6, v4
  v_mul_u32_u24 v5, 12288, v5
  v_add_u32 v5, v5, v2
  v_add_u32 v114, 2048, v5
  v_bfe_u32 v5, v3, 4, 1
  v_lshl_or_b32 v4, v5, 1, v4
  v_lshrrev_b32 v5, 5, v3
  v_lshl_or_b32 v4, v5, 6, v4
  v_mul_u32_u24 v4, 12288, v4
  v_add_u32 v4, v4, v2
  v_add_u32 v120, 2048, v4
  v_add_u32 v2, 192, v1
  v_add_u32 v2, s26, v2
  v_mul_u32_u24 v3, 2731, v2
  v_lshrrev_b32 v3, 16, v3
  v_mul_u32_u24 v4, 24, v3
  v_sub_u32 v2, v2, v4
  v_bfe_u32 v4, v3, 1, 2
  v_lshlrev_b32 v4, 1, v4
  v_xor_b32 v2, v2, v4
  v_lshlrev_b32 v2, 4, v2
  v_and_b32 v4, 1, v3
  v_bfe_u32 v5, v3, 1, 3
  v_lshl_or_b32 v4, v5, 2, v4
  v_lshrrev_b32 v5, 4, v3
  v_lshl_or_b32 v5, v5, 6, v4
  v_mul_u32_u24 v5, 12288, v5
  v_add_u32 v5, v5, v2
  v_add_u32 v115, 1024, v5
  v_bfe_u32 v5, v3, 4, 1
  v_lshl_or_b32 v4, v5, 1, v4
  v_lshrrev_b32 v5, 5, v3
  v_lshl_or_b32 v4, v5, 6, v4
  v_mul_u32_u24 v4, 12288, v4
  v_add_u32 v4, v4, v2
  v_add_u32 v121, 1024, v4
  v_add_u32 v2, 256, v1
  v_add_u32 v2, s26, v2
  v_mul_u32_u24 v3, 2731, v2
  v_lshrrev_b32 v3, 16, v3
  v_mul_u32_u24 v4, 24, v3
  v_sub_u32 v2, v2, v4
  v_bfe_u32 v4, v3, 1, 2
  v_lshlrev_b32 v4, 1, v4
  v_xor_b32 v2, v2, v4
  v_lshlrev_b32 v2, 4, v2
  v_and_b32 v4, 1, v3
  v_bfe_u32 v5, v3, 1, 3
  v_lshl_or_b32 v4, v5, 2, v4
  v_lshrrev_b32 v5, 4, v3
  v_lshl_or_b32 v5, v5, 6, v4
  v_mul_u32_u24 v5, 12288, v5
  v_add_u32 v5, v5, v2
  v_add_u32 v116, 4096, v5
  v_bfe_u32 v5, v3, 4, 1
  v_lshl_or_b32 v4, v5, 1, v4
  v_lshrrev_b32 v5, 5, v3
  v_lshl_or_b32 v4, v5, 6, v4
  v_mul_u32_u24 v4, 12288, v4
  v_add_u32 v4, v4, v2
  v_add_u32 v122, 4096, v4
  v_add_u32 v2, 320, v1
  v_add_u32 v2, s26, v2
  v_mul_u32_u24 v3, 2731, v2
  v_lshrrev_b32 v3, 16, v3
  v_mul_u32_u24 v4, 24, v3
  v_sub_u32 v2, v2, v4
  v_bfe_u32 v4, v3, 1, 2
  v_lshlrev_b32 v4, 1, v4
  v_xor_b32 v2, v2, v4
  v_lshlrev_b32 v2, 4, v2
  v_and_b32 v4, 1, v3
  v_bfe_u32 v5, v3, 1, 3
  v_lshl_or_b32 v4, v5, 2, v4
  v_lshrrev_b32 v5, 4, v3
  v_lshl_or_b32 v5, v5, 6, v4
  v_mul_u32_u24 v5, 12288, v5
  v_add_u32 v5, v5, v2
  v_add_u32 v117, 3072, v5
  v_bfe_u32 v5, v3, 4, 1
  v_lshl_or_b32 v4, v5, 1, v4
  v_lshrrev_b32 v5, 5, v3
  v_lshl_or_b32 v4, v5, 6, v4
  v_mul_u32_u24 v4, 12288, v4
  v_add_u32 v4, v4, v2
  v_add_u32 v123, 3072, v4
  v_bfe_u32 v2, v1, 2, 1
  v_bfe_u32 v3, v1, 4, 1
  v_lshl_or_b32 v2, v3, 1, v2
  v_bfe_u32 v3, v1, 3, 1
  v_lshl_or_b32 v2, v3, 2, v2
  v_bfe_u32 v3, v1, 5, 1
  v_lshl_or_b32 v2, v3, 3, v2
  v_bfe_u32 v3, v2, 1, 2
  v_mul_u32_u24 v2, 384, v2
  v_and_b32 v4, 3, v1
  v_lshl_add_u32 v2, v4, 3, v2
  s_mul_i32 s26, s21, 3
  s_and_b32 s27, s21, 1
  s_add_u32 s29, s27, 0
  s_cmp_eq_u32 s29, 3
  s_cselect_b32 s29, 0, s29
  s_add_u32 s29, s29, s26
  v_xor_b32 v4, s29, v3
  v_lshl_add_u32 v18, v4, 5, v2
  s_add_u32 s29, s27, 1
  s_cmp_eq_u32 s29, 3
  s_cselect_b32 s29, 0, s29
  s_add_u32 s29, s29, s26
  v_xor_b32 v4, s29, v3
  v_lshl_add_u32 v19, v4, 5, v2
  s_add_u32 s29, s27, 2
  s_cmp_eq_u32 s29, 3
  s_cselect_b32 s29, 0, s29
  s_add_u32 s29, s29, s26
  v_xor_b32 v4, s29, v3
  v_lshl_add_u32 v20, v4, 5, v2
  s_add_u32 s29, s21, 0
  s_and_b32 s29, s29, 3
  s_mul_i32 s29, s29, 6144
  v_add_u32 v6, s29, v18
  v_add_u32 v7, s29, v19
  v_add_u32 v8, s29, v20
  s_add_u32 s29, s21, 1
  s_and_b32 s29, s29, 3
  s_mul_i32 s29, s29, 6144
  v_add_u32 v9, s29, v18
  v_add_u32 v10, s29, v19
  v_add_u32 v11, s29, v20
  s_add_u32 s29, s21, 2
  s_and_b32 s29, s29, 3
  s_mul_i32 s29, s29, 6144
  v_add_u32 v12, s29, v18
  v_add_u32 v13, s29, v19
  v_add_u32 v14, s29, v20
  s_add_u32 s29, s21, 3
  s_and_b32 s29, s29, 3
  s_mul_i32 s29, s29, 6144
  v_add_u32 v15, s29, v18
  v_add_u32 v16, s29, v19
  v_add_u32 v17, s29, v20
  s_mul_i32 s28, s20, 384
  s_mul_i32 s35, s21, 6144
  s_add_u32 s27, s28, 0x0
  s_add_u32 m0, s35, 0
  s_nop 0
  buffer_load_dwordx4 v112, s[8:11], s27 offen offset:0 lds
  buffer_load_dwordx4 v113, s[8:11], s27 offen offset:1024 lds
  buffer_load_dwordx4 v114, s[8:11], s27 offen offset:2048 lds
  buffer_load_dwordx4 v115, s[8:11], s27 offen offset:3072 lds
  s_add_u32 m0, s35, 4096
  s_nop 0
  buffer_load_dwordx4 v116, s[8:11], s27 offen offset:0 lds
  buffer_load_dwordx4 v117, s[8:11], s27 offen offset:1024 lds
  s_add_u32 s27, s28, 0x6000
  s_add_u32 m0, s35, 24576
  s_nop 0
  buffer_load_dwordx4 v112, s[8:11], s27 offen offset:0 lds
  buffer_load_dwordx4 v113, s[8:11], s27 offen offset:1024 lds
  buffer_load_dwordx4 v114, s[8:11], s27 offen offset:2048 lds
  buffer_load_dwordx4 v115, s[8:11], s27 offen offset:3072 lds
  s_add_u32 m0, s35, 28672
  s_nop 0
  buffer_load_dwordx4 v116, s[8:11], s27 offen offset:0 lds
  buffer_load_dwordx4 v117, s[8:11], s27 offen offset:1024 lds
  s_add_u32 s27, s28, 0x60000
  s_add_u32 m0, s35, 49152
  s_nop 0
  buffer_load_dwordx4 v112, s[8:11], s27 offen offset:0 lds
  buffer_load_dwordx4 v113, s[8:11], s27 offen offset:1024 lds
  buffer_load_dwordx4 v114, s[8:11], s27 offen offset:2048 lds
  buffer_load_dwordx4 v115, s[8:11], s27 offen offset:3072 lds
  s_add_u32 m0, s35, 53248
  s_nop 0
  buffer_load_dwordx4 v116, s[8:11], s27 offen offset:0 lds
  buffer_load_dwordx4 v117, s[8:11], s27 offen offset:1024 lds
  s_add_u32 s27, s28, 0x66000
  s_add_u32 m0, s35, 73728
  s_nop 0
  buffer_load_dwordx4 v112, s[8:11], s27 offen offset:0 lds
  buffer_load_dwordx4 v113, s[8:11], s27 offen offset:1024 lds
  buffer_load_dwordx4 v114, s[8:11], s27 offen offset:2048 lds
  buffer_load_dwordx4 v115, s[8:11], s27 offen offset:3072 lds
  s_add_u32 m0, s35, 77824
  s_nop 0
  buffer_load_dwordx4 v116, s[8:11], s27 offen offset:0 lds
  buffer_load_dwordx4 v117, s[8:11], s27 offen offset:1024 lds
  s_waitcnt vmcnt(18) lgkmcnt(0)
  s_barrier
  s_add_u32 s27, s28, 0x300000
  s_add_u32 m0, s35, 98304
  s_nop 0
  buffer_load_dwordx4 v112, s[8:11], s27 offen offset:0 lds
  buffer_load_dwordx4 v113, s[8:11], s27 offen offset:1024 lds
  buffer_load_dwordx4 v114, s[8:11], s27 offen offset:2048 lds
  buffer_load_dwordx4 v115, s[8:11], s27 offen offset:3072 lds
  s_add_u32 m0, s35, 102400
  s_nop 0
  buffer_load_dwordx4 v116, s[8:11], s27 offen offset:0 lds
  buffer_load_dwordx4 v117, s[8:11], s27 offen offset:1024 lds
  ds_read_b64_tr_b16 a[0:1], v6 offset:0
  ds_read_b64_tr_b16 a[8:9], v7 offset:0
  ds_read_b64_tr_b16 a[16:17], v8 offset:0
  ds_read_b64_tr_b16 a[24:25], v9 offset:0
  ds_read_b64_tr_b16 a[32:33], v10 offset:0
  ds_read_b64_tr_b16 a[40:41], v11 offset:0
  ds_read_b64_tr_b16 a[48:49], v12 offset:0
  ds_read_b64_tr_b16 a[56:57], v13 offset:0
  ds_read_b64_tr_b16 a[64:65], v14 offset:0
  ds_read_b64_tr_b16 a[72:73], v15 offset:0
  ds_read_b64_tr_b16 a[80:81], v16 offset:0
  ds_read_b64_tr_b16 a[88:89], v17 offset:0
  s_waitcnt vmcnt(18) lgkmcnt(0)
  s_barrier
  s_add_u32 s27, s28, 0x306000
  s_add_u32 m0, s35, 0
  s_nop 0
  buffer_load_dwordx4 v112, s[8:11], s27 offen offset:0 lds
  buffer_load_dwordx4 v113, s[8:11], s27 offen offset:1024 lds
  buffer_load_dwordx4 v114, s[8:11], s27 offen offset:2048 lds
  buffer_load_dwordx4 v115, s[8:11], s27 offen offset:3072 lds
  s_add_u32 m0, s35, 4096
  s_nop 0
  buffer_load_dwordx4 v116, s[8:11], s27 offen offset:0 lds
  buffer_load_dwordx4 v117, s[8:11], s27 offen offset:1024 lds
  ds_read_b64_tr_b16 a[2:3], v6 offset:24576
  ds_read_b64_tr_b16 a[10:11], v7 offset:24576
  ds_read_b64_tr_b16 a[18:19], v8 offset:24576
  ds_read_b64_tr_b16 a[26:27], v9 offset:24576
  ds_read_b64_tr_b16 a[34:35], v10 offset:24576
  ds_read_b64_tr_b16 a[42:43], v11 offset:24576
  ds_read_b64_tr_b16 a[50:51], v12 offset:24576
  ds_read_b64_tr_b16 a[58:59], v13 offset:24576
  ds_read_b64_tr_b16 a[66:67], v14 offset:24576
  ds_read_b64_tr_b16 a[74:75], v15 offset:24576
  ds_read_b64_tr_b16 a[82:83], v16 offset:24576
  ds_read_b64_tr_b16 a[90:91], v17 offset:24576
  s_waitcnt vmcnt(18) lgkmcnt(0)
  s_barrier
  s_add_u32 s27, s28, 0x360000
  s_add_u32 m0, s35, 24576
  s_nop 0
  buffer_load_dwordx4 v112, s[8:11], s27 offen offset:0 lds
  buffer_load_dwordx4 v113, s[8:11], s27 offen offset:1024 lds
  buffer_load_dwordx4 v114, s[8:11], s27 offen offset:2048 lds
  buffer_load_dwordx4 v115, s[8:11], s27 offen offset:3072 lds
  s_add_u32 m0, s35, 28672
  s_nop 0
  buffer_load_dwordx4 v116, s[8:11], s27 offen offset:0 lds
  buffer_load_dwordx4 v117, s[8:11], s27 offen offset:1024 lds
  v_add_u32 v2, 49152, v6
  ds_read_b64_tr_b16 a[4:5], v2 offset:0
  v_add_u32 v2, 49152, v7
  ds_read_b64_tr_b16 a[12:13], v2 offset:0
  v_add_u32 v2, 49152, v8
  ds_read_b64_tr_b16 a[20:21], v2 offset:0
  v_add_u32 v2, 49152, v9
  ds_read_b64_tr_b16 a[28:29], v2 offset:0
  v_add_u32 v2, 49152, v10
  ds_read_b64_tr_b16 a[36:37], v2 offset:0
  v_add_u32 v2, 49152, v11
  ds_read_b64_tr_b16 a[44:45], v2 offset:0
  v_add_u32 v2, 49152, v12
  ds_read_b64_tr_b16 a[52:53], v2 offset:0
  v_add_u32 v2, 49152, v13
  ds_read_b64_tr_b16 a[60:61], v2 offset:0
  v_add_u32 v2, 49152, v14
  ds_read_b64_tr_b16 a[68:69], v2 offset:0
  v_add_u32 v2, 49152, v15
  ds_read_b64_tr_b16 a[76:77], v2 offset:0
  v_add_u32 v2, 49152, v16
  ds_read_b64_tr_b16 a[84:85], v2 offset:0
  v_add_u32 v2, 49152, v17
  ds_read_b64_tr_b16 a[92:93], v2 offset:0
  s_waitcnt vmcnt(18) lgkmcnt(0)
  s_barrier
  s_add_u32 s27, s28, 0x366000
  s_add_u32 m0, s35, 49152
  s_nop 0
  buffer_load_dwordx4 v112, s[8:11], s27 offen offset:0 lds
  buffer_load_dwordx4 v113, s[8:11], s27 offen offset:1024 lds
  buffer_load_dwordx4 v114, s[8:11], s27 offen offset:2048 lds
  buffer_load_dwordx4 v115, s[8:11], s27 offen offset:3072 lds
  s_add_u32 m0, s35, 53248
  s_nop 0
  buffer_load_dwordx4 v116, s[8:11], s27 offen offset:0 lds
  buffer_load_dwordx4 v117, s[8:11], s27 offen offset:1024 lds
  v_add_u32 v2, 73728, v6
  ds_read_b64_tr_b16 a[6:7], v2 offset:0
  v_add_u32 v2, 73728, v7
  ds_read_b64_tr_b16 a[14:15], v2 offset:0
  v_add_u32 v2, 73728, v8
  ds_read_b64_tr_b16 a[22:23], v2 offset:0
  v_add_u32 v2, 73728, v9
  ds_read_b64_tr_b16 a[30:31], v2 offset:0
  v_add_u32 v2, 73728, v10
  ds_read_b64_tr_b16 a[38:39], v2 offset:0
  v_add_u32 v2, 73728, v11
  ds_read_b64_tr_b16 a[46:47], v2 offset:0
  v_add_u32 v2, 73728, v12
  ds_read_b64_tr_b16 a[54:55], v2 offset:0
  v_add_u32 v2, 73728, v13
  ds_read_b64_tr_b16 a[62:63], v2 offset:0
  v_add_u32 v2, 73728, v14
  ds_read_b64_tr_b16 a[70:71], v2 offset:0
  v_add_u32 v2, 73728, v15
  ds_read_b64_tr_b16 a[78:79], v2 offset:0
  v_add_u32 v2, 73728, v16
  ds_read_b64_tr_b16 a[86:87], v2 offset:0
  v_add_u32 v2, 73728, v17
  ds_read_b64_tr_b16 a[94:95], v2 offset:0
  s_waitcnt vmcnt(18) lgkmcnt(0)
  s_barrier
  s_add_u32 s27, s28, 0x600000
  s_add_u32 m0, s35, 73728
  s_nop 0
  buffer_load_dwordx4 v118, s[8:11], s27 offen offset:0 lds
  buffer_load_dwordx4 v119, s[8:11], s27 offen offset:1024 lds
  buffer_load_dwordx4 v120, s[8:11], s27 offen offset:2048 lds
  buffer_load_dwordx4 v121, s[8:11], s27 offen offset:3072 lds
  s_add_u32 m0, s35, 77824
  s_nop 0
  buffer_load_dwordx4 v122, s[8:11], s27 offen offset:0 lds
  buffer_load_dwordx4 v123, s[8:11], s27 offen offset:1024 lds
  v_add_u32 v2, 98304, v6
  ds_read_b64_tr_b16 a[96:97], v2 offset:0
  v_add_u32 v2, 98304, v7
  ds_read_b64_tr_b16 a[104:105], v2 offset:0
  v_add_u32 v2, 98304, v8
  ds_read_b64_tr_b16 a[112:113], v2 offset:0
  v_add_u32 v2, 98304, v9
  ds_read_b64_tr_b16 a[120:121], v2 offset:0
  v_add_u32 v2, 98304, v10
  ds_read_b64_tr_b16 a[128:129], v2 offset:0
  v_add_u32 v2, 98304, v11
  ds_read_b64_tr_b16 a[136:137], v2 offset:0
  v_add_u32 v2, 98304, v12
  ds_read_b64_tr_b16 a[144:145], v2 offset:0
  v_add_u32 v2, 98304, v13
  ds_read_b64_tr_b16 a[152:153], v2 offset:0
  v_add_u32 v2, 98304, v14
  ds_read_b64_tr_b16 a[160:161], v2 offset:0
  v_add_u32 v2, 98304, v15
  ds_read_b64_tr_b16 a[168:169], v2 offset:0
  v_add_u32 v2, 98304, v16
  ds_read_b64_tr_b16 a[176:177], v2 offset:0
  v_add_u32 v2, 98304, v17
  ds_read_b64_tr_b16 a[184:185], v2 offset:0
  s_waitcnt vmcnt(18) lgkmcnt(0)
  s_barrier
  s_add_u32 s27, s28, 0x660000
  s_add_u32 m0, s35, 98304
  s_nop 0
  buffer_load_dwordx4 v118, s[8:11], s27 offen offset:0 lds
  buffer_load_dwordx4 v119, s[8:11], s27 offen offset:1024 lds
  buffer_load_dwordx4 v120, s[8:11], s27 offen offset:2048 lds
  buffer_load_dwordx4 v121, s[8:11], s27 offen offset:3072 lds
  s_add_u32 m0, s35, 102400
  s_nop 0
  buffer_load_dwordx4 v122, s[8:11], s27 offen offset:0 lds
  buffer_load_dwordx4 v123, s[8:11], s27 offen offset:1024 lds
  ds_read_b64_tr_b16 a[98:99], v6 offset:0
  ds_read_b64_tr_b16 a[106:107], v7 offset:0
  ds_read_b64_tr_b16 a[114:115], v8 offset:0
  ds_read_b64_tr_b16 a[122:123], v9 offset:0
  ds_read_b64_tr_b16 a[130:131], v10 offset:0
  ds_read_b64_tr_b16 a[138:139], v11 offset:0
  ds_read_b64_tr_b16 a[146:147], v12 offset:0
  ds_read_b64_tr_b16 a[154:155], v13 offset:0
  ds_read_b64_tr_b16 a[162:163], v14 offset:0
  ds_read_b64_tr_b16 a[170:171], v15 offset:0
  ds_read_b64_tr_b16 a[178:179], v16 offset:0
  ds_read_b64_tr_b16 a[186:187], v17 offset:0
  s_waitcnt vmcnt(18) lgkmcnt(0)
  s_barrier
  ds_read_b64_tr_b16 a[100:101], v6 offset:24576
  ds_read_b64_tr_b16 a[108:109], v7 offset:24576
  ds_read_b64_tr_b16 a[116:117], v8 offset:24576
  ds_read_b64_tr_b16 a[124:125], v9 offset:24576
  ds_read_b64_tr_b16 a[132:133], v10 offset:24576
  ds_read_b64_tr_b16 a[140:141], v11 offset:24576
  ds_read_b64_tr_b16 a[148:149], v12 offset:24576
  ds_read_b64_tr_b16 a[156:157], v13 offset:24576
  ds_read_b64_tr_b16 a[164:165], v14 offset:24576
  ds_read_b64_tr_b16 a[172:173], v15 offset:24576
  ds_read_b64_tr_b16 a[180:181], v16 offset:24576
  ds_read_b64_tr_b16 a[188:189], v17 offset:24576
  s_waitcnt vmcnt(12) lgkmcnt(0)
  s_barrier
  v_add_u32 v2, 49152, v6
  ds_read_b64_tr_b16 a[102:103], v2 offset:0
  v_add_u32 v2, 49152, v7
  ds_read_b64_tr_b16 a[110:111], v2 offset:0
  v_add_u32 v2, 49152, v8
  ds_read_b64_tr_b16 a[118:119], v2 offset:0
  v_add_u32 v2, 49152, v9
  ds_read_b64_tr_b16 a[126:127], v2 offset:0
  v_add_u32 v2, 49152, v10
  ds_read_b64_tr_b16 a[134:135], v2 offset:0
  v_add_u32 v2, 49152, v11
  ds_read_b64_tr_b16 a[142:143], v2 offset:0
  v_add_u32 v2, 49152, v12
  ds_read_b64_tr_b16 a[150:151], v2 offset:0
  v_add_u32 v2, 49152, v13
  ds_read_b64_tr_b16 a[158:159], v2 offset:0
  v_add_u32 v2, 49152, v14
  ds_read_b64_tr_b16 a[166:167], v2 offset:0
  v_add_u32 v2, 49152, v15
  ds_read_b64_tr_b16 a[174:175], v2 offset:0
  v_add_u32 v2, 49152, v16
  ds_read_b64_tr_b16 a[182:183], v2 offset:0
  v_add_u32 v2, 49152, v17
  ds_read_b64_tr_b16 a[190:191], v2 offset:0
  s_waitcnt vmcnt(6) lgkmcnt(0)
  s_barrier
  v_add_u32 v2, 73728, v18
  ds_read_b64_tr_b16 a[192:193], v2 offset:0
  ds_read_b64_tr_b16 a[194:195], v2 offset:6144
  ds_read_b64_tr_b16 v[24:25], v2 offset:12288
  ds_read_b64_tr_b16 v[26:27], v2 offset:18432
  v_add_u32 v2, 73728, v19
  ds_read_b64_tr_b16 a[200:201], v2 offset:0
  ds_read_b64_tr_b16 a[202:203], v2 offset:6144
  ds_read_b64_tr_b16 v[32:33], v2 offset:12288
  ds_read_b64_tr_b16 v[34:35], v2 offset:18432
  v_add_u32 v2, 73728, v20
  ds_read_b64_tr_b16 a[208:209], v2 offset:0
  ds_read_b64_tr_b16 a[210:211], v2 offset:6144
  ds_read_b64_tr_b16 v[40:41], v2 offset:12288
  ds_read_b64_tr_b16 v[42:43], v2 offset:18432
  s_waitcnt vmcnt(0) lgkmcnt(0)
  s_barrier
  v_add_u32 v2, 98304, v18
  ds_read_b64_tr_b16 a[196:197], v2 offset:0
  ds_read_b64_tr_b16 a[198:199], v2 offset:6144
  ds_read_b64_tr_b16 v[28:29], v2 offset:12288
  ds_read_b64_tr_b16 v[30:31], v2 offset:18432
  v_add_u32 v2, 98304, v19
  ds_read_b64_tr_b16 a[204:205], v2 offset:0
  ds_read_b64_tr_b16 a[206:207], v2 offset:6144
  ds_read_b64_tr_b16 v[36:37], v2 offset:12288
  ds_read_b64_tr_b16 v[38:39], v2 offset:18432
  v_add_u32 v2, 98304, v20
  ds_read_b64_tr_b16 a[212:213], v2 offset:0
  ds_read_b64_tr_b16 a[214:215], v2 offset:6144
  ds_read_b64_tr_b16 v[44:45], v2 offset:12288
  ds_read_b64_tr_b16 v[46:47], v2 offset:18432
  s_waitcnt lgkmcnt(0)
  s_barrier
  s_mov_b32 s8, s42
  s_and_b32 s9, s43, 0xffff
  s_mov_b32 s10, 0x780000
  s_mov_b32 s11, 0x20000
  s_sub_u32 s8, s8, 4096
  s_subb_u32 s9, s9, 0
  s_mov_b32 s10, 0x781000
  s_mul_i32 s26, s21, 640
  v_add_u32 v2, 0, v1
  v_add_u32 v2, s26, v2
  v_mul_u32_u24 v3, 13108, v2
  v_lshrrev_b32 v3, 20, v3
  v_mul_u32_u24 v4, 80, v3
  v_sub_u32 v2, v2, v4
  v_bfe_u32 v4, v3, 1, 2
  v_bfe_u32 v5, v3, 4, 1
  v_lshl_or_b32 v4, v5, 2, v4
  v_lshlrev_b32 v4, 1, v4
  v_xor_b32 v2, v2, v4
  v_mul_u32_u24 v3, 1280, v3
  v_lshl_add_u32 v3, v2, 4, v3
  v_add_u32 v6, 4096, v3
  v_add_u32 v2, 64, v1
  v_add_u32 v2, s26, v2
  v_mul_u32_u24 v3, 13108, v2
  v_lshrrev_b32 v3, 20, v3
  v_mul_u32_u24 v4, 80, v3
  v_sub_u32 v2, v2, v4
  v_bfe_u32 v4, v3, 1, 2
  v_bfe_u32 v5, v3, 4, 1
  v_lshl_or_b32 v4, v5, 2, v4
  v_lshlrev_b32 v4, 1, v4
  v_xor_b32 v2, v2, v4
  v_mul_u32_u24 v3, 1280, v3
  v_lshl_add_u32 v3, v2, 4, v3
  v_add_u32 v7, 3072, v3
  v_add_u32 v2, 128, v1
  v_add_u32 v2, s26, v2
  v_mul_u32_u24 v3, 13108, v2
  v_lshrrev_b32 v3, 20, v3
  v_mul_u32_u24 v4, 80, v3
  v_sub_u32 v2, v2, v4
  v_bfe_u32 v4, v3, 1, 2
  v_bfe_u32 v5, v3, 4, 1
  v_lshl_or_b32 v4, v5, 2, v4
  v_lshlrev_b32 v4, 1, v4
  v_xor_b32 v2, v2, v4
  v_mul_u32_u24 v3, 1280, v3
  v_lshl_add_u32 v3, v2, 4, v3
  v_add_u32 v8, 2048, v3
  v_add_u32 v2, 192, v1
  v_add_u32 v2, s26, v2
  v_mul_u32_u24 v3, 13108, v2
  v_lshrrev_b32 v3, 20, v3
  v_mul_u32_u24 v4, 80, v3
  v_sub_u32 v2, v2, v4
  v_bfe_u32 v4, v3, 1, 2
  v_bfe_u32 v5, v3, 4, 1
  v_lshl_or_b32 v4, v5, 2, v4
  v_lshlrev_b32 v4, 1, v4
  v_xor_b32 v2, v2, v4
  v_mul_u32_u24 v3, 1280, v3
  v_lshl_add_u32 v3, v2, 4, v3
  v_add_u32 v9, 1024, v3
  v_add_u32 v2, 256, v1
  v_add_u32 v2, s26, v2
  v_mul_u32_u24 v3, 13108, v2
  v_lshrrev_b32 v3, 20, v3
  v_mul_u32_u24 v4, 80, v3
  v_sub_u32 v2, v2, v4
  v_bfe_u32 v4, v3, 1, 2
  v_bfe_u32 v5, v3, 4, 1
  v_lshl_or_b32 v4, v5, 2, v4
  v_lshlrev_b32 v4, 1, v4
  v_xor_b32 v2, v2, v4
  v_mul_u32_u24 v3, 1280, v3
  v_lshl_add_u32 v3, v2, 4, v3
  v_add_u32 v10, 4096, v3
  v_add_u32 v2, 320, v1
  v_add_u32 v2, s26, v2
  v_mul_u32_u24 v3, 13108, v2
  v_lshrrev_b32 v3, 20, v3
  v_mul_u32_u24 v4, 80, v3
  v_sub_u32 v2, v2, v4
  v_bfe_u32 v4, v3, 1, 2
  v_bfe_u32 v5, v3, 4, 1
  v_lshl_or_b32 v4, v5, 2, v4
  v_lshlrev_b32 v4, 1, v4
  v_xor_b32 v2, v2, v4
  v_mul_u32_u24 v3, 1280, v3
  v_lshl_add_u32 v3, v2, 4, v3
  v_add_u32 v11, 3072, v3
  v_add_u32 v2, 384, v1
  v_add_u32 v2, s26, v2
  v_mul_u32_u24 v3, 13108, v2
  v_lshrrev_b32 v3, 20, v3
  v_mul_u32_u24 v4, 80, v3
  v_sub_u32 v2, v2, v4
  v_bfe_u32 v4, v3, 1, 2
  v_bfe_u32 v5, v3, 4, 1
  v_lshl_or_b32 v4, v5, 2, v4
  v_lshlrev_b32 v4, 1, v4
  v_xor_b32 v2, v2, v4
  v_mul_u32_u24 v3, 1280, v3
  v_lshl_add_u32 v3, v2, 4, v3
  v_add_u32 v12, 2048, v3
  v_add_u32 v2, 448, v1
  v_add_u32 v2, s26, v2
  v_mul_u32_u24 v3, 13108, v2
  v_lshrrev_b32 v3, 20, v3
  v_mul_u32_u24 v4, 80, v3
  v_sub_u32 v2, v2, v4
  v_bfe_u32 v4, v3, 1, 2
  v_bfe_u32 v5, v3, 4, 1
  v_lshl_or_b32 v4, v5, 2, v4
  v_lshlrev_b32 v4, 1, v4
  v_xor_b32 v2, v2, v4
  v_mul_u32_u24 v3, 1280, v3
  v_lshl_add_u32 v3, v2, 4, v3
  v_add_u32 v13, 1024, v3
  v_add_u32 v2, 512, v1
  v_add_u32 v2, s26, v2
  v_mul_u32_u24 v3, 13108, v2
  v_lshrrev_b32 v3, 20, v3
  v_mul_u32_u24 v4, 80, v3
  v_sub_u32 v2, v2, v4
  v_bfe_u32 v4, v3, 1, 2
  v_bfe_u32 v5, v3, 4, 1
  v_lshl_or_b32 v4, v5, 2, v4
  v_lshlrev_b32 v4, 1, v4
  v_xor_b32 v2, v2, v4
  v_mul_u32_u24 v3, 1280, v3
  v_lshl_add_u32 v3, v2, 4, v3
  v_add_u32 v14, 4096, v3
  v_add_u32 v2, 576, v1
  v_add_u32 v2, s26, v2
  v_mul_u32_u24 v3, 13108, v2
  v_lshrrev_b32 v3, 20, v3
  v_mul_u32_u24 v4, 80, v3
  v_sub_u32 v2, v2, v4
  v_bfe_u32 v4, v3, 1, 2
  v_bfe_u32 v5, v3, 4, 1
  v_lshl_or_b32 v4, v5, 2, v4
  v_lshlrev_b32 v4, 1, v4
  v_xor_b32 v2, v2, v4
  v_mul_u32_u24 v3, 1280, v3
  v_lshl_add_u32 v3, v2, 4, v3
  v_add_u32 v15, 3072, v3
  v_bfe_u32 v2, v1, 4, 1
  v_bfe_u32 v3, v1, 3, 1
  v_lshl_or_b32 v2, v3, 1, v2
  v_bfe_u32 v3, v1, 2, 1
  v_lshl_or_b32 v4, v3, 2, v2
  v_lshlrev_b32 v2, 1, v2
  v_lshl_or_b32 v2, v3, 4, v2
  v_bfe_u32 v3, v1, 5, 1
  v_lshl_or_b32 v2, v3, 3, v2
  v_mul_u32_u24 v2, 1280, v2
  v_and_b32 v3, 3, v1
  v_lshl_add_u32 v2, v3, 3, v2
  s_mul_i32 s26, s21, 10
  s_add_u32 s27, s26, 0
  v_xor_b32 v3, s27, v4
  v_lshl_add_u32 v248, v3, 5, v2
  s_add_u32 s27, s26, 1
  v_xor_b32 v3, s27, v4
  v_lshl_add_u32 v249, v3, 5, v2
  s_add_u32 s27, s26, 2
  v_xor_b32 v3, s27, v4
  v_lshl_add_u32 v250, v3, 5, v2
  s_add_u32 s27, s26, 3
  v_xor_b32 v3, s27, v4
  v_lshl_add_u32 v251, v3, 5, v2
  s_add_u32 s27, s26, 4
  v_xor_b32 v3, s27, v4
  v_lshl_add_u32 v252, v3, 5, v2
  s_add_u32 s27, s26, 5
  v_xor_b32 v3, s27, v4
  v_lshl_add_u32 v253, v3, 5, v2
  s_add_u32 s27, s26, 6
  v_xor_b32 v3, s27, v4
  v_lshl_add_u32 v254, v3, 5, v2
  s_add_u32 s27, s26, 7
  v_xor_b32 v3, s27, v4
  v_lshl_add_u32 v255, v3, 5, v2
  s_add_u32 s27, s26, 8
  v_xor_b32 v3, s27, v4
  v_lshl_add_u32 v22, v3, 5, v2
  s_add_u32 s27, s26, 9
  v_xor_b32 v3, s27, v4
  v_lshl_add_u32 v23, v3, 5, v2
  s_mul_i32 s28, s20, 245760
  s_mul_i32 s35, s21, 10240
  s_add_u32 s27, s28, 0x0
  s_add_u32 m0, s35, 0
  s_nop 0
  buffer_load_dwordx4 v6, s[8:11], s27 offen offset:0 lds
  buffer_load_dwordx4 v7, s[8:11], s27 offen offset:1024 lds
  buffer_load_dwordx4 v8, s[8:11], s27 offen offset:2048 lds
  buffer_load_dwordx4 v9, s[8:11], s27 offen offset:3072 lds
  s_add_u32 m0, s35, 4096
  s_nop 0
  buffer_load_dwordx4 v10, s[8:11], s27 offen offset:0 lds
  buffer_load_dwordx4 v11, s[8:11], s27 offen offset:1024 lds
  buffer_load_dwordx4 v12, s[8:11], s27 offen offset:2048 lds
  buffer_load_dwordx4 v13, s[8:11], s27 offen offset:3072 lds
  s_add_u32 m0, s35, 8192
  s_nop 0
  buffer_load_dwordx4 v14, s[8:11], s27 offen offset:0 lds
  buffer_load_dwordx4 v15, s[8:11], s27 offen offset:1024 lds
  s_add_u32 s27, s28, 0xa000
  s_add_u32 m0, s35, 40960
  s_nop 0
  buffer_load_dwordx4 v6, s[8:11], s27 offen offset:0 lds
  buffer_load_dwordx4 v7, s[8:11], s27 offen offset:1024 lds
  buffer_load_dwordx4 v8, s[8:11], s27 offen offset:2048 lds
  buffer_load_dwordx4 v9, s[8:11], s27 offen offset:3072 lds
  s_add_u32 m0, s35, 45056
  s_nop 0
  buffer_load_dwordx4 v10, s[8:11], s27 offen offset:0 lds
  buffer_load_dwordx4 v11, s[8:11], s27 offen offset:1024 lds
  buffer_load_dwordx4 v12, s[8:11], s27 offen offset:2048 lds
  buffer_load_dwordx4 v13, s[8:11], s27 offen offset:3072 lds
  s_add_u32 m0, s35, 49152
  s_nop 0
  buffer_load_dwordx4 v14, s[8:11], s27 offen offset:0 lds
  buffer_load_dwordx4 v15, s[8:11], s27 offen offset:1024 lds
  s_waitcnt vmcnt(10) lgkmcnt(0)
  s_barrier
  s_add_u32 s27, s28, 0x14000
  s_add_u32 m0, s35, 81920
  s_nop 0
  buffer_load_dwordx4 v6, s[8:11], s27 offen offset:0 lds
  buffer_load_dwordx4 v7, s[8:11], s27 offen offset:1024 lds
  buffer_load_dwordx4 v8, s[8:11], s27 offen offset:2048 lds
  buffer_load_dwordx4 v9, s[8:11], s27 offen offset:3072 lds
  s_add_u32 m0, s35, 86016
  s_nop 0
  buffer_load_dwordx4 v10, s[8:11], s27 offen offset:0 lds
  buffer_load_dwordx4 v11, s[8:11], s27 offen offset:1024 lds
  buffer_load_dwordx4 v12, s[8:11], s27 offen offset:2048 lds
  buffer_load_dwordx4 v13, s[8:11], s27 offen offset:3072 lds
  s_add_u32 m0, s35, 90112
  s_nop 0
  buffer_load_dwordx4 v14, s[8:11], s27 offen offset:0 lds
  buffer_load_dwordx4 v15, s[8:11], s27 offen offset:1024 lds
  ds_read_b64_tr_b16 a[216:217], v248 offset:0
  ds_read_b64_tr_b16 a[218:219], v248 offset:1280
  ds_read_b64_tr_b16 a[224:225], v249 offset:0
  ds_read_b64_tr_b16 a[226:227], v249 offset:1280
  ds_read_b64_tr_b16 a[232:233], v250 offset:0
  ds_read_b64_tr_b16 a[234:235], v250 offset:1280
  ds_read_b64_tr_b16 a[240:241], v251 offset:0
  ds_read_b64_tr_b16 a[242:243], v251 offset:1280
  ds_read_b64_tr_b16 a[248:249], v252 offset:0
  ds_read_b64_tr_b16 a[250:251], v252 offset:1280
  ds_read_b64_tr_b16 v[128:129], v253 offset:0
  ds_read_b64_tr_b16 v[130:131], v253 offset:1280
  ds_read_b64_tr_b16 v[136:137], v254 offset:0
  ds_read_b64_tr_b16 v[138:139], v254 offset:1280
  ds_read_b64_tr_b16 v[144:145], v255 offset:0
  ds_read_b64_tr_b16 v[146:147], v255 offset:1280
  ds_read_b64_tr_b16 v[152:153], v22 offset:0
  ds_read_b64_tr_b16 v[154:155], v22 offset:1280
  ds_read_b64_tr_b16 v[160:161], v23 offset:0
  ds_read_b64_tr_b16 v[162:163], v23 offset:1280
  s_waitcnt vmcnt(10) lgkmcnt(0)
  s_barrier
  s_add_u32 s27, s28, 0x1e000
  s_add_u32 m0, s35, 122880
  s_nop 0
  buffer_load_dwordx4 v6, s[8:11], s27 offen offset:0 lds
  buffer_load_dwordx4 v7, s[8:11], s27 offen offset:1024 lds
  buffer_load_dwordx4 v8, s[8:11], s27 offen offset:2048 lds
  buffer_load_dwordx4 v9, s[8:11], s27 offen offset:3072 lds
  s_add_u32 m0, s35, 126976
  s_nop 0
  buffer_load_dwordx4 v10, s[8:11], s27 offen offset:0 lds
  buffer_load_dwordx4 v11, s[8:11], s27 offen offset:1024 lds
  buffer_load_dwordx4 v12, s[8:11], s27 offen offset:2048 lds
  buffer_load_dwordx4 v13, s[8:11], s27 offen offset:3072 lds
  s_add_u32 m0, s35, 131072
  s_nop 0
  buffer_load_dwordx4 v14, s[8:11], s27 offen offset:0 lds
  buffer_load_dwordx4 v15, s[8:11], s27 offen offset:1024 lds
  v_add_u32 v2, 40960, v248
  ds_read_b64_tr_b16 a[220:221], v2 offset:0
  ds_read_b64_tr_b16 a[222:223], v2 offset:1280
  v_add_u32 v2, 40960, v249
  ds_read_b64_tr_b16 a[228:229], v2 offset:0
  ds_read_b64_tr_b16 a[230:231], v2 offset:1280
  v_add_u32 v2, 40960, v250
  ds_read_b64_tr_b16 a[236:237], v2 offset:0
  ds_read_b64_tr_b16 a[238:239], v2 offset:1280
  v_add_u32 v2, 40960, v251
  ds_read_b64_tr_b16 a[244:245], v2 offset:0
  ds_read_b64_tr_b16 a[246:247], v2 offset:1280
  v_add_u32 v2, 40960, v252
  ds_read_b64_tr_b16 a[252:253], v2 offset:0
  ds_read_b64_tr_b16 a[254:255], v2 offset:1280
  v_add_u32 v2, 40960, v253
  ds_read_b64_tr_b16 v[132:133], v2 offset:0
  ds_read_b64_tr_b16 v[134:135], v2 offset:1280
  v_add_u32 v2, 40960, v254
  ds_read_b64_tr_b16 v[140:141], v2 offset:0
  ds_read_b64_tr_b16 v[142:143], v2 offset:1280
  v_add_u32 v2, 40960, v255
  ds_read_b64_tr_b16 v[148:149], v2 offset:0
  ds_read_b64_tr_b16 v[150:151], v2 offset:1280
  v_add_u32 v2, 40960, v22
  ds_read_b64_tr_b16 v[156:157], v2 offset:0
  ds_read_b64_tr_b16 v[158:159], v2 offset:1280
  v_add_u32 v2, 40960, v23
  ds_read_b64_tr_b16 v[164:165], v2 offset:0
  ds_read_b64_tr_b16 v[166:167], v2 offset:1280
  s_waitcnt vmcnt(10) lgkmcnt(0)
  s_barrier
  s_add_u32 s27, s28, 0x28000
  s_add_u32 m0, s35, 0
  s_nop 0
  buffer_load_dwordx4 v6, s[8:11], s27 offen offset:0 lds
  buffer_load_dwordx4 v7, s[8:11], s27 offen offset:1024 lds
  buffer_load_dwordx4 v8, s[8:11], s27 offen offset:2048 lds
  buffer_load_dwordx4 v9, s[8:11], s27 offen offset:3072 lds
  s_add_u32 m0, s35, 4096
  s_nop 0
  buffer_load_dwordx4 v10, s[8:11], s27 offen offset:0 lds
  buffer_load_dwordx4 v11, s[8:11], s27 offen offset:1024 lds
  buffer_load_dwordx4 v12, s[8:11], s27 offen offset:2048 lds
  buffer_load_dwordx4 v13, s[8:11], s27 offen offset:3072 lds
  s_add_u32 m0, s35, 8192
  s_nop 0
  buffer_load_dwordx4 v14, s[8:11], s27 offen offset:0 lds
  buffer_load_dwordx4 v15, s[8:11], s27 offen offset:1024 lds
  v_add_u32 v2, 81920, v248
  ds_read_b64_tr_b16 v[168:169], v2 offset:0
  ds_read_b64_tr_b16 v[170:171], v2 offset:1280
  v_add_u32 v2, 81920, v249
  ds_read_b64_tr_b16 v[176:177], v2 offset:0
  ds_read_b64_tr_b16 v[178:179], v2 offset:1280
  v_add_u32 v2, 81920, v250
  ds_read_b64_tr_b16 v[184:185], v2 offset:0
  ds_read_b64_tr_b16 v[186:187], v2 offset:1280
  v_add_u32 v2, 81920, v251
  ds_read_b64_tr_b16 v[192:193], v2 offset:0
  ds_read_b64_tr_b16 v[194:195], v2 offset:1280
  v_add_u32 v2, 81920, v252
  ds_read_b64_tr_b16 v[200:201], v2 offset:0
  ds_read_b64_tr_b16 v[202:203], v2 offset:1280
  v_add_u32 v2, 81920, v253
  ds_read_b64_tr_b16 v[208:209], v2 offset:0
  ds_read_b64_tr_b16 v[210:211], v2 offset:1280
  v_add_u32 v2, 81920, v254
  ds_read_b64_tr_b16 v[216:217], v2 offset:0
  ds_read_b64_tr_b16 v[218:219], v2 offset:1280
  v_add_u32 v2, 81920, v255
  ds_read_b64_tr_b16 v[224:225], v2 offset:0
  ds_read_b64_tr_b16 v[226:227], v2 offset:1280
  v_add_u32 v2, 81920, v22
  ds_read_b64_tr_b16 v[232:233], v2 offset:0
  ds_read_b64_tr_b16 v[234:235], v2 offset:1280
  v_add_u32 v2, 81920, v23
  ds_read_b64_tr_b16 v[240:241], v2 offset:0
  ds_read_b64_tr_b16 v[242:243], v2 offset:1280
  s_waitcnt vmcnt(10) lgkmcnt(0)
  s_barrier
  s_add_u32 s27, s28, 0x32000
  s_add_u32 m0, s35, 40960
  s_nop 0
  buffer_load_dwordx4 v6, s[8:11], s27 offen offset:0 lds
  buffer_load_dwordx4 v7, s[8:11], s27 offen offset:1024 lds
  buffer_load_dwordx4 v8, s[8:11], s27 offen offset:2048 lds
  buffer_load_dwordx4 v9, s[8:11], s27 offen offset:3072 lds
  s_add_u32 m0, s35, 45056
  s_nop 0
  buffer_load_dwordx4 v10, s[8:11], s27 offen offset:0 lds
  buffer_load_dwordx4 v11, s[8:11], s27 offen offset:1024 lds
  buffer_load_dwordx4 v12, s[8:11], s27 offen offset:2048 lds
  buffer_load_dwordx4 v13, s[8:11], s27 offen offset:3072 lds
  s_add_u32 m0, s35, 49152
  s_nop 0
  buffer_load_dwordx4 v14, s[8:11], s27 offen offset:0 lds
  buffer_load_dwordx4 v15, s[8:11], s27 offen offset:1024 lds
  v_add_u32 v2, 122880, v248
  ds_read_b64_tr_b16 v[172:173], v2 offset:0
  ds_read_b64_tr_b16 v[174:175], v2 offset:1280
  v_add_u32 v2, 122880, v249
  ds_read_b64_tr_b16 v[180:181], v2 offset:0
  ds_read_b64_tr_b16 v[182:183], v2 offset:1280
  v_add_u32 v2, 122880, v250
  ds_read_b64_tr_b16 v[188:189], v2 offset:0
  ds_read_b64_tr_b16 v[190:191], v2 offset:1280
  v_add_u32 v2, 122880, v251
  ds_read_b64_tr_b16 v[196:197], v2 offset:0
  ds_read_b64_tr_b16 v[198:199], v2 offset:1280
  v_add_u32 v2, 122880, v252
  ds_read_b64_tr_b16 v[204:205], v2 offset:0
  ds_read_b64_tr_b16 v[206:207], v2 offset:1280
  v_add_u32 v2, 122880, v253
  ds_read_b64_tr_b16 v[212:213], v2 offset:0
  ds_read_b64_tr_b16 v[214:215], v2 offset:1280
  v_add_u32 v2, 122880, v254
  ds_read_b64_tr_b16 v[220:221], v2 offset:0
  ds_read_b64_tr_b16 v[222:223], v2 offset:1280
  v_add_u32 v2, 122880, v255
  ds_read_b64_tr_b16 v[228:229], v2 offset:0
  ds_read_b64_tr_b16 v[230:231], v2 offset:1280
  v_add_u32 v2, 122880, v22
  ds_read_b64_tr_b16 v[236:237], v2 offset:0
  ds_read_b64_tr_b16 v[238:239], v2 offset:1280
  v_add_u32 v2, 122880, v23
  ds_read_b64_tr_b16 v[244:245], v2 offset:0
  ds_read_b64_tr_b16 v[246:247], v2 offset:1280
  s_waitcnt vmcnt(10) lgkmcnt(0)
  s_barrier
  ds_read_b64_tr_b16 v[48:49], v248 offset:0
  ds_read_b64_tr_b16 v[50:51], v248 offset:1280
  ds_read_b64_tr_b16 v[56:57], v249 offset:0
  ds_read_b64_tr_b16 v[58:59], v249 offset:1280
  ds_read_b64_tr_b16 v[64:65], v250 offset:0
  ds_read_b64_tr_b16 v[66:67], v250 offset:1280
  ds_read_b64_tr_b16 v[72:73], v251 offset:0
  ds_read_b64_tr_b16 v[74:75], v251 offset:1280
  ds_read_b64_tr_b16 v[80:81], v252 offset:0
  ds_read_b64_tr_b16 v[82:83], v252 offset:1280
  ds_read_b64_tr_b16 v[88:89], v253 offset:0
  ds_read_b64_tr_b16 v[90:91], v253 offset:1280
  ds_read_b64_tr_b16 v[96:97], v254 offset:0
  ds_read_b64_tr_b16 v[98:99], v254 offset:1280
  ds_read_b64_tr_b16 v[104:105], v255 offset:0
  ds_read_b64_tr_b16 v[106:107], v255 offset:1280
  ds_read_b64_tr_b16 v[112:113], v22 offset:0
  ds_read_b64_tr_b16 v[114:115], v22 offset:1280
  ds_read_b64_tr_b16 v[120:121], v23 offset:0
  ds_read_b64_tr_b16 v[122:123], v23 offset:1280
  s_waitcnt vmcnt(0) lgkmcnt(0)
  s_barrier
  v_add_u32 v2, 40960, v248
  ds_read_b64_tr_b16 v[52:53], v2 offset:0
  ds_read_b64_tr_b16 v[54:55], v2 offset:1280
  v_add_u32 v2, 40960, v249
  ds_read_b64_tr_b16 v[60:61], v2 offset:0
  ds_read_b64_tr_b16 v[62:63], v2 offset:1280
  v_add_u32 v2, 40960, v250
  ds_read_b64_tr_b16 v[68:69], v2 offset:0
  ds_read_b64_tr_b16 v[70:71], v2 offset:1280
  v_add_u32 v2, 40960, v251
  ds_read_b64_tr_b16 v[76:77], v2 offset:0
  ds_read_b64_tr_b16 v[78:79], v2 offset:1280
  v_add_u32 v2, 40960, v252
  ds_read_b64_tr_b16 v[84:85], v2 offset:0
  ds_read_b64_tr_b16 v[86:87], v2 offset:1280
  v_add_u32 v2, 40960, v253
  ds_read_b64_tr_b16 v[92:93], v2 offset:0
  ds_read_b64_tr_b16 v[94:95], v2 offset:1280
  v_add_u32 v2, 40960, v254
  ds_read_b64_tr_b16 v[100:101], v2 offset:0
  ds_read_b64_tr_b16 v[102:103], v2 offset:1280
  v_add_u32 v2, 40960, v255
  ds_read_b64_tr_b16 v[108:109], v2 offset:0
  ds_read_b64_tr_b16 v[110:111], v2 offset:1280
  v_add_u32 v2, 40960, v22
  ds_read_b64_tr_b16 v[116:117], v2 offset:0
  ds_read_b64_tr_b16 v[118:119], v2 offset:1280
  v_add_u32 v2, 40960, v23
  ds_read_b64_tr_b16 v[124:125], v2 offset:0
  ds_read_b64_tr_b16 v[126:127], v2 offset:1280
  s_waitcnt lgkmcnt(0)
  s_barrier
  s_mul_i32 s34, s21, 26624
  s_add_u32 s34, s34, 16384
  v_lshlrev_b32 v4, 4, v1
  v_add_u32 v4, s34, v4
  ds_write_b128 v4, v[24:27] offset:0
  ds_write_b128 v4, v[28:31] offset:1024
  ds_write_b128 v4, v[32:35] offset:2048
  ds_write_b128 v4, v[36:39] offset:3072
  ds_write_b128 v4, v[40:43] offset:4096
  ds_write_b128 v4, v[44:47] offset:5120
  ds_write_b128 v4, v[48:51] offset:6144
  ds_write_b128 v4, v[52:55] offset:7168
  ds_write_b128 v4, v[56:59] offset:8192
  ds_write_b128 v4, v[60:63] offset:9216
  ds_write_b128 v4, v[64:67] offset:10240
  ds_write_b128 v4, v[68:71] offset:11264
  ds_write_b128 v4, v[72:75] offset:12288
  ds_write_b128 v4, v[76:79] offset:13312
  ds_write_b128 v4, v[80:83] offset:14336
  ds_write_b128 v4, v[84:87] offset:15360
  ds_write_b128 v4, v[88:91] offset:16384
  ds_write_b128 v4, v[92:95] offset:17408
  ds_write_b128 v4, v[96:99] offset:18432
  ds_write_b128 v4, v[100:103] offset:19456
  ds_write_b128 v4, v[104:107] offset:20480
  ds_write_b128 v4, v[108:111] offset:21504
  ds_write_b128 v4, v[112:115] offset:22528
  ds_write_b128 v4, v[116:119] offset:23552
  ds_write_b128 v4, v[120:123] offset:24576
  ds_write_b128 v4, v[124:127] offset:25600
  s_waitcnt lgkmcnt(0)
  v_and_b32 v2, 3, v1
  v_lshlrev_b32 v2, 2, v2
Lcw_117:
  s_add_u32 s24, s24, 1
  s_cmp_gt_u32 s24, 300000
  s_cbranch_scc1 Lfail_116
  buffer_load_dword v3, v2, s[12:15], 0 offen offset:128 sc1
  s_waitcnt vmcnt(0)
  v_cmp_eq_u32 vcc, 0, v3
  s_and_b32 s26, vcc_lo, 10
  s_cmp_eq_u32 s26, 0
  s_cbranch_scc1 Lcok_118
  s_sleep 6
  s_branch Lcw_117
Lcok_118:
  v_readlane_b32 s23, v3, 3
  s_and_b32 s23, s23, 0x2000
  v_lshlrev_b32 v6, 4, v1
  s_lshl_b32 s26, s21, 10
  v_add_u32 v7, s26, v6
  v_lshrrev_b32 v8, 1, v7
  v_and_b32 v2, 1, v1
  v_mov_b32 v3, 0x4444
  v_mov_b32 v9, 0xeeee
  v_cmp_eq_u32 vcc, 0, v2
  s_nop 1
  v_cndmask_b32 v9, v9, v3, vcc
  v_mov_b32 v0, 0
  s_add_u32 s48, s23, 0x178000
  s_add_u32 s49, s48, 16384
  s_add_u32 s26, s21, 1
  s_and_b32 s26, s26, 3
  s_lshl_b32 s80, s26, 10
  s_add_u32 s26, s21, 2
  s_and_b32 s26, s26, 3
  s_lshl_b32 s81, s26, 10
  s_add_u32 s26, s21, 3
  s_and_b32 s26, s26, 3
  s_lshl_b32 s82, s26, 10
  s_lshr_b32 s27, s21, 1
  s_mul_i32 s27, s27, 3
  s_and_b32 s28, s21, 1
  s_lshl_b32 s28, s28, 1
  s_add_u32 s26, s27, s28
  s_add_u32 s27, s27, 1
  v_bfe_u32 v2, v1, 3, 1
  v_lshlrev_b32 v2, 8, v2
  v_bfe_u32 v3, v1, 2, 1
  v_lshl_add_u32 v2, v3, 4, v2
  v_and_b32 v3, 3, v1
  v_lshl_add_u32 v2, v3, 2, v2
  v_lshrrev_b32 v3, 4, v1
  v_lshl_add_u32 v2, v3, 6, v2
  s_lshl_b32 s26, s26, 9
  s_add_u32 s26, s26, 12288
  v_add_u32 v11, s26, v2
  s_lshl_b32 s27, s27, 9
  s_add_u32 s27, s27, s28
  s_add_u32 s27, s27, 12288
  v_add_u32 v14, s27, v2
  v_and_b32 v2, 15, v1
  v_lshlrev_b32 v2, 4, v2
  v_lshl_add_u32 v15, v3, 14, v2
  v_mov_b32 v252, -1
  v_mov_b32 v253, -1
  v_mov_b32 v254, -1
  v_mov_b32 v255, -1
  s_mul_i32 s53, s21, 163840
  s_lshl_b32 s26, s20, 8
  s_add_u32 s53, s53, s26
  s_add_u32 s53, s53, s23
  s_lshl_b32 s47, s20, 7
  s_add_u32 s47, s47, s48
  s_add_u32 s47, s47, 4096
  s_mov_b32 s22, 0
  s_barrier
Lvl_119:
  v_mov_b32 v56, 0
  v_mov_b32 v57, 0
  v_mov_b32 v58, 0
  v_mov_b32 v59, 0
  v_mov_b32 v60, 0
  v_mov_b32 v61, 0
  v_mov_b32 v62, 0
  v_mov_b32 v63, 0
  v_mov_b32 v64, 0
  v_mov_b32 v65, 0
  v_mov_b32 v66, 0
  v_mov_b32 v67, 0
  ds_read_b128 v[80:83], v4 offset:0
  ds_read_b128 v[84:87], v4 offset:1024
  ds_read_b128 v[88:91], v4 offset:2048
  ds_read_b128 v[92:95], v4 offset:3072
  ds_read_b128 v[96:99], v4 offset:4096
  ds_read_b128 v[100:103], v4 offset:5120
  ds_read_b128 v[104:107], v4 offset:6144
  ds_read_b128 v[108:111], v4 offset:7168
  ds_read_b128 v[112:115], v4 offset:8192
  ds_read_b128 v[116:119], v4 offset:9216
  ds_read_b128 v[120:123], v4 offset:10240
  ds_read_b128 v[124:127], v4 offset:11264
  s_and_b32 s26, s22, 1
  s_mul_i32 s27, s26, 655360
  s_add_u32 s60, s53, s27
  s_xor_b32 s26, s26, 1
  s_mul_i32 s27, s26, 655360
  s_add_u32 s62, s53, s27
  s_and_b32 s26, s22, 3
  s_lshl_b32 s26, s26, 15
  s_add_u32 s50, s26, s23
  s_add_u32 s50, s50, 0x158000
  s_add_u32 s51, s50, 4096
  s_add_u32 s52, s50, 16384
  s_mov_b32 s38, s22
  s_cmp_eq_u32 s22, 0
  s_cbranch_scc1 Lmp0_121
  v_and_b32 v2, 7, v1
  s_lshl_b32 s26, s21, 3
  v_add_u32 v2, s26, v2
  v_lshlrev_b32 v2, 7, v2
  v_bfe_u32 v3, v1, 3, 1
  v_lshl_add_u32 v3, v3, 12, v2
Ltf_122:
  buffer_load_dword v2, v3, s[4:7], s48 offen sc1
  s_memrealtime s[98:99]
  s_add_u32 s24, s24, 1
  s_cmp_gt_u32 s24, 300000
  s_cbranch_scc1 Lfail_120
  s_waitcnt vmcnt(0) lgkmcnt(0)
Ltk_125:
  v_and_b32 v12, 0xff, v2
  v_cmp_gt_u32 vcc, s38, v12
  s_cbranch_vccz Ltok_126
  s_sleep 1
  s_branch Ltf_122
Ltok_126:
  v_cmp_lt_u32 vcc, s38, v12
  s_cbranch_vccnz Ltg_123
  s_lshl_b32 s98, s98, 8
  v_subrev_u32 v2, s98, v2
  s_nop 1
  v_max_i32_dpp v2, v2, v2 row_ror:8 row_mask:0xf bank_mask:0xf
  s_nop 1
  v_max_i32_dpp v2, v2, v2 row_ror:4 row_mask:0xf bank_mask:0xf
  s_nop 1
  v_max_i32_dpp v2, v2, v2 row_ror:2 row_mask:0xf bank_mask:0xf
  s_nop 1
  v_max_i32_dpp v2, v2, v2 row_ror:1 row_mask:0xf bank_mask:0xf
  s_nop 0
  v_readlane_b32 s96, v2, 0
  s_min_i32 s96, s96, 0x6700
  s_add_u32 s96, s96, s98
  s_add_u32 s96, s96, 0x4d00
Ltc_127:
  s_memrealtime s[98:99]
  s_waitcnt lgkmcnt(0)
  s_lshl_b32 s98, s98, 8
  s_sub_u32 s98, s96, s98
  s_cmp_gt_i32 s98, 255
  s_cbranch_scc1 Ltc_127
Ltg_123:
Lmp0_121:
Lmp_128:
  buffer_load_dwordx4 v[16:19], v7, s[4:7], s50 offen sc1
  buffer_load_dwordx4 v[32:35], v7, s[4:7], s51 offen sc1
  buffer_load_dwordx2 v[52:53], v8, s[4:7], s52 offen sc1
  s_add_u32 s24, s24, 1
  s_cmp_gt_u32 s24, 300000
  s_cbranch_scc1 Lfail_120
  v_add_u32 v3, s81, v6
  v_add_u32 v12, s82, v6
  s_waitcnt vmcnt(0) lgkmcnt(0)
  v_max3_u32 v2, v16, v17, v18
  v_max3_u32 v2, v2, v19, v32
  v_max3_u32 v2, v2, v33, v34
  v_max3_u32 v2, v2, v35, v52
  v_max_u32 v2, v2, v53
  v_cmp_eq_u32 vcc, -1, v2
  s_cbranch_vccnz Lmp_128
  ds_write_b128 v7, v[16:19] offset:0
  ds_write_b128 v7, v[32:35] offset:4096
  ds_write_b64 v8, v[52:53] offset:8192
  v_add_u32 v2, s80, v6
  v_smfmac_f32_16x16x64_bf16 v[56:59], v[16:19], a[0:7], v9
  v_smfmac_f32_16x16x64_bf16 v[60:63], v[16:19], a[8:15], v9
  v_smfmac_f32_16x16x64_bf16 v[64:67], v[16:19], a[16:23], v9
  s_waitcnt lgkmcnt(0)
  s_barrier
  ds_read_b128 v[52:55], v6 offset:9216
  ds_read_b128 v[48:51], v6 offset:8192
  ds_read_b128 v[20:23], v2 offset:0
  ds_read_b128 v[24:27], v3 offset:0
  ds_read_b128 v[28:31], v12 offset:0
  ds_read_b128 v[36:39], v2 offset:4096
  ds_read_b128 v[40:43], v3 offset:4096
  ds_read_b128 v[44:47], v12 offset:4096
  s_memrealtime s[96:97]
  v_smfmac_f32_16x16x64_bf16 v[56:59], v[32:35], a[96:103], v9
  v_smfmac_f32_16x16x64_bf16 v[60:63], v[32:35], a[104:111], v9
  v_smfmac_f32_16x16x64_bf16 v[64:67], v[32:35], a[112:119], v9
  v_mov_b64 v[16:17], 0
  v_mov_b64 v[18:19], 0
  s_waitcnt lgkmcnt(7)
  v_smfmac_f32_16x16x64_bf16 v[56:59], v[52:55], v[80:87], v9
  v_mov_b64 v[32:33], 0
  v_mov_b64 v[34:35], 0
  v_smfmac_f32_16x16x64_bf16 v[60:63], v[52:55], v[88:95], v9
  v_smfmac_f32_16x16x64_bf16 v[64:67], v[52:55], v[96:103], v9
  s_waitcnt lgkmcnt(6)
  v_smfmac_f32_16x16x64_bf16 v[56:59], v[48:51], a[192:199], v9
  v_mov_b64 v[52:53], 0
  v_mov_b64 v[54:55], 0
  v_smfmac_f32_16x16x64_bf16 v[60:63], v[48:51], a[200:207], v9
  v_smfmac_f32_16x16x64_bf16 v[64:67], v[48:51], a[208:215], v9
  s_waitcnt lgkmcnt(5)
  v_smfmac_f32_16x16x64_bf16 v[56:59], v[20:23], a[24:31], v9
  v_mov_b64 v[48:49], 0
  v_mov_b64 v[50:51], 0
  v_smfmac_f32_16x16x64_bf16 v[60:63], v[20:23], a[32:39], v9
  v_smfmac_f32_16x16x64_bf16 v[64:67], v[20:23], a[40:47], v9
  s_waitcnt lgkmcnt(0)
  s_cmp_lg_u32 s21, 3
  s_cbranch_scc1 Lefv_129
  s_add_u32 s26, s96, 83
  s_lshl_b32 s26, s26, 8
  s_add_u32 s26, s26, s22
  s_add_u32 s26, s26, 1
  v_mov_b32 v13, s26
  s_mov_b64 exec, 1
  buffer_store_dword v13, v0, s[4:7], s47 offen sc1
  s_mov_b64 exec, -1
Lefv_129:
  v_smfmac_f32_16x16x64_bf16 v[56:59], v[24:27], a[48:55], v9
  v_mov_b64 v[20:21], 0
  v_mov_b64 v[22:23], 0
  v_smfmac_f32_16x16x64_bf16 v[60:63], v[24:27], a[56:63], v9
  v_smfmac_f32_16x16x64_bf16 v[64:67], v[24:27], a[64:71], v9
  v_smfmac_f32_16x16x64_bf16 v[56:59], v[28:31], a[72:79], v9
  v_mov_b64 v[24:25], 0
  v_mov_b64 v[26:27], 0
  v_smfmac_f32_16x16x64_bf16 v[60:63], v[28:31], a[80:87], v9
  ds_read_b128 v[80:83], v4 offset:12288
  ds_read_b128 v[84:87], v4 offset:13312
  v_smfmac_f32_16x16x64_bf16 v[64:67], v[28:31], a[88:95], v9
  v_smfmac_f32_16x16x64_bf16 v[56:59], v[36:39], a[120:127], v9
  v_mov_b64 v[28:29], 0
  v_mov_b64 v[30:31], 0
  v_smfmac_f32_16x16x64_bf16 v[60:63], v[36:39], a[128:135], v9
  ds_read_b128 v[88:91], v4 offset:14336
  ds_read_b128 v[92:95], v4 offset:15360
  v_smfmac_f32_16x16x64_bf16 v[64:67], v[36:39], a[136:143], v9
  v_smfmac_f32_16x16x64_bf16 v[56:59], v[40:43], a[144:151], v9
  v_mov_b64 v[36:37], 0
  v_mov_b64 v[38:39], 0
  v_smfmac_f32_16x16x64_bf16 v[60:63], v[40:43], a[152:159], v9
  ds_read_b128 v[96:99], v4 offset:16384
  ds_read_b128 v[100:103], v4 offset:17408
  v_smfmac_f32_16x16x64_bf16 v[64:67], v[40:43], a[160:167], v9
  v_smfmac_f32_16x16x64_bf16 v[56:59], v[44:47], a[168:175], v9
  v_mov_b64 v[40:41], 0
  v_mov_b64 v[42:43], 0
  v_smfmac_f32_16x16x64_bf16 v[60:63], v[44:47], a[176:183], v9
  v_smfmac_f32_16x16x64_bf16 v[64:67], v[44:47], a[184:191], v9
  v_mov_b64 v[44:45], 0
  v_mov_b64 v[46:47], 0
  s_nop 5
  v_add_f32 v56, v56, v57
  v_add_f32 v58, v58, v59
  v_add_f32 v60, v60, v61
  v_add_f32 v62, v62, v63
  v_add_f32 v64, v64, v65
  v_add_f32 v66, v66, v67
  v_cvt_pk_bf16_f32 v57, v56, v60
  v_cvt_pk_bf16_f32 v59, v58, v62
  v_cvt_pk_bf16_f32 v65, v64, v66
  ds_write_b32 v11, v57
  ds_write_b32 v11, v59 offset:32
  ds_write_b16 v14, v65
  ds_write_b16_d16_hi v14, v65 offset:32
  s_waitcnt lgkmcnt(0)
  s_barrier
  ds_read_b128 v[76:79], v6 offset:14336
  ds_read_b128 v[68:71], v6 offset:12288
  ds_read_b128 v[72:75], v6 offset:13312
  s_waitcnt lgkmcnt(0)
  v_smfmac_f32_16x16x64_bf16 v[16:19], v[76:79], v[104:111], v9
  ds_read_b128 v[104:107], v4 offset:18432
  ds_read_b128 v[108:111], v4 offset:19456
  v_smfmac_f32_16x16x64_bf16 v[16:19], v[68:71], a[216:223], v9
  v_smfmac_f32_16x16x64_bf16 v[16:19], v[72:75], v[168:175], v9
  v_smfmac_f32_16x16x64_bf16 v[20:23], v[76:79], v[112:119], v9
  ds_read_b128 v[112:115], v4 offset:20480
  ds_read_b128 v[116:119], v4 offset:21504
  v_smfmac_f32_16x16x64_bf16 v[20:23], v[68:71], a[224:231], v9
  s_nop 2
  v_smfmac_f32_16x16x64_bf16 v[20:23], v[72:75], v[176:183], v9
  v_smfmac_f32_16x16x64_bf16 v[24:27], v[76:79], v[120:127], v9
  v_add_f32 v16, v16, v17
  v_add_f32 v18, v18, v19
  v_smfmac_f32_16x16x64_bf16 v[24:27], v[68:71], a[232:239], v9
  v_cvt_pk_bf16_f32 v56, v16, v18
  v_min_u32 v56, -2, v56
  v_smfmac_f32_16x16x64_bf16 v[24:27], v[72:75], v[184:191], v9
  ds_read_b128 v[120:123], v4 offset:22528
  ds_read_b128 v[124:127], v4 offset:23552
  v_smfmac_f32_16x16x64_bf16 v[28:31], v[76:79], v[80:87], v9
  v_add_f32 v20, v20, v21
  v_add_f32 v22, v22, v23
  v_smfmac_f32_16x16x64_bf16 v[28:31], v[68:71], a[240:247], v9
  v_cvt_pk_bf16_f32 v57, v20, v22
  v_min_u32 v57, -2, v57
  v_smfmac_f32_16x16x64_bf16 v[28:31], v[72:75], v[192:199], v9
  ds_read_b128 v[80:83], v4 offset:24576
  ds_read_b128 v[84:87], v4 offset:25600
  v_smfmac_f32_16x16x64_bf16 v[32:35], v[76:79], v[88:95], v9
  v_add_f32 v24, v24, v25
  v_add_f32 v26, v26, v27
  v_smfmac_f32_16x16x64_bf16 v[32:35], v[68:71], a[248:255], v9
  v_cvt_pk_bf16_f32 v58, v24, v26
  v_min_u32 v58, -2, v58
  v_smfmac_f32_16x16x64_bf16 v[32:35], v[72:75], v[200:207], v9
  s_nop 0
  v_smfmac_f32_16x16x64_bf16 v[36:39], v[76:79], v[96:103], v9
  v_add_f32 v28, v28, v29
  v_add_f32 v30, v30, v31
  v_smfmac_f32_16x16x64_bf16 v[36:39], v[68:71], v[128:135], v9
  v_cvt_pk_bf16_f32 v59, v28, v30
  v_min_u32 v59, -2, v59
  v_smfmac_f32_16x16x64_bf16 v[36:39], v[72:75], v[208:215], v9
  s_nop 0
  s_waitcnt lgkmcnt(0)
  v_smfmac_f32_16x16x64_bf16 v[40:43], v[76:79], v[104:111], v9
  v_add_f32 v32, v32, v33
  v_add_f32 v34, v34, v35
  v_smfmac_f32_16x16x64_bf16 v[40:43], v[68:71], v[136:143], v9
  v_cvt_pk_bf16_f32 v60, v32, v34
  v_min_u32 v60, -2, v60
  v_smfmac_f32_16x16x64_bf16 v[40:43], v[72:75], v[216:223], v9
  s_nop 1
  v_permlane32_swap_b32 v56, v58
  v_permlane32_swap_b32 v57, v59
  s_nop 1
  v_permlane16_swap_b32 v56, v57
  v_permlane16_swap_b32 v58, v59
  buffer_store_dwordx4 v[56:59], v15, s[4:7], s60 offen sc1
  s_add_u32 s60, s60, 65536
  v_smfmac_f32_16x16x64_bf16 v[44:47], v[76:79], v[112:119], v9
  v_add_f32 v36, v36, v37
  v_add_f32 v38, v38, v39
  v_smfmac_f32_16x16x64_bf16 v[44:47], v[68:71], v[144:151], v9
  v_cvt_pk_bf16_f32 v61, v36, v38
  v_min_u32 v61, -2, v61
  v_smfmac_f32_16x16x64_bf16 v[44:47], v[72:75], v[224:231], v9
  s_nop 0
  v_smfmac_f32_16x16x64_bf16 v[48:51], v[76:79], v[120:127], v9
  v_add_f32 v40, v40, v41
  v_add_f32 v42, v42, v43
  v_smfmac_f32_16x16x64_bf16 v[48:51], v[68:71], v[152:159], v9
  v_cvt_pk_bf16_f32 v62, v40, v42
  v_min_u32 v62, -2, v62
  v_smfmac_f32_16x16x64_bf16 v[48:51], v[72:75], v[232:239], v9
  s_nop 0
  v_smfmac_f32_16x16x64_bf16 v[52:55], v[76:79], v[80:87], v9
  v_add_f32 v44, v44, v45
  v_add_f32 v46, v46, v47
  v_smfmac_f32_16x16x64_bf16 v[52:55], v[68:71], v[160:167], v9
  v_cvt_pk_bf16_f32 v63, v44, v46
  v_min_u32 v63, -2, v63
  v_smfmac_f32_16x16x64_bf16 v[52:55], v[72:75], v[240:247], v9
  s_nop 1
  v_permlane32_swap_b32 v60, v62
  v_permlane32_swap_b32 v61, v63
  s_nop 1
  v_permlane16_swap_b32 v60, v61
  v_permlane16_swap_b32 v62, v63
  buffer_store_dwordx4 v[60:63], v15, s[4:7], s60 offen sc1
  s_add_u32 s60, s60, 65536
  v_add_f32 v48, v48, v49
  v_add_f32 v50, v50, v51
  v_cvt_pk_bf16_f32 v64, v48, v50
  v_min_u32 v64, -2, v64
  s_nop 0
  v_add_f32 v52, v52, v53
  v_add_f32 v54, v54, v55
  v_cvt_pk_bf16_f32 v65, v52, v54
  v_min_u32 v65, -2, v65
  s_nop 1
  v_permlane32_swap_b32 v64, v66
  v_permlane32_swap_b32 v65, v67
  s_nop 1
  v_permlane16_swap_b32 v64, v65
  v_permlane16_swap_b32 v66, v67
  s_mov_b32 exec_hi, 0
  buffer_store_dwordx4 v[64:67], v15, s[4:7], s60 offen sc1
  s_mov_b32 exec_hi, -1
  s_nop 1
  s_add_u32 s22, s22, 1
  s_cmp_lt_u32 s22, 64
  s_cbranch_scc1 Lvl_119
  s_branch Lmain_end
.p2align 6
Lrole_F:
  v_lshlrev_b32 v6, 4, v1
  s_lshl_b32 s26, s21, 10
  v_add_u32 v7, s26, v6
  v_lshrrev_b32 v8, 1, v7
  v_and_b32 v2, 1, v1
  v_mov_b32 v3, 0x4444
  v_mov_b32 v9, 0xeeee
  v_cmp_eq_u32 vcc, 0, v2
  s_nop 1
  v_cndmask_b32 v9, v9, v3, vcc
  v_mov_b32 v0, 0
  s_add_u32 s48, s23, 0x178000
  s_add_u32 s49, s48, 16384
  s_add_u32 s26, s21, 1
  s_and_b32 s26, s26, 3
  s_lshl_b32 s80, s26, 10
  s_add_u32 s26, s21, 2
  s_and_b32 s26, s26, 3
  s_lshl_b32 s81, s26, 10
  s_add_u32 s26, s21, 3
  s_and_b32 s26, s26, 3
  s_lshl_b32 s82, s26, 10
  v_and_b32 v2, 7, v1
  s_lshl_b32 s26, s21, 3
  v_add_u32 v2, s26, v2
  v_lshlrev_b32 v2, 7, v2
  v_bfe_u32 v3, v1, 3, 1
  v_lshl_add_u32 v18, v3, 12, v2
  v_and_b32 v2, 7, v1
  v_lshlrev_b32 v10, 2, v2
  s_mul_i32 s26, s20, 6554
  s_lshr_b32 s26, s26, 16
  s_lshl_b32 s29, s26, 7
  s_lshl_b32 s26, s21, 5
  s_add_u32 s29, s29, s26
  s_add_u32 s29, s29, 0xc00
  s_lshl_b32 s30, s20, 15
  s_lshl_b32 s26, s21, 13
  s_add_u32 s30, s30, s26
  s_add_u32 s30, s30, 0x4e00000
  s_lshr_b32 s26, s21, 1
  s_lshl_b32 s53, s26, 14
  s_and_b32 s26, s21, 1
  s_lshl_b32 s26, s26, 12
  s_add_u32 s53, s53, s26
  s_add_u32 s53, s53, 0x180000
  s_add_u32 s53, s53, s23
  s_lshl_b32 s54, s21, 10
  s_add_u32 s54, s54, 0x188000
  s_add_u32 s54, s54, s23
  s_lshl_b32 s55, s20, 14
  s_lshl_b32 s26, s21, 11
  s_add_u32 s55, s55, s26
  s_add_u32 s55, s55, s23
  s_lshl_b32 s56, s20, 8
  s_cmp_ge_u32 s20, 32
  s_cselect_b32 s26, 8192, 0
  s_add_u32 s56, s56, s26
  s_add_u32 s56, s56, 0x158000
  s_add_u32 s56, s56, s23
  s_lshl_b32 s57, s20, 8
  s_add_u32 s57, s57, 0xce00000
  s_lshl_b32 s47, s20, 7
  s_add_u32 s47, s47, s49
  s_cmp_eq_u32 s21, 3
  s_cselect_b32 s47, s47, 0x7ff00000
  s_lshl_b32 s45, s20, 13
  s_lshl_b32 s26, s21, 11
  s_add_u32 s45, s45, s26
  s_add_u32 s45, s45, 0xa400000
  s_lshl_b32 s33, s20, 4
  s_lshl_b32 s26, s21, 2
  s_add_u32 s33, s33, s26
  s_add_u32 s33, s33, 0x1400
  v_lshrrev_b32 v2, 4, v1
  v_and_b32 v3, 15, v1
  v_lshlrev_b32 v12, 8, v2
  v_lshl_add_u32 v17, v3, 3, v12
  v_lshlrev_b32 v2, 7, v2
  v_lshl_add_u32 v2, v3, 2, v2
  s_lshl_b32 s26, s21, 9
  v_add_u32 v11, s26, v2
  v_lshlrev_b32 v14, 3, v1
  v_lshlrev_b32 v15, 2, v1
  s_mov_b32 s22, 0
  s_mov_b32 s46, 0
  s_mov_b32 s92, 0
  v_mov_b32 v20, -1
  v_mov_b32 v21, -1
  v_mov_b32 v22, -1
  v_mov_b32 v23, -1
  s_lshl_b32 s29, s29, 5
  s_add_u32 s29, s29, 0x200000
  s_lshl_b32 s33, s33, 5
  s_add_u32 s33, s33, 0x200000
  v_lshlrev_b32 v10, 5, v10
  s_add_u32 s38, s22, 1
  s_cmp_ge_u32 s46, s38
  s_cbranch_scc1 Luok_132
Lup_133:
  s_add_u32 s24, s24, 1
  s_cmp_gt_u32 s24, 300000
  s_cbranch_scc1 Lfail_130
  buffer_load_dword v16, v10, s[4:7], s29 offen sc1
  s_waitcnt vmcnt(0)
  v_cmp_gt_u32 vcc, s38, v16
  s_cbranch_vccz Lrok_134
  s_sleep 2
  s_branch Lup_133
Lrok_134:
Luok_132:
  s_sub_u32 s26, s38, 1
  s_mul_i32 s27, s26, 1310720
  s_add_u32 s27, s27, s30
  s_add_u32 s28, s27, 4096
  buffer_load_dwordx4 v[32:35], v6, s[4:7], s27 offen offset:0 sc1
  buffer_load_dwordx4 v[36:39], v6, s[4:7], s27 offen offset:1024 sc1
  buffer_load_dwordx4 v[40:43], v6, s[4:7], s27 offen offset:2048 sc1
  buffer_load_dwordx4 v[44:47], v6, s[4:7], s27 offen offset:3072 sc1
  buffer_load_dwordx4 v[48:51], v6, s[4:7], s28 offen offset:0 sc1
  buffer_load_dwordx4 v[52:55], v6, s[4:7], s28 offen offset:1024 sc1
  buffer_load_dwordx4 v[56:59], v6, s[4:7], s28 offen offset:2048 sc1
  buffer_load_dwordx4 v[60:63], v6, s[4:7], s28 offen offset:3072 sc1
  buffer_load_dword v16, v10, s[4:7], s29 offen sc1
Lfl_135:
  s_add_u32 s60, s53, s92
  s_add_u32 s61, s54, s92
  s_add_u32 s62, s55, 0
  s_add_u32 s92, s92, 49152
  s_cmp_eq_u32 s92, 147456
  s_cselect_b32 s92, 0, s92
  s_add_u32 s26, s22, 1
  s_and_b32 s27, s26, 3
  s_lshl_b32 s27, s27, 15
  s_add_u32 s63, s56, s27
  s_mul_i32 s64, s26, 10240
  s_add_u32 s64, s64, s57
  s_and_b32 s27, s22, 3
  s_lshl_b32 s27, s27, 15
  s_add_u32 s65, s56, s27
  s_add_u32 s38, s22, 1
  v_mov_b64 v[124:125], 0
  v_mov_b64 v[126:127], 0
  v_mov_b64 v[128:129], 0
  v_mov_b64 v[130:131], 0
  v_and_b32 v2, 7, v1
  s_lshl_b32 s26, s21, 3
  v_add_u32 v2, s26, v2
  v_lshlrev_b32 v2, 7, v2
  v_bfe_u32 v3, v1, 3, 1
  v_lshl_add_u32 v3, v3, 12, v2
Ltf_137:
  buffer_load_dword v2, v3, s[4:7], s48 offen sc1
  s_memrealtime s[98:99]
  s_add_u32 s24, s24, 1
  s_cmp_gt_u32 s24, 300000
  s_cbranch_scc1 Lfail_131
  s_waitcnt vmcnt(0) lgkmcnt(0)
Ltk_140:
  v_and_b32 v12, 0xff, v2
  v_cmp_gt_u32 vcc, s38, v12
  s_cbranch_vccz Ltok_141
  s_sleep 1
  s_branch Ltf_137
Ltok_141:
  v_cmp_lt_u32 vcc, s38, v12
  s_cbranch_vccnz Ltg_138
  s_lshl_b32 s98, s98, 8
  v_subrev_u32 v2, s98, v2
  s_nop 1
  v_max_i32_dpp v2, v2, v2 row_ror:8 row_mask:0xf bank_mask:0xf
  s_nop 1
  v_max_i32_dpp v2, v2, v2 row_ror:4 row_mask:0xf bank_mask:0xf
  s_nop 1
  v_max_i32_dpp v2, v2, v2 row_ror:2 row_mask:0xf bank_mask:0xf
  s_nop 1
  v_max_i32_dpp v2, v2, v2 row_ror:1 row_mask:0xf bank_mask:0xf
  s_nop 0
  v_readlane_b32 s96, v2, 0
  s_min_i32 s96, s96, 0x6700
  s_add_u32 s96, s96, s98
  s_add_u32 s96, s96, 0x0
  s_sub_u32 s97, s96, 0x0
Ltc_142:
  s_memrealtime s[98:99]
  s_waitcnt lgkmcnt(0)
  s_lshl_b32 s98, s98, 8
  s_sub_u32 s98, s97, s98
  s_cmp_gt_i32 s98, 255
  s_cbranch_scc1 Ltc_142
  buffer_load_dwordx4 v[116:119], v6, s[4:7], s62 offen offset:0 sc1
  buffer_load_dwordx4 v[120:123], v6, s[4:7], s62 offen offset:1024 sc1
Ltc_143:
  s_memrealtime s[98:99]
  s_waitcnt lgkmcnt(0)
  s_lshl_b32 s98, s98, 8
  s_sub_u32 s98, s96, s98
  s_cmp_gt_i32 s98, 255
  s_cbranch_scc1 Ltc_143
  s_branch Ltg2_139
Ltg_138:
  buffer_load_dwordx4 v[116:119], v6, s[4:7], s62 offen offset:0 sc1
  buffer_load_dwordx4 v[120:123], v6, s[4:7], s62 offen offset:1024 sc1
Ltg2_139:
  buffer_load_dwordx4 v[96:99], v6, s[4:7], s60 offen offset:0 sc1
  buffer_load_dwordx4 v[100:103], v6, s[4:7], s60 offen offset:1024 sc1
  buffer_load_dwordx4 v[104:107], v6, s[4:7], s60 offen offset:2048 sc1
  buffer_load_dwordx4 v[108:111], v6, s[4:7], s60 offen offset:3072 sc1
  buffer_load_dwordx2 v[112:113], v17, s[4:7], s61 offen offset:0 sc1
  buffer_load_dwordx2 v[114:115], v17, s[4:7], s61 offen offset:128 sc1
  s_waitcnt vmcnt(6)
  v_max3_u32 v3, v116, v117, v118
  v_max3_u32 v3, v3, v119, v120
  v_max3_u32 v3, v3, v121, v122
  v_max_u32 v3, v3, v123
  s_waitcnt vmcnt(5)
  v_smfmac_f32_16x16x64_bf16 v[124:127], v[96:99], v[32:39], v9
  v_max3_u32 v2, v96, v97, v98
  v_max_u32 v2, v2, v99
  s_waitcnt vmcnt(4)
  v_smfmac_f32_16x16x64_bf16 v[128:131], v[100:103], v[40:47], v9
  v_max3_u32 v2, v2, v100, v101
  v_max3_u32 v2, v2, v102, v103
  s_waitcnt vmcnt(3)
  v_smfmac_f32_16x16x64_bf16 v[124:127], v[104:107], v[48:55], v9
  v_max3_u32 v2, v2, v104, v105
  v_max3_u32 v2, v2, v106, v107
  s_waitcnt vmcnt(2)
  v_smfmac_f32_16x16x64_bf16 v[128:131], v[108:111], v[56:63], v9
  v_max3_u32 v2, v2, v108, v109
  v_max3_u32 v2, v2, v110, v111
  s_waitcnt vmcnt(0)
  v_smfmac_f32_16x16x64_bf16 v[124:127], v[112:115], v[116:123], v9
  v_max3_u32 v2, v2, v112, v113
  v_max3_u32 v2, v2, v114, v115
  v_max_u32 v12, v2, v3
  v_cmp_eq_u32 vcc, -1, v12
  s_cbranch_vccnz Lfbad_144
Lfgood_145:
  s_nop 1
  v_add_f32 v128, v128, v129
  v_add_f32 v130, v130, v131
  v_add_f32 v124, v124, v125
  v_add_f32 v126, v126, v127
  v_add_f32 v124, v124, v128
  v_add_f32 v126, v126, v130
  ds_write_b32 v11, v124
  ds_write_b32 v11, v126 offset:64
  s_waitcnt lgkmcnt(0)
  s_barrier
  s_cmp_lg_u32 s21, 0
  s_cbranch_scc1 Lfnw_146
  ds_read_b64 v[96:97], v14 offset:0
  ds_read_b64 v[98:99], v14 offset:512
  ds_read_b64 v[100:101], v14 offset:1024
  ds_read_b64 v[102:103], v14 offset:1536
  s_waitcnt lgkmcnt(0)
  v_add_f32 v96, v96, v98
  v_add_f32 v97, v97, v99
  v_add_f32 v100, v100, v102
  v_add_f32 v101, v101, v103
  v_add_f32 v96, v96, v100
  v_add_f32 v97, v97, v101
  v_cvt_pk_bf16_f32 v96, v96, v97
  v_min_u32 v96, -2, v96
  buffer_store_dword v96, v15, s[4:7], s63 offen sc1
Lfnw_146:
  s_cmp_lg_u32 s21, 0
  s_cbranch_scc1 Lfnw2_147
  v_mov_b32 v3, -1
  buffer_store_dword v3, v15, s[4:7], s65 offen sc1
Lfnw2_147:
  s_cmp_ge_u32 s22, 62
  s_cbranch_scc1 Lffin_136
  s_add_u32 s38, s22, 2
  s_cmp_ge_u32 s46, s38
  s_cbranch_scc1 Luok_148
Lup_149:
  s_add_u32 s24, s24, 1
  s_cmp_gt_u32 s24, 300000
  s_cbranch_scc1 Lfail_130
  buffer_load_dword v16, v10, s[4:7], s29 offen sc1
  s_waitcnt vmcnt(0)
  v_cmp_gt_u32 vcc, s38, v16
  s_cbranch_vccz Lrok_150
  s_sleep 2
  s_branch Lup_149
Lrok_150:
Luok_148:
  s_sub_u32 s26, s38, 1
  s_mul_i32 s27, s26, 1310720
  s_add_u32 s27, s27, s30
  s_add_u32 s28, s27, 4096
  buffer_load_dwordx4 v[64:67], v6, s[4:7], s27 offen offset:0 sc1
  s_sleep 1
  buffer_load_dwordx4 v[68:71], v6, s[4:7], s27 offen offset:1024 sc1
  s_sleep 1
  buffer_load_dwordx4 v[72:75], v6, s[4:7], s27 offen offset:2048 sc1
  s_sleep 1
  buffer_load_dwordx4 v[76:79], v6, s[4:7], s27 offen offset:3072 sc1
  s_sleep 1
  buffer_load_dwordx4 v[80:83], v6, s[4:7], s28 offen offset:0 sc1
  s_sleep 1
  buffer_load_dwordx4 v[84:87], v6, s[4:7], s28 offen offset:1024 sc1
  s_sleep 1
  buffer_load_dwordx4 v[88:91], v6, s[4:7], s28 offen offset:2048 sc1
  s_sleep 1
  buffer_load_dwordx4 v[92:95], v6, s[4:7], s28 offen offset:3072 sc1
  s_sleep 1
  buffer_load_dword v16, v10, s[4:7], s29 offen sc1
  s_mul_i32 s27, s22, 327680
  s_add_u32 s27, s27, s45
  buffer_store_dwordx4 v[116:119], v6, s[4:7], s27 offen offset:0 sc1
  buffer_store_dwordx4 v[120:123], v6, s[4:7], s27 offen offset:1024 sc1
  buffer_store_dwordx4 v[20:23], v6, s[4:7], s62 offen offset:0 sc1
  buffer_store_dwordx4 v[20:23], v6, s[4:7], s62 offen offset:1024 sc1
  s_waitcnt vmcnt(0)
  s_add_u32 s26, s22, 1
  v_mov_b32 v2, s26
  s_mov_b64 exec, 1
  buffer_store_dword v2, v0, s[4:7], s33 offen sc1
  s_mov_b64 exec, -1
  v_readlane_b32 s46, v16, 0
  v_readlane_b32 s26, v16, 1
  s_min_u32 s46, s46, s26
  v_readlane_b32 s26, v16, 2
  s_min_u32 s46, s46, s26
  v_readlane_b32 s26, v16, 3
  s_min_u32 s46, s46, s26
  v_readlane_b32 s26, v16, 4
  s_min_u32 s46, s46, s26
  v_readlane_b32 s26, v16, 5
  s_min_u32 s46, s46, s26
  v_readlane_b32 s26, v16, 6
  s_min_u32 s46, s46, s26
  v_readlane_b32 s26, v16, 7
  s_min_u32 s46, s46, s26
  s_add_u32 s22, s22, 1
  s_add_u32 s60, s53, s92
  s_add_u32 s61, s54, s92
  s_add_u32 s62, s55, 655360
  s_add_u32 s92, s92, 49152
  s_cmp_eq_u32 s92, 147456
  s_cselect_b32 s92, 0, s92
  s_add_u32 s26, s22, 1
  s_and_b32 s27, s26, 3
  s_lshl_b32 s27, s27, 15
  s_add_u32 s63, s56, s27
  s_mul_i32 s64, s26, 10240
  s_add_u32 s64, s64, s57
  s_and_b32 s27, s22, 3
  s_lshl_b32 s27, s27, 15
  s_add_u32 s65, s56, s27
  s_add_u32 s38, s22, 1
  v_mov_b64 v[124:125], 0
  v_mov_b64 v[126:127], 0
  v_mov_b64 v[128:129], 0
  v_mov_b64 v[130:131], 0
  v_and_b32 v2, 7, v1
  s_lshl_b32 s26, s21, 3
  v_add_u32 v2, s26, v2
  v_lshlrev_b32 v2, 7, v2
  v_bfe_u32 v3, v1, 3, 1
  v_lshl_add_u32 v3, v3, 12, v2
Ltf_151:
  buffer_load_dword v2, v3, s[4:7], s48 offen sc1
  s_memrealtime s[98:99]
  s_add_u32 s24, s24, 1
  s_cmp_gt_u32 s24, 300000
  s_cbranch_scc1 Lfail_131
  s_waitcnt vmcnt(0) lgkmcnt(0)
Ltk_154:
  v_and_b32 v12, 0xff, v2
  v_cmp_gt_u32 vcc, s38, v12
  s_cbranch_vccz Ltok_155
  s_sleep 1
  s_branch Ltf_151
Ltok_155:
  v_cmp_lt_u32 vcc, s38, v12
  s_cbranch_vccnz Ltg_152
  s_lshl_b32 s98, s98, 8
  v_subrev_u32 v2, s98, v2
  s_nop 1
  v_max_i32_dpp v2, v2, v2 row_ror:8 row_mask:0xf bank_mask:0xf
  s_nop 1
  v_max_i32_dpp v2, v2, v2 row_ror:4 row_mask:0xf bank_mask:0xf
  s_nop 1
  v_max_i32_dpp v2, v2, v2 row_ror:2 row_mask:0xf bank_mask:0xf
  s_nop 1
  v_max_i32_dpp v2, v2, v2 row_ror:1 row_mask:0xf bank_mask:0xf
  s_nop 0
  v_readlane_b32 s96, v2, 0
  s_min_i32 s96, s96, 0x6700
  s_add_u32 s96, s96, s98
  s_add_u32 s96, s96, 0x0
  s_sub_u32 s97, s96, 0x0
Ltc_156:
  s_memrealtime s[98:99]
  s_waitcnt lgkmcnt(0)
  s_lshl_b32 s98, s98, 8
  s_sub_u32 s98, s97, s98
  s_cmp_gt_i32 s98, 255
  s_cbranch_scc1 Ltc_156
  buffer_load_dwordx4 v[116:119], v6, s[4:7], s62 offen offset:0 sc1
  buffer_load_dwordx4 v[120:123], v6, s[4:7], s62 offen offset:1024 sc1
Ltc_157:
  s_memrealtime s[98:99]
  s_waitcnt lgkmcnt(0)
  s_lshl_b32 s98, s98, 8
  s_sub_u32 s98, s96, s98
  s_cmp_gt_i32 s98, 255
  s_cbranch_scc1 Ltc_157
  s_branch Ltg2_153
Ltg_152:
  buffer_load_dwordx4 v[116:119], v6, s[4:7], s62 offen offset:0 sc1
  buffer_load_dwordx4 v[120:123], v6, s[4:7], s62 offen offset:1024 sc1
Ltg2_153:
  buffer_load_dwordx4 v[96:99], v6, s[4:7], s60 offen offset:0 sc1
  buffer_load_dwordx4 v[100:103], v6, s[4:7], s60 offen offset:1024 sc1
  buffer_load_dwordx4 v[104:107], v6, s[4:7], s60 offen offset:2048 sc1
  buffer_load_dwordx4 v[108:111], v6, s[4:7], s60 offen offset:3072 sc1
  buffer_load_dwordx2 v[112:113], v17, s[4:7], s61 offen offset:0 sc1
  buffer_load_dwordx2 v[114:115], v17, s[4:7], s61 offen offset:128 sc1
  s_waitcnt vmcnt(6)
  v_max3_u32 v3, v116, v117, v118
  v_max3_u32 v3, v3, v119, v120
  v_max3_u32 v3, v3, v121, v122
  v_max_u32 v3, v3, v123
  s_waitcnt vmcnt(5)
  v_smfmac_f32_16x16x64_bf16 v[124:127], v[96:99], v[64:71], v9
  v_max3_u32 v2, v96, v97, v98
  v_max_u32 v2, v2, v99
  s_waitcnt vmcnt(4)
  v_smfmac_f32_16x16x64_bf16 v[128:131], v[100:103], v[72:79], v9
  v_max3_u32 v2, v2, v100, v101
  v_max3_u32 v2, v2, v102, v103
  s_waitcnt vmcnt(3)
  v_smfmac_f32_16x16x64_bf16 v[124:127], v[104:107], v[80:87], v9
  v_max3_u32 v2, v2, v104, v105
  v_max3_u32 v2, v2, v106, v107
  s_waitcnt vmcnt(2)
  v_smfmac_f32_16x16x64_bf16 v[128:131], v[108:111], v[88:95], v9
  v_max3_u32 v2, v2, v108, v109
  v_max3_u32 v2, v2, v110, v111
  s_waitcnt vmcnt(0)
  v_smfmac_f32_16x16x64_bf16 v[124:127], v[112:115], v[116:123], v9
  v_max3_u32 v2, v2, v112, v113
  v_max3_u32 v2, v2, v114, v115
  v_max_u32 v12, v2, v3
  v_cmp_eq_u32 vcc, -1, v12
  s_cbranch_vccnz Lfbad_158
Lfgood_159:
  s_nop 1
  v_add_f32 v128, v128, v129
  v_add_f32 v130, v130, v131
  v_add_f32 v124, v124, v125
  v_add_f32 v126, v126, v127
  v_add_f32 v124, v124, v128
  v_add_f32 v126, v126, v130
  ds_write_b32 v11, v124
  ds_write_b32 v11, v126 offset:64
  s_waitcnt lgkmcnt(0)
  s_barrier
  s_cmp_lg_u32 s21, 0
  s_cbranch_scc1 Lfnw_160
  ds_read_b64 v[96:97], v14 offset:0
  ds_read_b64 v[98:99], v14 offset:512
  ds_read_b64 v[100:101], v14 offset:1024
  ds_read_b64 v[102:103], v14 offset:1536
  s_waitcnt lgkmcnt(0)
  v_add_f32 v96, v96, v98
  v_add_f32 v97, v97, v99
  v_add_f32 v100, v100, v102
  v_add_f32 v101, v101, v103
  v_add_f32 v96, v96, v100
  v_add_f32 v97, v97, v101
  v_cvt_pk_bf16_f32 v96, v96, v97
  v_min_u32 v96, -2, v96
  buffer_store_dword v96, v15, s[4:7], s63 offen sc1
Lfnw_160:
  s_cmp_lg_u32 s21, 0
  s_cbranch_scc1 Lfnw2_161
  v_mov_b32 v3, -1
  buffer_store_dword v3, v15, s[4:7], s65 offen sc1
Lfnw2_161:
  s_cmp_ge_u32 s22, 62
  s_cbranch_scc1 Lffin_136
  s_add_u32 s38, s22, 2
  s_cmp_ge_u32 s46, s38
  s_cbranch_scc1 Luok_162
Lup_163:
  s_add_u32 s24, s24, 1
  s_cmp_gt_u32 s24, 300000
  s_cbranch_scc1 Lfail_130
  buffer_load_dword v16, v10, s[4:7], s29 offen sc1
  s_waitcnt vmcnt(0)
  v_cmp_gt_u32 vcc, s38, v16
  s_cbranch_vccz Lrok_164
  s_sleep 2
  s_branch Lup_163
Lrok_164:
Luok_162:
  s_sub_u32 s26, s38, 1
  s_mul_i32 s27, s26, 1310720
  s_add_u32 s27, s27, s30
  s_add_u32 s28, s27, 4096
  buffer_load_dwordx4 v[32:35], v6, s[4:7], s27 offen offset:0 sc1
  s_sleep 1
  buffer_load_dwordx4 v[36:39], v6, s[4:7], s27 offen offset:1024 sc1
  s_sleep 1
  buffer_load_dwordx4 v[40:43], v6, s[4:7], s27 offen offset:2048 sc1
  s_sleep 1
  buffer_load_dwordx4 v[44:47], v6, s[4:7], s27 offen offset:3072 sc1
  s_sleep 1
  buffer_load_dwordx4 v[48:51], v6, s[4:7], s28 offen offset:0 sc1
  s_sleep 1
  buffer_load_dwordx4 v[52:55], v6, s[4:7], s28 offen offset:1024 sc1
  s_sleep 1
  buffer_load_dwordx4 v[56:59], v6, s[4:7], s28 offen offset:2048 sc1
  s_sleep 1
  buffer_load_dwordx4 v[60:63], v6, s[4:7], s28 offen offset:3072 sc1
  s_sleep 1
  buffer_load_dword v16, v10, s[4:7], s29 offen sc1
  s_mul_i32 s27, s22, 327680
  s_add_u32 s27, s27, s45
  buffer_store_dwordx4 v[116:119], v6, s[4:7], s27 offen offset:0 sc1
  buffer_store_dwordx4 v[120:123], v6, s[4:7], s27 offen offset:1024 sc1
  buffer_store_dwordx4 v[20:23], v6, s[4:7], s62 offen offset:0 sc1
  buffer_store_dwordx4 v[20:23], v6, s[4:7], s62 offen offset:1024 sc1
  s_waitcnt vmcnt(0)
  s_add_u32 s26, s22, 1
  v_mov_b32 v2, s26
  s_mov_b64 exec, 1
  buffer_store_dword v2, v0, s[4:7], s33 offen sc1
  s_mov_b64 exec, -1
  v_readlane_b32 s46, v16, 0
  v_readlane_b32 s26, v16, 1
  s_min_u32 s46, s46, s26
  v_readlane_b32 s26, v16, 2
  s_min_u32 s46, s46, s26
  v_readlane_b32 s26, v16, 3
  s_min_u32 s46, s46, s26
  v_readlane_b32 s26, v16, 4
  s_min_u32 s46, s46, s26
  v_readlane_b32 s26, v16, 5
  s_min_u32 s46, s46, s26
  v_readlane_b32 s26, v16, 6
  s_min_u32 s46, s46, s26
  v_readlane_b32 s26, v16, 7
  s_min_u32 s46, s46, s26
  s_add_u32 s22, s22, 1
  s_branch Lfl_135
Lfbad_144:
  s_add_u32 s24, s24, 1
  s_cmp_gt_u32 s24, 300000
  s_cbranch_scc1 Lfail_131
  v_cmp_eq_u32 vcc, -1, v3
  s_cbranch_vccz Lfny_165
  buffer_load_dwordx4 v[116:119], v6, s[4:7], s62 offen offset:0 sc1
  buffer_load_dwordx4 v[120:123], v6, s[4:7], s62 offen offset:1024 sc1
Lfny_165:
  v_cmp_eq_u32 vcc, -1, v2
  s_cbranch_vccz Lfnp_166
  buffer_load_dwordx4 v[96:99], v6, s[4:7], s60 offen offset:0 sc1
  buffer_load_dwordx4 v[100:103], v6, s[4:7], s60 offen offset:1024 sc1
  buffer_load_dwordx4 v[104:107], v6, s[4:7], s60 offen offset:2048 sc1
  buffer_load_dwordx4 v[108:111], v6, s[4:7], s60 offen offset:3072 sc1
  buffer_load_dwordx2 v[112:113], v17, s[4:7], s61 offen offset:0 sc1
  buffer_load_dwordx2 v[114:115], v17, s[4:7], s61 offen offset:128 sc1
Lfnp_166:
  s_nop 3
  v_mov_b64 v[124:125], 0
  v_mov_b64 v[126:127], 0
  v_mov_b64 v[128:129], 0
  v_mov_b64 v[130:131], 0
  s_waitcnt vmcnt(0)
  v_smfmac_f32_16x16x64_bf16 v[124:127], v[96:99], v[32:39], v9
  v_smfmac_f32_16x16x64_bf16 v[128:131], v[100:103], v[40:47], v9
  v_smfmac_f32_16x16x64_bf16 v[124:127], v[104:107], v[48:55], v9
  v_smfmac_f32_16x16x64_bf16 v[128:131], v[108:111], v[56:63], v9
  v_smfmac_f32_16x16x64_bf16 v[124:127], v[112:115], v[116:123], v9
  v_max3_u32 v3, v116, v117, v118
  v_max3_u32 v3, v3, v119, v120
  v_max3_u32 v3, v3, v121, v122
  v_max_u32 v3, v3, v123
  v_max3_u32 v2, v96, v97, v98
  v_max3_u32 v2, v2, v99, v100
  v_max3_u32 v2, v2, v101, v102
  v_max3_u32 v2, v2, v103, v104
  v_max3_u32 v2, v2, v105, v106
  v_max3_u32 v2, v2, v107, v108
  v_max3_u32 v2, v2, v109, v110
  v_max3_u32 v2, v2, v111, v112
  v_max3_u32 v2, v2, v113, v114
  v_max_u32 v2, v2, v115
  v_max_u32 v12, v2, v3
  v_cmp_eq_u32 vcc, -1, v12
  s_cbranch_vccnz Lfbad_144
  s_branch Lfgood_145
Lfbad_158:
  s_add_u32 s24, s24, 1
  s_cmp_gt_u32 s24, 300000
  s_cbranch_scc1 Lfail_131
  v_cmp_eq_u32 vcc, -1, v3
  s_cbranch_vccz Lfny_167
  buffer_load_dwordx4 v[116:119], v6, s[4:7], s62 offen offset:0 sc1
  buffer_load_dwordx4 v[120:123], v6, s[4:7], s62 offen offset:1024 sc1
Lfny_167:
  v_cmp_eq_u32 vcc, -1, v2
  s_cbranch_vccz Lfnp_168
  buffer_load_dwordx4 v[96:99], v6, s[4:7], s60 offen offset:0 sc1
  buffer_load_dwordx4 v[100:103], v6, s[4:7], s60 offen offset:1024 sc1
  buffer_load_dwordx4 v[104:107], v6, s[4:7], s60 offen offset:2048 sc1
  buffer_load_dwordx4 v[108:111], v6, s[4:7], s60 offen offset:3072 sc1
  buffer_load_dwordx2 v[112:113], v17, s[4:7], s61 offen offset:0 sc1
  buffer_load_dwordx2 v[114:115], v17, s[4:7], s61 offen offset:128 sc1
Lfnp_168:
  s_nop 3
  v_mov_b64 v[124:125], 0
  v_mov_b64 v[126:127], 0
  v_mov_b64 v[128:129], 0
  v_mov_b64 v[130:131], 0
  s_waitcnt vmcnt(0)
  v_smfmac_f32_16x16x64_bf16 v[124:127], v[96:99], v[64:71], v9
  v_smfmac_f32_16x16x64_bf16 v[128:131], v[100:103], v[72:79], v9
  v_smfmac_f32_16x16x64_bf16 v[124:127], v[104:107], v[80:87], v9
  v_smfmac_f32_16x16x64_bf16 v[128:131], v[108:111], v[88:95], v9
  v_smfmac_f32_16x16x64_bf16 v[124:127], v[112:115], v[116:123], v9
  v_max3_u32 v3, v116, v117, v118
  v_max3_u32 v3, v3, v119, v120
  v_max3_u32 v3, v3, v121, v122
  v_max_u32 v3, v3, v123
  v_max3_u32 v2, v96, v97, v98
  v_max3_u32 v2, v2, v99, v100
  v_max3_u32 v2, v2, v101, v102
  v_max3_u32 v2, v2, v103, v104
  v_max3_u32 v2, v2, v105, v106
  v_max3_u32 v2, v2, v107, v108
  v_max3_u32 v2, v2, v109, v110
  v_max3_u32 v2, v2, v111, v112
  v_max3_u32 v2, v2, v113, v114
  v_max_u32 v2, v2, v115
  v_max_u32 v12, v2, v3
  v_cmp_eq_u32 vcc, -1, v12
  s_cbranch_vccnz Lfbad_158
  s_branch Lfgood_159
Lffin_136:
  s_mul_i32 s27, s22, 327680
  s_add_u32 s27, s27, s45
  buffer_store_dwordx4 v[116:119], v6, s[4:7], s27 offen offset:0 sc1
  buffer_store_dwordx4 v[120:123], v6, s[4:7], s27 offen offset:1024 sc1
  s_waitcnt vmcnt(0)
  s_mov_b32 s26, 63
  v_mov_b32 v2, s26
  s_mov_b64 exec, 1
  buffer_store_dword v2, v0, s[4:7], s33 offen sc1
  s_mov_b64 exec, -1
  s_mov_b32 s22, 63
  s_add_u32 s62, s55, 655360
Lfy_169:
  buffer_load_dwordx4 v[116:119], v6, s[4:7], s62 offen offset:0 sc1
  buffer_load_dwordx4 v[120:123], v6, s[4:7], s62 offen offset:1024 sc1
  s_add_u32 s24, s24, 1
  s_cmp_gt_u32 s24, 300000
  s_cbranch_scc1 Lfail_131
  s_waitcnt vmcnt(0)
  v_max3_u32 v2, v116, v117, v118
  v_max3_u32 v2, v2, v119, v120
  v_max3_u32 v2, v2, v121, v122
  v_max_u32 v2, v2, v123
  v_cmp_eq_u32 vcc, -1, v2
  s_cbranch_vccnz Lfy_169
  s_mul_i32 s27, s22, 327680
  s_add_u32 s27, s27, s45
  buffer_store_dwordx4 v[116:119], v6, s[4:7], s27 offen offset:0 sc1
  buffer_store_dwordx4 v[120:123], v6, s[4:7], s27 offen offset:1024 sc1
  s_waitcnt vmcnt(0)
  s_mov_b32 s26, 64
  v_mov_b32 v2, s26
  s_mov_b64 exec, 1
  buffer_store_dword v2, v0, s[4:7], s33 offen sc1
  s_mov_b64 exec, -1
  s_branch Lmain_end
.p2align 6
Lrole_ATT:
  s_lshl_b32 s20, s20, 2
  s_add_u32 s20, s20, s21
  v_lshlrev_b32 v5, 4, v1
  v_mov_b32 v0, 0
  v_min_u32 v2, 5, v1
  v_lshlrev_b32 v3, 2, v2
  v_add_u32 v4, 1012, v3
  v_cmp_lt_u32 vcc, 2, v2
  s_nop 1
  v_cndmask_b32 v6, v3, v4, vcc
  v_lshrrev_b32 v3, 4, v1
  v_and_b32 v2, 7, v1
  v_lshlrev_b32 v2, 4, v2
  v_lshl_add_u32 v7, v3, 7, v2
  v_and_b32 v2, 15, v1
  v_lshlrev_b32 v4, 4, v2
  v_lshl_add_u32 v8, v3, 3, v4
  v_lshlrev_b32 v3, 2, v3
  v_add_u32 v4, 0, v3
  v_cmp_le_u32 s[50:51], v4, v2
  v_add_u32 v4, 1, v3
  v_cmp_le_u32 s[52:53], v4, v2
  v_add_u32 v4, 2, v3
  v_cmp_le_u32 s[54:55], v4, v2
  v_add_u32 v4, 3, v3
  v_cmp_le_u32 s[56:57], v4, v2
  s_mov_b32 s58, -1
  s_mov_b32 s59, 0
  s_mul_i32 s29, s20, 12
  s_add_u32 s29, s29, 0x0
  s_lshl_b32 s30, s20, 2
  s_add_u32 s33, s30, 0x1800
  s_add_u32 s30, s30, 0x1000
  s_mul_i32 s31, s20, 12288
  s_mul_i32 s34, s20, 3072
  s_add_u32 s34, s34, 0x9e00000
  s_lshl_b32 s35, s20, 11
  s_add_u32 s35, s35, 0xb800000
  s_lshr_b32 s26, s20, 2
  s_lshl_b32 s36, s26, 11
  s_and_b32 s26, s20, 3
  s_lshl_b32 s26, s26, 8
  s_add_u32 s36, s36, s26
  s_add_u32 s36, s36, 0xb810000
  s_mov_b32 s55, 0
  s_mov_b32 s60, 0x3dd53b95
  s_mov_b32 s46, 0
  s_mov_b32 s22, 0
  v_add_u32 v4, 2, v3
  v_cmp_le_u32 s[54:55], v4, v2
  s_lshl_b32 s29, s29, 5
  s_add_u32 s29, s29, 0x200000
  s_lshl_b32 s30, s30, 5
  s_add_u32 s30, s30, 0x200000
  s_lshl_b32 s33, s33, 5
  s_add_u32 s33, s33, 0x200000
  v_lshlrev_b32 v6, 5, v6
  v_mov_b32 v176, 0xff800000
  s_add_u32 s39, s22, 1
  s_min_u32 s39, s39, 64
  s_cmp_ge_u32 s46, s39
  s_cbranch_scc1 Lwok_172
Lwf_173:
  s_add_u32 s24, s24, 1
  s_cmp_gt_u32 s24, 300000
  s_cbranch_scc1 Lfail_170
  buffer_load_dword v9, v6, s[4:7], s29 offen sc1
  s_waitcnt vmcnt(0)
  v_cmp_gt_u32 vcc, s39, v9
  s_cbranch_vccz Lrok_174
  s_sleep 2
  s_branch Lwf_173
Lrok_174:
  s_add_u32 s26, s39, 6
  s_min_u32 s26, s26, 64
  s_nop 0
  v_cmp_gt_u32 vcc, s26, v9
  s_cmp_eq_u64 vcc, 0
  s_cselect_b32 s46, s26, s39
Lwok_172:
  s_sub_u32 s26, s39, 1
  s_mul_i32 s27, s26, 393216
  s_add_u32 s27, s27, s31
  s_add_u32 s28, s27, 0x1e00000
  s_add_u32 s27, s27, 0x600000
  s_cmp_ge_u32 s22, 63
  s_cselect_b32 s27, 0x7ff00000, s27
  s_cselect_b32 s28, 0x7ff00000, s28
  buffer_load_dwordx4 v[32:35], v5, s[4:7], s27 offen offset:0 sc1
  buffer_load_dwordx4 v[80:83], v5, s[4:7], s28 offen offset:0 sc1
  buffer_load_dwordx4 v[36:39], v5, s[4:7], s27 offen offset:1024 sc1
  buffer_load_dwordx4 v[84:87], v5, s[4:7], s28 offen offset:1024 sc1
  buffer_load_dwordx4 v[40:43], v5, s[4:7], s27 offen offset:2048 sc1
  buffer_load_dwordx4 v[88:91], v5, s[4:7], s28 offen offset:2048 sc1
  buffer_load_dwordx4 v[44:47], v5, s[4:7], s27 offen offset:3072 sc1
  buffer_load_dwordx4 v[92:95], v5, s[4:7], s28 offen offset:3072 sc1
  s_add_u32 s27, s27, 4096
  s_add_u32 s28, s28, 4096
  buffer_load_dwordx4 v[48:51], v5, s[4:7], s27 offen offset:0 sc1
  buffer_load_dwordx4 v[96:99], v5, s[4:7], s28 offen offset:0 sc1
  buffer_load_dwordx4 v[52:55], v5, s[4:7], s27 offen offset:1024 sc1
  buffer_load_dwordx4 v[100:103], v5, s[4:7], s28 offen offset:1024 sc1
  buffer_load_dwordx4 v[56:59], v5, s[4:7], s27 offen offset:2048 sc1
  buffer_load_dwordx4 v[104:107], v5, s[4:7], s28 offen offset:2048 sc1
  buffer_load_dwordx4 v[60:63], v5, s[4:7], s27 offen offset:3072 sc1
  buffer_load_dwordx4 v[108:111], v5, s[4:7], s28 offen offset:3072 sc1
  s_add_u32 s27, s27, 4096
  s_add_u32 s28, s28, 4096
  buffer_load_dwordx4 v[64:67], v5, s[4:7], s27 offen offset:0 sc1
  buffer_load_dwordx4 v[112:115], v5, s[4:7], s28 offen offset:0 sc1
  buffer_load_dwordx4 v[68:71], v5, s[4:7], s27 offen offset:1024 sc1
  buffer_load_dwordx4 v[116:119], v5, s[4:7], s28 offen offset:1024 sc1
  buffer_load_dwordx4 v[72:75], v5, s[4:7], s27 offen offset:2048 sc1
  buffer_load_dwordx4 v[120:123], v5, s[4:7], s28 offen offset:2048 sc1
  buffer_load_dwordx4 v[76:79], v5, s[4:7], s27 offen offset:3072 sc1
  buffer_load_dwordx4 v[124:127], v5, s[4:7], s28 offen offset:3072 sc1
  s_waitcnt vmcnt(0)
  v_mfma_f32_16x16x32_bf16 v[152:155], v[80:83], v[32:35], 0
  v_mfma_f32_16x16x32_bf16 v[156:159], v[80:83], v[36:39], 0
  v_mfma_f32_16x16x32_bf16 v[160:163], v[84:87], v[36:39], 0
  v_mfma_f32_16x16x32_bf16 v[152:155], v[88:91], v[40:43], v[152:155]
  v_mfma_f32_16x16x32_bf16 v[156:159], v[88:91], v[44:47], v[156:159]
  v_mfma_f32_16x16x32_bf16 v[160:163], v[92:95], v[44:47], v[160:163]
  v_mfma_f32_16x16x32_bf16 v[152:155], v[96:99], v[48:51], v[152:155]
  v_mfma_f32_16x16x32_bf16 v[156:159], v[96:99], v[52:55], v[156:159]
  v_mfma_f32_16x16x32_bf16 v[160:163], v[100:103], v[52:55], v[160:163]
  v_mfma_f32_16x16x32_bf16 v[152:155], v[104:107], v[56:59], v[152:155]
  v_mfma_f32_16x16x32_bf16 v[156:159], v[104:107], v[60:63], v[156:159]
  v_mfma_f32_16x16x32_bf16 v[160:163], v[108:111], v[60:63], v[160:163]
  v_mfma_f32_16x16x32_bf16 v[152:155], v[112:115], v[64:67], v[152:155]
  v_mfma_f32_16x16x32_bf16 v[156:159], v[112:115], v[68:71], v[156:159]
  v_mfma_f32_16x16x32_bf16 v[160:163], v[116:119], v[68:71], v[160:163]
  v_mfma_f32_16x16x32_bf16 v[152:155], v[120:123], v[72:75], v[152:155]
  v_mfma_f32_16x16x32_bf16 v[156:159], v[120:123], v[76:79], v[156:159]
  v_mfma_f32_16x16x32_bf16 v[160:163], v[124:127], v[76:79], v[160:163]
Lal_175:
  s_add_u32 s39, s22, 2
  s_min_u32 s39, s39, 64
  s_cmp_ge_u32 s46, s39
  s_cbranch_scc1 Lwok_177
Lwf_178:
  s_add_u32 s24, s24, 1
  s_cmp_gt_u32 s24, 300000
  s_cbranch_scc1 Lfail_170
  buffer_load_dword v9, v6, s[4:7], s29 offen sc1
  s_waitcnt vmcnt(0)
  v_cmp_gt_u32 vcc, s39, v9
  s_cbranch_vccz Lrok_179
  s_sleep 2
  s_branch Lwf_178
Lrok_179:
  s_add_u32 s26, s39, 6
  s_min_u32 s26, s26, 64
  s_nop 0
  v_cmp_gt_u32 vcc, s26, v9
  s_cmp_eq_u64 vcc, 0
  s_cselect_b32 s46, s26, s39
Lwok_177:
  s_add_u32 s38, s22, 1
Lwf_181:
  s_add_u32 s24, s24, 1
  s_cmp_gt_u32 s24, 300000
  s_cbranch_scc1 Lfail_171
  buffer_load_dword v9, v0, s[4:7], s30 offen sc1
  s_waitcnt vmcnt(0)
  v_cmp_gt_u32 vcc, s38, v9
  s_cbranch_vccz Lrok_182
  s_sleep 2
  s_branch Lwf_181
Lrok_182:
Lwok_180:
  s_mul_i32 s27, s22, 98304
  s_add_u32 s27, s27, s34
  buffer_load_dwordx4 v[128:131], v7, s[4:7], s27 offen offset:0 sc1
  buffer_load_dwordx4 v[132:135], v7, s[4:7], s27 offen offset:512 sc1
  buffer_load_dwordx4 v[136:139], v7, s[4:7], s27 offen offset:1024 sc1
  buffer_load_dwordx4 v[140:143], v7, s[4:7], s27 offen offset:1536 sc1
  buffer_load_dwordx4 v[144:147], v7, s[4:7], s27 offen offset:2048 sc1
  buffer_load_dwordx4 v[148:151], v7, s[4:7], s27 offen offset:2560 sc1
  s_sub_u32 s26, s39, 1
  s_mul_i32 s27, s26, 393216
  s_add_u32 s27, s27, s31
  s_add_u32 s28, s27, 0x1e00000
  s_add_u32 s27, s27, 0x600000
  s_cmp_ge_u32 s22, 63
  s_cselect_b32 s27, 0x7ff00000, s27
  s_cselect_b32 s28, 0x7ff00000, s28
  buffer_load_dwordx4 v[200:203], v5, s[4:7], s27 offen offset:0 sc1
  buffer_load_dwordx4 v[80:83], v5, s[4:7], s28 offen offset:0 sc1
  buffer_load_dwordx4 v[204:207], v5, s[4:7], s27 offen offset:1024 sc1
  buffer_load_dwordx4 v[84:87], v5, s[4:7], s28 offen offset:1024 sc1
  buffer_load_dwordx4 v[208:211], v5, s[4:7], s27 offen offset:2048 sc1
  buffer_load_dwordx4 v[88:91], v5, s[4:7], s28 offen offset:2048 sc1
  buffer_load_dwordx4 v[212:215], v5, s[4:7], s27 offen offset:3072 sc1
  buffer_load_dwordx4 v[92:95], v5, s[4:7], s28 offen offset:3072 sc1
  s_add_u32 s27, s27, 4096
  s_add_u32 s28, s28, 4096
  buffer_load_dwordx4 v[216:219], v5, s[4:7], s27 offen offset:0 sc1
  buffer_load_dwordx4 v[96:99], v5, s[4:7], s28 offen offset:0 sc1
  buffer_load_dwordx4 v[220:223], v5, s[4:7], s27 offen offset:1024 sc1
  buffer_load_dwordx4 v[100:103], v5, s[4:7], s28 offen offset:1024 sc1
  buffer_load_dwordx4 v[224:227], v5, s[4:7], s27 offen offset:2048 sc1
  buffer_load_dwordx4 v[104:107], v5, s[4:7], s28 offen offset:2048 sc1
  buffer_load_dwordx4 v[228:231], v5, s[4:7], s27 offen offset:3072 sc1
  buffer_load_dwordx4 v[108:111], v5, s[4:7], s28 offen offset:3072 sc1
  s_add_u32 s27, s27, 4096
  s_add_u32 s28, s28, 4096
  buffer_load_dwordx4 v[232:235], v5, s[4:7], s27 offen offset:0 sc1
  buffer_load_dwordx4 v[112:115], v5, s[4:7], s28 offen offset:0 sc1
  buffer_load_dwordx4 v[236:239], v5, s[4:7], s27 offen offset:1024 sc1
  buffer_load_dwordx4 v[116:119], v5, s[4:7], s28 offen offset:1024 sc1
  buffer_load_dwordx4 v[240:243], v5, s[4:7], s27 offen offset:2048 sc1
  buffer_load_dwordx4 v[120:123], v5, s[4:7], s28 offen offset:2048 sc1
  buffer_load_dwordx4 v[244:247], v5, s[4:7], s27 offen offset:3072 sc1
  buffer_load_dwordx4 v[124:127], v5, s[4:7], s28 offen offset:3072 sc1
  v_cndmask_b32 v152, v176, v152, s[50:51]
  v_cndmask_b32 v160, v176, v160, s[50:51]
  v_cndmask_b32 v153, v176, v153, s[52:53]
  v_cndmask_b32 v161, v176, v161, s[52:53]
  v_cndmask_b32 v154, v176, v154, s[54:55]
  v_cndmask_b32 v162, v176, v162, s[54:55]
  v_cndmask_b32 v155, v176, v155, s[56:57]
  v_cndmask_b32 v163, v176, v163, s[56:57]
  v_max3_f32 v177, v152, v153, v154
  v_max_f32 v177, v177, v155
  v_max3_f32 v178, v156, v157, v158
  v_max3_f32 v178, v178, v159, v160
  v_max3_f32 v178, v178, v161, v162
  v_max_f32 v178, v178, v163
  s_waitcnt vmcnt(29)
  v_mfma_f32_16x16x32_bf16 v[164:167], v[128:131], v[32:35], 0
  v_mfma_f32_16x16x32_bf16 v[168:171], v[128:131], v[36:39], 0
  s_waitcnt vmcnt(28)
  v_mfma_f32_16x16x32_bf16 v[164:167], v[132:135], v[40:43], v[164:167]
  v_mfma_f32_16x16x32_bf16 v[168:171], v[132:135], v[44:47], v[168:171]
  s_waitcnt vmcnt(27)
  v_mfma_f32_16x16x32_bf16 v[164:167], v[136:139], v[48:51], v[164:167]
  v_mfma_f32_16x16x32_bf16 v[168:171], v[136:139], v[52:55], v[168:171]
  s_waitcnt vmcnt(26)
  v_mfma_f32_16x16x32_bf16 v[164:167], v[140:143], v[56:59], v[164:167]
  v_mfma_f32_16x16x32_bf16 v[168:171], v[140:143], v[60:63], v[168:171]
  s_waitcnt vmcnt(25)
  v_mfma_f32_16x16x32_bf16 v[164:167], v[144:147], v[64:67], v[164:167]
  v_mfma_f32_16x16x32_bf16 v[168:171], v[144:147], v[68:71], v[168:171]
  s_waitcnt vmcnt(24)
  v_mfma_f32_16x16x32_bf16 v[164:167], v[148:151], v[72:75], v[164:167]
  v_mfma_f32_16x16x32_bf16 v[168:171], v[148:151], v[76:79], v[168:171]
  s_nop 7
  v_cndmask_b32 v164, v176, v164, s[58:59]
  v_cndmask_b32 v168, v176, v168, s[58:59]
  v_cndmask_b32 v165, v176, v165, s[58:59]
  v_cndmask_b32 v169, v176, v169, s[58:59]
  v_cndmask_b32 v166, v176, v166, s[58:59]
  v_cndmask_b32 v170, v176, v170, s[58:59]
  v_cndmask_b32 v167, v176, v167, s[58:59]
  v_cndmask_b32 v171, v176, v171, s[58:59]
  v_max3_f32 v177, v177, v164, v165
  v_max3_f32 v178, v178, v168, v169
  v_max3_f32 v177, v177, v166, v167
  v_max3_f32 v178, v178, v170, v171
  v_mov_b32 v179, v177
  v_mov_b32 v180, v178
  s_nop 1
  v_permlane32_swap_b32 v177, v179
  v_permlane32_swap_b32 v178, v180
  s_nop 0
  v_max_f32 v177, v177, v179
  v_max_f32 v178, v178, v180
  v_mov_b32 v179, v177
  v_mov_b32 v180, v178
  s_nop 1
  v_permlane16_swap_b32 v177, v179
  v_permlane16_swap_b32 v178, v180
  s_nop 0
  v_max_f32 v177, v177, v179
  v_max_f32 v178, v178, v180
  v_sub_f32 v152, v152, v177
  v_sub_f32 v153, v153, v177
  v_sub_f32 v154, v154, v177
  v_sub_f32 v155, v155, v177
  v_sub_f32 v164, v164, v177
  v_sub_f32 v165, v165, v177
  v_sub_f32 v166, v166, v177
  v_sub_f32 v167, v167, v177
  v_sub_f32 v156, v156, v178
  v_sub_f32 v157, v157, v178
  v_sub_f32 v158, v158, v178
  v_sub_f32 v159, v159, v178
  v_sub_f32 v160, v160, v178
  v_sub_f32 v161, v161, v178
  v_sub_f32 v162, v162, v178
  v_sub_f32 v163, v163, v178
  v_sub_f32 v168, v168, v178
  v_sub_f32 v169, v169, v178
  v_sub_f32 v170, v170, v178
  v_sub_f32 v171, v171, v178
  v_mul_f32 v152, s60, v152
  v_mul_f32 v153, s60, v153
  v_mul_f32 v154, s60, v154
  v_mul_f32 v155, s60, v155
  v_mul_f32 v164, s60, v164
  v_mul_f32 v165, s60, v165
  v_mul_f32 v166, s60, v166
  v_mul_f32 v167, s60, v167
  v_mul_f32 v156, s60, v156
  v_mul_f32 v157, s60, v157
  v_mul_f32 v158, s60, v158
  v_mul_f32 v159, s60, v159
  v_mul_f32 v160, s60, v160
  v_mul_f32 v161, s60, v161
  v_mul_f32 v162, s60, v162
  v_mul_f32 v163, s60, v163
  v_mul_f32 v168, s60, v168
  v_mul_f32 v169, s60, v169
  v_mul_f32 v170, s60, v170
  v_mul_f32 v171, s60, v171
  v_exp_f32 v152, v152
  v_exp_f32 v153, v153
  v_exp_f32 v154, v154
  v_exp_f32 v155, v155
  v_exp_f32 v164, v164
  v_exp_f32 v165, v165
  v_exp_f32 v166, v166
  v_exp_f32 v167, v167
  v_exp_f32 v156, v156
  v_exp_f32 v157, v157
  v_exp_f32 v158, v158
  v_exp_f32 v159, v159
  v_exp_f32 v160, v160
  v_exp_f32 v161, v161
  v_exp_f32 v162, v162
  v_exp_f32 v163, v163
  v_exp_f32 v168, v168
  v_exp_f32 v169, v169
  v_exp_f32 v170, v170
  v_exp_f32 v171, v171
  v_add_f32 v177, v152, v153
  v_add_f32 v178, v156, v157
  v_add_f32 v177, v177, v154
  v_add_f32 v177, v177, v155
  v_add_f32 v177, v177, v164
  v_add_f32 v177, v177, v165
  v_add_f32 v177, v177, v166
  v_add_f32 v177, v177, v167
  v_add_f32 v178, v178, v158
  v_add_f32 v178, v178, v159
  v_add_f32 v178, v178, v160
  v_add_f32 v178, v178, v161
  v_add_f32 v178, v178, v162
  v_add_f32 v178, v178, v163
  v_add_f32 v178, v178, v168
  v_add_f32 v178, v178, v169
  v_add_f32 v178, v178, v170
  v_add_f32 v178, v178, v171
  v_mov_b32 v179, v177
  v_mov_b32 v180, v178
  s_nop 1
  v_permlane32_swap_b32 v177, v179
  v_permlane32_swap_b32 v178, v180
  s_nop 0
  v_add_f32 v177, v177, v179
  v_add_f32 v178, v178, v180
  v_mov_b32 v179, v177
  v_mov_b32 v180, v178
  s_nop 1
  v_permlane16_swap_b32 v177, v179
  v_permlane16_swap_b32 v178, v180
  s_nop 0
  v_add_f32 v177, v177, v179
  v_add_f32 v178, v178, v180
  v_rcp_f32 v177, v177
  v_rcp_f32 v178, v178
  s_nop 0
  v_mul_f32 v152, v152, v177
  v_mul_f32 v153, v153, v177
  v_mul_f32 v154, v154, v177
  v_mul_f32 v155, v155, v177
  v_mul_f32 v164, v164, v177
  v_mul_f32 v165, v165, v177
  v_mul_f32 v166, v166, v177
  v_mul_f32 v167, v167, v177
  v_mul_f32 v156, v156, v178
  v_mul_f32 v157, v157, v178
  v_mul_f32 v158, v158, v178
  v_mul_f32 v159, v159, v178
  v_mul_f32 v160, v160, v178
  v_mul_f32 v161, v161, v178
  v_mul_f32 v162, v162, v178
  v_mul_f32 v163, v163, v178
  v_mul_f32 v168, v168, v178
  v_mul_f32 v169, v169, v178
  v_mul_f32 v170, v170, v178
  v_mul_f32 v171, v171, v178
  v_cvt_pk_bf16_f32 v184, v152, 0
  v_cvt_pk_bf16_f32 v188, v156, v160
  v_cvt_pk_bf16_f32 v185, v153, 0
  v_cvt_pk_bf16_f32 v189, v157, v161
  v_cvt_pk_bf16_f32 v186, v154, 0
  v_cvt_pk_bf16_f32 v190, v158, v162
  v_cvt_pk_bf16_f32 v187, v155, 0
  v_cvt_pk_bf16_f32 v191, v159, v163
  v_cvt_pk_bf16_f32 v192, v164, v165
  v_cvt_pk_bf16_f32 v194, v168, v169
  v_cvt_pk_bf16_f32 v193, v166, v167
  v_cvt_pk_bf16_f32 v195, v170, v171
  s_mul_i32 s26, s22, 81920
  s_add_u32 s27, s26, s35
  s_add_u32 s28, s26, s36
  buffer_store_dwordx4 v[184:187], v5, s[4:7], s27 offen sc1
  buffer_store_dwordx4 v[188:191], v5, s[4:7], s27 offen offset:1024 sc1
  s_mov_b32 exec_hi, 0
  buffer_store_dwordx2 v[192:193], v8, s[4:7], s28 offen sc1
  buffer_store_dwordx2 v[194:195], v8, s[4:7], s28 offen offset:1024 sc1
  s_mov_b32 exec_hi, -1
  s_waitcnt vmcnt(4)
  v_mfma_f32_16x16x32_bf16 v[152:155], v[80:83], v[200:203], 0
  v_mfma_f32_16x16x32_bf16 v[156:159], v[80:83], v[204:207], 0
  v_mfma_f32_16x16x32_bf16 v[160:163], v[84:87], v[204:207], 0
  v_mfma_f32_16x16x32_bf16 v[152:155], v[88:91], v[208:211], v[152:155]
  v_mfma_f32_16x16x32_bf16 v[156:159], v[88:91], v[212:215], v[156:159]
  v_mfma_f32_16x16x32_bf16 v[160:163], v[92:95], v[212:215], v[160:163]
  v_mfma_f32_16x16x32_bf16 v[152:155], v[96:99], v[216:219], v[152:155]
  v_mfma_f32_16x16x32_bf16 v[156:159], v[96:99], v[220:223], v[156:159]
  v_mfma_f32_16x16x32_bf16 v[160:163], v[100:103], v[220:223], v[160:163]
  v_mfma_f32_16x16x32_bf16 v[152:155], v[104:107], v[224:227], v[152:155]
  v_mfma_f32_16x16x32_bf16 v[156:159], v[104:107], v[228:231], v[156:159]
  v_mfma_f32_16x16x32_bf16 v[160:163], v[108:111], v[228:231], v[160:163]
  v_mfma_f32_16x16x32_bf16 v[152:155], v[112:115], v[232:235], v[152:155]
  v_mfma_f32_16x16x32_bf16 v[156:159], v[112:115], v[236:239], v[156:159]
  v_mfma_f32_16x16x32_bf16 v[160:163], v[116:119], v[236:239], v[160:163]
  v_mfma_f32_16x16x32_bf16 v[152:155], v[120:123], v[240:243], v[152:155]
  v_mfma_f32_16x16x32_bf16 v[156:159], v[120:123], v[244:247], v[156:159]
  v_mfma_f32_16x16x32_bf16 v[160:163], v[124:127], v[244:247], v[160:163]
  s_waitcnt vmcnt(0)
  s_add_u32 s26, s22, 1
  v_mov_b32 v2, s26
  s_mov_b64 exec, 1
  buffer_store_dword v2, v0, s[4:7], s33 offen sc1
  s_mov_b64 exec, -1
  s_add_u32 s22, s22, 1
  s_add_u32 s39, s22, 2
  s_min_u32 s39, s39, 64
  s_cmp_ge_u32 s46, s39
  s_cbranch_scc1 Lwok_183
Lwf_184:
  s_add_u32 s24, s24, 1
  s_cmp_gt_u32 s24, 300000
  s_cbranch_scc1 Lfail_170
  buffer_load_dword v9, v6, s[4:7], s29 offen sc1
  s_waitcnt vmcnt(0)
  v_cmp_gt_u32 vcc, s39, v9
  s_cbranch_vccz Lrok_185
  s_sleep 2
  s_branch Lwf_184
Lrok_185:
  s_add_u32 s26, s39, 6
  s_min_u32 s26, s26, 64
  s_nop 0
  v_cmp_gt_u32 vcc, s26, v9
  s_cmp_eq_u64 vcc, 0
  s_cselect_b32 s46, s26, s39
Lwok_183:
  s_add_u32 s38, s22, 1
Lwf_187:
  s_add_u32 s24, s24, 1
  s_cmp_gt_u32 s24, 300000
  s_cbranch_scc1 Lfail_171
  buffer_load_dword v9, v0, s[4:7], s30 offen sc1
  s_waitcnt vmcnt(0)
  v_cmp_gt_u32 vcc, s38, v9
  s_cbranch_vccz Lrok_188
  s_sleep 2
  s_branch Lwf_187
Lrok_188:
Lwok_186:
  s_mul_i32 s27, s22, 98304
  s_add_u32 s27, s27, s34
  buffer_load_dwordx4 v[128:131], v7, s[4:7], s27 offen offset:0 sc1
  buffer_load_dwordx4 v[132:135], v7, s[4:7], s27 offen offset:512 sc1
  buffer_load_dwordx4 v[136:139], v7, s[4:7], s27 offen offset:1024 sc1
  buffer_load_dwordx4 v[140:143], v7, s[4:7], s27 offen offset:1536 sc1
  buffer_load_dwordx4 v[144:147], v7, s[4:7], s27 offen offset:2048 sc1
  buffer_load_dwordx4 v[148:151], v7, s[4:7], s27 offen offset:2560 sc1
  s_sub_u32 s26, s39, 1
  s_mul_i32 s27, s26, 393216
  s_add_u32 s27, s27, s31
  s_add_u32 s28, s27, 0x1e00000
  s_add_u32 s27, s27, 0x600000
  s_cmp_ge_u32 s22, 63
  s_cselect_b32 s27, 0x7ff00000, s27
  s_cselect_b32 s28, 0x7ff00000, s28
  buffer_load_dwordx4 v[32:35], v5, s[4:7], s27 offen offset:0 sc1
  buffer_load_dwordx4 v[80:83], v5, s[4:7], s28 offen offset:0 sc1
  buffer_load_dwordx4 v[36:39], v5, s[4:7], s27 offen offset:1024 sc1
  buffer_load_dwordx4 v[84:87], v5, s[4:7], s28 offen offset:1024 sc1
  buffer_load_dwordx4 v[40:43], v5, s[4:7], s27 offen offset:2048 sc1
  buffer_load_dwordx4 v[88:91], v5, s[4:7], s28 offen offset:2048 sc1
  buffer_load_dwordx4 v[44:47], v5, s[4:7], s27 offen offset:3072 sc1
  buffer_load_dwordx4 v[92:95], v5, s[4:7], s28 offen offset:3072 sc1
  s_add_u32 s27, s27, 4096
  s_add_u32 s28, s28, 4096
  buffer_load_dwordx4 v[48:51], v5, s[4:7], s27 offen offset:0 sc1
  buffer_load_dwordx4 v[96:99], v5, s[4:7], s28 offen offset:0 sc1
  buffer_load_dwordx4 v[52:55], v5, s[4:7], s27 offen offset:1024 sc1
  buffer_load_dwordx4 v[100:103], v5, s[4:7], s28 offen offset:1024 sc1
  buffer_load_dwordx4 v[56:59], v5, s[4:7], s27 offen offset:2048 sc1
  buffer_load_dwordx4 v[104:107], v5, s[4:7], s28 offen offset:2048 sc1
  buffer_load_dwordx4 v[60:63], v5, s[4:7], s27 offen offset:3072 sc1
  buffer_load_dwordx4 v[108:111], v5, s[4:7], s28 offen offset:3072 sc1
  s_add_u32 s27, s27, 4096
  s_add_u32 s28, s28, 4096
  buffer_load_dwordx4 v[64:67], v5, s[4:7], s27 offen offset:0 sc1
  buffer_load_dwordx4 v[112:115], v5, s[4:7], s28 offen offset:0 sc1
  buffer_load_dwordx4 v[68:71], v5, s[4:7], s27 offen offset:1024 sc1
  buffer_load_dwordx4 v[116:119], v5, s[4:7], s28 offen offset:1024 sc1
  buffer_load_dwordx4 v[72:75], v5, s[4:7], s27 offen offset:2048 sc1
  buffer_load_dwordx4 v[120:123], v5, s[4:7], s28 offen offset:2048 sc1
  buffer_load_dwordx4 v[76:79], v5, s[4:7], s27 offen offset:3072 sc1
  buffer_load_dwordx4 v[124:127], v5, s[4:7], s28 offen offset:3072 sc1
  v_cndmask_b32 v152, v176, v152, s[50:51]
  v_cndmask_b32 v160, v176, v160, s[50:51]
  v_cndmask_b32 v153, v176, v153, s[52:53]
  v_cndmask_b32 v161, v176, v161, s[52:53]
  v_cndmask_b32 v154, v176, v154, s[54:55]
  v_cndmask_b32 v162, v176, v162, s[54:55]
  v_cndmask_b32 v155, v176, v155, s[56:57]
  v_cndmask_b32 v163, v176, v163, s[56:57]
  v_max3_f32 v177, v152, v153, v154
  v_max_f32 v177, v177, v155
  v_max3_f32 v178, v156, v157, v158
  v_max3_f32 v178, v178, v159, v160
  v_max3_f32 v178, v178, v161, v162
  v_max_f32 v178, v178, v163
  s_waitcnt vmcnt(29)
  v_mfma_f32_16x16x32_bf16 v[164:167], v[128:131], v[200:203], 0
  v_mfma_f32_16x16x32_bf16 v[168:171], v[128:131], v[204:207], 0
  s_waitcnt vmcnt(28)
  v_mfma_f32_16x16x32_bf16 v[164:167], v[132:135], v[208:211], v[164:167]
  v_mfma_f32_16x16x32_bf16 v[168:171], v[132:135], v[212:215], v[168:171]
  s_waitcnt vmcnt(27)
  v_mfma_f32_16x16x32_bf16 v[164:167], v[136:139], v[216:219], v[164:167]
  v_mfma_f32_16x16x32_bf16 v[168:171], v[136:139], v[220:223], v[168:171]
  s_waitcnt vmcnt(26)
  v_mfma_f32_16x16x32_bf16 v[164:167], v[140:143], v[224:227], v[164:167]
  v_mfma_f32_16x16x32_bf16 v[168:171], v[140:143], v[228:231], v[168:171]
  s_waitcnt vmcnt(25)
  v_mfma_f32_16x16x32_bf16 v[164:167], v[144:147], v[232:235], v[164:167]
  v_mfma_f32_16x16x32_bf16 v[168:171], v[144:147], v[236:239], v[168:171]
  s_waitcnt vmcnt(24)
  v_mfma_f32_16x16x32_bf16 v[164:167], v[148:151], v[240:243], v[164:167]
  v_mfma_f32_16x16x32_bf16 v[168:171], v[148:151], v[244:247], v[168:171]
  s_nop 7
  v_cndmask_b32 v164, v176, v164, s[58:59]
  v_cndmask_b32 v168, v176, v168, s[58:59]
  v_cndmask_b32 v165, v176, v165, s[58:59]
  v_cndmask_b32 v169, v176, v169, s[58:59]
  v_cndmask_b32 v166, v176, v166, s[58:59]
  v_cndmask_b32 v170, v176, v170, s[58:59]
  v_cndmask_b32 v167, v176, v167, s[58:59]
  v_cndmask_b32 v171, v176, v171, s[58:59]
  v_max3_f32 v177, v177, v164, v165
  v_max3_f32 v178, v178, v168, v169
  v_max3_f32 v177, v177, v166, v167
  v_max3_f32 v178, v178, v170, v171
  v_mov_b32 v179, v177
  v_mov_b32 v180, v178
  s_nop 1
  v_permlane32_swap_b32 v177, v179
  v_permlane32_swap_b32 v178, v180
  s_nop 0
  v_max_f32 v177, v177, v179
  v_max_f32 v178, v178, v180
  v_mov_b32 v179, v177
  v_mov_b32 v180, v178
  s_nop 1
  v_permlane16_swap_b32 v177, v179
  v_permlane16_swap_b32 v178, v180
  s_nop 0
  v_max_f32 v177, v177, v179
  v_max_f32 v178, v178, v180
  v_sub_f32 v152, v152, v177
  v_sub_f32 v153, v153, v177
  v_sub_f32 v154, v154, v177
  v_sub_f32 v155, v155, v177
  v_sub_f32 v164, v164, v177
  v_sub_f32 v165, v165, v177
  v_sub_f32 v166, v166, v177
  v_sub_f32 v167, v167, v177
  v_sub_f32 v156, v156, v178
  v_sub_f32 v157, v157, v178
  v_sub_f32 v158, v158, v178
  v_sub_f32 v159, v159, v178
  v_sub_f32 v160, v160, v178
  v_sub_f32 v161, v161, v178
  v_sub_f32 v162, v162, v178
  v_sub_f32 v163, v163, v178
  v_sub_f32 v168, v168, v178
  v_sub_f32 v169, v169, v178
  v_sub_f32 v170, v170, v178
  v_sub_f32 v171, v171, v178
  v_mul_f32 v152, s60, v152
  v_mul_f32 v153, s60, v153
  v_mul_f32 v154, s60, v154
  v_mul_f32 v155, s60, v155
  v_mul_f32 v164, s60, v164
  v_mul_f32 v165, s60, v165
  v_mul_f32 v166, s60, v166
  v_mul_f32 v167, s60, v167
  v_mul_f32 v156, s60, v156
  v_mul_f32 v157, s60, v157
  v_mul_f32 v158, s60, v158
  v_mul_f32 v159, s60, v159
  v_mul_f32 v160, s60, v160
  v_mul_f32 v161, s60, v161
  v_mul_f32 v162, s60, v162
  v_mul_f32 v163, s60, v163
  v_mul_f32 v168, s60, v168
  v_mul_f32 v169, s60, v169
  v_mul_f32 v170, s60, v170
  v_mul_f32 v171, s60, v171
  v_exp_f32 v152, v152
  v_exp_f32 v153, v153
  v_exp_f32 v154, v154
  v_exp_f32 v155, v155
  v_exp_f32 v164, v164
  v_exp_f32 v165, v165
  v_exp_f32 v166, v166
  v_exp_f32 v167, v167
  v_exp_f32 v156, v156
  v_exp_f32 v157, v157
  v_exp_f32 v158, v158
  v_exp_f32 v159, v159
  v_exp_f32 v160, v160
  v_exp_f32 v161, v161
  v_exp_f32 v162, v162
  v_exp_f32 v163, v163
  v_exp_f32 v168, v168
  v_exp_f32 v169, v169
  v_exp_f32 v170, v170
  v_exp_f32 v171, v171
  v_add_f32 v177, v152, v153
  v_add_f32 v178, v156, v157
  v_add_f32 v177, v177, v154
  v_add_f32 v177, v177, v155
  v_add_f32 v177, v177, v164
  v_add_f32 v177, v177, v165
  v_add_f32 v177, v177, v166
  v_add_f32 v177, v177, v167
  v_add_f32 v178, v178, v158
  v_add_f32 v178, v178, v159
  v_add_f32 v178, v178, v160
  v_add_f32 v178, v178, v161
  v_add_f32 v178, v178, v162
  v_add_f32 v178, v178, v163
  v_add_f32 v178, v178, v168
  v_add_f32 v178, v178, v169
  v_add_f32 v178, v178, v170
  v_add_f32 v178, v178, v171
  v_mov_b32 v179, v177
  v_mov_b32 v180, v178
  s_nop 1
  v_permlane32_swap_b32 v177, v179
  v_permlane32_swap_b32 v178, v180
  s_nop 0
  v_add_f32 v177, v177, v179
  v_add_f32 v178, v178, v180
  v_mov_b32 v179, v177
  v_mov_b32 v180, v178
  s_nop 1
  v_permlane16_swap_b32 v177, v179
  v_permlane16_swap_b32 v178, v180
  s_nop 0
  v_add_f32 v177, v177, v179
  v_add_f32 v178, v178, v180
  v_rcp_f32 v177, v177
  v_rcp_f32 v178, v178
  s_nop 0
  v_mul_f32 v152, v152, v177
  v_mul_f32 v153, v153, v177
  v_mul_f32 v154, v154, v177
  v_mul_f32 v155, v155, v177
  v_mul_f32 v164, v164, v177
  v_mul_f32 v165, v165, v177
  v_mul_f32 v166, v166, v177
  v_mul_f32 v167, v167, v177
  v_mul_f32 v156, v156, v178
  v_mul_f32 v157, v157, v178
  v_mul_f32 v158, v158, v178
  v_mul_f32 v159, v159, v178
  v_mul_f32 v160, v160, v178
  v_mul_f32 v161, v161, v178
  v_mul_f32 v162, v162, v178
  v_mul_f32 v163, v163, v178
  v_mul_f32 v168, v168, v178
  v_mul_f32 v169, v169, v178
  v_mul_f32 v170, v170, v178
  v_mul_f32 v171, v171, v178
  v_cvt_pk_bf16_f32 v184, v152, 0
  v_cvt_pk_bf16_f32 v188, v156, v160
  v_cvt_pk_bf16_f32 v185, v153, 0
  v_cvt_pk_bf16_f32 v189, v157, v161
  v_cvt_pk_bf16_f32 v186, v154, 0
  v_cvt_pk_bf16_f32 v190, v158, v162
  v_cvt_pk_bf16_f32 v187, v155, 0
  v_cvt_pk_bf16_f32 v191, v159, v163
  v_cvt_pk_bf16_f32 v192, v164, v165
  v_cvt_pk_bf16_f32 v194, v168, v169
  v_cvt_pk_bf16_f32 v193, v166, v167
  v_cvt_pk_bf16_f32 v195, v170, v171
  s_mul_i32 s26, s22, 81920
  s_add_u32 s27, s26, s35
  s_add_u32 s28, s26, s36
  buffer_store_dwordx4 v[184:187], v5, s[4:7], s27 offen sc1
  buffer_store_dwordx4 v[188:191], v5, s[4:7], s27 offen offset:1024 sc1
  s_mov_b32 exec_hi, 0
  buffer_store_dwordx2 v[192:193], v8, s[4:7], s28 offen sc1
  buffer_store_dwordx2 v[194:195], v8, s[4:7], s28 offen offset:1024 sc1
  s_mov_b32 exec_hi, -1
  s_waitcnt vmcnt(4)
  v_mfma_f32_16x16x32_bf16 v[152:155], v[80:83], v[32:35], 0
  v_mfma_f32_16x16x32_bf16 v[156:159], v[80:83], v[36:39], 0
  v_mfma_f32_16x16x32_bf16 v[160:163], v[84:87], v[36:39], 0
  v_mfma_f32_16x16x32_bf16 v[152:155], v[88:91], v[40:43], v[152:155]
  v_mfma_f32_16x16x32_bf16 v[156:159], v[88:91], v[44:47], v[156:159]
  v_mfma_f32_16x16x32_bf16 v[160:163], v[92:95], v[44:47], v[160:163]
  v_mfma_f32_16x16x32_bf16 v[152:155], v[96:99], v[48:51], v[152:155]
  v_mfma_f32_16x16x32_bf16 v[156:159], v[96:99], v[52:55], v[156:159]
  v_mfma_f32_16x16x32_bf16 v[160:163], v[100:103], v[52:55], v[160:163]
  v_mfma_f32_16x16x32_bf16 v[152:155], v[104:107], v[56:59], v[152:155]
  v_mfma_f32_16x16x32_bf16 v[156:159], v[104:107], v[60:63], v[156:159]
  v_mfma_f32_16x16x32_bf16 v[160:163], v[108:111], v[60:63], v[160:163]
  v_mfma_f32_16x16x32_bf16 v[152:155], v[112:115], v[64:67], v[152:155]
  v_mfma_f32_16x16x32_bf16 v[156:159], v[112:115], v[68:71], v[156:159]
  v_mfma_f32_16x16x32_bf16 v[160:163], v[116:119], v[68:71], v[160:163]
  v_mfma_f32_16x16x32_bf16 v[152:155], v[120:123], v[72:75], v[152:155]
  v_mfma_f32_16x16x32_bf16 v[156:159], v[120:123], v[76:79], v[156:159]
  v_mfma_f32_16x16x32_bf16 v[160:163], v[124:127], v[76:79], v[160:163]
  s_waitcnt vmcnt(0)
  s_add_u32 s26, s22, 1
  v_mov_b32 v2, s26
  s_mov_b64 exec, 1
  buffer_store_dword v2, v0, s[4:7], s33 offen sc1
  s_mov_b64 exec, -1
  s_add_u32 s22, s22, 1
  s_cmp_lt_u32 s22, 64
  s_cbranch_scc1 Lal_175
  s_branch Lmain_end
.p2align 6
Lrole_PZ:
  s_mov_b32 s16, s32
  s_and_b32 s17, s33, 0xffff
  s_mov_b32 s18, 0x280000
  s_mov_b32 s19, 0x20000
  s_and_b32 s44, s20, 1
  s_lshr_b32 s45, s20, 1
  v_lshlrev_b32 v5, 4, v1
  v_mov_b32 v0, 0
  s_lshl_b32 s26, s45, 2
  s_mul_i32 s27, s26, 6554
  s_lshr_b32 s27, s27, 16
  s_lshl_b32 s27, s27, 7
  s_add_u32 s26, s26, 3
  s_mul_i32 s28, s26, 6554
  s_lshr_b32 s28, s28, 16
  s_lshl_b32 s28, s28, 7
  v_mov_b32 v2, s27
  v_mov_b32 v3, s28
  v_and_b32 v4, 8, v1
  v_cmp_ne_u32 vcc, 0, v4
  s_nop 1
  v_cndmask_b32 v2, v2, v3, vcc
  v_and_b32 v3, 7, v1
  v_lshl_add_u32 v6, v3, 2, v2
  s_lshl_b32 s29, s21, 5
  s_add_u32 s29, s29, 0xc00
  s_lshl_b32 s26, s21, 5
  s_add_u32 s26, s26, 1024
  v_lshl_add_u32 v2, v3, 2, s26
  s_lshl_b32 s26, s45, 6
  s_lshl_b32 s27, s21, 2
  s_add_u32 s26, s26, s27
  v_and_b32 v3, 3, v1
  v_lshl_add_u32 v3, v3, 4, s26
  v_cndmask_b32 v7, v2, v3, vcc
  s_mov_b32 s30, 0x1400
  s_lshl_b32 s31, s45, 17
  s_lshl_b32 s26, s21, 13
  s_add_u32 s31, s31, s26
  s_add_u32 s31, s31, 0x4e00000
  s_lshl_b32 s34, s45, 15
  s_lshl_b32 s26, s21, 11
  s_add_u32 s34, s34, s26
  s_add_u32 s34, s34, 0xa400000
  s_lshl_b32 s35, s21, 14
  s_add_u32 s35, s35, 0xb800000
  s_lshl_b32 s36, s21, 12
  s_add_u32 s36, s36, 0xb810000
  s_mul_i32 s33, s44, 160
  s_lshl_b32 s26, s45, 4
  s_add_u32 s33, s33, s26
  s_lshl_b32 s26, s21, 2
  s_add_u32 s33, s33, s26
  s_add_u32 s33, s33, 0x1c00
  s_lshl_b32 s26, s21, 13
  v_add_u32 v9, s26, v5
  s_lshl_b32 s26, s21, 11
  v_add_u32 v10, s26, v5
  s_lshl_b32 s26, s45, 6
  s_lshl_b32 s27, s21, 4
  s_add_u32 s26, s26, s27
  v_lshrrev_b32 v2, 4, v1
  v_lshl_add_u32 v2, v2, 2, s26
  v_and_b32 v3, 15, v1
  v_mul_u32_u24 v3, 1280, v3
  v_lshl_add_u32 v11, v2, 1, v3
  v_lshlrev_b32 v14, 1, v11
  v_lshlrev_b32 v2, 2, v2
  s_mov_b32 s26, 0x281400
  buffer_load_dwordx4 v[176:179], v2, s[4:7], s26 offen sc1
  s_mov_b32 s46, 0
  s_mov_b32 s22, s44
  s_mov_b32 s47, 0
  s_lshl_b32 s29, s29, 5
  s_add_u32 s29, s29, 0x200000
  s_lshl_b32 s30, s30, 5
  s_add_u32 s30, s30, 0x200000
  s_lshl_b32 s33, s33, 5
  s_add_u32 s33, s33, 0x200000
  v_lshlrev_b32 v6, 5, v6
  v_lshlrev_b32 v7, 5, v7
  s_add_u32 s39, s22, 1
  s_min_u32 s39, s39, 64
  s_cmp_ge_u32 s46, s39
  s_cbranch_scc1 Lwok_191
Lwf_192:
  s_add_u32 s24, s24, 1
  s_cmp_gt_u32 s24, 300000
  s_cbranch_scc1 Lfail_189
  buffer_load_dword v8, v6, s[4:7], s29 offen sc1
  s_waitcnt vmcnt(0)
  v_cmp_gt_u32 vcc, s39, v8
  s_cbranch_vccz Lrok_193
  s_sleep 2
  s_branch Lwf_192
Lrok_193:
  s_add_u32 s26, s39, 6
  s_min_u32 s26, s26, 64
  s_nop 0
  v_cmp_gt_u32 vcc, s26, v8
  s_cmp_eq_u64 vcc, 0
  s_cselect_b32 s46, s26, s39
Lwok_191:
  s_add_u32 s26, s22, 0
  s_mul_i32 s40, s26, 1310720
  s_add_u32 s40, s40, s31
  s_mul_i32 s41, s26, 40960
  s_add_u32 s42, s41, 20480
  buffer_load_dwordx4 a[0:3], v5, s[4:7], s40 offen offset:0 sc1
  buffer_load_dwordx4 a[4:7], v5, s[4:7], s40 offen offset:1024 sc1
  buffer_load_dwordx4 a[8:11], v5, s[4:7], s40 offen offset:2048 sc1
  buffer_load_dwordx4 a[12:15], v5, s[4:7], s40 offen offset:3072 sc1
  s_add_u32 s40, s40, 4096
  buffer_load_dwordx4 a[16:19], v5, s[4:7], s40 offen offset:0 sc1
  buffer_load_dwordx4 a[20:23], v5, s[4:7], s40 offen offset:1024 sc1
  buffer_load_dwordx4 a[24:27], v5, s[4:7], s40 offen offset:2048 sc1
  buffer_load_dwordx4 a[28:31], v5, s[4:7], s40 offen offset:3072 sc1
  s_add_u32 s40, s40, 28672
  buffer_load_dwordx4 a[32:35], v5, s[4:7], s40 offen offset:0 sc1
  buffer_load_dwordx4 a[36:39], v5, s[4:7], s40 offen offset:1024 sc1
  buffer_load_dwordx4 a[40:43], v5, s[4:7], s40 offen offset:2048 sc1
  buffer_load_dwordx4 a[44:47], v5, s[4:7], s40 offen offset:3072 sc1
  s_add_u32 s40, s40, 4096
  buffer_load_dwordx4 a[48:51], v5, s[4:7], s40 offen offset:0 sc1
  buffer_load_dwordx4 a[52:55], v5, s[4:7], s40 offen offset:1024 sc1
  buffer_load_dwordx4 a[56:59], v5, s[4:7], s40 offen offset:2048 sc1
  buffer_load_dwordx4 a[60:63], v5, s[4:7], s40 offen offset:3072 sc1
  s_add_u32 s40, s40, 28672
  buffer_load_dwordx4 a[64:67], v5, s[4:7], s40 offen offset:0 sc1
  buffer_load_dwordx4 a[68:71], v5, s[4:7], s40 offen offset:1024 sc1
  buffer_load_dwordx4 a[72:75], v5, s[4:7], s40 offen offset:2048 sc1
  buffer_load_dwordx4 a[76:79], v5, s[4:7], s40 offen offset:3072 sc1
  s_add_u32 s40, s40, 4096
  buffer_load_dwordx4 a[80:83], v5, s[4:7], s40 offen offset:0 sc1
  buffer_load_dwordx4 a[84:87], v5, s[4:7], s40 offen offset:1024 sc1
  buffer_load_dwordx4 a[88:91], v5, s[4:7], s40 offen offset:2048 sc1
  buffer_load_dwordx4 a[92:95], v5, s[4:7], s40 offen offset:3072 sc1
  s_add_u32 s40, s40, 28672
  buffer_load_dwordx4 a[96:99], v5, s[4:7], s40 offen offset:0 sc1
  buffer_load_dwordx4 a[100:103], v5, s[4:7], s40 offen offset:1024 sc1
  buffer_load_dwordx4 a[104:107], v5, s[4:7], s40 offen offset:2048 sc1
  buffer_load_dwordx4 a[108:111], v5, s[4:7], s40 offen offset:3072 sc1
  s_add_u32 s40, s40, 4096
  buffer_load_dwordx4 a[112:115], v5, s[4:7], s40 offen offset:0 sc1
  buffer_load_dwordx4 a[116:119], v5, s[4:7], s40 offen offset:1024 sc1
  buffer_load_dwordx4 a[120:123], v5, s[4:7], s40 offen offset:2048 sc1
  buffer_load_dwordx4 a[124:127], v5, s[4:7], s40 offen offset:3072 sc1
  buffer_load_dwordx2 v[180:181], v11, s[16:19], s41 offen
  buffer_load_dwordx2 v[182:183], v11, s[16:19], s42 offen
  s_mov_b32 s25, 0
Lpl_194:
  s_add_u32 s39, s22, 3
  s_min_u32 s39, s39, 64
  s_cmp_ge_u32 s46, s39
  s_cbranch_scc1 Lwok_196
Lwf_197:
  s_add_u32 s24, s24, 1
  s_cmp_gt_u32 s24, 300000
  s_cbranch_scc1 Lfail_189
  buffer_load_dword v8, v6, s[4:7], s29 offen sc1
  s_waitcnt vmcnt(0)
  v_cmp_gt_u32 vcc, s39, v8
  s_cbranch_vccz Lrok_198
  s_sleep 2
  s_branch Lwf_197
Lrok_198:
  s_add_u32 s26, s39, 6
  s_min_u32 s26, s26, 64
  s_nop 0
  v_cmp_gt_u32 vcc, s26, v8
  s_cmp_eq_u64 vcc, 0
  s_cselect_b32 s46, s26, s39
Lwok_196:
  s_add_u32 s26, s22, 2
  s_mul_i32 s40, s26, 1310720
  s_add_u32 s40, s40, s31
  s_mul_i32 s41, s26, 40960
  s_add_u32 s42, s41, 20480
  s_cmp_eq_u32 s25, 1
  s_cbranch_scc1 Lppre_199
  s_add_u32 s38, s22, 1
Lwf_201:
  s_add_u32 s24, s24, 1
  s_cmp_gt_u32 s24, 300000
  s_cbranch_scc1 Lfail_190
  buffer_load_dword v8, v7, s[4:7], s30 offen sc1
  s_waitcnt vmcnt(0)
  v_cmp_gt_u32 vcc, s38, v8
  s_cbranch_vccz Lrok_202
  s_sleep 2
  s_branch Lwf_201
Lrok_202:
Lwok_200:
  s_add_u32 s43, s22, 0
  s_mul_i32 s26, s43, 81920
  s_add_u32 s27, s26, s35
  s_add_u32 s28, s26, s36
  s_mul_i32 s39, s43, 327680
  s_add_u32 s39, s39, s34
  buffer_load_dwordx4 v[32:35], v5, s[4:7], s27 offen offset:0 sc1
  buffer_load_dwordx4 v[36:39], v5, s[4:7], s27 offen offset:1024 sc1
  buffer_load_dwordx4 v[40:43], v5, s[4:7], s27 offen offset:2048 sc1
  buffer_load_dwordx4 v[44:47], v5, s[4:7], s27 offen offset:3072 sc1
  s_add_u32 s27, s27, 4096
  buffer_load_dwordx4 v[48:51], v5, s[4:7], s27 offen offset:0 sc1
  buffer_load_dwordx4 v[52:55], v5, s[4:7], s27 offen offset:1024 sc1
  buffer_load_dwordx4 v[56:59], v5, s[4:7], s27 offen offset:2048 sc1
  buffer_load_dwordx4 v[60:63], v5, s[4:7], s27 offen offset:3072 sc1
  s_add_u32 s27, s27, 4096
  buffer_load_dwordx4 v[64:67], v5, s[4:7], s27 offen offset:0 sc1
  buffer_load_dwordx4 v[68:71], v5, s[4:7], s27 offen offset:1024 sc1
  buffer_load_dwordx4 v[72:75], v5, s[4:7], s27 offen offset:2048 sc1
  buffer_load_dwordx4 v[76:79], v5, s[4:7], s27 offen offset:3072 sc1
  s_add_u32 s27, s27, 4096
  buffer_load_dwordx4 v[80:83], v5, s[4:7], s27 offen offset:0 sc1
  buffer_load_dwordx4 v[84:87], v5, s[4:7], s27 offen offset:1024 sc1
  buffer_load_dwordx4 v[88:91], v5, s[4:7], s27 offen offset:2048 sc1
  buffer_load_dwordx4 v[92:95], v5, s[4:7], s27 offen offset:3072 sc1
  buffer_load_dwordx4 v[96:99], v5, s[4:7], s28 offen offset:0 sc1
  buffer_load_dwordx4 v[100:103], v5, s[4:7], s28 offen offset:1024 sc1
  buffer_load_dwordx4 v[104:107], v5, s[4:7], s28 offen offset:2048 sc1
  buffer_load_dwordx4 v[108:111], v5, s[4:7], s28 offen offset:3072 sc1
  buffer_load_dwordx4 v[192:195], v5, s[4:7], s39 offen offset:0 sc1
  buffer_load_dwordx4 v[196:199], v5, s[4:7], s39 offen offset:1024 sc1
  s_add_u32 s39, s39, 8192
  buffer_load_dwordx4 v[200:203], v5, s[4:7], s39 offen offset:0 sc1
  buffer_load_dwordx4 v[204:207], v5, s[4:7], s39 offen offset:1024 sc1
  s_add_u32 s39, s39, 8192
  buffer_load_dwordx4 v[208:211], v5, s[4:7], s39 offen offset:0 sc1
  buffer_load_dwordx4 v[212:215], v5, s[4:7], s39 offen offset:1024 sc1
  s_add_u32 s39, s39, 8192
  buffer_load_dwordx4 v[216:219], v5, s[4:7], s39 offen offset:0 sc1
  buffer_load_dwordx4 v[220:223], v5, s[4:7], s39 offen offset:1024 sc1
  buffer_load_dword v2, v0, s[4:7], s30 offen sc1
Lppre_199:
  buffer_load_dword v15, v7, s[4:7], s30 offen sc1
  s_cmp_ge_u32 s22, 62
  s_cbranch_scc1 Lpnp_203
  s_waitcnt vmcnt(29)
  v_mfma_f32_16x16x32_bf16 v[112:115], a[0:3], v[32:35], 0
  v_mfma_f32_16x16x32_bf16 v[120:123], a[32:35], v[32:35], 0
  buffer_load_dwordx4 a[128:131], v5, s[4:7], s40 offen offset:0 sc1
  v_mfma_f32_16x16x32_bf16 v[128:131], a[64:67], v[32:35], 0
  v_mfma_f32_16x16x32_bf16 v[136:139], a[96:99], v[32:35], 0
  buffer_load_dwordx4 a[132:135], v5, s[4:7], s40 offen offset:1024 sc1
  s_waitcnt vmcnt(30)
  v_mfma_f32_16x16x32_bf16 v[116:119], a[0:3], v[36:39], 0
  v_mfma_f32_16x16x32_bf16 v[124:127], a[32:35], v[36:39], 0
  buffer_load_dwordx4 a[136:139], v5, s[4:7], s40 offen offset:2048 sc1
  v_mfma_f32_16x16x32_bf16 v[132:135], a[64:67], v[36:39], 0
  v_mfma_f32_16x16x32_bf16 v[140:143], a[96:99], v[36:39], 0
  buffer_load_dwordx4 a[140:143], v5, s[4:7], s40 offen offset:3072 sc1
  s_waitcnt vmcnt(31)
  v_mfma_f32_16x16x32_bf16 v[112:115], a[4:7], v[40:43], v[112:115]
  v_mfma_f32_16x16x32_bf16 v[120:123], a[36:39], v[40:43], v[120:123]
  s_add_u32 s40, s40, 4096
  buffer_load_dwordx4 a[144:147], v5, s[4:7], s40 offen offset:0 sc1
  v_mfma_f32_16x16x32_bf16 v[128:131], a[68:71], v[40:43], v[128:131]
  v_mfma_f32_16x16x32_bf16 v[136:139], a[100:103], v[40:43], v[136:139]
  buffer_load_dwordx4 a[148:151], v5, s[4:7], s40 offen offset:1024 sc1
  s_waitcnt vmcnt(32)
  v_mfma_f32_16x16x32_bf16 v[116:119], a[4:7], v[44:47], v[116:119]
  v_mfma_f32_16x16x32_bf16 v[124:127], a[36:39], v[44:47], v[124:127]
  buffer_load_dwordx4 a[152:155], v5, s[4:7], s40 offen offset:2048 sc1
  v_mfma_f32_16x16x32_bf16 v[132:135], a[68:71], v[44:47], v[132:135]
  v_mfma_f32_16x16x32_bf16 v[140:143], a[100:103], v[44:47], v[140:143]
  buffer_load_dwordx4 a[156:159], v5, s[4:7], s40 offen offset:3072 sc1
  s_waitcnt vmcnt(33)
  v_mfma_f32_16x16x32_bf16 v[112:115], a[8:11], v[48:51], v[112:115]
  v_mfma_f32_16x16x32_bf16 v[120:123], a[40:43], v[48:51], v[120:123]
  s_add_u32 s40, s40, 28672
  buffer_load_dwordx4 a[160:163], v5, s[4:7], s40 offen offset:0 sc1
  v_mfma_f32_16x16x32_bf16 v[128:131], a[72:75], v[48:51], v[128:131]
  v_mfma_f32_16x16x32_bf16 v[136:139], a[104:107], v[48:51], v[136:139]
  buffer_load_dwordx4 a[164:167], v5, s[4:7], s40 offen offset:1024 sc1
  s_waitcnt vmcnt(34)
  v_mfma_f32_16x16x32_bf16 v[116:119], a[8:11], v[52:55], v[116:119]
  v_mfma_f32_16x16x32_bf16 v[124:127], a[40:43], v[52:55], v[124:127]
  buffer_load_dwordx4 a[168:171], v5, s[4:7], s40 offen offset:2048 sc1
  v_mfma_f32_16x16x32_bf16 v[132:135], a[72:75], v[52:55], v[132:135]
  v_mfma_f32_16x16x32_bf16 v[140:143], a[104:107], v[52:55], v[140:143]
  buffer_load_dwordx4 a[172:175], v5, s[4:7], s40 offen offset:3072 sc1
  s_waitcnt vmcnt(35)
  v_mfma_f32_16x16x32_bf16 v[112:115], a[12:15], v[56:59], v[112:115]
  v_mfma_f32_16x16x32_bf16 v[120:123], a[44:47], v[56:59], v[120:123]
  s_add_u32 s40, s40, 4096
  buffer_load_dwordx4 a[176:179], v5, s[4:7], s40 offen offset:0 sc1
  v_mfma_f32_16x16x32_bf16 v[128:131], a[76:79], v[56:59], v[128:131]
  v_mfma_f32_16x16x32_bf16 v[136:139], a[108:111], v[56:59], v[136:139]
  buffer_load_dwordx4 a[180:183], v5, s[4:7], s40 offen offset:1024 sc1
  s_waitcnt vmcnt(36)
  v_mfma_f32_16x16x32_bf16 v[116:119], a[12:15], v[60:63], v[116:119]
  v_mfma_f32_16x16x32_bf16 v[124:127], a[44:47], v[60:63], v[124:127]
  buffer_load_dwordx4 a[184:187], v5, s[4:7], s40 offen offset:2048 sc1
  v_mfma_f32_16x16x32_bf16 v[132:135], a[76:79], v[60:63], v[132:135]
  v_mfma_f32_16x16x32_bf16 v[140:143], a[108:111], v[60:63], v[140:143]
  buffer_load_dwordx4 a[188:191], v5, s[4:7], s40 offen offset:3072 sc1
  s_waitcnt vmcnt(37)
  v_mfma_f32_16x16x32_bf16 v[112:115], a[16:19], v[64:67], v[112:115]
  v_mfma_f32_16x16x32_bf16 v[120:123], a[48:51], v[64:67], v[120:123]
  s_add_u32 s40, s40, 28672
  buffer_load_dwordx4 a[192:195], v5, s[4:7], s40 offen offset:0 sc1
  v_mfma_f32_16x16x32_bf16 v[128:131], a[80:83], v[64:67], v[128:131]
  v_mfma_f32_16x16x32_bf16 v[136:139], a[112:115], v[64:67], v[136:139]
  buffer_load_dwordx4 a[196:199], v5, s[4:7], s40 offen offset:1024 sc1
  s_waitcnt vmcnt(38)
  v_mfma_f32_16x16x32_bf16 v[116:119], a[16:19], v[68:71], v[116:119]
  v_mfma_f32_16x16x32_bf16 v[124:127], a[48:51], v[68:71], v[124:127]
  buffer_load_dwordx4 a[200:203], v5, s[4:7], s40 offen offset:2048 sc1
  v_mfma_f32_16x16x32_bf16 v[132:135], a[80:83], v[68:71], v[132:135]
  v_mfma_f32_16x16x32_bf16 v[140:143], a[112:115], v[68:71], v[140:143]
  buffer_load_dwordx4 a[204:207], v5, s[4:7], s40 offen offset:3072 sc1
  s_waitcnt vmcnt(39)
  v_mfma_f32_16x16x32_bf16 v[112:115], a[20:23], v[72:75], v[112:115]
  v_mfma_f32_16x16x32_bf16 v[120:123], a[52:55], v[72:75], v[120:123]
  s_add_u32 s40, s40, 4096
  buffer_load_dwordx4 a[208:211], v5, s[4:7], s40 offen offset:0 sc1
  v_mfma_f32_16x16x32_bf16 v[128:131], a[84:87], v[72:75], v[128:131]
  v_mfma_f32_16x16x32_bf16 v[136:139], a[116:119], v[72:75], v[136:139]
  buffer_load_dwordx4 a[212:215], v5, s[4:7], s40 offen offset:1024 sc1
  s_waitcnt vmcnt(40)
  v_mfma_f32_16x16x32_bf16 v[116:119], a[20:23], v[76:79], v[116:119]
  v_mfma_f32_16x16x32_bf16 v[124:127], a[52:55], v[76:79], v[124:127]
  buffer_load_dwordx4 a[216:219], v5, s[4:7], s40 offen offset:2048 sc1
  v_mfma_f32_16x16x32_bf16 v[132:135], a[84:87], v[76:79], v[132:135]
  v_mfma_f32_16x16x32_bf16 v[140:143], a[116:119], v[76:79], v[140:143]
  buffer_load_dwordx4 a[220:223], v5, s[4:7], s40 offen offset:3072 sc1
  s_waitcnt vmcnt(41)
  v_mfma_f32_16x16x32_bf16 v[112:115], a[24:27], v[80:83], v[112:115]
  v_mfma_f32_16x16x32_bf16 v[120:123], a[56:59], v[80:83], v[120:123]
  s_add_u32 s40, s40, 28672
  buffer_load_dwordx4 a[224:227], v5, s[4:7], s40 offen offset:0 sc1
  v_mfma_f32_16x16x32_bf16 v[128:131], a[88:91], v[80:83], v[128:131]
  v_mfma_f32_16x16x32_bf16 v[136:139], a[120:123], v[80:83], v[136:139]
  buffer_load_dwordx4 a[228:231], v5, s[4:7], s40 offen offset:1024 sc1
  s_waitcnt vmcnt(42)
  v_mfma_f32_16x16x32_bf16 v[116:119], a[24:27], v[84:87], v[116:119]
  v_mfma_f32_16x16x32_bf16 v[124:127], a[56:59], v[84:87], v[124:127]
  buffer_load_dwordx4 a[232:235], v5, s[4:7], s40 offen offset:2048 sc1
  v_mfma_f32_16x16x32_bf16 v[132:135], a[88:91], v[84:87], v[132:135]
  v_mfma_f32_16x16x32_bf16 v[140:143], a[120:123], v[84:87], v[140:143]
  buffer_load_dwordx4 a[236:239], v5, s[4:7], s40 offen offset:3072 sc1
  s_waitcnt vmcnt(43)
  v_mfma_f32_16x16x32_bf16 v[112:115], a[28:31], v[88:91], v[112:115]
  v_mfma_f32_16x16x32_bf16 v[120:123], a[60:63], v[88:91], v[120:123]
  s_add_u32 s40, s40, 4096
  buffer_load_dwordx4 a[240:243], v5, s[4:7], s40 offen offset:0 sc1
  v_mfma_f32_16x16x32_bf16 v[128:131], a[92:95], v[88:91], v[128:131]
  v_mfma_f32_16x16x32_bf16 v[136:139], a[124:127], v[88:91], v[136:139]
  buffer_load_dwordx4 a[244:247], v5, s[4:7], s40 offen offset:1024 sc1
  s_waitcnt vmcnt(44)
  v_mfma_f32_16x16x32_bf16 v[116:119], a[28:31], v[92:95], v[116:119]
  v_mfma_f32_16x16x32_bf16 v[124:127], a[60:63], v[92:95], v[124:127]
  buffer_load_dwordx4 a[248:251], v5, s[4:7], s40 offen offset:2048 sc1
  v_mfma_f32_16x16x32_bf16 v[132:135], a[92:95], v[92:95], v[132:135]
  v_mfma_f32_16x16x32_bf16 v[140:143], a[124:127], v[92:95], v[140:143]
  buffer_load_dwordx4 a[252:255], v5, s[4:7], s40 offen offset:3072 sc1
  s_waitcnt vmcnt(40)
  v_mfma_f32_16x16x32_bf16 v[112:115], v[192:195], v[96:99], v[112:115]
  v_mfma_f32_16x16x32_bf16 v[116:119], v[192:195], v[100:103], v[116:119]
  buffer_load_dwordx2 v[184:185], v11, s[16:19], s41 offen
  v_mfma_f32_16x16x32_bf16 v[112:115], v[196:199], v[104:107], v[112:115]
  v_mfma_f32_16x16x32_bf16 v[116:119], v[196:199], v[108:111], v[116:119]
  buffer_load_dwordx2 v[186:187], v11, s[16:19], s42 offen
  s_waitcnt vmcnt(40)
  v_mfma_f32_16x16x32_bf16 v[120:123], v[200:203], v[96:99], v[120:123]
  v_mfma_f32_16x16x32_bf16 v[124:127], v[200:203], v[100:103], v[124:127]
  v_mfma_f32_16x16x32_bf16 v[120:123], v[204:207], v[104:107], v[120:123]
  v_mfma_f32_16x16x32_bf16 v[124:127], v[204:207], v[108:111], v[124:127]
  s_waitcnt vmcnt(38)
  v_mfma_f32_16x16x32_bf16 v[128:131], v[208:211], v[96:99], v[128:131]
  v_mfma_f32_16x16x32_bf16 v[132:135], v[208:211], v[100:103], v[132:135]
  v_mfma_f32_16x16x32_bf16 v[128:131], v[212:215], v[104:107], v[128:131]
  v_mfma_f32_16x16x32_bf16 v[132:135], v[212:215], v[108:111], v[132:135]
  s_waitcnt vmcnt(34)
  v_mfma_f32_16x16x32_bf16 v[136:139], v[216:219], v[96:99], v[136:139]
  v_mfma_f32_16x16x32_bf16 v[140:143], v[216:219], v[100:103], v[140:143]
  v_mfma_f32_16x16x32_bf16 v[136:139], v[220:223], v[104:107], v[136:139]
  v_mfma_f32_16x16x32_bf16 v[140:143], v[220:223], v[108:111], v[140:143]
  s_branch Lpjn_204
Lpnp_203:
  s_waitcnt vmcnt(29)
  v_mfma_f32_16x16x32_bf16 v[112:115], a[0:3], v[32:35], 0
  v_mfma_f32_16x16x32_bf16 v[120:123], a[32:35], v[32:35], 0
  v_mfma_f32_16x16x32_bf16 v[128:131], a[64:67], v[32:35], 0
  v_mfma_f32_16x16x32_bf16 v[136:139], a[96:99], v[32:35], 0
  s_waitcnt vmcnt(28)
  v_mfma_f32_16x16x32_bf16 v[116:119], a[0:3], v[36:39], 0
  v_mfma_f32_16x16x32_bf16 v[124:127], a[32:35], v[36:39], 0
  v_mfma_f32_16x16x32_bf16 v[132:135], a[64:67], v[36:39], 0
  v_mfma_f32_16x16x32_bf16 v[140:143], a[96:99], v[36:39], 0
  s_waitcnt vmcnt(27)
  v_mfma_f32_16x16x32_bf16 v[112:115], a[4:7], v[40:43], v[112:115]
  v_mfma_f32_16x16x32_bf16 v[120:123], a[36:39], v[40:43], v[120:123]
  v_mfma_f32_16x16x32_bf16 v[128:131], a[68:71], v[40:43], v[128:131]
  v_mfma_f32_16x16x32_bf16 v[136:139], a[100:103], v[40:43], v[136:139]
  s_waitcnt vmcnt(26)
  v_mfma_f32_16x16x32_bf16 v[116:119], a[4:7], v[44:47], v[116:119]
  v_mfma_f32_16x16x32_bf16 v[124:127], a[36:39], v[44:47], v[124:127]
  v_mfma_f32_16x16x32_bf16 v[132:135], a[68:71], v[44:47], v[132:135]
  v_mfma_f32_16x16x32_bf16 v[140:143], a[100:103], v[44:47], v[140:143]
  s_waitcnt vmcnt(25)
  v_mfma_f32_16x16x32_bf16 v[112:115], a[8:11], v[48:51], v[112:115]
  v_mfma_f32_16x16x32_bf16 v[120:123], a[40:43], v[48:51], v[120:123]
  v_mfma_f32_16x16x32_bf16 v[128:131], a[72:75], v[48:51], v[128:131]
  v_mfma_f32_16x16x32_bf16 v[136:139], a[104:107], v[48:51], v[136:139]
  s_waitcnt vmcnt(24)
  v_mfma_f32_16x16x32_bf16 v[116:119], a[8:11], v[52:55], v[116:119]
  v_mfma_f32_16x16x32_bf16 v[124:127], a[40:43], v[52:55], v[124:127]
  v_mfma_f32_16x16x32_bf16 v[132:135], a[72:75], v[52:55], v[132:135]
  v_mfma_f32_16x16x32_bf16 v[140:143], a[104:107], v[52:55], v[140:143]
  s_waitcnt vmcnt(23)
  v_mfma_f32_16x16x32_bf16 v[112:115], a[12:15], v[56:59], v[112:115]
  v_mfma_f32_16x16x32_bf16 v[120:123], a[44:47], v[56:59], v[120:123]
  v_mfma_f32_16x16x32_bf16 v[128:131], a[76:79], v[56:59], v[128:131]
  v_mfma_f32_16x16x32_bf16 v[136:139], a[108:111], v[56:59], v[136:139]
  s_waitcnt vmcnt(22)
  v_mfma_f32_16x16x32_bf16 v[116:119], a[12:15], v[60:63], v[116:119]
  v_mfma_f32_16x16x32_bf16 v[124:127], a[44:47], v[60:63], v[124:127]
  v_mfma_f32_16x16x32_bf16 v[132:135], a[76:79], v[60:63], v[132:135]
  v_mfma_f32_16x16x32_bf16 v[140:143], a[108:111], v[60:63], v[140:143]
  s_waitcnt vmcnt(21)
  v_mfma_f32_16x16x32_bf16 v[112:115], a[16:19], v[64:67], v[112:115]
  v_mfma_f32_16x16x32_bf16 v[120:123], a[48:51], v[64:67], v[120:123]
  v_mfma_f32_16x16x32_bf16 v[128:131], a[80:83], v[64:67], v[128:131]
  v_mfma_f32_16x16x32_bf16 v[136:139], a[112:115], v[64:67], v[136:139]
  s_waitcnt vmcnt(20)
  v_mfma_f32_16x16x32_bf16 v[116:119], a[16:19], v[68:71], v[116:119]
  v_mfma_f32_16x16x32_bf16 v[124:127], a[48:51], v[68:71], v[124:127]
  v_mfma_f32_16x16x32_bf16 v[132:135], a[80:83], v[68:71], v[132:135]
  v_mfma_f32_16x16x32_bf16 v[140:143], a[112:115], v[68:71], v[140:143]
  s_waitcnt vmcnt(19)
  v_mfma_f32_16x16x32_bf16 v[112:115], a[20:23], v[72:75], v[112:115]
  v_mfma_f32_16x16x32_bf16 v[120:123], a[52:55], v[72:75], v[120:123]
  v_mfma_f32_16x16x32_bf16 v[128:131], a[84:87], v[72:75], v[128:131]
  v_mfma_f32_16x16x32_bf16 v[136:139], a[116:119], v[72:75], v[136:139]
  s_waitcnt vmcnt(18)
  v_mfma_f32_16x16x32_bf16 v[116:119], a[20:23], v[76:79], v[116:119]
  v_mfma_f32_16x16x32_bf16 v[124:127], a[52:55], v[76:79], v[124:127]
  v_mfma_f32_16x16x32_bf16 v[132:135], a[84:87], v[76:79], v[132:135]
  v_mfma_f32_16x16x32_bf16 v[140:143], a[116:119], v[76:79], v[140:143]
  s_waitcnt vmcnt(17)
  v_mfma_f32_16x16x32_bf16 v[112:115], a[24:27], v[80:83], v[112:115]
  v_mfma_f32_16x16x32_bf16 v[120:123], a[56:59], v[80:83], v[120:123]
  v_mfma_f32_16x16x32_bf16 v[128:131], a[88:91], v[80:83], v[128:131]
  v_mfma_f32_16x16x32_bf16 v[136:139], a[120:123], v[80:83], v[136:139]
  s_waitcnt vmcnt(16)
  v_mfma_f32_16x16x32_bf16 v[116:119], a[24:27], v[84:87], v[116:119]
  v_mfma_f32_16x16x32_bf16 v[124:127], a[56:59], v[84:87], v[124:127]
  v_mfma_f32_16x16x32_bf16 v[132:135], a[88:91], v[84:87], v[132:135]
  v_mfma_f32_16x16x32_bf16 v[140:143], a[120:123], v[84:87], v[140:143]
  s_waitcnt vmcnt(15)
  v_mfma_f32_16x16x32_bf16 v[112:115], a[28:31], v[88:91], v[112:115]
  v_mfma_f32_16x16x32_bf16 v[120:123], a[60:63], v[88:91], v[120:123]
  v_mfma_f32_16x16x32_bf16 v[128:131], a[92:95], v[88:91], v[128:131]
  v_mfma_f32_16x16x32_bf16 v[136:139], a[124:127], v[88:91], v[136:139]
  s_waitcnt vmcnt(14)
  v_mfma_f32_16x16x32_bf16 v[116:119], a[28:31], v[92:95], v[116:119]
  v_mfma_f32_16x16x32_bf16 v[124:127], a[60:63], v[92:95], v[124:127]
  v_mfma_f32_16x16x32_bf16 v[132:135], a[92:95], v[92:95], v[132:135]
  v_mfma_f32_16x16x32_bf16 v[140:143], a[124:127], v[92:95], v[140:143]
  s_waitcnt vmcnt(8)
  v_mfma_f32_16x16x32_bf16 v[112:115], v[192:195], v[96:99], v[112:115]
  v_mfma_f32_16x16x32_bf16 v[116:119], v[192:195], v[100:103], v[116:119]
  v_mfma_f32_16x16x32_bf16 v[112:115], v[196:199], v[104:107], v[112:115]
  v_mfma_f32_16x16x32_bf16 v[116:119], v[196:199], v[108:111], v[116:119]
  s_waitcnt vmcnt(6)
  v_mfma_f32_16x16x32_bf16 v[120:123], v[200:203], v[96:99], v[120:123]
  v_mfma_f32_16x16x32_bf16 v[124:127], v[200:203], v[100:103], v[124:127]
  v_mfma_f32_16x16x32_bf16 v[120:123], v[204:207], v[104:107], v[120:123]
  v_mfma_f32_16x16x32_bf16 v[124:127], v[204:207], v[108:111], v[124:127]
  s_waitcnt vmcnt(4)
  v_mfma_f32_16x16x32_bf16 v[128:131], v[208:211], v[96:99], v[128:131]
  v_mfma_f32_16x16x32_bf16 v[132:135], v[208:211], v[100:103], v[132:135]
  v_mfma_f32_16x16x32_bf16 v[128:131], v[212:215], v[104:107], v[128:131]
  v_mfma_f32_16x16x32_bf16 v[132:135], v[212:215], v[108:111], v[132:135]
  s_waitcnt vmcnt(0)
  v_mfma_f32_16x16x32_bf16 v[136:139], v[216:219], v[96:99], v[136:139]
  v_mfma_f32_16x16x32_bf16 v[140:143], v[216:219], v[100:103], v[140:143]
  v_mfma_f32_16x16x32_bf16 v[136:139], v[220:223], v[104:107], v[136:139]
  v_mfma_f32_16x16x32_bf16 v[140:143], v[220:223], v[108:111], v[140:143]
Lpjn_204:
  s_add_u32 s38, s22, 3
  v_add_u32 v2, s47, v9
  v_add_u32 v3, s47, v10
  s_xor_b32 s47, s47, 0x8000
  v_cmp_gt_u32 vcc, s38, v15
  s_nop 0
  s_cmp_eq_u64 vcc, 0
  s_cselect_b32 s25, 1, 0
  s_nop 0
  ds_write_b128 v2, v[112:115] offset:0
  ds_write_b128 v2, v[116:119] offset:1024
  ds_write_b128 v2, v[120:123] offset:2048
  ds_write_b128 v2, v[124:127] offset:3072
  ds_write_b128 v2, v[128:131] offset:4096
  ds_write_b128 v2, v[132:135] offset:5120
  ds_write_b128 v2, v[136:139] offset:6144
  ds_write_b128 v2, v[140:143] offset:7168
  s_waitcnt lgkmcnt(0)
  s_barrier
  ds_read_b128 v[144:147], v3 offset:0
  ds_read_b128 v[148:151], v3 offset:1024
  ds_read_b128 v[152:155], v3 offset:8192
  ds_read_b128 v[156:159], v3 offset:9216
  ds_read_b128 v[160:163], v3 offset:16384
  ds_read_b128 v[164:167], v3 offset:17408
  ds_read_b128 v[168:171], v3 offset:24576
  ds_read_b128 v[172:175], v3 offset:25600
  s_mul_i32 s27, s22, 81920
  s_add_u32 s27, s27, 0xbe00000
  s_add_u32 s28, s27, 40960
  s_waitcnt lgkmcnt(0)
  v_add_f32 v144, v144, v152
  v_add_f32 v160, v160, v168
  v_add_f32 v144, v144, v160
  v_lshlrev_b32 v2, 16, v180
  v_fma_f32 v144, v144, v176, v2
  v_add_f32 v145, v145, v153
  v_add_f32 v161, v161, v169
  v_add_f32 v145, v145, v161
  v_and_b32 v2, 0xffff0000, v180
  v_fma_f32 v145, v145, v177, v2
  v_add_f32 v146, v146, v154
  v_add_f32 v162, v162, v170
  v_add_f32 v146, v146, v162
  v_lshlrev_b32 v2, 16, v181
  v_fma_f32 v146, v146, v178, v2
  v_add_f32 v147, v147, v155
  v_add_f32 v163, v163, v171
  v_add_f32 v147, v147, v163
  v_and_b32 v2, 0xffff0000, v181
  v_fma_f32 v147, v147, v179, v2
  buffer_store_dwordx4 v[144:147], v14, s[4:7], s27 offen sc1
  v_add_f32 v148, v148, v156
  v_add_f32 v164, v164, v172
  v_add_f32 v148, v148, v164
  v_lshlrev_b32 v2, 16, v182
  v_fma_f32 v148, v148, v176, v2
  v_add_f32 v149, v149, v157
  v_add_f32 v165, v165, v173
  v_add_f32 v149, v149, v165
  v_and_b32 v2, 0xffff0000, v182
  v_fma_f32 v149, v149, v177, v2
  v_add_f32 v150, v150, v158
  v_add_f32 v166, v166, v174
  v_add_f32 v150, v150, v166
  v_lshlrev_b32 v2, 16, v183
  v_fma_f32 v150, v150, v178, v2
  v_add_f32 v151, v151, v159
  v_add_f32 v167, v167, v175
  v_add_f32 v151, v151, v167
  v_and_b32 v2, 0xffff0000, v183
  v_fma_f32 v151, v151, v179, v2
  buffer_store_dwordx4 v[148:151], v14, s[4:7], s28 offen sc1
  s_cmp_eq_u32 s25, 0
  s_cbranch_scc1 Lpnq_205
  s_add_u32 s43, s22, 2
  s_mul_i32 s26, s43, 81920
  s_add_u32 s27, s26, s35
  s_add_u32 s28, s26, s36
  s_mul_i32 s39, s43, 327680
  s_add_u32 s39, s39, s34
  buffer_load_dwordx4 v[32:35], v5, s[4:7], s27 offen offset:0 sc1
  buffer_load_dwordx4 v[36:39], v5, s[4:7], s27 offen offset:1024 sc1
  buffer_load_dwordx4 v[40:43], v5, s[4:7], s27 offen offset:2048 sc1
  buffer_load_dwordx4 v[44:47], v5, s[4:7], s27 offen offset:3072 sc1
  s_add_u32 s27, s27, 4096
  buffer_load_dwordx4 v[48:51], v5, s[4:7], s27 offen offset:0 sc1
  buffer_load_dwordx4 v[52:55], v5, s[4:7], s27 offen offset:1024 sc1
  buffer_load_dwordx4 v[56:59], v5, s[4:7], s27 offen offset:2048 sc1
  buffer_load_dwordx4 v[60:63], v5, s[4:7], s27 offen offset:3072 sc1
  s_add_u32 s27, s27, 4096
  buffer_load_dwordx4 v[64:67], v5, s[4:7], s27 offen offset:0 sc1
  buffer_load_dwordx4 v[68:71], v5, s[4:7], s27 offen offset:1024 sc1
  buffer_load_dwordx4 v[72:75], v5, s[4:7], s27 offen offset:2048 sc1
  buffer_load_dwordx4 v[76:79], v5, s[4:7], s27 offen offset:3072 sc1
  s_add_u32 s27, s27, 4096
  buffer_load_dwordx4 v[80:83], v5, s[4:7], s27 offen offset:0 sc1
  buffer_load_dwordx4 v[84:87], v5, s[4:7], s27 offen offset:1024 sc1
  buffer_load_dwordx4 v[88:91], v5, s[4:7], s27 offen offset:2048 sc1
  buffer_load_dwordx4 v[92:95], v5, s[4:7], s27 offen offset:3072 sc1
  buffer_load_dwordx4 v[96:99], v5, s[4:7], s28 offen offset:0 sc1
  buffer_load_dwordx4 v[100:103], v5, s[4:7], s28 offen offset:1024 sc1
  buffer_load_dwordx4 v[104:107], v5, s[4:7], s28 offen offset:2048 sc1
  buffer_load_dwordx4 v[108:111], v5, s[4:7], s28 offen offset:3072 sc1
  buffer_load_dwordx4 v[192:195], v5, s[4:7], s39 offen offset:0 sc1
  buffer_load_dwordx4 v[196:199], v5, s[4:7], s39 offen offset:1024 sc1
  s_add_u32 s39, s39, 8192
  buffer_load_dwordx4 v[200:203], v5, s[4:7], s39 offen offset:0 sc1
  buffer_load_dwordx4 v[204:207], v5, s[4:7], s39 offen offset:1024 sc1
  s_add_u32 s39, s39, 8192
  buffer_load_dwordx4 v[208:211], v5, s[4:7], s39 offen offset:0 sc1
  buffer_load_dwordx4 v[212:215], v5, s[4:7], s39 offen offset:1024 sc1
  s_add_u32 s39, s39, 8192
  buffer_load_dwordx4 v[216:219], v5, s[4:7], s39 offen offset:0 sc1
  buffer_load_dwordx4 v[220:223], v5, s[4:7], s39 offen offset:1024 sc1
  s_waitcnt vmcnt(28)
  s_branch Lpsg_206
Lpnq_205:
  s_waitcnt vmcnt(0)
Lpsg_206:
  s_add_u32 s26, s22, 1
  v_mov_b32 v2, s26
  s_mov_b64 exec, 1
  buffer_store_dword v2, v0, s[4:7], s33 offen sc1
  s_mov_b64 exec, -1
  s_cmp_ge_u32 s22, 62
  s_cbranch_scc1 Lplast_195
  s_add_u32 s22, s22, 2
  s_add_u32 s39, s22, 3
  s_min_u32 s39, s39, 64
  s_cmp_ge_u32 s46, s39
  s_cbranch_scc1 Lwok_207
Lwf_208:
  s_add_u32 s24, s24, 1
  s_cmp_gt_u32 s24, 300000
  s_cbranch_scc1 Lfail_189
  buffer_load_dword v8, v6, s[4:7], s29 offen sc1
  s_waitcnt vmcnt(0)
  v_cmp_gt_u32 vcc, s39, v8
  s_cbranch_vccz Lrok_209
  s_sleep 2
  s_branch Lwf_208
Lrok_209:
  s_add_u32 s26, s39, 6
  s_min_u32 s26, s26, 64
  s_nop 0
  v_cmp_gt_u32 vcc, s26, v8
  s_cmp_eq_u64 vcc, 0
  s_cselect_b32 s46, s26, s39
Lwok_207:
  s_add_u32 s26, s22, 2
  s_mul_i32 s40, s26, 1310720
  s_add_u32 s40, s40, s31
  s_mul_i32 s41, s26, 40960
  s_add_u32 s42, s41, 20480
  s_cmp_eq_u32 s25, 1
  s_cbranch_scc1 Lppre_210
  s_add_u32 s38, s22, 1
Lwf_212:
  s_add_u32 s24, s24, 1
  s_cmp_gt_u32 s24, 300000
  s_cbranch_scc1 Lfail_190
  buffer_load_dword v8, v7, s[4:7], s30 offen sc1
  s_waitcnt vmcnt(0)
  v_cmp_gt_u32 vcc, s38, v8
  s_cbranch_vccz Lrok_213
  s_sleep 2
  s_branch Lwf_212
Lrok_213:
Lwok_211:
  s_add_u32 s43, s22, 0
  s_mul_i32 s26, s43, 81920
  s_add_u32 s27, s26, s35
  s_add_u32 s28, s26, s36
  s_mul_i32 s39, s43, 327680
  s_add_u32 s39, s39, s34
  buffer_load_dwordx4 v[32:35], v5, s[4:7], s27 offen offset:0 sc1
  buffer_load_dwordx4 v[36:39], v5, s[4:7], s27 offen offset:1024 sc1
  buffer_load_dwordx4 v[40:43], v5, s[4:7], s27 offen offset:2048 sc1
  buffer_load_dwordx4 v[44:47], v5, s[4:7], s27 offen offset:3072 sc1
  s_add_u32 s27, s27, 4096
  buffer_load_dwordx4 v[48:51], v5, s[4:7], s27 offen offset:0 sc1
  buffer_load_dwordx4 v[52:55], v5, s[4:7], s27 offen offset:1024 sc1
  buffer_load_dwordx4 v[56:59], v5, s[4:7], s27 offen offset:2048 sc1
  buffer_load_dwordx4 v[60:63], v5, s[4:7], s27 offen offset:3072 sc1
  s_add_u32 s27, s27, 4096
  buffer_load_dwordx4 v[64:67], v5, s[4:7], s27 offen offset:0 sc1
  buffer_load_dwordx4 v[68:71], v5, s[4:7], s27 offen offset:1024 sc1
  buffer_load_dwordx4 v[72:75], v5, s[4:7], s27 offen offset:2048 sc1
  buffer_load_dwordx4 v[76:79], v5, s[4:7], s27 offen offset:3072 sc1
  s_add_u32 s27, s27, 4096
  buffer_load_dwordx4 v[80:83], v5, s[4:7], s27 offen offset:0 sc1
  buffer_load_dwordx4 v[84:87], v5, s[4:7], s27 offen offset:1024 sc1
  buffer_load_dwordx4 v[88:91], v5, s[4:7], s27 offen offset:2048 sc1
  buffer_load_dwordx4 v[92:95], v5, s[4:7], s27 offen offset:3072 sc1
  buffer_load_dwordx4 v[96:99], v5, s[4:7], s28 offen offset:0 sc1
  buffer_load_dwordx4 v[100:103], v5, s[4:7], s28 offen offset:1024 sc1
  buffer_load_dwordx4 v[104:107], v5, s[4:7], s28 offen offset:2048 sc1
  buffer_load_dwordx4 v[108:111], v5, s[4:7], s28 offen offset:3072 sc1
  buffer_load_dwordx4 v[192:195], v5, s[4:7], s39 offen offset:0 sc1
  buffer_load_dwordx4 v[196:199], v5, s[4:7], s39 offen offset:1024 sc1
  s_add_u32 s39, s39, 8192
  buffer_load_dwordx4 v[200:203], v5, s[4:7], s39 offen offset:0 sc1
  buffer_load_dwordx4 v[204:207], v5, s[4:7], s39 offen offset:1024 sc1
  s_add_u32 s39, s39, 8192
  buffer_load_dwordx4 v[208:211], v5, s[4:7], s39 offen offset:0 sc1
  buffer_load_dwordx4 v[212:215], v5, s[4:7], s39 offen offset:1024 sc1
  s_add_u32 s39, s39, 8192
  buffer_load_dwordx4 v[216:219], v5, s[4:7], s39 offen offset:0 sc1
  buffer_load_dwordx4 v[220:223], v5, s[4:7], s39 offen offset:1024 sc1
  buffer_load_dword v2, v0, s[4:7], s30 offen sc1
Lppre_210:
  buffer_load_dword v15, v7, s[4:7], s30 offen sc1
  s_cmp_ge_u32 s22, 62
  s_cbranch_scc1 Lpnp_214
  s_waitcnt vmcnt(29)
  v_mfma_f32_16x16x32_bf16 v[112:115], a[128:131], v[32:35], 0
  v_mfma_f32_16x16x32_bf16 v[120:123], a[160:163], v[32:35], 0
  buffer_load_dwordx4 a[0:3], v5, s[4:7], s40 offen offset:0 sc1
  v_mfma_f32_16x16x32_bf16 v[128:131], a[192:195], v[32:35], 0
  v_mfma_f32_16x16x32_bf16 v[136:139], a[224:227], v[32:35], 0
  buffer_load_dwordx4 a[4:7], v5, s[4:7], s40 offen offset:1024 sc1
  s_waitcnt vmcnt(30)
  v_mfma_f32_16x16x32_bf16 v[116:119], a[128:131], v[36:39], 0
  v_mfma_f32_16x16x32_bf16 v[124:127], a[160:163], v[36:39], 0
  buffer_load_dwordx4 a[8:11], v5, s[4:7], s40 offen offset:2048 sc1
  v_mfma_f32_16x16x32_bf16 v[132:135], a[192:195], v[36:39], 0
  v_mfma_f32_16x16x32_bf16 v[140:143], a[224:227], v[36:39], 0
  buffer_load_dwordx4 a[12:15], v5, s[4:7], s40 offen offset:3072 sc1
  s_waitcnt vmcnt(31)
  v_mfma_f32_16x16x32_bf16 v[112:115], a[132:135], v[40:43], v[112:115]
  v_mfma_f32_16x16x32_bf16 v[120:123], a[164:167], v[40:43], v[120:123]
  s_add_u32 s40, s40, 4096
  buffer_load_dwordx4 a[16:19], v5, s[4:7], s40 offen offset:0 sc1
  v_mfma_f32_16x16x32_bf16 v[128:131], a[196:199], v[40:43], v[128:131]
  v_mfma_f32_16x16x32_bf16 v[136:139], a[228:231], v[40:43], v[136:139]
  buffer_load_dwordx4 a[20:23], v5, s[4:7], s40 offen offset:1024 sc1
  s_waitcnt vmcnt(32)
  v_mfma_f32_16x16x32_bf16 v[116:119], a[132:135], v[44:47], v[116:119]
  v_mfma_f32_16x16x32_bf16 v[124:127], a[164:167], v[44:47], v[124:127]
  buffer_load_dwordx4 a[24:27], v5, s[4:7], s40 offen offset:2048 sc1
  v_mfma_f32_16x16x32_bf16 v[132:135], a[196:199], v[44:47], v[132:135]
  v_mfma_f32_16x16x32_bf16 v[140:143], a[228:231], v[44:47], v[140:143]
  buffer_load_dwordx4 a[28:31], v5, s[4:7], s40 offen offset:3072 sc1
  s_waitcnt vmcnt(33)
  v_mfma_f32_16x16x32_bf16 v[112:115], a[136:139], v[48:51], v[112:115]
  v_mfma_f32_16x16x32_bf16 v[120:123], a[168:171], v[48:51], v[120:123]
  s_add_u32 s40, s40, 28672
  buffer_load_dwordx4 a[32:35], v5, s[4:7], s40 offen offset:0 sc1
  v_mfma_f32_16x16x32_bf16 v[128:131], a[200:203], v[48:51], v[128:131]
  v_mfma_f32_16x16x32_bf16 v[136:139], a[232:235], v[48:51], v[136:139]
  buffer_load_dwordx4 a[36:39], v5, s[4:7], s40 offen offset:1024 sc1
  s_waitcnt vmcnt(34)
  v_mfma_f32_16x16x32_bf16 v[116:119], a[136:139], v[52:55], v[116:119]
  v_mfma_f32_16x16x32_bf16 v[124:127], a[168:171], v[52:55], v[124:127]
  buffer_load_dwordx4 a[40:43], v5, s[4:7], s40 offen offset:2048 sc1
  v_mfma_f32_16x16x32_bf16 v[132:135], a[200:203], v[52:55], v[132:135]
  v_mfma_f32_16x16x32_bf16 v[140:143], a[232:235], v[52:55], v[140:143]
  buffer_load_dwordx4 a[44:47], v5, s[4:7], s40 offen offset:3072 sc1
  s_waitcnt vmcnt(35)
  v_mfma_f32_16x16x32_bf16 v[112:115], a[140:143], v[56:59], v[112:115]
  v_mfma_f32_16x16x32_bf16 v[120:123], a[172:175], v[56:59], v[120:123]
  s_add_u32 s40, s40, 4096
  buffer_load_dwordx4 a[48:51], v5, s[4:7], s40 offen offset:0 sc1
  v_mfma_f32_16x16x32_bf16 v[128:131], a[204:207], v[56:59], v[128:131]
  v_mfma_f32_16x16x32_bf16 v[136:139], a[236:239], v[56:59], v[136:139]
  buffer_load_dwordx4 a[52:55], v5, s[4:7], s40 offen offset:1024 sc1
  s_waitcnt vmcnt(36)
  v_mfma_f32_16x16x32_bf16 v[116:119], a[140:143], v[60:63], v[116:119]
  v_mfma_f32_16x16x32_bf16 v[124:127], a[172:175], v[60:63], v[124:127]
  buffer_load_dwordx4 a[56:59], v5, s[4:7], s40 offen offset:2048 sc1
  v_mfma_f32_16x16x32_bf16 v[132:135], a[204:207], v[60:63], v[132:135]
  v_mfma_f32_16x16x32_bf16 v[140:143], a[236:239], v[60:63], v[140:143]
  buffer_load_dwordx4 a[60:63], v5, s[4:7], s40 offen offset:3072 sc1
  s_waitcnt vmcnt(37)
  v_mfma_f32_16x16x32_bf16 v[112:115], a[144:147], v[64:67], v[112:115]
  v_mfma_f32_16x16x32_bf16 v[120:123], a[176:179], v[64:67], v[120:123]
  s_add_u32 s40, s40, 28672
  buffer_load_dwordx4 a[64:67], v5, s[4:7], s40 offen offset:0 sc1
  v_mfma_f32_16x16x32_bf16 v[128:131], a[208:211], v[64:67], v[128:131]
  v_mfma_f32_16x16x32_bf16 v[136:139], a[240:243], v[64:67], v[136:139]
  buffer_load_dwordx4 a[68:71], v5, s[4:7], s40 offen offset:1024 sc1
  s_waitcnt vmcnt(38)
  v_mfma_f32_16x16x32_bf16 v[116:119], a[144:147], v[68:71], v[116:119]
  v_mfma_f32_16x16x32_bf16 v[124:127], a[176:179], v[68:71], v[124:127]
  buffer_load_dwordx4 a[72:75], v5, s[4:7], s40 offen offset:2048 sc1
  v_mfma_f32_16x16x32_bf16 v[132:135], a[208:211], v[68:71], v[132:135]
  v_mfma_f32_16x16x32_bf16 v[140:143], a[240:243], v[68:71], v[140:143]
  buffer_load_dwordx4 a[76:79], v5, s[4:7], s40 offen offset:3072 sc1
  s_waitcnt vmcnt(39)
  v_mfma_f32_16x16x32_bf16 v[112:115], a[148:151], v[72:75], v[112:115]
  v_mfma_f32_16x16x32_bf16 v[120:123], a[180:183], v[72:75], v[120:123]
  s_add_u32 s40, s40, 4096
  buffer_load_dwordx4 a[80:83], v5, s[4:7], s40 offen offset:0 sc1
  v_mfma_f32_16x16x32_bf16 v[128:131], a[212:215], v[72:75], v[128:131]
  v_mfma_f32_16x16x32_bf16 v[136:139], a[244:247], v[72:75], v[136:139]
  buffer_load_dwordx4 a[84:87], v5, s[4:7], s40 offen offset:1024 sc1
  s_waitcnt vmcnt(40)
  v_mfma_f32_16x16x32_bf16 v[116:119], a[148:151], v[76:79], v[116:119]
  v_mfma_f32_16x16x32_bf16 v[124:127], a[180:183], v[76:79], v[124:127]
  buffer_load_dwordx4 a[88:91], v5, s[4:7], s40 offen offset:2048 sc1
  v_mfma_f32_16x16x32_bf16 v[132:135], a[212:215], v[76:79], v[132:135]
  v_mfma_f32_16x16x32_bf16 v[140:143], a[244:247], v[76:79], v[140:143]
  buffer_load_dwordx4 a[92:95], v5, s[4:7], s40 offen offset:3072 sc1
  s_waitcnt vmcnt(41)
  v_mfma_f32_16x16x32_bf16 v[112:115], a[152:155], v[80:83], v[112:115]
  v_mfma_f32_16x16x32_bf16 v[120:123], a[184:187], v[80:83], v[120:123]
  s_add_u32 s40, s40, 28672
  buffer_load_dwordx4 a[96:99], v5, s[4:7], s40 offen offset:0 sc1
  v_mfma_f32_16x16x32_bf16 v[128:131], a[216:219], v[80:83], v[128:131]
  v_mfma_f32_16x16x32_bf16 v[136:139], a[248:251], v[80:83], v[136:139]
  buffer_load_dwordx4 a[100:103], v5, s[4:7], s40 offen offset:1024 sc1
  s_waitcnt vmcnt(42)
  v_mfma_f32_16x16x32_bf16 v[116:119], a[152:155], v[84:87], v[116:119]
  v_mfma_f32_16x16x32_bf16 v[124:127], a[184:187], v[84:87], v[124:127]
  buffer_load_dwordx4 a[104:107], v5, s[4:7], s40 offen offset:2048 sc1
  v_mfma_f32_16x16x32_bf16 v[132:135], a[216:219], v[84:87], v[132:135]
  v_mfma_f32_16x16x32_bf16 v[140:143], a[248:251], v[84:87], v[140:143]
  buffer_load_dwordx4 a[108:111], v5, s[4:7], s40 offen offset:3072 sc1
  s_waitcnt vmcnt(43)
  v_mfma_f32_16x16x32_bf16 v[112:115], a[156:159], v[88:91], v[112:115]
  v_mfma_f32_16x16x32_bf16 v[120:123], a[188:191], v[88:91], v[120:123]
  s_add_u32 s40, s40, 4096
  buffer_load_dwordx4 a[112:115], v5, s[4:7], s40 offen offset:0 sc1
  v_mfma_f32_16x16x32_bf16 v[128:131], a[220:223], v[88:91], v[128:131]
  v_mfma_f32_16x16x32_bf16 v[136:139], a[252:255], v[88:91], v[136:139]
  buffer_load_dwordx4 a[116:119], v5, s[4:7], s40 offen offset:1024 sc1
  s_waitcnt vmcnt(44)
  v_mfma_f32_16x16x32_bf16 v[116:119], a[156:159], v[92:95], v[116:119]
  v_mfma_f32_16x16x32_bf16 v[124:127], a[188:191], v[92:95], v[124:127]
  buffer_load_dwordx4 a[120:123], v5, s[4:7], s40 offen offset:2048 sc1
  v_mfma_f32_16x16x32_bf16 v[132:135], a[220:223], v[92:95], v[132:135]
  v_mfma_f32_16x16x32_bf16 v[140:143], a[252:255], v[92:95], v[140:143]
  buffer_load_dwordx4 a[124:127], v5, s[4:7], s40 offen offset:3072 sc1
  s_waitcnt vmcnt(40)
  v_mfma_f32_16x16x32_bf16 v[112:115], v[192:195], v[96:99], v[112:115]
  v_mfma_f32_16x16x32_bf16 v[116:119], v[192:195], v[100:103], v[116:119]
  buffer_load_dwordx2 v[180:181], v11, s[16:19], s41 offen
  v_mfma_f32_16x16x32_bf16 v[112:115], v[196:199], v[104:107], v[112:115]
  v_mfma_f32_16x16x32_bf16 v[116:119], v[196:199], v[108:111], v[116:119]
  buffer_load_dwordx2 v[182:183], v11, s[16:19], s42 offen
  s_waitcnt vmcnt(40)
  v_mfma_f32_16x16x32_bf16 v[120:123], v[200:203], v[96:99], v[120:123]
  v_mfma_f32_16x16x32_bf16 v[124:127], v[200:203], v[100:103], v[124:127]
  v_mfma_f32_16x16x32_bf16 v[120:123], v[204:207], v[104:107], v[120:123]
  v_mfma_f32_16x16x32_bf16 v[124:127], v[204:207], v[108:111], v[124:127]
  s_waitcnt vmcnt(38)
  v_mfma_f32_16x16x32_bf16 v[128:131], v[208:211], v[96:99], v[128:131]
  v_mfma_f32_16x16x32_bf16 v[132:135], v[208:211], v[100:103], v[132:135]
  v_mfma_f32_16x16x32_bf16 v[128:131], v[212:215], v[104:107], v[128:131]
  v_mfma_f32_16x16x32_bf16 v[132:135], v[212:215], v[108:111], v[132:135]
  s_waitcnt vmcnt(34)
  v_mfma_f32_16x16x32_bf16 v[136:139], v[216:219], v[96:99], v[136:139]
  v_mfma_f32_16x16x32_bf16 v[140:143], v[216:219], v[100:103], v[140:143]
  v_mfma_f32_16x16x32_bf16 v[136:139], v[220:223], v[104:107], v[136:139]
  v_mfma_f32_16x16x32_bf16 v[140:143], v[220:223], v[108:111], v[140:143]
  s_branch Lpjn_215
Lpnp_214:
  s_waitcnt vmcnt(29)
  v_mfma_f32_16x16x32_bf16 v[112:115], a[128:131], v[32:35], 0
  v_mfma_f32_16x16x32_bf16 v[120:123], a[160:163], v[32:35], 0
  v_mfma_f32_16x16x32_bf16 v[128:131], a[192:195], v[32:35], 0
  v_mfma_f32_16x16x32_bf16 v[136:139], a[224:227], v[32:35], 0
  s_waitcnt vmcnt(28)
  v_mfma_f32_16x16x32_bf16 v[116:119], a[128:131], v[36:39], 0
  v_mfma_f32_16x16x32_bf16 v[124:127], a[160:163], v[36:39], 0
  v_mfma_f32_16x16x32_bf16 v[132:135], a[192:195], v[36:39], 0
  v_mfma_f32_16x16x32_bf16 v[140:143], a[224:227], v[36:39], 0
  s_waitcnt vmcnt(27)
  v_mfma_f32_16x16x32_bf16 v[112:115], a[132:135], v[40:43], v[112:115]
  v_mfma_f32_16x16x32_bf16 v[120:123], a[164:167], v[40:43], v[120:123]
  v_mfma_f32_16x16x32_bf16 v[128:131], a[196:199], v[40:43], v[128:131]
  v_mfma_f32_16x16x32_bf16 v[136:139], a[228:231], v[40:43], v[136:139]
  s_waitcnt vmcnt(26)
  v_mfma_f32_16x16x32_bf16 v[116:119], a[132:135], v[44:47], v[116:119]
  v_mfma_f32_16x16x32_bf16 v[124:127], a[164:167], v[44:47], v[124:127]
  v_mfma_f32_16x16x32_bf16 v[132:135], a[196:199], v[44:47], v[132:135]
  v_mfma_f32_16x16x32_bf16 v[140:143], a[228:231], v[44:47], v[140:143]
  s_waitcnt vmcnt(25)
  v_mfma_f32_16x16x32_bf16 v[112:115], a[136:139], v[48:51], v[112:115]
  v_mfma_f32_16x16x32_bf16 v[120:123], a[168:171], v[48:51], v[120:123]
  v_mfma_f32_16x16x32_bf16 v[128:131], a[200:203], v[48:51], v[128:131]
  v_mfma_f32_16x16x32_bf16 v[136:139], a[232:235], v[48:51], v[136:139]
  s_waitcnt vmcnt(24)
  v_mfma_f32_16x16x32_bf16 v[116:119], a[136:139], v[52:55], v[116:119]
  v_mfma_f32_16x16x32_bf16 v[124:127], a[168:171], v[52:55], v[124:127]
  v_mfma_f32_16x16x32_bf16 v[132:135], a[200:203], v[52:55], v[132:135]
  v_mfma_f32_16x16x32_bf16 v[140:143], a[232:235], v[52:55], v[140:143]
  s_waitcnt vmcnt(23)
  v_mfma_f32_16x16x32_bf16 v[112:115], a[140:143], v[56:59], v[112:115]
  v_mfma_f32_16x16x32_bf16 v[120:123], a[172:175], v[56:59], v[120:123]
  v_mfma_f32_16x16x32_bf16 v[128:131], a[204:207], v[56:59], v[128:131]
  v_mfma_f32_16x16x32_bf16 v[136:139], a[236:239], v[56:59], v[136:139]
  s_waitcnt vmcnt(22)
  v_mfma_f32_16x16x32_bf16 v[116:119], a[140:143], v[60:63], v[116:119]
  v_mfma_f32_16x16x32_bf16 v[124:127], a[172:175], v[60:63], v[124:127]
  v_mfma_f32_16x16x32_bf16 v[132:135], a[204:207], v[60:63], v[132:135]
  v_mfma_f32_16x16x32_bf16 v[140:143], a[236:239], v[60:63], v[140:143]
  s_waitcnt vmcnt(21)
  v_mfma_f32_16x16x32_bf16 v[112:115], a[144:147], v[64:67], v[112:115]
  v_mfma_f32_16x16x32_bf16 v[120:123], a[176:179], v[64:67], v[120:123]
  v_mfma_f32_16x16x32_bf16 v[128:131], a[208:211], v[64:67], v[128:131]
  v_mfma_f32_16x16x32_bf16 v[136:139], a[240:243], v[64:67], v[136:139]
  s_waitcnt vmcnt(20)
  v_mfma_f32_16x16x32_bf16 v[116:119], a[144:147], v[68:71], v[116:119]
  v_mfma_f32_16x16x32_bf16 v[124:127], a[176:179], v[68:71], v[124:127]
  v_mfma_f32_16x16x32_bf16 v[132:135], a[208:211], v[68:71], v[132:135]
  v_mfma_f32_16x16x32_bf16 v[140:143], a[240:243], v[68:71], v[140:143]
  s_waitcnt vmcnt(19)
  v_mfma_f32_16x16x32_bf16 v[112:115], a[148:151], v[72:75], v[112:115]
  v_mfma_f32_16x16x32_bf16 v[120:123], a[180:183], v[72:75], v[120:123]
  v_mfma_f32_16x16x32_bf16 v[128:131], a[212:215], v[72:75], v[128:131]
  v_mfma_f32_16x16x32_bf16 v[136:139], a[244:247], v[72:75], v[136:139]
  s_waitcnt vmcnt(18)
  v_mfma_f32_16x16x32_bf16 v[116:119], a[148:151], v[76:79], v[116:119]
  v_mfma_f32_16x16x32_bf16 v[124:127], a[180:183], v[76:79], v[124:127]
  v_mfma_f32_16x16x32_bf16 v[132:135], a[212:215], v[76:79], v[132:135]
  v_mfma_f32_16x16x32_bf16 v[140:143], a[244:247], v[76:79], v[140:143]
  s_waitcnt vmcnt(17)
  v_mfma_f32_16x16x32_bf16 v[112:115], a[152:155], v[80:83], v[112:115]
  v_mfma_f32_16x16x32_bf16 v[120:123], a[184:187], v[80:83], v[120:123]
  v_mfma_f32_16x16x32_bf16 v[128:131], a[216:219], v[80:83], v[128:131]
  v_mfma_f32_16x16x32_bf16 v[136:139], a[248:251], v[80:83], v[136:139]
  s_waitcnt vmcnt(16)
  v_mfma_f32_16x16x32_bf16 v[116:119], a[152:155], v[84:87], v[116:119]
  v_mfma_f32_16x16x32_bf16 v[124:127], a[184:187], v[84:87], v[124:127]
  v_mfma_f32_16x16x32_bf16 v[132:135], a[216:219], v[84:87], v[132:135]
  v_mfma_f32_16x16x32_bf16 v[140:143], a[248:251], v[84:87], v[140:143]
  s_waitcnt vmcnt(15)
  v_mfma_f32_16x16x32_bf16 v[112:115], a[156:159], v[88:91], v[112:115]
  v_mfma_f32_16x16x32_bf16 v[120:123], a[188:191], v[88:91], v[120:123]
  v_mfma_f32_16x16x32_bf16 v[128:131], a[220:223], v[88:91], v[128:131]
  v_mfma_f32_16x16x32_bf16 v[136:139], a[252:255], v[88:91], v[136:139]
  s_waitcnt vmcnt(14)
  v_mfma_f32_16x16x32_bf16 v[116:119], a[156:159], v[92:95], v[116:119]
  v_mfma_f32_16x16x32_bf16 v[124:127], a[188:191], v[92:95], v[124:127]
  v_mfma_f32_16x16x32_bf16 v[132:135], a[220:223], v[92:95], v[132:135]
  v_mfma_f32_16x16x32_bf16 v[140:143], a[252:255], v[92:95], v[140:143]
  s_waitcnt vmcnt(8)
  v_mfma_f32_16x16x32_bf16 v[112:115], v[192:195], v[96:99], v[112:115]
  v_mfma_f32_16x16x32_bf16 v[116:119], v[192:195], v[100:103], v[116:119]
  v_mfma_f32_16x16x32_bf16 v[112:115], v[196:199], v[104:107], v[112:115]
  v_mfma_f32_16x16x32_bf16 v[116:119], v[196:199], v[108:111], v[116:119]
  s_waitcnt vmcnt(6)
  v_mfma_f32_16x16x32_bf16 v[120:123], v[200:203], v[96:99], v[120:123]
  v_mfma_f32_16x16x32_bf16 v[124:127], v[200:203], v[100:103], v[124:127]
  v_mfma_f32_16x16x32_bf16 v[120:123], v[204:207], v[104:107], v[120:123]
  v_mfma_f32_16x16x32_bf16 v[124:127], v[204:207], v[108:111], v[124:127]
  s_waitcnt vmcnt(4)
  v_mfma_f32_16x16x32_bf16 v[128:131], v[208:211], v[96:99], v[128:131]
  v_mfma_f32_16x16x32_bf16 v[132:135], v[208:211], v[100:103], v[132:135]
  v_mfma_f32_16x16x32_bf16 v[128:131], v[212:215], v[104:107], v[128:131]
  v_mfma_f32_16x16x32_bf16 v[132:135], v[212:215], v[108:111], v[132:135]
  s_waitcnt vmcnt(0)
  v_mfma_f32_16x16x32_bf16 v[136:139], v[216:219], v[96:99], v[136:139]
  v_mfma_f32_16x16x32_bf16 v[140:143], v[216:219], v[100:103], v[140:143]
  v_mfma_f32_16x16x32_bf16 v[136:139], v[220:223], v[104:107], v[136:139]
  v_mfma_f32_16x16x32_bf16 v[140:143], v[220:223], v[108:111], v[140:143]
Lpjn_215:
  s_add_u32 s38, s22, 3
  v_add_u32 v2, s47, v9
  v_add_u32 v3, s47, v10
  s_xor_b32 s47, s47, 0x8000
  v_cmp_gt_u32 vcc, s38, v15
  s_nop 0
  s_cmp_eq_u64 vcc, 0
  s_cselect_b32 s25, 1, 0
  s_nop 0
  ds_write_b128 v2, v[112:115] offset:0
  ds_write_b128 v2, v[116:119] offset:1024
  ds_write_b128 v2, v[120:123] offset:2048
  ds_write_b128 v2, v[124:127] offset:3072
  ds_write_b128 v2, v[128:131] offset:4096
  ds_write_b128 v2, v[132:135] offset:5120
  ds_write_b128 v2, v[136:139] offset:6144
  ds_write_b128 v2, v[140:143] offset:7168
  s_waitcnt lgkmcnt(0)
  s_barrier
  ds_read_b128 v[144:147], v3 offset:0
  ds_read_b128 v[148:151], v3 offset:1024
  ds_read_b128 v[152:155], v3 offset:8192
  ds_read_b128 v[156:159], v3 offset:9216
  ds_read_b128 v[160:163], v3 offset:16384
  ds_read_b128 v[164:167], v3 offset:17408
  ds_read_b128 v[168:171], v3 offset:24576
  ds_read_b128 v[172:175], v3 offset:25600
  s_mul_i32 s27, s22, 81920
  s_add_u32 s27, s27, 0xbe00000
  s_add_u32 s28, s27, 40960
  s_waitcnt lgkmcnt(0)
  v_add_f32 v144, v144, v152
  v_add_f32 v160, v160, v168
  v_add_f32 v144, v144, v160
  v_lshlrev_b32 v2, 16, v184
  v_fma_f32 v144, v144, v176, v2
  v_add_f32 v145, v145, v153
  v_add_f32 v161, v161, v169
  v_add_f32 v145, v145, v161
  v_and_b32 v2, 0xffff0000, v184
  v_fma_f32 v145, v145, v177, v2
  v_add_f32 v146, v146, v154
  v_add_f32 v162, v162, v170
  v_add_f32 v146, v146, v162
  v_lshlrev_b32 v2, 16, v185
  v_fma_f32 v146, v146, v178, v2
  v_add_f32 v147, v147, v155
  v_add_f32 v163, v163, v171
  v_add_f32 v147, v147, v163
  v_and_b32 v2, 0xffff0000, v185
  v_fma_f32 v147, v147, v179, v2
  buffer_store_dwordx4 v[144:147], v14, s[4:7], s27 offen sc1
  v_add_f32 v148, v148, v156
  v_add_f32 v164, v164, v172
  v_add_f32 v148, v148, v164
  v_lshlrev_b32 v2, 16, v186
  v_fma_f32 v148, v148, v176, v2
  v_add_f32 v149, v149, v157
  v_add_f32 v165, v165, v173
  v_add_f32 v149, v149, v165
  v_and_b32 v2, 0xffff0000, v186
  v_fma_f32 v149, v149, v177, v2
  v_add_f32 v150, v150, v158
  v_add_f32 v166, v166, v174
  v_add_f32 v150, v150, v166
  v_lshlrev_b32 v2, 16, v187
  v_fma_f32 v150, v150, v178, v2
  v_add_f32 v151, v151, v159
  v_add_f32 v167, v167, v175
  v_add_f32 v151, v151, v167
  v_and_b32 v2, 0xffff0000, v187
  v_fma_f32 v151, v151, v179, v2
  buffer_store_dwordx4 v[148:151], v14, s[4:7], s28 offen sc1
  s_cmp_eq_u32 s25, 0
  s_cbranch_scc1 Lpnq_216
  s_add_u32 s43, s22, 2
  s_mul_i32 s26, s43, 81920
  s_add_u32 s27, s26, s35
  s_add_u32 s28, s26, s36
  s_mul_i32 s39, s43, 327680
  s_add_u32 s39, s39, s34
  buffer_load_dwordx4 v[32:35], v5, s[4:7], s27 offen offset:0 sc1
  buffer_load_dwordx4 v[36:39], v5, s[4:7], s27 offen offset:1024 sc1
  buffer_load_dwordx4 v[40:43], v5, s[4:7], s27 offen offset:2048 sc1
  buffer_load_dwordx4 v[44:47], v5, s[4:7], s27 offen offset:3072 sc1
  s_add_u32 s27, s27, 4096
  buffer_load_dwordx4 v[48:51], v5, s[4:7], s27 offen offset:0 sc1
  buffer_load_dwordx4 v[52:55], v5, s[4:7], s27 offen offset:1024 sc1
  buffer_load_dwordx4 v[56:59], v5, s[4:7], s27 offen offset:2048 sc1
  buffer_load_dwordx4 v[60:63], v5, s[4:7], s27 offen offset:3072 sc1
  s_add_u32 s27, s27, 4096
  buffer_load_dwordx4 v[64:67], v5, s[4:7], s27 offen offset:0 sc1
  buffer_load_dwordx4 v[68:71], v5, s[4:7], s27 offen offset:1024 sc1
  buffer_load_dwordx4 v[72:75], v5, s[4:7], s27 offen offset:2048 sc1
  buffer_load_dwordx4 v[76:79], v5, s[4:7], s27 offen offset:3072 sc1
  s_add_u32 s27, s27, 4096
  buffer_load_dwordx4 v[80:83], v5, s[4:7], s27 offen offset:0 sc1
  buffer_load_dwordx4 v[84:87], v5, s[4:7], s27 offen offset:1024 sc1
  buffer_load_dwordx4 v[88:91], v5, s[4:7], s27 offen offset:2048 sc1
  buffer_load_dwordx4 v[92:95], v5, s[4:7], s27 offen offset:3072 sc1
  buffer_load_dwordx4 v[96:99], v5, s[4:7], s28 offen offset:0 sc1
  buffer_load_dwordx4 v[100:103], v5, s[4:7], s28 offen offset:1024 sc1
  buffer_load_dwordx4 v[104:107], v5, s[4:7], s28 offen offset:2048 sc1
  buffer_load_dwordx4 v[108:111], v5, s[4:7], s28 offen offset:3072 sc1
  buffer_load_dwordx4 v[192:195], v5, s[4:7], s39 offen offset:0 sc1
  buffer_load_dwordx4 v[196:199], v5, s[4:7], s39 offen offset:1024 sc1
  s_add_u32 s39, s39, 8192
  buffer_load_dwordx4 v[200:203], v5, s[4:7], s39 offen offset:0 sc1
  buffer_load_dwordx4 v[204:207], v5, s[4:7], s39 offen offset:1024 sc1
  s_add_u32 s39, s39, 8192
  buffer_load_dwordx4 v[208:211], v5, s[4:7], s39 offen offset:0 sc1
  buffer_load_dwordx4 v[212:215], v5, s[4:7], s39 offen offset:1024 sc1
  s_add_u32 s39, s39, 8192
  buffer_load_dwordx4 v[216:219], v5, s[4:7], s39 offen offset:0 sc1
  buffer_load_dwordx4 v[220:223], v5, s[4:7], s39 offen offset:1024 sc1
  s_waitcnt vmcnt(28)
  s_branch Lpsg_217
Lpnq_216:
  s_waitcnt vmcnt(0)
Lpsg_217:
  s_add_u32 s26, s22, 1
  v_mov_b32 v2, s26
  s_mov_b64 exec, 1
  buffer_store_dword v2, v0, s[4:7], s33 offen sc1
  s_mov_b64 exec, -1
  s_cmp_ge_u32 s22, 62
  s_cbranch_scc1 Lplast_195
  s_add_u32 s22, s22, 2
  s_branch Lpl_194
Lplast_195:
  s_branch Lmain_end
.p2align 6
Lrole_LN:
  s_lshr_b32 s44, s20, 1
  s_and_b32 s45, s20, 1
  v_mov_b32 v0, 0
  v_lshrrev_b32 v3, 4, v1
  s_lshl_b32 s26, s21, 2
  v_add_u32 v3, s26, v3
  v_and_b32 v4, 15, v1
  v_lshlrev_b32 v2, 5, v4
  v_mul_u32_u24 v5, 2560, v3
  v_add_u32 v5, v5, v2
  s_mov_b32 s27, 0x281e00
  s_mov_b32 s28, 0x282800
  buffer_load_dwordx4 v[112:115], v2, s[4:7], s27 offen offset:0 sc1
  buffer_load_dwordx4 v[72:75], v2, s[4:7], s28 offen offset:0 sc1
  buffer_load_dwordx4 v[116:119], v2, s[4:7], s27 offen offset:16 sc1
  buffer_load_dwordx4 v[76:79], v2, s[4:7], s28 offen offset:16 sc1
  buffer_load_dwordx4 v[120:123], v2, s[4:7], s27 offen offset:512 sc1
  buffer_load_dwordx4 v[80:83], v2, s[4:7], s28 offen offset:512 sc1
  buffer_load_dwordx4 v[124:127], v2, s[4:7], s27 offen offset:528 sc1
  buffer_load_dwordx4 v[84:87], v2, s[4:7], s28 offen offset:528 sc1
  buffer_load_dwordx4 v[128:131], v2, s[4:7], s27 offen offset:1024 sc1
  buffer_load_dwordx4 v[88:91], v2, s[4:7], s28 offen offset:1024 sc1
  buffer_load_dwordx4 v[132:135], v2, s[4:7], s27 offen offset:1040 sc1
  buffer_load_dwordx4 v[92:95], v2, s[4:7], s28 offen offset:1040 sc1
  buffer_load_dwordx4 v[136:139], v2, s[4:7], s27 offen offset:1536 sc1
  buffer_load_dwordx4 v[96:99], v2, s[4:7], s28 offen offset:1536 sc1
  buffer_load_dwordx4 v[140:143], v2, s[4:7], s27 offen offset:1552 sc1
  buffer_load_dwordx4 v[100:103], v2, s[4:7], s28 offen offset:1552 sc1
  buffer_load_dwordx4 v[144:147], v2, s[4:7], s27 offen offset:2048 sc1
  buffer_load_dwordx4 v[104:107], v2, s[4:7], s28 offen offset:2048 sc1
  buffer_load_dwordx4 v[148:151], v2, s[4:7], s27 offen offset:2064 sc1
  buffer_load_dwordx4 v[108:111], v2, s[4:7], s28 offen offset:2064 sc1
  v_lshrrev_b32 v9, 2, v4
  v_lshlrev_b32 v9, 11, v9
  v_and_b32 v10, 3, v4
  v_lshl_add_u32 v9, v10, 8, v9
  v_lshl_add_u32 v6, v3, 4, v9
  v_min_u32 v2, 39, v1
  v_lshlrev_b32 v7, 2, v2
  s_mul_i32 s29, s44, 160
  s_add_u32 s29, s29, 0x1c00
  s_lshl_b32 s33, s20, 4
  s_lshl_b32 s26, s21, 2
  s_add_u32 s33, s33, s26
  s_add_u32 s33, s33, 0x2000
  s_mul_i32 s30, s45, 40960
  s_add_u32 s30, s30, 0xbe00000
  s_lshl_b32 s31, s45, 10
  s_add_u32 s31, s31, 0xc400000
  s_mov_b32 s22, s44
  s_lshl_b32 s29, s29, 5
  s_add_u32 s29, s29, 0x200000
  s_lshl_b32 s33, s33, 5
  s_add_u32 s33, s33, 0x200000
  v_lshlrev_b32 v7, 5, v7
Lll_219:
  s_add_u32 s38, s22, 1
Lwf_221:
  s_add_u32 s24, s24, 1
  s_cmp_gt_u32 s24, 300000
  s_cbranch_scc1 Lfail_218
  buffer_load_dword v8, v7, s[4:7], s29 offen sc1
  s_waitcnt vmcnt(0)
  v_cmp_gt_u32 vcc, s38, v8
  s_cbranch_vccz Lrok_222
  s_sleep 2
  s_branch Lwf_221
Lrok_222:
Lwok_220:
  s_mul_i32 s27, s22, 81920
  s_add_u32 s27, s27, s30
  buffer_load_dwordx4 v[32:35], v5, s[4:7], s27 offen offset:0 sc1
  buffer_load_dwordx4 v[36:39], v5, s[4:7], s27 offen offset:16 sc1
  buffer_load_dwordx4 v[40:43], v5, s[4:7], s27 offen offset:512 sc1
  buffer_load_dwordx4 v[44:47], v5, s[4:7], s27 offen offset:528 sc1
  buffer_load_dwordx4 v[48:51], v5, s[4:7], s27 offen offset:1024 sc1
  buffer_load_dwordx4 v[52:55], v5, s[4:7], s27 offen offset:1040 sc1
  buffer_load_dwordx4 v[56:59], v5, s[4:7], s27 offen offset:1536 sc1
  buffer_load_dwordx4 v[60:63], v5, s[4:7], s27 offen offset:1552 sc1
  buffer_load_dwordx4 v[64:67], v5, s[4:7], s27 offen offset:2048 sc1
  buffer_load_dwordx4 v[68:71], v5, s[4:7], s27 offen offset:2064 sc1
  s_waitcnt vmcnt(0)
  v_pk_add_f32 v[16:17], v[32:33], v[34:35]
  v_pk_add_f32 v[18:19], v[36:37], v[38:39]
  v_pk_add_f32 v[16:17], v[16:17], v[40:41]
  v_pk_add_f32 v[18:19], v[18:19], v[42:43]
  v_pk_add_f32 v[16:17], v[16:17], v[44:45]
  v_pk_add_f32 v[18:19], v[18:19], v[46:47]
  v_pk_add_f32 v[16:17], v[16:17], v[48:49]
  v_pk_add_f32 v[18:19], v[18:19], v[50:51]
  v_pk_add_f32 v[16:17], v[16:17], v[52:53]
  v_pk_add_f32 v[18:19], v[18:19], v[54:55]
  v_pk_add_f32 v[16:17], v[16:17], v[56:57]
  v_pk_add_f32 v[18:19], v[18:19], v[58:59]
  v_pk_add_f32 v[16:17], v[16:17], v[60:61]
  v_pk_add_f32 v[18:19], v[18:19], v[62:63]
  v_pk_add_f32 v[16:17], v[16:17], v[64:65]
  v_pk_add_f32 v[18:19], v[18:19], v[66:67]
  v_pk_add_f32 v[16:17], v[16:17], v[68:69]
  v_pk_add_f32 v[18:19], v[18:19], v[70:71]
  v_pk_add_f32 v[16:17], v[16:17], v[18:19]
  v_add_f32 v9, v16, v17
  s_nop 1
  v_add_f32_dpp v9, v9, v9 row_ror:8 row_mask:0xf bank_mask:0xf
  s_nop 1
  v_add_f32_dpp v9, v9, v9 row_ror:4 row_mask:0xf bank_mask:0xf
  s_nop 1
  v_add_f32_dpp v9, v9, v9 row_ror:2 row_mask:0xf bank_mask:0xf
  s_nop 1
  v_add_f32_dpp v9, v9, v9 row_ror:1 row_mask:0xf bank_mask:0xf
  v_mul_f32 v16, 0xbacccccd, v9
  v_pk_add_f32 v[32:33], v[32:33], v[16:17] op_sel_hi:[1,0]
  v_pk_add_f32 v[34:35], v[34:35], v[16:17] op_sel_hi:[1,0]
  v_pk_add_f32 v[36:37], v[36:37], v[16:17] op_sel_hi:[1,0]
  v_pk_add_f32 v[38:39], v[38:39], v[16:17] op_sel_hi:[1,0]
  v_pk_add_f32 v[40:41], v[40:41], v[16:17] op_sel_hi:[1,0]
  v_pk_add_f32 v[42:43], v[42:43], v[16:17] op_sel_hi:[1,0]
  v_pk_add_f32 v[44:45], v[44:45], v[16:17] op_sel_hi:[1,0]
  v_pk_add_f32 v[46:47], v[46:47], v[16:17] op_sel_hi:[1,0]
  v_pk_add_f32 v[48:49], v[48:49], v[16:17] op_sel_hi:[1,0]
  v_pk_add_f32 v[50:51], v[50:51], v[16:17] op_sel_hi:[1,0]
  v_pk_add_f32 v[52:53], v[52:53], v[16:17] op_sel_hi:[1,0]
  v_pk_add_f32 v[54:55], v[54:55], v[16:17] op_sel_hi:[1,0]
  v_pk_add_f32 v[56:57], v[56:57], v[16:17] op_sel_hi:[1,0]
  v_pk_add_f32 v[58:59], v[58:59], v[16:17] op_sel_hi:[1,0]
  v_pk_add_f32 v[60:61], v[60:61], v[16:17] op_sel_hi:[1,0]
  v_pk_add_f32 v[62:63], v[62:63], v[16:17] op_sel_hi:[1,0]
  v_pk_add_f32 v[64:65], v[64:65], v[16:17] op_sel_hi:[1,0]
  v_pk_add_f32 v[66:67], v[66:67], v[16:17] op_sel_hi:[1,0]
  v_pk_add_f32 v[68:69], v[68:69], v[16:17] op_sel_hi:[1,0]
  v_pk_add_f32 v[70:71], v[70:71], v[16:17] op_sel_hi:[1,0]
  v_pk_mul_f32 v[16:17], v[32:33], v[32:33]
  v_pk_mul_f32 v[18:19], v[34:35], v[34:35]
  v_pk_fma_f32 v[16:17], v[36:37], v[36:37], v[16:17]
  v_pk_fma_f32 v[18:19], v[38:39], v[38:39], v[18:19]
  v_pk_fma_f32 v[16:17], v[40:41], v[40:41], v[16:17]
  v_pk_fma_f32 v[18:19], v[42:43], v[42:43], v[18:19]
  v_pk_fma_f32 v[16:17], v[44:45], v[44:45], v[16:17]
  v_pk_fma_f32 v[18:19], v[46:47], v[46:47], v[18:19]
  v_pk_fma_f32 v[16:17], v[48:49], v[48:49], v[16:17]
  v_pk_fma_f32 v[18:19], v[50:51], v[50:51], v[18:19]
  v_pk_fma_f32 v[16:17], v[52:53], v[52:53], v[16:17]
  v_pk_fma_f32 v[18:19], v[54:55], v[54:55], v[18:19]
  v_pk_fma_f32 v[16:17], v[56:57], v[56:57], v[16:17]
  v_pk_fma_f32 v[18:19], v[58:59], v[58:59], v[18:19]
  v_pk_fma_f32 v[16:17], v[60:61], v[60:61], v[16:17]
  v_pk_fma_f32 v[18:19], v[62:63], v[62:63], v[18:19]
  v_pk_fma_f32 v[16:17], v[64:65], v[64:65], v[16:17]
  v_pk_fma_f32 v[18:19], v[66:67], v[66:67], v[18:19]
  v_pk_fma_f32 v[16:17], v[68:69], v[68:69], v[16:17]
  v_pk_fma_f32 v[18:19], v[70:71], v[70:71], v[18:19]
  v_pk_add_f32 v[16:17], v[16:17], v[18:19]
  v_add_f32 v10, v16, v17
  s_nop 1
  v_add_f32_dpp v10, v10, v10 row_ror:8 row_mask:0xf bank_mask:0xf
  s_nop 1
  v_add_f32_dpp v10, v10, v10 row_ror:4 row_mask:0xf bank_mask:0xf
  s_nop 1
  v_add_f32_dpp v10, v10, v10 row_ror:2 row_mask:0xf bank_mask:0xf
  s_nop 1
  v_add_f32_dpp v10, v10, v10 row_ror:1 row_mask:0xf bank_mask:0xf
  v_mov_b32 v11, 0x3727c5ac
  v_fmac_f32 v11, 0x3acccccd, v10
  v_rsq_f32 v10, v11
  s_nop 0
  v_pk_mul_f32 v[32:33], v[32:33], v[10:11] op_sel_hi:[1,0]
  v_pk_fma_f32 v[32:33], v[32:33], v[72:73], v[112:113]
  v_pk_mul_f32 v[34:35], v[34:35], v[10:11] op_sel_hi:[1,0]
  v_pk_fma_f32 v[34:35], v[34:35], v[74:75], v[114:115]
  v_pk_mul_f32 v[36:37], v[36:37], v[10:11] op_sel_hi:[1,0]
  v_pk_fma_f32 v[36:37], v[36:37], v[76:77], v[116:117]
  v_pk_mul_f32 v[38:39], v[38:39], v[10:11] op_sel_hi:[1,0]
  v_pk_fma_f32 v[38:39], v[38:39], v[78:79], v[118:119]
  v_pk_mul_f32 v[40:41], v[40:41], v[10:11] op_sel_hi:[1,0]
  v_pk_fma_f32 v[40:41], v[40:41], v[80:81], v[120:121]
  v_pk_mul_f32 v[42:43], v[42:43], v[10:11] op_sel_hi:[1,0]
  v_pk_fma_f32 v[42:43], v[42:43], v[82:83], v[122:123]
  v_pk_mul_f32 v[44:45], v[44:45], v[10:11] op_sel_hi:[1,0]
  v_pk_fma_f32 v[44:45], v[44:45], v[84:85], v[124:125]
  v_pk_mul_f32 v[46:47], v[46:47], v[10:11] op_sel_hi:[1,0]
  v_pk_fma_f32 v[46:47], v[46:47], v[86:87], v[126:127]
  v_pk_mul_f32 v[48:49], v[48:49], v[10:11] op_sel_hi:[1,0]
  v_pk_fma_f32 v[48:49], v[48:49], v[88:89], v[128:129]
  v_pk_mul_f32 v[50:51], v[50:51], v[10:11] op_sel_hi:[1,0]
  v_pk_fma_f32 v[50:51], v[50:51], v[90:91], v[130:131]
  v_pk_mul_f32 v[52:53], v[52:53], v[10:11] op_sel_hi:[1,0]
  v_pk_fma_f32 v[52:53], v[52:53], v[92:93], v[132:133]
  v_pk_mul_f32 v[54:55], v[54:55], v[10:11] op_sel_hi:[1,0]
  v_pk_fma_f32 v[54:55], v[54:55], v[94:95], v[134:135]
  v_pk_mul_f32 v[56:57], v[56:57], v[10:11] op_sel_hi:[1,0]
  v_pk_fma_f32 v[56:57], v[56:57], v[96:97], v[136:137]
  v_pk_mul_f32 v[58:59], v[58:59], v[10:11] op_sel_hi:[1,0]
  v_pk_fma_f32 v[58:59], v[58:59], v[98:99], v[138:139]
  v_pk_mul_f32 v[60:61], v[60:61], v[10:11] op_sel_hi:[1,0]
  v_pk_fma_f32 v[60:61], v[60:61], v[100:101], v[140:141]
  v_pk_mul_f32 v[62:63], v[62:63], v[10:11] op_sel_hi:[1,0]
  v_pk_fma_f32 v[62:63], v[62:63], v[102:103], v[142:143]
  v_pk_mul_f32 v[64:65], v[64:65], v[10:11] op_sel_hi:[1,0]
  v_pk_fma_f32 v[64:65], v[64:65], v[104:105], v[144:145]
  v_pk_mul_f32 v[66:67], v[66:67], v[10:11] op_sel_hi:[1,0]
  v_pk_fma_f32 v[66:67], v[66:67], v[106:107], v[146:147]
  v_pk_mul_f32 v[68:69], v[68:69], v[10:11] op_sel_hi:[1,0]
  v_pk_fma_f32 v[68:69], v[68:69], v[108:109], v[148:149]
  v_pk_mul_f32 v[70:71], v[70:71], v[10:11] op_sel_hi:[1,0]
  v_pk_fma_f32 v[70:71], v[70:71], v[110:111], v[150:151]
  v_pk_add_f32 v[16:17], v[32:33], v[34:35]
  v_pk_add_f32 v[18:19], v[36:37], v[38:39]
  v_pk_add_f32 v[16:17], v[16:17], v[40:41]
  v_pk_add_f32 v[18:19], v[18:19], v[42:43]
  v_pk_add_f32 v[16:17], v[16:17], v[44:45]
  v_pk_add_f32 v[18:19], v[18:19], v[46:47]
  v_pk_add_f32 v[16:17], v[16:17], v[48:49]
  v_pk_add_f32 v[18:19], v[18:19], v[50:51]
  v_pk_add_f32 v[16:17], v[16:17], v[52:53]
  v_pk_add_f32 v[18:19], v[18:19], v[54:55]
  v_pk_add_f32 v[16:17], v[16:17], v[56:57]
  v_pk_add_f32 v[18:19], v[18:19], v[58:59]
  v_pk_add_f32 v[16:17], v[16:17], v[60:61]
  v_pk_add_f32 v[18:19], v[18:19], v[62:63]
  v_pk_add_f32 v[16:17], v[16:17], v[64:65]
  v_pk_add_f32 v[18:19], v[18:19], v[66:67]
  v_pk_add_f32 v[16:17], v[16:17], v[68:69]
  v_pk_add_f32 v[18:19], v[18:19], v[70:71]
  v_pk_add_f32 v[16:17], v[16:17], v[18:19]
  v_add_f32 v9, v16, v17
  s_nop 1
  v_add_f32_dpp v9, v9, v9 row_ror:8 row_mask:0xf bank_mask:0xf
  s_nop 1
  v_add_f32_dpp v9, v9, v9 row_ror:4 row_mask:0xf bank_mask:0xf
  s_nop 1
  v_add_f32_dpp v9, v9, v9 row_ror:2 row_mask:0xf bank_mask:0xf
  s_nop 1
  v_add_f32_dpp v9, v9, v9 row_ror:1 row_mask:0xf bank_mask:0xf
  v_mul_f32 v16, 0xbacccccd, v9
  v_pk_add_f32 v[32:33], v[32:33], v[16:17] op_sel_hi:[1,0]
  v_pk_add_f32 v[34:35], v[34:35], v[16:17] op_sel_hi:[1,0]
  v_pk_add_f32 v[36:37], v[36:37], v[16:17] op_sel_hi:[1,0]
  v_pk_add_f32 v[38:39], v[38:39], v[16:17] op_sel_hi:[1,0]
  v_pk_add_f32 v[40:41], v[40:41], v[16:17] op_sel_hi:[1,0]
  v_pk_add_f32 v[42:43], v[42:43], v[16:17] op_sel_hi:[1,0]
  v_pk_add_f32 v[44:45], v[44:45], v[16:17] op_sel_hi:[1,0]
  v_pk_add_f32 v[46:47], v[46:47], v[16:17] op_sel_hi:[1,0]
  v_pk_add_f32 v[48:49], v[48:49], v[16:17] op_sel_hi:[1,0]
  v_pk_add_f32 v[50:51], v[50:51], v[16:17] op_sel_hi:[1,0]
  v_pk_add_f32 v[52:53], v[52:53], v[16:17] op_sel_hi:[1,0]
  v_pk_add_f32 v[54:55], v[54:55], v[16:17] op_sel_hi:[1,0]
  v_pk_add_f32 v[56:57], v[56:57], v[16:17] op_sel_hi:[1,0]
  v_pk_add_f32 v[58:59], v[58:59], v[16:17] op_sel_hi:[1,0]
  v_pk_add_f32 v[60:61], v[60:61], v[16:17] op_sel_hi:[1,0]
  v_pk_add_f32 v[62:63], v[62:63], v[16:17] op_sel_hi:[1,0]
  v_pk_add_f32 v[64:65], v[64:65], v[16:17] op_sel_hi:[1,0]
  v_pk_add_f32 v[66:67], v[66:67], v[16:17] op_sel_hi:[1,0]
  v_pk_add_f32 v[68:69], v[68:69], v[16:17] op_sel_hi:[1,0]
  v_pk_add_f32 v[70:71], v[70:71], v[16:17] op_sel_hi:[1,0]
  v_pk_mul_f32 v[16:17], v[32:33], v[32:33]
  v_pk_mul_f32 v[18:19], v[34:35], v[34:35]
  v_pk_fma_f32 v[16:17], v[36:37], v[36:37], v[16:17]
  v_pk_fma_f32 v[18:19], v[38:39], v[38:39], v[18:19]
  v_pk_fma_f32 v[16:17], v[40:41], v[40:41], v[16:17]
  v_pk_fma_f32 v[18:19], v[42:43], v[42:43], v[18:19]
  v_pk_fma_f32 v[16:17], v[44:45], v[44:45], v[16:17]
  v_pk_fma_f32 v[18:19], v[46:47], v[46:47], v[18:19]
  v_pk_fma_f32 v[16:17], v[48:49], v[48:49], v[16:17]
  v_pk_fma_f32 v[18:19], v[50:51], v[50:51], v[18:19]
  v_pk_fma_f32 v[16:17], v[52:53], v[52:53], v[16:17]
  v_pk_fma_f32 v[18:19], v[54:55], v[54:55], v[18:19]
  v_pk_fma_f32 v[16:17], v[56:57], v[56:57], v[16:17]
  v_pk_fma_f32 v[18:19], v[58:59], v[58:59], v[18:19]
  v_pk_fma_f32 v[16:17], v[60:61], v[60:61], v[16:17]
  v_pk_fma_f32 v[18:19], v[62:63], v[62:63], v[18:19]
  v_pk_fma_f32 v[16:17], v[64:65], v[64:65], v[16:17]
  v_pk_fma_f32 v[18:19], v[66:67], v[66:67], v[18:19]
  v_pk_fma_f32 v[16:17], v[68:69], v[68:69], v[16:17]
  v_pk_fma_f32 v[18:19], v[70:71], v[70:71], v[18:19]
  v_pk_add_f32 v[16:17], v[16:17], v[18:19]
  v_add_f32 v10, v16, v17
  s_nop 1
  v_add_f32_dpp v10, v10, v10 row_ror:8 row_mask:0xf bank_mask:0xf
  s_nop 1
  v_add_f32_dpp v10, v10, v10 row_ror:4 row_mask:0xf bank_mask:0xf
  s_nop 1
  v_add_f32_dpp v10, v10, v10 row_ror:2 row_mask:0xf bank_mask:0xf
  s_nop 1
  v_add_f32_dpp v10, v10, v10 row_ror:1 row_mask:0xf bank_mask:0xf
  v_mov_b32 v11, 0x3727c5ac
  v_fmac_f32 v11, 0x3acccccd, v10
  v_rsq_f32 v10, v11
  s_nop 0
  v_pk_mul_f32 v[32:33], v[32:33], v[10:11] op_sel_hi:[1,0]
  v_pk_mul_f32 v[34:35], v[34:35], v[10:11] op_sel_hi:[1,0]
  v_pk_mul_f32 v[36:37], v[36:37], v[10:11] op_sel_hi:[1,0]
  v_pk_mul_f32 v[38:39], v[38:39], v[10:11] op_sel_hi:[1,0]
  v_pk_mul_f32 v[40:41], v[40:41], v[10:11] op_sel_hi:[1,0]
  v_pk_mul_f32 v[42:43], v[42:43], v[10:11] op_sel_hi:[1,0]
  v_pk_mul_f32 v[44:45], v[44:45], v[10:11] op_sel_hi:[1,0]
  v_pk_mul_f32 v[46:47], v[46:47], v[10:11] op_sel_hi:[1,0]
  v_pk_mul_f32 v[48:49], v[48:49], v[10:11] op_sel_hi:[1,0]
  v_pk_mul_f32 v[50:51], v[50:51], v[10:11] op_sel_hi:[1,0]
  v_pk_mul_f32 v[52:53], v[52:53], v[10:11] op_sel_hi:[1,0]
  v_pk_mul_f32 v[54:55], v[54:55], v[10:11] op_sel_hi:[1,0]
  v_pk_mul_f32 v[56:57], v[56:57], v[10:11] op_sel_hi:[1,0]
  v_pk_mul_f32 v[58:59], v[58:59], v[10:11] op_sel_hi:[1,0]
  v_pk_mul_f32 v[60:61], v[60:61], v[10:11] op_sel_hi:[1,0]
  v_pk_mul_f32 v[62:63], v[62:63], v[10:11] op_sel_hi:[1,0]
  v_pk_mul_f32 v[64:65], v[64:65], v[10:11] op_sel_hi:[1,0]
  v_pk_mul_f32 v[66:67], v[66:67], v[10:11] op_sel_hi:[1,0]
  v_pk_mul_f32 v[68:69], v[68:69], v[10:11] op_sel_hi:[1,0]
  v_pk_mul_f32 v[70:71], v[70:71], v[10:11] op_sel_hi:[1,0]
  v_cvt_pk_bf16_f32 v152, v32, v33
  v_cvt_pk_bf16_f32 v153, v34, v35
  v_cvt_pk_bf16_f32 v154, v36, v37
  v_cvt_pk_bf16_f32 v155, v38, v39
  v_cvt_pk_bf16_f32 v156, v40, v41
  v_cvt_pk_bf16_f32 v157, v42, v43
  v_cvt_pk_bf16_f32 v158, v44, v45
  v_cvt_pk_bf16_f32 v159, v46, v47
  v_cvt_pk_bf16_f32 v160, v48, v49
  v_cvt_pk_bf16_f32 v161, v50, v51
  v_cvt_pk_bf16_f32 v162, v52, v53
  v_cvt_pk_bf16_f32 v163, v54, v55
  v_cvt_pk_bf16_f32 v164, v56, v57
  v_cvt_pk_bf16_f32 v165, v58, v59
  v_cvt_pk_bf16_f32 v166, v60, v61
  v_cvt_pk_bf16_f32 v167, v62, v63
  v_cvt_pk_bf16_f32 v168, v64, v65
  v_cvt_pk_bf16_f32 v169, v66, v67
  v_cvt_pk_bf16_f32 v170, v68, v69
  v_cvt_pk_bf16_f32 v171, v70, v71
  s_mul_i32 s27, s22, 40960
  s_add_u32 s27, s27, s31
  buffer_store_dwordx4 v[152:155], v6, s[4:7], s27 offen sc1
  s_add_u32 s27, s27, 8192
  buffer_store_dwordx4 v[156:159], v6, s[4:7], s27 offen sc1
  s_add_u32 s27, s27, 8192
  buffer_store_dwordx4 v[160:163], v6, s[4:7], s27 offen sc1
  s_add_u32 s27, s27, 8192
  buffer_store_dwordx4 v[164:167], v6, s[4:7], s27 offen sc1
  s_add_u32 s27, s27, 8192
  buffer_store_dwordx4 v[168:171], v6, s[4:7], s27 offen sc1
  s_waitcnt vmcnt(0)
  s_add_u32 s26, s22, 1
  v_mov_b32 v2, s26
  s_mov_b64 exec, 1
  buffer_store_dword v2, v0, s[4:7], s33 offen sc1
  s_mov_b64 exec, -1
  s_add_u32 s22, s22, 2
  s_cmp_lt_u32 s22, 64
  s_cbranch_scc1 Lll_219
  s_branch Lmain_end
.p2align 6
Lrole_M1:
  s_mov_b32 s8, s48
  s_and_b32 s9, s49, 0xffff
  s_mov_b32 s10, 0x1e0000
  s_mov_b32 s11, 0x20000
  s_mov_b32 s16, s50
  s_and_b32 s17, s51, 0xffff
  s_mov_b32 s18, 0xc00
  s_mov_b32 s19, 0x20000
  s_lshl_b32 s27, s20, 2
  s_add_u32 s27, s27, s21
  s_lshl_b32 s28, s27, 7
  s_lshl_b32 s26, s27, 12
  s_add_u32 s30, s26, 0xc700000
  s_lshl_b32 s26, s27, 2
  s_add_u32 s33, s26, 0x2400
  s_lshl_b32 s26, s83, 7
  s_add_u32 s33, s33, s26
  s_mov_b32 s29, 0xc400000
  s_mov_b32 s31, 98304
  v_and_b32 v2, 3, v1
  v_lshlrev_b32 v2, 2, v2
Lcw_225:
  s_add_u32 s24, s24, 1
  s_cmp_gt_u32 s24, 300000
  s_cbranch_scc1 Lfail_224
  buffer_load_dword v3, v2, s[12:15], 0 offen offset:128 sc1
  s_waitcnt vmcnt(0)
  v_cmp_eq_u32 vcc, 0, v3
  s_and_b32 s26, vcc_lo, 1
  s_cmp_eq_u32 s26, 0
  s_cbranch_scc1 Lcok_226
  s_sleep 6
  s_branch Lcw_225
Lcok_226:
Lnodelay_223:
  v_lshrrev_b32 v2, 3, v1
  v_and_b32 v3, 7, v1
  v_mul_u32_u24 v2, 3072, v2
  v_lshl_add_u32 v2, v3, 4, v2
  v_add_u32 v16, 0, v2
  v_add_u32 v17, 23552, v2
  v_add_u32 v18, 47104, v2
  v_add_u32 v19, 70656, v2
  v_add_u32 v20, 98304, v2
  v_add_u32 v21, 121856, v2
  v_add_u32 v22, 145408, v2
  v_add_u32 v23, 168960, v2
  v_lshrrev_b32 v2, 4, v1
  v_bfe_u32 v3, v1, 2, 2
  v_lshl_add_u32 v2, v2, 3, v3
  v_lshlrev_b32 v2, 7, v2
  v_bfe_u32 v3, v1, 1, 1
  v_lshl_add_u32 v2, v3, 6, v2
  v_and_b32 v3, 1, v1
  v_lshl_add_u32 v2, v3, 4, v2
  s_lshl_b32 s34, s21, 15
  v_add_u32 v4, s34, v2
  s_add_u32 s27, s28, 0x0
  s_add_u32 m0, s34, 0
  s_nop 0
  buffer_load_dwordx4 v16, s[8:11], s27 offen offset:0 lds
  buffer_load_dwordx4 v17, s[8:11], s27 offen offset:1024 lds
  buffer_load_dwordx4 v18, s[8:11], s27 offen offset:2048 lds
  buffer_load_dwordx4 v19, s[8:11], s27 offen offset:3072 lds
  s_add_u32 m0, s34, 4096
  s_nop 0
  buffer_load_dwordx4 v20, s[8:11], s27 offen offset:0 lds
  buffer_load_dwordx4 v21, s[8:11], s27 offen offset:1024 lds
  buffer_load_dwordx4 v22, s[8:11], s27 offen offset:2048 lds
  buffer_load_dwordx4 v23, s[8:11], s27 offen offset:3072 lds
  s_add_u32 s27, s28, 0x30000
  s_add_u32 m0, s34, 8192
  s_nop 0
  buffer_load_dwordx4 v16, s[8:11], s27 offen offset:0 lds
  buffer_load_dwordx4 v17, s[8:11], s27 offen offset:1024 lds
  buffer_load_dwordx4 v18, s[8:11], s27 offen offset:2048 lds
  buffer_load_dwordx4 v19, s[8:11], s27 offen offset:3072 lds
  s_add_u32 m0, s34, 12288
  s_nop 0
  buffer_load_dwordx4 v20, s[8:11], s27 offen offset:0 lds
  buffer_load_dwordx4 v21, s[8:11], s27 offen offset:1024 lds
  buffer_load_dwordx4 v22, s[8:11], s27 offen offset:2048 lds
  buffer_load_dwordx4 v23, s[8:11], s27 offen offset:3072 lds
  s_add_u32 s27, s28, 0x60000
  s_add_u32 m0, s34, 16384
  s_nop 0
  buffer_load_dwordx4 v16, s[8:11], s27 offen offset:0 lds
  buffer_load_dwordx4 v17, s[8:11], s27 offen offset:1024 lds
  buffer_load_dwordx4 v18, s[8:11], s27 offen offset:2048 lds
  buffer_load_dwordx4 v19, s[8:11], s27 offen offset:3072 lds
  s_add_u32 m0, s34, 20480
  s_nop 0
  buffer_load_dwordx4 v20, s[8:11], s27 offen offset:0 lds
  buffer_load_dwordx4 v21, s[8:11], s27 offen offset:1024 lds
  buffer_load_dwordx4 v22, s[8:11], s27 offen offset:2048 lds
  buffer_load_dwordx4 v23, s[8:11], s27 offen offset:3072 lds
  s_waitcnt vmcnt(16)
  s_waitcnt lgkmcnt(0)
  s_add_u32 s27, s28, 0x90000
  s_add_u32 m0, s34, 24576
  s_nop 0
  buffer_load_dwordx4 v16, s[8:11], s27 offen offset:0 lds
  buffer_load_dwordx4 v17, s[8:11], s27 offen offset:1024 lds
  buffer_load_dwordx4 v18, s[8:11], s27 offen offset:2048 lds
  buffer_load_dwordx4 v19, s[8:11], s27 offen offset:3072 lds
  s_add_u32 m0, s34, 28672
  s_nop 0
  buffer_load_dwordx4 v20, s[8:11], s27 offen offset:0 lds
  buffer_load_dwordx4 v21, s[8:11], s27 offen offset:1024 lds
  buffer_load_dwordx4 v22, s[8:11], s27 offen offset:2048 lds
  buffer_load_dwordx4 v23, s[8:11], s27 offen offset:3072 lds
  ds_read_b64_tr_b16 a[0:1], v4 offset:0
  ds_read_b64_tr_b16 a[2:3], v4 offset:512
  ds_read_b64_tr_b16 a[4:5], v4 offset:8
  ds_read_b64_tr_b16 a[6:7], v4 offset:520
  ds_read_b64_tr_b16 a[8:9], v4 offset:32
  ds_read_b64_tr_b16 a[10:11], v4 offset:544
  ds_read_b64_tr_b16 a[12:13], v4 offset:40
  ds_read_b64_tr_b16 a[14:15], v4 offset:552
  ds_read_b64_tr_b16 a[16:17], v4 offset:4096
  ds_read_b64_tr_b16 a[18:19], v4 offset:4608
  ds_read_b64_tr_b16 a[20:21], v4 offset:4104
  ds_read_b64_tr_b16 a[22:23], v4 offset:4616
  ds_read_b64_tr_b16 a[24:25], v4 offset:4128
  ds_read_b64_tr_b16 a[26:27], v4 offset:4640
  ds_read_b64_tr_b16 a[28:29], v4 offset:4136
  ds_read_b64_tr_b16 a[30:31], v4 offset:4648
  s_waitcnt vmcnt(16)
  s_waitcnt lgkmcnt(0)
  s_add_u32 s27, s28, 0xc0000
  s_add_u32 m0, s34, 0
  s_nop 0
  buffer_load_dwordx4 v16, s[8:11], s27 offen offset:0 lds
  buffer_load_dwordx4 v17, s[8:11], s27 offen offset:1024 lds
  buffer_load_dwordx4 v18, s[8:11], s27 offen offset:2048 lds
  buffer_load_dwordx4 v19, s[8:11], s27 offen offset:3072 lds
  s_add_u32 m0, s34, 4096
  s_nop 0
  buffer_load_dwordx4 v20, s[8:11], s27 offen offset:0 lds
  buffer_load_dwordx4 v21, s[8:11], s27 offen offset:1024 lds
  buffer_load_dwordx4 v22, s[8:11], s27 offen offset:2048 lds
  buffer_load_dwordx4 v23, s[8:11], s27 offen offset:3072 lds
  ds_read_b64_tr_b16 a[32:33], v4 offset:8192
  ds_read_b64_tr_b16 a[34:35], v4 offset:8704
  ds_read_b64_tr_b16 a[36:37], v4 offset:8200
  ds_read_b64_tr_b16 a[38:39], v4 offset:8712
  ds_read_b64_tr_b16 a[40:41], v4 offset:8224
  ds_read_b64_tr_b16 a[42:43], v4 offset:8736
  ds_read_b64_tr_b16 a[44:45], v4 offset:8232
  ds_read_b64_tr_b16 a[46:47], v4 offset:8744
  ds_read_b64_tr_b16 a[48:49], v4 offset:12288
  ds_read_b64_tr_b16 a[50:51], v4 offset:12800
  ds_read_b64_tr_b16 a[52:53], v4 offset:12296
  ds_read_b64_tr_b16 a[54:55], v4 offset:12808
  ds_read_b64_tr_b16 a[56:57], v4 offset:12320
  ds_read_b64_tr_b16 a[58:59], v4 offset:12832
  ds_read_b64_tr_b16 a[60:61], v4 offset:12328
  ds_read_b64_tr_b16 a[62:63], v4 offset:12840
  s_waitcnt vmcnt(16)
  s_waitcnt lgkmcnt(0)
  s_add_u32 s27, s28, 0xf0000
  s_add_u32 m0, s34, 8192
  s_nop 0
  buffer_load_dwordx4 v16, s[8:11], s27 offen offset:0 lds
  buffer_load_dwordx4 v17, s[8:11], s27 offen offset:1024 lds
  buffer_load_dwordx4 v18, s[8:11], s27 offen offset:2048 lds
  buffer_load_dwordx4 v19, s[8:11], s27 offen offset:3072 lds
  s_add_u32 m0, s34, 12288
  s_nop 0
  buffer_load_dwordx4 v20, s[8:11], s27 offen offset:0 lds
  buffer_load_dwordx4 v21, s[8:11], s27 offen offset:1024 lds
  buffer_load_dwordx4 v22, s[8:11], s27 offen offset:2048 lds
  buffer_load_dwordx4 v23, s[8:11], s27 offen offset:3072 lds
  ds_read_b64_tr_b16 a[64:65], v4 offset:16384
  ds_read_b64_tr_b16 a[66:67], v4 offset:16896
  ds_read_b64_tr_b16 a[68:69], v4 offset:16392
  ds_read_b64_tr_b16 a[70:71], v4 offset:16904
  ds_read_b64_tr_b16 a[72:73], v4 offset:16416
  ds_read_b64_tr_b16 a[74:75], v4 offset:16928
  ds_read_b64_tr_b16 a[76:77], v4 offset:16424
  ds_read_b64_tr_b16 a[78:79], v4 offset:16936
  ds_read_b64_tr_b16 a[80:81], v4 offset:20480
  ds_read_b64_tr_b16 a[82:83], v4 offset:20992
  ds_read_b64_tr_b16 a[84:85], v4 offset:20488
  ds_read_b64_tr_b16 a[86:87], v4 offset:21000
  ds_read_b64_tr_b16 a[88:89], v4 offset:20512
  ds_read_b64_tr_b16 a[90:91], v4 offset:21024
  ds_read_b64_tr_b16 a[92:93], v4 offset:20520
  ds_read_b64_tr_b16 a[94:95], v4 offset:21032
  s_waitcnt vmcnt(16)
  s_waitcnt lgkmcnt(0)
  s_add_u32 s27, s28, 0x120000
  s_add_u32 m0, s34, 16384
  s_nop 0
  buffer_load_dwordx4 v16, s[8:11], s27 offen offset:0 lds
  buffer_load_dwordx4 v17, s[8:11], s27 offen offset:1024 lds
  buffer_load_dwordx4 v18, s[8:11], s27 offen offset:2048 lds
  buffer_load_dwordx4 v19, s[8:11], s27 offen offset:3072 lds
  s_add_u32 m0, s34, 20480
  s_nop 0
  buffer_load_dwordx4 v20, s[8:11], s27 offen offset:0 lds
  buffer_load_dwordx4 v21, s[8:11], s27 offen offset:1024 lds
  buffer_load_dwordx4 v22, s[8:11], s27 offen offset:2048 lds
  buffer_load_dwordx4 v23, s[8:11], s27 offen offset:3072 lds
  ds_read_b64_tr_b16 a[96:97], v4 offset:24576
  ds_read_b64_tr_b16 a[98:99], v4 offset:25088
  ds_read_b64_tr_b16 a[100:101], v4 offset:24584
  ds_read_b64_tr_b16 a[102:103], v4 offset:25096
  ds_read_b64_tr_b16 a[104:105], v4 offset:24608
  ds_read_b64_tr_b16 a[106:107], v4 offset:25120
  ds_read_b64_tr_b16 a[108:109], v4 offset:24616
  ds_read_b64_tr_b16 a[110:111], v4 offset:25128
  ds_read_b64_tr_b16 a[112:113], v4 offset:28672
  ds_read_b64_tr_b16 a[114:115], v4 offset:29184
  ds_read_b64_tr_b16 a[116:117], v4 offset:28680
  ds_read_b64_tr_b16 a[118:119], v4 offset:29192
  ds_read_b64_tr_b16 a[120:121], v4 offset:28704
  ds_read_b64_tr_b16 a[122:123], v4 offset:29216
  ds_read_b64_tr_b16 a[124:125], v4 offset:28712
  ds_read_b64_tr_b16 a[126:127], v4 offset:29224
  s_waitcnt vmcnt(16)
  s_waitcnt lgkmcnt(0)
  s_add_u32 s27, s28, 0x150000
  s_add_u32 m0, s34, 24576
  s_nop 0
  buffer_load_dwordx4 v16, s[8:11], s27 offen offset:0 lds
  buffer_load_dwordx4 v17, s[8:11], s27 offen offset:1024 lds
  buffer_load_dwordx4 v18, s[8:11], s27 offen offset:2048 lds
  buffer_load_dwordx4 v19, s[8:11], s27 offen offset:3072 lds
  s_add_u32 m0, s34, 28672
  s_nop 0
  buffer_load_dwordx4 v20, s[8:11], s27 offen offset:0 lds
  buffer_load_dwordx4 v21, s[8:11], s27 offen offset:1024 lds
  buffer_load_dwordx4 v22, s[8:11], s27 offen offset:2048 lds
  buffer_load_dwordx4 v23, s[8:11], s27 offen offset:3072 lds
  ds_read_b64_tr_b16 a[128:129], v4 offset:0
  ds_read_b64_tr_b16 a[130:131], v4 offset:512
  ds_read_b64_tr_b16 a[132:133], v4 offset:8
  ds_read_b64_tr_b16 a[134:135], v4 offset:520
  ds_read_b64_tr_b16 a[136:137], v4 offset:32
  ds_read_b64_tr_b16 a[138:139], v4 offset:544
  ds_read_b64_tr_b16 a[140:141], v4 offset:40
  ds_read_b64_tr_b16 a[142:143], v4 offset:552
  ds_read_b64_tr_b16 a[144:145], v4 offset:4096
  ds_read_b64_tr_b16 a[146:147], v4 offset:4608
  ds_read_b64_tr_b16 a[148:149], v4 offset:4104
  ds_read_b64_tr_b16 a[150:151], v4 offset:4616
  ds_read_b64_tr_b16 a[152:153], v4 offset:4128
  ds_read_b64_tr_b16 a[154:155], v4 offset:4640
  ds_read_b64_tr_b16 a[156:157], v4 offset:4136
  ds_read_b64_tr_b16 a[158:159], v4 offset:4648
  s_waitcnt vmcnt(16)
  s_waitcnt lgkmcnt(0)
  s_add_u32 s27, s28, 0x180000
  s_add_u32 m0, s34, 0
  s_nop 0
  buffer_load_dwordx4 v16, s[8:11], s27 offen offset:0 lds
  buffer_load_dwordx4 v17, s[8:11], s27 offen offset:1024 lds
  buffer_load_dwordx4 v18, s[8:11], s27 offen offset:2048 lds
  buffer_load_dwordx4 v19, s[8:11], s27 offen offset:3072 lds
  s_add_u32 m0, s34, 4096
  s_nop 0
  buffer_load_dwordx4 v20, s[8:11], s27 offen offset:0 lds
  buffer_load_dwordx4 v21, s[8:11], s27 offen offset:1024 lds
  buffer_load_dwordx4 v22, s[8:11], s27 offen offset:2048 lds
  buffer_load_dwordx4 v23, s[8:11], s27 offen offset:3072 lds
  ds_read_b64_tr_b16 a[160:161], v4 offset:8192
  ds_read_b64_tr_b16 a[162:163], v4 offset:8704
  ds_read_b64_tr_b16 a[164:165], v4 offset:8200
  ds_read_b64_tr_b16 a[166:167], v4 offset:8712
  ds_read_b64_tr_b16 a[168:169], v4 offset:8224
  ds_read_b64_tr_b16 a[170:171], v4 offset:8736
  ds_read_b64_tr_b16 a[172:173], v4 offset:8232
  ds_read_b64_tr_b16 a[174:175], v4 offset:8744
  ds_read_b64_tr_b16 a[176:177], v4 offset:12288
  ds_read_b64_tr_b16 a[178:179], v4 offset:12800
  ds_read_b64_tr_b16 a[180:181], v4 offset:12296
  ds_read_b64_tr_b16 a[182:183], v4 offset:12808
  ds_read_b64_tr_b16 a[184:185], v4 offset:12320
  ds_read_b64_tr_b16 a[186:187], v4 offset:12832
  ds_read_b64_tr_b16 a[188:189], v4 offset:12328
  ds_read_b64_tr_b16 a[190:191], v4 offset:12840
  s_waitcnt vmcnt(16)
  s_waitcnt lgkmcnt(0)
  s_add_u32 s27, s28, 0x1b0000
  s_add_u32 m0, s34, 8192
  s_nop 0
  buffer_load_dwordx4 v16, s[8:11], s27 offen offset:0 lds
  buffer_load_dwordx4 v17, s[8:11], s27 offen offset:1024 lds
  buffer_load_dwordx4 v18, s[8:11], s27 offen offset:2048 lds
  buffer_load_dwordx4 v19, s[8:11], s27 offen offset:3072 lds
  s_add_u32 m0, s34, 12288
  s_nop 0
  buffer_load_dwordx4 v20, s[8:11], s27 offen offset:0 lds
  buffer_load_dwordx4 v21, s[8:11], s27 offen offset:1024 lds
  buffer_load_dwordx4 v22, s[8:11], s27 offen offset:2048 lds
  buffer_load_dwordx4 v23, s[8:11], s27 offen offset:3072 lds
  ds_read_b64_tr_b16 a[192:193], v4 offset:16384
  ds_read_b64_tr_b16 a[194:195], v4 offset:16896
  ds_read_b64_tr_b16 a[196:197], v4 offset:16392
  ds_read_b64_tr_b16 a[198:199], v4 offset:16904
  ds_read_b64_tr_b16 a[200:201], v4 offset:16416
  ds_read_b64_tr_b16 a[202:203], v4 offset:16928
  ds_read_b64_tr_b16 a[204:205], v4 offset:16424
  ds_read_b64_tr_b16 a[206:207], v4 offset:16936
  ds_read_b64_tr_b16 a[208:209], v4 offset:20480
  ds_read_b64_tr_b16 a[210:211], v4 offset:20992
  ds_read_b64_tr_b16 a[212:213], v4 offset:20488
  ds_read_b64_tr_b16 a[214:215], v4 offset:21000
  ds_read_b64_tr_b16 a[216:217], v4 offset:20512
  ds_read_b64_tr_b16 a[218:219], v4 offset:21024
  ds_read_b64_tr_b16 a[220:221], v4 offset:20520
  ds_read_b64_tr_b16 a[222:223], v4 offset:21032
  s_waitcnt vmcnt(16)
  ds_read_b64_tr_b16 a[224:225], v4 offset:24576
  ds_read_b64_tr_b16 a[226:227], v4 offset:25088
  ds_read_b64_tr_b16 a[228:229], v4 offset:24584
  ds_read_b64_tr_b16 a[230:231], v4 offset:25096
  ds_read_b64_tr_b16 a[232:233], v4 offset:24608
  ds_read_b64_tr_b16 a[234:235], v4 offset:25120
  ds_read_b64_tr_b16 a[236:237], v4 offset:24616
  ds_read_b64_tr_b16 a[238:239], v4 offset:25128
  ds_read_b64_tr_b16 a[240:241], v4 offset:28672
  ds_read_b64_tr_b16 a[242:243], v4 offset:29184
  ds_read_b64_tr_b16 a[244:245], v4 offset:28680
  ds_read_b64_tr_b16 a[246:247], v4 offset:29192
  ds_read_b64_tr_b16 a[248:249], v4 offset:28704
  ds_read_b64_tr_b16 a[250:251], v4 offset:29216
  ds_read_b64_tr_b16 a[252:253], v4 offset:28712
  ds_read_b64_tr_b16 a[254:255], v4 offset:29224
  s_waitcnt vmcnt(8)
  ds_read_b64_tr_b16 v[192:193], v4 offset:0
  ds_read_b64_tr_b16 v[194:195], v4 offset:512
  ds_read_b64_tr_b16 v[196:197], v4 offset:8
  ds_read_b64_tr_b16 v[198:199], v4 offset:520
  ds_read_b64_tr_b16 v[200:201], v4 offset:32
  ds_read_b64_tr_b16 v[202:203], v4 offset:544
  ds_read_b64_tr_b16 v[204:205], v4 offset:40
  ds_read_b64_tr_b16 v[206:207], v4 offset:552
  ds_read_b64_tr_b16 v[208:209], v4 offset:4096
  ds_read_b64_tr_b16 v[210:211], v4 offset:4608
  ds_read_b64_tr_b16 v[212:213], v4 offset:4104
  ds_read_b64_tr_b16 v[214:215], v4 offset:4616
  ds_read_b64_tr_b16 v[216:217], v4 offset:4128
  ds_read_b64_tr_b16 v[218:219], v4 offset:4640
  ds_read_b64_tr_b16 v[220:221], v4 offset:4136
  ds_read_b64_tr_b16 v[222:223], v4 offset:4648
  s_waitcnt vmcnt(0)
  ds_read_b64_tr_b16 v[224:225], v4 offset:8192
  ds_read_b64_tr_b16 v[226:227], v4 offset:8704
  ds_read_b64_tr_b16 v[228:229], v4 offset:8200
  ds_read_b64_tr_b16 v[230:231], v4 offset:8712
  ds_read_b64_tr_b16 v[232:233], v4 offset:8224
  ds_read_b64_tr_b16 v[234:235], v4 offset:8736
  ds_read_b64_tr_b16 v[236:237], v4 offset:8232
  ds_read_b64_tr_b16 v[238:239], v4 offset:8744
  ds_read_b64_tr_b16 v[240:241], v4 offset:12288
  ds_read_b64_tr_b16 v[242:243], v4 offset:12800
  ds_read_b64_tr_b16 v[244:245], v4 offset:12296
  ds_read_b64_tr_b16 v[246:247], v4 offset:12808
  ds_read_b64_tr_b16 v[248:249], v4 offset:12320
  ds_read_b64_tr_b16 v[250:251], v4 offset:12832
  ds_read_b64_tr_b16 v[252:253], v4 offset:12328
  ds_read_b64_tr_b16 v[254:255], v4 offset:12840
  s_waitcnt vmcnt(0) lgkmcnt(0)
  v_and_b32 v2, 3, v1
  v_lshlrev_b32 v2, 2, v2
Lcw_228:
  s_add_u32 s24, s24, 1
  s_cmp_gt_u32 s24, 300000
  s_cbranch_scc1 Lfail_227
  buffer_load_dword v3, v2, s[12:15], 0 offen offset:128 sc1
  s_waitcnt vmcnt(0)
  v_cmp_eq_u32 vcc, 0, v3
  s_and_b32 s26, vcc_lo, 4
  s_cmp_eq_u32 s26, 0
  s_cbranch_scc1 Lcok_229
  s_sleep 6
  s_branch Lcw_228
Lcok_229:
  v_readlane_b32 s23, v3, 3
  s_and_b32 s23, s23, 0x2000
  v_lshlrev_b32 v5, 4, v1
  v_mov_b32 v8, 0
  v_lshrrev_b32 v2, 5, v1
  v_lshlrev_b32 v2, 11, v2
  v_bfe_u32 v3, v1, 4, 1
  v_lshl_add_u32 v2, v3, 9, v2
  v_and_b32 v3, 15, v1
  v_lshl_add_u32 v7, v3, 4, v2
  v_lshrrev_b32 v2, 5, v1
  v_lshlrev_b32 v2, 6, v2
  v_bfe_u32 v3, v1, 4, 1
  v_lshl_add_u32 v2, v3, 4, v2
  buffer_load_dwordx2 v[80:81], v2, s[16:19], s28 offen offset:0
  buffer_load_dwordx2 v[82:83], v2, s[16:19], s28 offen offset:8
  buffer_load_dwordx2 v[84:85], v2, s[16:19], s28 offen offset:32
  buffer_load_dwordx2 v[86:87], v2, s[16:19], s28 offen offset:40
  s_waitcnt vmcnt(0)
  v_lshlrev_b32 v112, 16, v80
  v_and_b32 v113, 0xffff0000, v80
  v_lshlrev_b32 v114, 16, v81
  v_and_b32 v115, 0xffff0000, v81
  v_lshlrev_b32 v116, 16, v82
  v_and_b32 v117, 0xffff0000, v82
  v_lshlrev_b32 v118, 16, v83
  v_and_b32 v119, 0xffff0000, v83
  v_lshlrev_b32 v120, 16, v84
  v_and_b32 v121, 0xffff0000, v84
  v_lshlrev_b32 v122, 16, v85
  v_and_b32 v123, 0xffff0000, v85
  v_lshlrev_b32 v124, 16, v86
  v_and_b32 v125, 0xffff0000, v86
  v_lshlrev_b32 v126, 16, v87
  v_and_b32 v127, 0xffff0000, v87
  v_and_b32 v2, 7, v1
  v_lshlrev_b32 v9, 2, v2
  s_lshl_b32 s33, s33, 5
  s_add_u32 s33, s33, 0x200000
  v_lshlrev_b32 v9, 5, v9
  s_mul_i32 s35, s21, 10240
  s_mov_b32 s41, 0xbdd2d3e8
  v_mov_b32 v11, 0xc0135761
  s_mov_b32 s22, 0
  s_mov_b32 s25, 0
  s_mov_b32 s45, 0
  s_mov_b32 s46, 0
  s_add_u32 s26, s83, 52
  s_cmp_lg_u32 s83, 0
  s_cselect_b32 s22, s26, 0
  s_barrier
  s_branch Lslow_230
Lslowep_233:
  s_and_b32 s37, s22, 1
  s_lshl_b32 s37, s37, 10
  s_add_u32 s37, s37, 0x240000
  buffer_load_dword v10, v9, s[4:7], s37 offen sc1
  s_add_i32 s38, s22, 1
  s_max_i32 s38, s38, 0
  s_nop 1
  v_mul_f32 v96, v48, v48
  v_mul_f32 v97, v49, v49
  v_fma_f32 v96, v96, s41, v11
  v_fma_f32 v97, v97, s41, v11
  v_mul_f32 v96, v96, v48
  v_mul_f32 v97, v97, v49
  v_exp_f32 v96, v96
  v_exp_f32 v97, v97
  v_add_f32 v96, 1.0, v96
  v_add_f32 v97, 1.0, v97
  v_rcp_f32 v96, v96
  v_rcp_f32 v97, v97
  v_mul_f32 v48, v48, v96
  v_mul_f32 v49, v49, v97
  v_mul_f32 v96, v50, v50
  v_mul_f32 v97, v51, v51
  v_fma_f32 v96, v96, s41, v11
  v_fma_f32 v97, v97, s41, v11
  v_mul_f32 v96, v96, v50
  v_mul_f32 v97, v97, v51
  v_exp_f32 v96, v96
  v_exp_f32 v97, v97
  v_add_f32 v96, 1.0, v96
  v_add_f32 v97, 1.0, v97
  v_rcp_f32 v96, v96
  v_rcp_f32 v97, v97
  v_mul_f32 v50, v50, v96
  v_mul_f32 v51, v51, v97
  v_mul_f32 v96, v52, v52
  v_mul_f32 v97, v53, v53
  v_fma_f32 v96, v96, s41, v11
  v_fma_f32 v97, v97, s41, v11
  v_mul_f32 v96, v96, v52
  v_mul_f32 v97, v97, v53
  v_exp_f32 v96, v96
  v_exp_f32 v97, v97
  v_add_f32 v96, 1.0, v96
  v_add_f32 v97, 1.0, v97
  v_rcp_f32 v96, v96
  v_rcp_f32 v97, v97
  v_mul_f32 v52, v52, v96
  v_mul_f32 v53, v53, v97
  v_mul_f32 v96, v54, v54
  v_mul_f32 v97, v55, v55
  v_fma_f32 v96, v96, s41, v11
  v_fma_f32 v97, v97, s41, v11
  v_mul_f32 v96, v96, v54
  v_mul_f32 v97, v97, v55
  v_exp_f32 v96, v96
  v_exp_f32 v97, v97
  v_add_f32 v96, 1.0, v96
  v_add_f32 v97, 1.0, v97
  v_rcp_f32 v96, v96
  v_rcp_f32 v97, v97
  v_mul_f32 v54, v54, v96
  v_mul_f32 v55, v55, v97
  v_mul_f32 v96, v56, v56
  v_mul_f32 v97, v57, v57
  v_fma_f32 v96, v96, s41, v11
  v_fma_f32 v97, v97, s41, v11
  v_mul_f32 v96, v96, v56
  v_mul_f32 v97, v97, v57
  v_exp_f32 v96, v96
  v_exp_f32 v97, v97
  v_add_f32 v96, 1.0, v96
  v_add_f32 v97, 1.0, v97
  v_rcp_f32 v96, v96
  v_rcp_f32 v97, v97
  v_mul_f32 v56, v56, v96
  v_mul_f32 v57, v57, v97
  v_mul_f32 v96, v58, v58
  v_mul_f32 v97, v59, v59
  v_fma_f32 v96, v96, s41, v11
  v_fma_f32 v97, v97, s41, v11
  v_mul_f32 v96, v96, v58
  v_mul_f32 v97, v97, v59
  v_exp_f32 v96, v96
  v_exp_f32 v97, v97
  v_add_f32 v96, 1.0, v96
  v_add_f32 v97, 1.0, v97
  v_rcp_f32 v96, v96
  v_rcp_f32 v97, v97
  v_mul_f32 v58, v58, v96
  v_mul_f32 v59, v59, v97
  v_mul_f32 v96, v60, v60
  v_mul_f32 v97, v61, v61
  v_fma_f32 v96, v96, s41, v11
  v_fma_f32 v97, v97, s41, v11
  v_mul_f32 v96, v96, v60
  v_mul_f32 v97, v97, v61
  v_exp_f32 v96, v96
  v_exp_f32 v97, v97
  v_add_f32 v96, 1.0, v96
  v_add_f32 v97, 1.0, v97
  v_rcp_f32 v96, v96
  v_rcp_f32 v97, v97
  v_mul_f32 v60, v60, v96
  v_mul_f32 v61, v61, v97
  v_mul_f32 v96, v62, v62
  v_mul_f32 v97, v63, v63
  v_fma_f32 v96, v96, s41, v11
  v_fma_f32 v97, v97, s41, v11
  v_mul_f32 v96, v96, v62
  v_mul_f32 v97, v97, v63
  v_exp_f32 v96, v96
  v_exp_f32 v97, v97
  v_add_f32 v96, 1.0, v96
  v_add_f32 v97, 1.0, v97
  v_rcp_f32 v96, v96
  v_rcp_f32 v97, v97
  v_mul_f32 v62, v62, v96
  v_mul_f32 v63, v63, v97
  v_cvt_pk_bf16_f32 v88, v48, v56
  v_cvt_pk_bf16_f32 v89, v49, v57
  v_cvt_pk_bf16_f32 v90, v50, v58
  v_cvt_pk_bf16_f32 v91, v51, v59
  v_cvt_pk_bf16_f32 v92, v52, v60
  v_cvt_pk_bf16_f32 v93, v53, v61
  v_cvt_pk_bf16_f32 v94, v54, v62
  v_cvt_pk_bf16_f32 v95, v55, v63
  buffer_store_dwordx4 v[88:91], v7, s[4:7], s40 offen offset:0 sc1
  buffer_store_dwordx4 v[92:95], v7, s[4:7], s40 offen offset:256 sc1
  s_waitcnt vmcnt(2)
  v_cmp_gt_u32 vcc, s38, v10
  s_cbranch_vccnz Ln2c_234
  s_cmp_ge_u32 s22, 64
  s_cbranch_scc1 Ln2c_234
  s_mul_i32 s42, s22, 40960
  s_add_u32 s42, s42, s29
  s_mov_b32 s43, s45
  s_add_u32 s42, s42, s35
  s_add_u32 s43, s43, s35
  s_add_u32 m0, s43, 0
  s_nop 0
  buffer_load_dwordx4 v5, s[4:7], s42 offen offset:0 sc1 lds
  buffer_load_dwordx4 v5, s[4:7], s42 offen offset:1024 sc1 lds
  buffer_load_dwordx4 v5, s[4:7], s42 offen offset:2048 sc1 lds
  buffer_load_dwordx4 v5, s[4:7], s42 offen offset:3072 sc1 lds
  s_add_u32 m0, s43, 4096
  s_add_u32 s42, s42, 4096
  buffer_load_dwordx4 v5, s[4:7], s42 offen offset:0 sc1 lds
  buffer_load_dwordx4 v5, s[4:7], s42 offen offset:1024 sc1 lds
  buffer_load_dwordx4 v5, s[4:7], s42 offen offset:2048 sc1 lds
  buffer_load_dwordx4 v5, s[4:7], s42 offen offset:3072 sc1 lds
  s_add_u32 m0, s43, 8192
  s_add_u32 s42, s42, 4096
  buffer_load_dwordx4 v5, s[4:7], s42 offen offset:0 sc1 lds
  buffer_load_dwordx4 v5, s[4:7], s42 offen offset:1024 sc1 lds
  s_mov_b32 s25, 1
  s_waitcnt vmcnt(10)
  s_mov_b32 s26, s46
  v_mov_b32 v2, s26
  s_mov_b64 exec, 1
  buffer_store_dword v2, v8, s[4:7], s33 offen sc1
  s_mov_b64 exec, -1
  s_waitcnt vmcnt(1)
  s_branch Lslow_230
Ln2c_234:
  s_waitcnt vmcnt(0)
  s_mov_b32 s26, s46
  v_mov_b32 v2, s26
  s_mov_b64 exec, 1
  buffer_store_dword v2, v8, s[4:7], s33 offen sc1
  s_mov_b64 exec, -1
  s_cmp_ge_u32 s22, 64
  s_cbranch_scc1 Lfin_232
Lslow_230:
  s_cmp_eq_u32 s25, 1
  s_cbranch_scc1 Lhv_235
  s_and_b32 s37, s22, 1
  s_lshl_b32 s37, s37, 10
  s_add_u32 s37, s37, 0x240000
  s_add_i32 s38, s22, 1
  s_max_i32 s38, s38, 0
Lsp_237:
  s_add_u32 s24, s24, 1
  s_cmp_gt_u32 s24, 300000
  s_cbranch_scc1 Lfail_236
  buffer_load_dword v10, v9, s[4:7], s37 offen sc1
  s_waitcnt vmcnt(0)
  v_cmp_gt_u32 vcc, s38, v10
  s_cbranch_vccz Lrok_238
  s_sleep 2
  s_branch Lsp_237
Lrok_238:
  s_mul_i32 s42, s22, 40960
  s_add_u32 s42, s42, s29
  s_mov_b32 s43, s45
  s_add_u32 s42, s42, s35
  s_add_u32 s43, s43, s35
  s_add_u32 m0, s43, 0
  s_nop 0
  buffer_load_dwordx4 v5, s[4:7], s42 offen offset:0 sc1 lds
  buffer_load_dwordx4 v5, s[4:7], s42 offen offset:1024 sc1 lds
  buffer_load_dwordx4 v5, s[4:7], s42 offen offset:2048 sc1 lds
  buffer_load_dwordx4 v5, s[4:7], s42 offen offset:3072 sc1 lds
  s_add_u32 m0, s43, 4096
  s_add_u32 s42, s42, 4096
  buffer_load_dwordx4 v5, s[4:7], s42 offen offset:0 sc1 lds
  buffer_load_dwordx4 v5, s[4:7], s42 offen offset:1024 sc1 lds
  buffer_load_dwordx4 v5, s[4:7], s42 offen offset:2048 sc1 lds
  buffer_load_dwordx4 v5, s[4:7], s42 offen offset:3072 sc1 lds
  s_add_u32 m0, s43, 8192
  s_add_u32 s42, s42, 4096
  buffer_load_dwordx4 v5, s[4:7], s42 offen offset:0 sc1 lds
  buffer_load_dwordx4 v5, s[4:7], s42 offen offset:1024 sc1 lds
  s_waitcnt vmcnt(0)
Lhv_235:
  s_barrier
  v_add_u32 v6, s45, v5
  ds_read_b128 v[64:67], v6 offset:0
  ds_read_b128 v[68:71], v6 offset:2048
  ds_read_b128 v[72:75], v6 offset:4096
  s_cmp_lt_u32 s22, 52
  s_cselect_b32 s44, 1, 4
  s_add_u32 s44, s44, s22
  s_and_b32 s37, s44, 1
  s_lshl_b32 s37, s37, 10
  s_add_u32 s37, s37, 0x240000
  buffer_load_dword v10, v9, s[4:7], s37 offen sc1
  s_mul_i32 s39, s22, 98304
  s_add_u32 s39, s39, s30
  ds_read_b128 v[76:79], v6 offset:6144
  s_waitcnt lgkmcnt(3)
  v_mfma_f32_16x16x32_bf16 v[32:35], a[0:3], v[64:67], v[112:115]
  v_mfma_f32_16x16x32_bf16 v[36:39], a[4:7], v[64:67], v[116:119]
  v_mfma_f32_16x16x32_bf16 v[40:43], a[8:11], v[64:67], v[120:123]
  v_mfma_f32_16x16x32_bf16 v[44:47], a[12:15], v[64:67], v[124:127]
  ds_read_b128 v[64:67], v6 offset:8192
  s_waitcnt lgkmcnt(3)
  v_mfma_f32_16x16x32_bf16 v[32:35], a[16:19], v[68:71], v[32:35]
  v_mfma_f32_16x16x32_bf16 v[36:39], a[20:23], v[68:71], v[36:39]
  v_mfma_f32_16x16x32_bf16 v[40:43], a[24:27], v[68:71], v[40:43]
  v_mfma_f32_16x16x32_bf16 v[44:47], a[28:31], v[68:71], v[44:47]
  ds_read_b128 v[68:71], v6 offset:10240
  s_waitcnt lgkmcnt(3)
  v_mfma_f32_16x16x32_bf16 v[32:35], a[32:35], v[72:75], v[32:35]
  v_mfma_f32_16x16x32_bf16 v[36:39], a[36:39], v[72:75], v[36:39]
  v_mfma_f32_16x16x32_bf16 v[40:43], a[40:43], v[72:75], v[40:43]
  v_mfma_f32_16x16x32_bf16 v[44:47], a[44:47], v[72:75], v[44:47]
  ds_read_b128 v[72:75], v6 offset:12288
  s_waitcnt lgkmcnt(3)
  v_mfma_f32_16x16x32_bf16 v[32:35], a[48:51], v[76:79], v[32:35]
  v_mfma_f32_16x16x32_bf16 v[36:39], a[52:55], v[76:79], v[36:39]
  v_mfma_f32_16x16x32_bf16 v[40:43], a[56:59], v[76:79], v[40:43]
  v_mfma_f32_16x16x32_bf16 v[44:47], a[60:63], v[76:79], v[44:47]
  ds_read_b128 v[76:79], v6 offset:14336
  s_waitcnt lgkmcnt(3)
  v_mfma_f32_16x16x32_bf16 v[32:35], a[64:67], v[64:67], v[32:35]
  v_mfma_f32_16x16x32_bf16 v[36:39], a[68:71], v[64:67], v[36:39]
  v_mfma_f32_16x16x32_bf16 v[40:43], a[72:75], v[64:67], v[40:43]
  v_mfma_f32_16x16x32_bf16 v[44:47], a[76:79], v[64:67], v[44:47]
  ds_read_b128 v[64:67], v6 offset:16384
  s_waitcnt lgkmcnt(3)
  v_mfma_f32_16x16x32_bf16 v[32:35], a[80:83], v[68:71], v[32:35]
  v_mfma_f32_16x16x32_bf16 v[36:39], a[84:87], v[68:71], v[36:39]
  v_mfma_f32_16x16x32_bf16 v[40:43], a[88:91], v[68:71], v[40:43]
  v_mfma_f32_16x16x32_bf16 v[44:47], a[92:95], v[68:71], v[44:47]
  ds_read_b128 v[68:71], v6 offset:18432
  s_waitcnt lgkmcnt(3)
  v_mfma_f32_16x16x32_bf16 v[32:35], a[96:99], v[72:75], v[32:35]
  v_mfma_f32_16x16x32_bf16 v[36:39], a[100:103], v[72:75], v[36:39]
  v_mfma_f32_16x16x32_bf16 v[40:43], a[104:107], v[72:75], v[40:43]
  v_mfma_f32_16x16x32_bf16 v[44:47], a[108:111], v[72:75], v[44:47]
  ds_read_b128 v[72:75], v6 offset:20480
  s_waitcnt lgkmcnt(3)
  v_mfma_f32_16x16x32_bf16 v[32:35], a[112:115], v[76:79], v[32:35]
  v_mfma_f32_16x16x32_bf16 v[36:39], a[116:119], v[76:79], v[36:39]
  v_mfma_f32_16x16x32_bf16 v[40:43], a[120:123], v[76:79], v[40:43]
  v_mfma_f32_16x16x32_bf16 v[44:47], a[124:127], v[76:79], v[44:47]
  ds_read_b128 v[76:79], v6 offset:22528
  s_waitcnt lgkmcnt(3)
  v_mfma_f32_16x16x32_bf16 v[32:35], a[128:131], v[64:67], v[32:35]
  v_mfma_f32_16x16x32_bf16 v[36:39], a[132:135], v[64:67], v[36:39]
  v_mfma_f32_16x16x32_bf16 v[40:43], a[136:139], v[64:67], v[40:43]
  v_mfma_f32_16x16x32_bf16 v[44:47], a[140:143], v[64:67], v[44:47]
  ds_read_b128 v[64:67], v6 offset:24576
  s_waitcnt lgkmcnt(3)
  v_mfma_f32_16x16x32_bf16 v[32:35], a[144:147], v[68:71], v[32:35]
  v_mfma_f32_16x16x32_bf16 v[36:39], a[148:151], v[68:71], v[36:39]
  v_mfma_f32_16x16x32_bf16 v[40:43], a[152:155], v[68:71], v[40:43]
  v_mfma_f32_16x16x32_bf16 v[44:47], a[156:159], v[68:71], v[44:47]
  ds_read_b128 v[68:71], v6 offset:26624
  s_waitcnt lgkmcnt(3)
  v_mfma_f32_16x16x32_bf16 v[32:35], a[160:163], v[72:75], v[32:35]
  v_mfma_f32_16x16x32_bf16 v[36:39], a[164:167], v[72:75], v[36:39]
  v_mfma_f32_16x16x32_bf16 v[40:43], a[168:171], v[72:75], v[40:43]
  v_mfma_f32_16x16x32_bf16 v[44:47], a[172:175], v[72:75], v[44:47]
  ds_read_b128 v[72:75], v6 offset:28672
  s_waitcnt lgkmcnt(3)
  v_mfma_f32_16x16x32_bf16 v[32:35], a[176:179], v[76:79], v[32:35]
  v_mfma_f32_16x16x32_bf16 v[36:39], a[180:183], v[76:79], v[36:39]
  v_mfma_f32_16x16x32_bf16 v[40:43], a[184:187], v[76:79], v[40:43]
  v_mfma_f32_16x16x32_bf16 v[44:47], a[188:191], v[76:79], v[44:47]
  ds_read_b128 v[76:79], v6 offset:30720
  s_waitcnt lgkmcnt(3)
  v_mfma_f32_16x16x32_bf16 v[32:35], a[192:195], v[64:67], v[32:35]
  v_mfma_f32_16x16x32_bf16 v[36:39], a[196:199], v[64:67], v[36:39]
  v_mfma_f32_16x16x32_bf16 v[40:43], a[200:203], v[64:67], v[40:43]
  v_mfma_f32_16x16x32_bf16 v[44:47], a[204:207], v[64:67], v[44:47]
  ds_read_b128 v[64:67], v6 offset:32768
  s_waitcnt lgkmcnt(3)
  v_mfma_f32_16x16x32_bf16 v[32:35], a[208:211], v[68:71], v[32:35]
  v_mfma_f32_16x16x32_bf16 v[36:39], a[212:215], v[68:71], v[36:39]
  v_mfma_f32_16x16x32_bf16 v[40:43], a[216:219], v[68:71], v[40:43]
  v_mfma_f32_16x16x32_bf16 v[44:47], a[220:223], v[68:71], v[44:47]
  s_waitcnt vmcnt(0)
  s_branch Lmid_231
Lfast_239:
  s_waitcnt vmcnt(3)
  s_barrier
  v_add_u32 v6, s45, v5
  ds_read_b128 v[64:67], v6 offset:0
  ds_read_b128 v[68:71], v6 offset:2048
  ds_read_b128 v[72:75], v6 offset:4096
  s_cmp_lt_u32 s22, 52
  s_cselect_b32 s44, 1, 4
  s_add_u32 s44, s44, s22
  s_and_b32 s37, s44, 1
  s_lshl_b32 s37, s37, 10
  s_add_u32 s37, s37, 0x240000
  buffer_load_dword v10, v9, s[4:7], s37 offen sc1
  s_mul_i32 s39, s22, 98304
  s_add_u32 s39, s39, s30
  ds_read_b128 v[76:79], v6 offset:6144
  s_waitcnt lgkmcnt(3)
  v_mfma_f32_16x16x32_bf16 v[32:35], a[0:3], v[64:67], v[112:115]
  v_mul_f32 v96, v48, v48
  v_mul_f32 v97, v49, v49
  v_mfma_f32_16x16x32_bf16 v[36:39], a[4:7], v[64:67], v[116:119]
  v_fma_f32 v96, v96, s41, v11
  v_fma_f32 v97, v97, s41, v11
  v_mfma_f32_16x16x32_bf16 v[40:43], a[8:11], v[64:67], v[120:123]
  v_mul_f32 v96, v96, v48
  v_mul_f32 v97, v97, v49
  v_mfma_f32_16x16x32_bf16 v[44:47], a[12:15], v[64:67], v[124:127]
  v_exp_f32 v96, v96
  v_exp_f32 v97, v97
  ds_read_b128 v[64:67], v6 offset:8192
  v_add_f32 v96, 1.0, v96
  v_add_f32 v97, 1.0, v97
  s_waitcnt lgkmcnt(3)
  v_rcp_f32 v96, v96
  v_rcp_f32 v97, v97
  v_mfma_f32_16x16x32_bf16 v[32:35], a[16:19], v[68:71], v[32:35]
  v_mul_f32 v48, v48, v96
  v_mul_f32 v49, v49, v97
  v_mfma_f32_16x16x32_bf16 v[36:39], a[20:23], v[68:71], v[36:39]
  v_mul_f32 v96, v50, v50
  v_mul_f32 v97, v51, v51
  v_mfma_f32_16x16x32_bf16 v[40:43], a[24:27], v[68:71], v[40:43]
  v_fma_f32 v96, v96, s41, v11
  v_fma_f32 v97, v97, s41, v11
  v_mfma_f32_16x16x32_bf16 v[44:47], a[28:31], v[68:71], v[44:47]
  v_mul_f32 v96, v96, v50
  v_mul_f32 v97, v97, v51
  ds_read_b128 v[68:71], v6 offset:10240
  v_exp_f32 v96, v96
  v_exp_f32 v97, v97
  s_waitcnt lgkmcnt(3)
  v_add_f32 v96, 1.0, v96
  v_add_f32 v97, 1.0, v97
  v_mfma_f32_16x16x32_bf16 v[32:35], a[32:35], v[72:75], v[32:35]
  v_rcp_f32 v96, v96
  v_rcp_f32 v97, v97
  v_mfma_f32_16x16x32_bf16 v[36:39], a[36:39], v[72:75], v[36:39]
  v_mul_f32 v50, v50, v96
  v_mul_f32 v51, v51, v97
  v_mfma_f32_16x16x32_bf16 v[40:43], a[40:43], v[72:75], v[40:43]
  v_mul_f32 v96, v52, v52
  v_mul_f32 v97, v53, v53
  v_mfma_f32_16x16x32_bf16 v[44:47], a[44:47], v[72:75], v[44:47]
  v_fma_f32 v96, v96, s41, v11
  v_fma_f32 v97, v97, s41, v11
  ds_read_b128 v[72:75], v6 offset:12288
  v_mul_f32 v96, v96, v52
  v_mul_f32 v97, v97, v53
  s_waitcnt lgkmcnt(3)
  v_exp_f32 v96, v96
  v_exp_f32 v97, v97
  v_mfma_f32_16x16x32_bf16 v[32:35], a[48:51], v[76:79], v[32:35]
  v_add_f32 v96, 1.0, v96
  v_add_f32 v97, 1.0, v97
  v_mfma_f32_16x16x32_bf16 v[36:39], a[52:55], v[76:79], v[36:39]
  v_rcp_f32 v96, v96
  v_rcp_f32 v97, v97
  v_mfma_f32_16x16x32_bf16 v[40:43], a[56:59], v[76:79], v[40:43]
  v_mul_f32 v52, v52, v96
  v_mul_f32 v53, v53, v97
  v_mfma_f32_16x16x32_bf16 v[44:47], a[60:63], v[76:79], v[44:47]
  v_mul_f32 v96, v54, v54
  v_mul_f32 v97, v55, v55
  ds_read_b128 v[76:79], v6 offset:14336
  v_fma_f32 v96, v96, s41, v11
  v_fma_f32 v97, v97, s41, v11
  s_waitcnt lgkmcnt(3)
  v_mul_f32 v96, v96, v54
  v_mul_f32 v97, v97, v55
  v_mfma_f32_16x16x32_bf16 v[32:35], a[64:67], v[64:67], v[32:35]
  v_exp_f32 v96, v96
  v_exp_f32 v97, v97
  v_mfma_f32_16x16x32_bf16 v[36:39], a[68:71], v[64:67], v[36:39]
  v_add_f32 v96, 1.0, v96
  v_add_f32 v97, 1.0, v97
  v_mfma_f32_16x16x32_bf16 v[40:43], a[72:75], v[64:67], v[40:43]
  v_rcp_f32 v96, v96
  v_rcp_f32 v97, v97
  v_mfma_f32_16x16x32_bf16 v[44:47], a[76:79], v[64:67], v[44:47]
  v_mul_f32 v54, v54, v96
  v_mul_f32 v55, v55, v97
  ds_read_b128 v[64:67], v6 offset:16384
  v_mul_f32 v96, v56, v56
  v_mul_f32 v97, v57, v57
  s_waitcnt lgkmcnt(3)
  v_fma_f32 v96, v96, s41, v11
  v_fma_f32 v97, v97, s41, v11
  v_mfma_f32_16x16x32_bf16 v[32:35], a[80:83], v[68:71], v[32:35]
  v_mul_f32 v96, v96, v56
  v_mul_f32 v97, v97, v57
  v_mfma_f32_16x16x32_bf16 v[36:39], a[84:87], v[68:71], v[36:39]
  v_exp_f32 v96, v96
  v_exp_f32 v97, v97
  v_mfma_f32_16x16x32_bf16 v[40:43], a[88:91], v[68:71], v[40:43]
  v_add_f32 v96, 1.0, v96
  v_add_f32 v97, 1.0, v97
  v_mfma_f32_16x16x32_bf16 v[44:47], a[92:95], v[68:71], v[44:47]
  v_rcp_f32 v96, v96
  v_rcp_f32 v97, v97
  ds_read_b128 v[68:71], v6 offset:18432
  v_mul_f32 v56, v56, v96
  v_mul_f32 v57, v57, v97
  s_waitcnt lgkmcnt(3)
  v_mul_f32 v96, v58, v58
  v_mul_f32 v97, v59, v59
  v_mfma_f32_16x16x32_bf16 v[32:35], a[96:99], v[72:75], v[32:35]
  v_fma_f32 v96, v96, s41, v11
  v_fma_f32 v97, v97, s41, v11
  v_mfma_f32_16x16x32_bf16 v[36:39], a[100:103], v[72:75], v[36:39]
  v_mul_f32 v96, v96, v58
  v_mul_f32 v97, v97, v59
  v_mfma_f32_16x16x32_bf16 v[40:43], a[104:107], v[72:75], v[40:43]
  v_exp_f32 v96, v96
  v_exp_f32 v97, v97
  v_mfma_f32_16x16x32_bf16 v[44:47], a[108:111], v[72:75], v[44:47]
  v_add_f32 v96, 1.0, v96
  v_add_f32 v97, 1.0, v97
  ds_read_b128 v[72:75], v6 offset:20480
  v_rcp_f32 v96, v96
  v_rcp_f32 v97, v97
  s_waitcnt lgkmcnt(3)
  v_mul_f32 v58, v58, v96
  v_mul_f32 v59, v59, v97
  v_mfma_f32_16x16x32_bf16 v[32:35], a[112:115], v[76:79], v[32:35]
  v_mul_f32 v96, v60, v60
  v_mul_f32 v97, v61, v61
  v_mfma_f32_16x16x32_bf16 v[36:39], a[116:119], v[76:79], v[36:39]
  v_fma_f32 v96, v96, s41, v11
  v_fma_f32 v97, v97, s41, v11
  v_mfma_f32_16x16x32_bf16 v[40:43], a[120:123], v[76:79], v[40:43]
  v_mul_f32 v96, v96, v60
  v_mul_f32 v97, v97, v61
  v_mfma_f32_16x16x32_bf16 v[44:47], a[124:127], v[76:79], v[44:47]
  v_exp_f32 v96, v96
  v_exp_f32 v97, v97
  ds_read_b128 v[76:79], v6 offset:22528
  v_add_f32 v96, 1.0, v96
  v_add_f32 v97, 1.0, v97
  s_waitcnt lgkmcnt(3)
  v_rcp_f32 v96, v96
  v_rcp_f32 v97, v97
  v_mfma_f32_16x16x32_bf16 v[32:35], a[128:131], v[64:67], v[32:35]
  v_mul_f32 v60, v60, v96
  v_mul_f32 v61, v61, v97
  v_mfma_f32_16x16x32_bf16 v[36:39], a[132:135], v[64:67], v[36:39]
  v_mul_f32 v96, v62, v62
  v_mul_f32 v97, v63, v63
  v_mfma_f32_16x16x32_bf16 v[40:43], a[136:139], v[64:67], v[40:43]
  v_fma_f32 v96, v96, s41, v11
  v_fma_f32 v97, v97, s41, v11
  v_mfma_f32_16x16x32_bf16 v[44:47], a[140:143], v[64:67], v[44:47]
  v_mul_f32 v96, v96, v62
  v_mul_f32 v97, v97, v63
  ds_read_b128 v[64:67], v6 offset:24576
  v_exp_f32 v96, v96
  v_exp_f32 v97, v97
  s_waitcnt lgkmcnt(3)
  v_add_f32 v96, 1.0, v96
  v_add_f32 v97, 1.0, v97
  v_mfma_f32_16x16x32_bf16 v[32:35], a[144:147], v[68:71], v[32:35]
  v_rcp_f32 v96, v96
  v_rcp_f32 v97, v97
  v_mfma_f32_16x16x32_bf16 v[36:39], a[148:151], v[68:71], v[36:39]
  v_mul_f32 v62, v62, v96
  v_mul_f32 v63, v63, v97
  v_mfma_f32_16x16x32_bf16 v[40:43], a[152:155], v[68:71], v[40:43]
  v_cvt_pk_bf16_f32 v88, v48, v56
  v_cvt_pk_bf16_f32 v89, v49, v57
  v_mfma_f32_16x16x32_bf16 v[44:47], a[156:159], v[68:71], v[44:47]
  v_cvt_pk_bf16_f32 v90, v50, v58
  v_cvt_pk_bf16_f32 v91, v51, v59
  ds_read_b128 v[68:71], v6 offset:26624
  v_cvt_pk_bf16_f32 v92, v52, v60
  v_cvt_pk_bf16_f32 v93, v53, v61
  s_waitcnt lgkmcnt(3)
  v_cvt_pk_bf16_f32 v94, v54, v62
  v_cvt_pk_bf16_f32 v95, v55, v63
  v_mfma_f32_16x16x32_bf16 v[32:35], a[160:163], v[72:75], v[32:35]
  buffer_store_dwordx4 v[88:91], v7, s[4:7], s40 offen offset:0 sc1
  buffer_store_dwordx4 v[92:95], v7, s[4:7], s40 offen offset:256 sc1
  v_mfma_f32_16x16x32_bf16 v[36:39], a[164:167], v[72:75], v[36:39]
  v_mfma_f32_16x16x32_bf16 v[40:43], a[168:171], v[72:75], v[40:43]
  v_mfma_f32_16x16x32_bf16 v[44:47], a[172:175], v[72:75], v[44:47]
  ds_read_b128 v[72:75], v6 offset:28672
  s_waitcnt lgkmcnt(3)
  v_mfma_f32_16x16x32_bf16 v[32:35], a[176:179], v[76:79], v[32:35]
  v_mfma_f32_16x16x32_bf16 v[36:39], a[180:183], v[76:79], v[36:39]
  v_mfma_f32_16x16x32_bf16 v[40:43], a[184:187], v[76:79], v[40:43]
  v_mfma_f32_16x16x32_bf16 v[44:47], a[188:191], v[76:79], v[44:47]
  ds_read_b128 v[76:79], v6 offset:30720
  s_waitcnt lgkmcnt(3)
  v_mfma_f32_16x16x32_bf16 v[32:35], a[192:195], v[64:67], v[32:35]
  v_mfma_f32_16x16x32_bf16 v[36:39], a[196:199], v[64:67], v[36:39]
  v_mfma_f32_16x16x32_bf16 v[40:43], a[200:203], v[64:67], v[40:43]
  v_mfma_f32_16x16x32_bf16 v[44:47], a[204:207], v[64:67], v[44:47]
  ds_read_b128 v[64:67], v6 offset:32768
  s_waitcnt lgkmcnt(3)
  v_mfma_f32_16x16x32_bf16 v[32:35], a[208:211], v[68:71], v[32:35]
  v_mfma_f32_16x16x32_bf16 v[36:39], a[212:215], v[68:71], v[36:39]
  v_mfma_f32_16x16x32_bf16 v[40:43], a[216:219], v[68:71], v[40:43]
  v_mfma_f32_16x16x32_bf16 v[44:47], a[220:223], v[68:71], v[44:47]
  s_waitcnt vmcnt(2)
Lmid_231:
  s_add_u32 s40, s39, 1024
  s_mul_i32 s42, s44, 40960
  s_add_u32 s42, s42, s29
  s_sub_u32 s43, 40960, s45
  s_add_u32 s42, s42, s35
  s_add_u32 s43, s43, s35
  s_mov_b32 s25, 1
  s_cmp_ge_u32 s44, 64
  s_cselect_b32 s25, 0, s25
  s_add_i32 s38, s44, 1
  s_max_i32 s38, s38, 0
  s_nop 0
  v_cmp_gt_u32 vcc, s38, v10
  s_cmp_lg_u64 vcc, 0
  s_cselect_b32 s25, 0, s25
  s_cmp_eq_u32 s25, 0
  s_cselect_b32 s42, 0x7ff00000, s42
  ds_read_b128 v[68:71], v6 offset:34816
  s_waitcnt lgkmcnt(3)
  v_mfma_f32_16x16x32_bf16 v[32:35], a[224:227], v[72:75], v[32:35]
  s_add_u32 m0, s43, 0
  s_nop 0
  buffer_load_dwordx4 v5, s[4:7], s42 offen offset:0 sc1 lds
  v_mfma_f32_16x16x32_bf16 v[36:39], a[228:231], v[72:75], v[36:39]
  v_mfma_f32_16x16x32_bf16 v[40:43], a[232:235], v[72:75], v[40:43]
  v_mfma_f32_16x16x32_bf16 v[44:47], a[236:239], v[72:75], v[44:47]
  ds_read_b128 v[72:75], v6 offset:36864
  s_waitcnt lgkmcnt(3)
  v_mfma_f32_16x16x32_bf16 v[32:35], a[240:243], v[76:79], v[32:35]
  buffer_load_dwordx4 v5, s[4:7], s42 offen offset:1024 sc1 lds
  v_mfma_f32_16x16x32_bf16 v[36:39], a[244:247], v[76:79], v[36:39]
  v_mfma_f32_16x16x32_bf16 v[40:43], a[248:251], v[76:79], v[40:43]
  v_mfma_f32_16x16x32_bf16 v[44:47], a[252:255], v[76:79], v[44:47]
  ds_read_b128 v[76:79], v6 offset:38912
  s_waitcnt lgkmcnt(3)
  v_mfma_f32_16x16x32_bf16 v[32:35], v[192:195], v[64:67], v[32:35]
  buffer_load_dwordx4 v5, s[4:7], s42 offen offset:2048 sc1 lds
  v_mfma_f32_16x16x32_bf16 v[36:39], v[196:199], v[64:67], v[36:39]
  v_mfma_f32_16x16x32_bf16 v[40:43], v[200:203], v[64:67], v[40:43]
  v_mfma_f32_16x16x32_bf16 v[44:47], v[204:207], v[64:67], v[44:47]
  ds_read_b128 v[64:67], v6 offset:1024
  s_waitcnt lgkmcnt(3)
  v_mfma_f32_16x16x32_bf16 v[32:35], v[208:211], v[68:71], v[32:35]
  buffer_load_dwordx4 v5, s[4:7], s42 offen offset:3072 sc1 lds
  v_mfma_f32_16x16x32_bf16 v[36:39], v[212:215], v[68:71], v[36:39]
  v_mfma_f32_16x16x32_bf16 v[40:43], v[216:219], v[68:71], v[40:43]
  v_mfma_f32_16x16x32_bf16 v[44:47], v[220:223], v[68:71], v[44:47]
  ds_read_b128 v[68:71], v6 offset:3072
  s_waitcnt lgkmcnt(3)
  v_mfma_f32_16x16x32_bf16 v[32:35], v[224:227], v[72:75], v[32:35]
  s_add_u32 m0, s43, 4096
  s_add_u32 s42, s42, 4096
  buffer_load_dwordx4 v5, s[4:7], s42 offen offset:0 sc1 lds
  v_mfma_f32_16x16x32_bf16 v[36:39], v[228:231], v[72:75], v[36:39]
  v_mfma_f32_16x16x32_bf16 v[40:43], v[232:235], v[72:75], v[40:43]
  v_mfma_f32_16x16x32_bf16 v[44:47], v[236:239], v[72:75], v[44:47]
  ds_read_b128 v[72:75], v6 offset:5120
  s_waitcnt lgkmcnt(3)
  v_mfma_f32_16x16x32_bf16 v[32:35], v[240:243], v[76:79], v[32:35]
  buffer_load_dwordx4 v5, s[4:7], s42 offen offset:1024 sc1 lds
  v_mfma_f32_16x16x32_bf16 v[36:39], v[244:247], v[76:79], v[36:39]
  v_mfma_f32_16x16x32_bf16 v[40:43], v[248:251], v[76:79], v[40:43]
  v_mfma_f32_16x16x32_bf16 v[44:47], v[252:255], v[76:79], v[44:47]
  ds_read_b128 v[76:79], v6 offset:7168
  s_waitcnt lgkmcnt(3)
  v_mfma_f32_16x16x32_bf16 v[48:51], a[0:3], v[64:67], v[112:115]
  buffer_load_dwordx4 v5, s[4:7], s42 offen offset:2048 sc1 lds
  v_mfma_f32_16x16x32_bf16 v[52:55], a[4:7], v[64:67], v[116:119]
  v_mfma_f32_16x16x32_bf16 v[56:59], a[8:11], v[64:67], v[120:123]
  v_mfma_f32_16x16x32_bf16 v[60:63], a[12:15], v[64:67], v[124:127]
  ds_read_b128 v[64:67], v6 offset:9216
  s_waitcnt lgkmcnt(3)
  v_mfma_f32_16x16x32_bf16 v[48:51], a[16:19], v[68:71], v[48:51]
  buffer_load_dwordx4 v5, s[4:7], s42 offen offset:3072 sc1 lds
  v_mfma_f32_16x16x32_bf16 v[52:55], a[20:23], v[68:71], v[52:55]
  v_mfma_f32_16x16x32_bf16 v[56:59], a[24:27], v[68:71], v[56:59]
  v_mfma_f32_16x16x32_bf16 v[60:63], a[28:31], v[68:71], v[60:63]
  ds_read_b128 v[68:71], v6 offset:11264
  s_waitcnt lgkmcnt(3)
  v_mfma_f32_16x16x32_bf16 v[48:51], a[32:35], v[72:75], v[48:51]
  s_add_u32 m0, s43, 8192
  s_add_u32 s42, s42, 4096
  buffer_load_dwordx4 v5, s[4:7], s42 offen offset:0 sc1 lds
  v_mfma_f32_16x16x32_bf16 v[52:55], a[36:39], v[72:75], v[52:55]
  v_mfma_f32_16x16x32_bf16 v[56:59], a[40:43], v[72:75], v[56:59]
  v_mfma_f32_16x16x32_bf16 v[60:63], a[44:47], v[72:75], v[60:63]
  ds_read_b128 v[72:75], v6 offset:13312
  s_waitcnt lgkmcnt(3)
  v_mfma_f32_16x16x32_bf16 v[48:51], a[48:51], v[76:79], v[48:51]
  buffer_load_dwordx4 v5, s[4:7], s42 offen offset:1024 sc1 lds
  v_mfma_f32_16x16x32_bf16 v[52:55], a[52:55], v[76:79], v[52:55]
  v_mfma_f32_16x16x32_bf16 v[56:59], a[56:59], v[76:79], v[56:59]
  v_mfma_f32_16x16x32_bf16 v[60:63], a[60:63], v[76:79], v[60:63]
  s_waitcnt vmcnt(10)
  s_mov_b32 s26, s46
  v_mov_b32 v2, s26
  s_mov_b64 exec, 1
  buffer_store_dword v2, v8, s[4:7], s33 offen sc1
  s_mov_b64 exec, -1
  ds_read_b128 v[76:79], v6 offset:15360
  s_waitcnt lgkmcnt(3)
  v_mfma_f32_16x16x32_bf16 v[48:51], a[64:67], v[64:67], v[48:51]
  v_mfma_f32_16x16x32_bf16 v[52:55], a[68:71], v[64:67], v[52:55]
  v_mfma_f32_16x16x32_bf16 v[56:59], a[72:75], v[64:67], v[56:59]
  v_mfma_f32_16x16x32_bf16 v[60:63], a[76:79], v[64:67], v[60:63]
  ds_read_b128 v[64:67], v6 offset:17408
  s_waitcnt lgkmcnt(3)
  v_mfma_f32_16x16x32_bf16 v[48:51], a[80:83], v[68:71], v[48:51]
  v_mfma_f32_16x16x32_bf16 v[52:55], a[84:87], v[68:71], v[52:55]
  v_mfma_f32_16x16x32_bf16 v[56:59], a[88:91], v[68:71], v[56:59]
  v_mul_f32 v96, v32, v32
  v_mul_f32 v97, v33, v33
  v_mfma_f32_16x16x32_bf16 v[60:63], a[92:95], v[68:71], v[60:63]
  v_fma_f32 v96, v96, s41, v11
  v_fma_f32 v97, v97, s41, v11
  ds_read_b128 v[68:71], v6 offset:19456
  v_mul_f32 v96, v96, v32
  v_mul_f32 v97, v97, v33
  s_waitcnt lgkmcnt(3)
  v_exp_f32 v96, v96
  v_exp_f32 v97, v97
  v_mfma_f32_16x16x32_bf16 v[48:51], a[96:99], v[72:75], v[48:51]
  v_add_f32 v96, 1.0, v96
  v_add_f32 v97, 1.0, v97
  v_mfma_f32_16x16x32_bf16 v[52:55], a[100:103], v[72:75], v[52:55]
  v_rcp_f32 v96, v96
  v_rcp_f32 v97, v97
  v_mfma_f32_16x16x32_bf16 v[56:59], a[104:107], v[72:75], v[56:59]
  v_mul_f32 v32, v32, v96
  v_mul_f32 v33, v33, v97
  v_mfma_f32_16x16x32_bf16 v[60:63], a[108:111], v[72:75], v[60:63]
  v_mul_f32 v96, v34, v34
  v_mul_f32 v97, v35, v35
  ds_read_b128 v[72:75], v6 offset:21504
  v_fma_f32 v96, v96, s41, v11
  v_fma_f32 v97, v97, s41, v11
  s_waitcnt lgkmcnt(3)
  v_mul_f32 v96, v96, v34
  v_mul_f32 v97, v97, v35
  v_mfma_f32_16x16x32_bf16 v[48:51], a[112:115], v[76:79], v[48:51]
  v_exp_f32 v96, v96
  v_exp_f32 v97, v97
  v_mfma_f32_16x16x32_bf16 v[52:55], a[116:119], v[76:79], v[52:55]
  v_add_f32 v96, 1.0, v96
  v_add_f32 v97, 1.0, v97
  v_mfma_f32_16x16x32_bf16 v[56:59], a[120:123], v[76:79], v[56:59]
  v_rcp_f32 v96, v96
  v_rcp_f32 v97, v97
  v_mfma_f32_16x16x32_bf16 v[60:63], a[124:127], v[76:79], v[60:63]
  v_mul_f32 v34, v34, v96
  v_mul_f32 v35, v35, v97
  ds_read_b128 v[76:79], v6 offset:23552
  v_mul_f32 v96, v36, v36
  v_mul_f32 v97, v37, v37
  s_waitcnt lgkmcnt(3)
  v_fma_f32 v96, v96, s41, v11
  v_fma_f32 v97, v97, s41, v11
  v_mfma_f32_16x16x32_bf16 v[48:51], a[128:131], v[64:67], v[48:51]
  v_mul_f32 v96, v96, v36
  v_mul_f32 v97, v97, v37
  v_mfma_f32_16x16x32_bf16 v[52:55], a[132:135], v[64:67], v[52:55]
  v_exp_f32 v96, v96
  v_exp_f32 v97, v97
  v_mfma_f32_16x16x32_bf16 v[56:59], a[136:139], v[64:67], v[56:59]
  v_add_f32 v96, 1.0, v96
  v_add_f32 v97, 1.0, v97
  v_mfma_f32_16x16x32_bf16 v[60:63], a[140:143], v[64:67], v[60:63]
  v_rcp_f32 v96, v96
  v_rcp_f32 v97, v97
  ds_read_b128 v[64:67], v6 offset:25600
  v_mul_f32 v36, v36, v96
  v_mul_f32 v37, v37, v97
  s_waitcnt lgkmcnt(3)
  v_mul_f32 v96, v38, v38
  v_mul_f32 v97, v39, v39
  v_mfma_f32_16x16x32_bf16 v[48:51], a[144:147], v[68:71], v[48:51]
  v_fma_f32 v96, v96, s41, v11
  v_fma_f32 v97, v97, s41, v11
  v_mfma_f32_16x16x32_bf16 v[52:55], a[148:151], v[68:71], v[52:55]
  v_mul_f32 v96, v96, v38
  v_mul_f32 v97, v97, v39
  v_mfma_f32_16x16x32_bf16 v[56:59], a[152:155], v[68:71], v[56:59]
  v_exp_f32 v96, v96
  v_exp_f32 v97, v97
  v_mfma_f32_16x16x32_bf16 v[60:63], a[156:159], v[68:71], v[60:63]
  v_add_f32 v96, 1.0, v96
  v_add_f32 v97, 1.0, v97
  ds_read_b128 v[68:71], v6 offset:27648
  v_rcp_f32 v96, v96
  v_rcp_f32 v97, v97
  s_waitcnt lgkmcnt(3)
  v_mul_f32 v38, v38, v96
  v_mul_f32 v39, v39, v97
  v_mfma_f32_16x16x32_bf16 v[48:51], a[160:163], v[72:75], v[48:51]
  v_mul_f32 v96, v40, v40
  v_mul_f32 v97, v41, v41
  v_mfma_f32_16x16x32_bf16 v[52:55], a[164:167], v[72:75], v[52:55]
  v_fma_f32 v96, v96, s41, v11
  v_fma_f32 v97, v97, s41, v11
  v_mfma_f32_16x16x32_bf16 v[56:59], a[168:171], v[72:75], v[56:59]
  v_mul_f32 v96, v96, v40
  v_mul_f32 v97, v97, v41
  v_mfma_f32_16x16x32_bf16 v[60:63], a[172:175], v[72:75], v[60:63]
  v_exp_f32 v96, v96
  v_exp_f32 v97, v97
  ds_read_b128 v[72:75], v6 offset:29696
  v_add_f32 v96, 1.0, v96
  v_add_f32 v97, 1.0, v97
  s_waitcnt lgkmcnt(3)
  v_rcp_f32 v96, v96
  v_rcp_f32 v97, v97
  v_mfma_f32_16x16x32_bf16 v[48:51], a[176:179], v[76:79], v[48:51]
  v_mul_f32 v40, v40, v96
  v_mul_f32 v41, v41, v97
  v_mfma_f32_16x16x32_bf16 v[52:55], a[180:183], v[76:79], v[52:55]
  v_mul_f32 v96, v42, v42
  v_mul_f32 v97, v43, v43
  v_mfma_f32_16x16x32_bf16 v[56:59], a[184:187], v[76:79], v[56:59]
  v_fma_f32 v96, v96, s41, v11
  v_fma_f32 v97, v97, s41, v11
  v_mfma_f32_16x16x32_bf16 v[60:63], a[188:191], v[76:79], v[60:63]
  v_mul_f32 v96, v96, v42
  v_mul_f32 v97, v97, v43
  ds_read_b128 v[76:79], v6 offset:31744
  v_exp_f32 v96, v96
  v_exp_f32 v97, v97
  s_waitcnt lgkmcnt(3)
  v_add_f32 v96, 1.0, v96
  v_add_f32 v97, 1.0, v97
  v_mfma_f32_16x16x32_bf16 v[48:51], a[192:195], v[64:67], v[48:51]
  v_rcp_f32 v96, v96
  v_rcp_f32 v97, v97
  v_mfma_f32_16x16x32_bf16 v[52:55], a[196:199], v[64:67], v[52:55]
  v_mul_f32 v42, v42, v96
  v_mul_f32 v43, v43, v97
  v_mfma_f32_16x16x32_bf16 v[56:59], a[200:203], v[64:67], v[56:59]
  v_mul_f32 v96, v44, v44
  v_mul_f32 v97, v45, v45
  v_mfma_f32_16x16x32_bf16 v[60:63], a[204:207], v[64:67], v[60:63]
  v_fma_f32 v96, v96, s41, v11
  v_fma_f32 v97, v97, s41, v11
  ds_read_b128 v[64:67], v6 offset:33792
  v_mul_f32 v96, v96, v44
  v_mul_f32 v97, v97, v45
  s_waitcnt lgkmcnt(3)
  v_exp_f32 v96, v96
  v_exp_f32 v97, v97
  v_mfma_f32_16x16x32_bf16 v[48:51], a[208:211], v[68:71], v[48:51]
  v_add_f32 v96, 1.0, v96
  v_add_f32 v97, 1.0, v97
  v_mfma_f32_16x16x32_bf16 v[52:55], a[212:215], v[68:71], v[52:55]
  v_rcp_f32 v96, v96
  v_rcp_f32 v97, v97
  v_mfma_f32_16x16x32_bf16 v[56:59], a[216:219], v[68:71], v[56:59]
  v_mul_f32 v44, v44, v96
  v_mul_f32 v45, v45, v97
  v_mfma_f32_16x16x32_bf16 v[60:63], a[220:223], v[68:71], v[60:63]
  v_mul_f32 v96, v46, v46
  v_mul_f32 v97, v47, v47
  ds_read_b128 v[68:71], v6 offset:35840
  v_fma_f32 v96, v96, s41, v11
  v_fma_f32 v97, v97, s41, v11
  s_waitcnt lgkmcnt(3)
  v_mul_f32 v96, v96, v46
  v_mul_f32 v97, v97, v47
  v_mfma_f32_16x16x32_bf16 v[48:51], a[224:227], v[72:75], v[48:51]
  v_exp_f32 v96, v96
  v_exp_f32 v97, v97
  v_mfma_f32_16x16x32_bf16 v[52:55], a[228:231], v[72:75], v[52:55]
  v_add_f32 v96, 1.0, v96
  v_add_f32 v97, 1.0, v97
  v_mfma_f32_16x16x32_bf16 v[56:59], a[232:235], v[72:75], v[56:59]
  v_rcp_f32 v96, v96
  v_rcp_f32 v97, v97
  v_mfma_f32_16x16x32_bf16 v[60:63], a[236:239], v[72:75], v[60:63]
  v_mul_f32 v46, v46, v96
  v_mul_f32 v47, v47, v97
  ds_read_b128 v[72:75], v6 offset:37888
  v_cvt_pk_bf16_f32 v80, v32, v40
  v_cvt_pk_bf16_f32 v81, v33, v41
  s_waitcnt lgkmcnt(3)
  v_cvt_pk_bf16_f32 v82, v34, v42
  v_cvt_pk_bf16_f32 v83, v35, v43
  v_mfma_f32_16x16x32_bf16 v[48:51], a[240:243], v[76:79], v[48:51]
  v_cvt_pk_bf16_f32 v84, v36, v44
  v_cvt_pk_bf16_f32 v85, v37, v45
  v_mfma_f32_16x16x32_bf16 v[52:55], a[244:247], v[76:79], v[52:55]
  v_cvt_pk_bf16_f32 v86, v38, v46
  v_cvt_pk_bf16_f32 v87, v39, v47
  v_mfma_f32_16x16x32_bf16 v[56:59], a[248:251], v[76:79], v[56:59]
  buffer_store_dwordx4 v[80:83], v7, s[4:7], s39 offen offset:0 sc1
  buffer_store_dwordx4 v[84:87], v7, s[4:7], s39 offen offset:256 sc1
  v_mfma_f32_16x16x32_bf16 v[60:63], a[252:255], v[76:79], v[60:63]
  ds_read_b128 v[76:79], v6 offset:39936
  s_waitcnt lgkmcnt(3)
  v_mfma_f32_16x16x32_bf16 v[48:51], v[192:195], v[64:67], v[48:51]
  v_mfma_f32_16x16x32_bf16 v[52:55], v[196:199], v[64:67], v[52:55]
  v_mfma_f32_16x16x32_bf16 v[56:59], v[200:203], v[64:67], v[56:59]
  v_mfma_f32_16x16x32_bf16 v[60:63], v[204:207], v[64:67], v[60:63]
  s_waitcnt lgkmcnt(2)
  v_mfma_f32_16x16x32_bf16 v[48:51], v[208:211], v[68:71], v[48:51]
  v_mfma_f32_16x16x32_bf16 v[52:55], v[212:215], v[68:71], v[52:55]
  v_mfma_f32_16x16x32_bf16 v[56:59], v[216:219], v[68:71], v[56:59]
  v_mfma_f32_16x16x32_bf16 v[60:63], v[220:223], v[68:71], v[60:63]
  s_waitcnt lgkmcnt(1)
  v_mfma_f32_16x16x32_bf16 v[48:51], v[224:227], v[72:75], v[48:51]
  v_mfma_f32_16x16x32_bf16 v[52:55], v[228:231], v[72:75], v[52:55]
  v_mfma_f32_16x16x32_bf16 v[56:59], v[232:235], v[72:75], v[56:59]
  v_mfma_f32_16x16x32_bf16 v[60:63], v[236:239], v[72:75], v[60:63]
  s_waitcnt lgkmcnt(0)
  v_mfma_f32_16x16x32_bf16 v[48:51], v[240:243], v[76:79], v[48:51]
  v_mfma_f32_16x16x32_bf16 v[52:55], v[244:247], v[76:79], v[52:55]
  v_mfma_f32_16x16x32_bf16 v[56:59], v[248:251], v[76:79], v[56:59]
  v_mfma_f32_16x16x32_bf16 v[60:63], v[252:255], v[76:79], v[60:63]
  s_add_u32 s46, s22, 1
  s_mov_b32 s22, s44
  s_sub_u32 s45, 40960, s45
  s_cmp_eq_u32 s25, 1
  s_cbranch_scc1 Lfast_239
  s_branch Lslowep_233
Lfin_232:
  s_branch Lmain_end
.p2align 6
Lrole_M2:
  s_mov_b32 s8, s52
  s_and_b32 s9, s53, 0xffff
  s_mov_b32 s10, 0x1e0000
  s_mov_b32 s11, 0x20000
  s_mov_b32 s16, s54
  s_and_b32 s17, s55, 0xffff
  s_mov_b32 s18, 0x500
  s_mov_b32 s19, 0x20000
  v_and_b32 v2, 3, v1
  v_lshlrev_b32 v2, 2, v2
Lcw_241:
  s_add_u32 s24, s24, 1
  s_cmp_gt_u32 s24, 300000
  s_cbranch_scc1 Lfail_240
  buffer_load_dword v3, v2, s[12:15], 0 offen offset:128 sc1
  s_waitcnt vmcnt(0)
  v_cmp_eq_u32 vcc, 0, v3
  s_and_b32 s26, vcc_lo, 1
  s_cmp_eq_u32 s26, 0
  s_cbranch_scc1 Lcok_242
  s_sleep 6
  s_branch Lcw_241
Lcok_242:
  v_lshrrev_b32 v2, 3, v1
  v_and_b32 v3, 7, v1
  v_mul_u32_u24 v2, 1280, v2
  v_lshl_add_u32 v2, v3, 4, v2
  v_add_u32 v16, 0, v2
  v_add_u32 v17, 9216, v2
  v_add_u32 v18, 18432, v2
  v_add_u32 v19, 27648, v2
  v_add_u32 v20, 40960, v2
  v_add_u32 v21, 50176, v2
  v_add_u32 v22, 59392, v2
  v_add_u32 v23, 68608, v2
  s_mul_i32 s28, s21, 491520
  s_lshl_b32 s26, s20, 7
  s_add_u32 s28, s28, s26
  s_lshl_b32 s34, s21, 15
  v_lshrrev_b32 v2, 4, v1
  v_lshlrev_b32 v2, 2, v2
  v_bfe_u32 v3, v1, 2, 1
  v_lshl_add_u32 v2, v3, 4, v2
  v_bfe_u32 v3, v1, 3, 1
  v_add_u32 v2, v2, v3
  v_lshlrev_b32 v2, 7, v2
  v_and_b32 v3, 3, v1
  v_lshl_add_u32 v2, v3, 5, v2
  v_add_u32 v4, s34, v2
  s_add_u32 s27, s28, 0x0
  s_add_u32 m0, s34, 0
  s_nop 0
  buffer_load_dwordx4 v16, s[8:11], s27 offen offset:0 lds
  buffer_load_dwordx4 v17, s[8:11], s27 offen offset:1024 lds
  buffer_load_dwordx4 v18, s[8:11], s27 offen offset:2048 lds
  buffer_load_dwordx4 v19, s[8:11], s27 offen offset:3072 lds
  s_add_u32 m0, s34, 4096
  s_nop 0
  buffer_load_dwordx4 v20, s[8:11], s27 offen offset:0 lds
  buffer_load_dwordx4 v21, s[8:11], s27 offen offset:1024 lds
  buffer_load_dwordx4 v22, s[8:11], s27 offen offset:2048 lds
  buffer_load_dwordx4 v23, s[8:11], s27 offen offset:3072 lds
  s_waitcnt vmcnt(0)
  s_waitcnt lgkmcnt(0)
  s_add_u32 s27, s28, 0x14000
  s_add_u32 m0, s34, 8192
  s_nop 0
  buffer_load_dwordx4 v16, s[8:11], s27 offen offset:0 lds
  buffer_load_dwordx4 v17, s[8:11], s27 offen offset:1024 lds
  buffer_load_dwordx4 v18, s[8:11], s27 offen offset:2048 lds
  buffer_load_dwordx4 v19, s[8:11], s27 offen offset:3072 lds
  s_add_u32 m0, s34, 12288
  s_nop 0
  buffer_load_dwordx4 v20, s[8:11], s27 offen offset:0 lds
  buffer_load_dwordx4 v21, s[8:11], s27 offen offset:1024 lds
  buffer_load_dwordx4 v22, s[8:11], s27 offen offset:2048 lds
  buffer_load_dwordx4 v23, s[8:11], s27 offen offset:3072 lds
  ds_read_b64_tr_b16 a[0:1], v4 offset:0
  ds_read_b64_tr_b16 a[2:3], v4 offset:256
  ds_read_b64_tr_b16 a[4:5], v4 offset:8
  ds_read_b64_tr_b16 a[6:7], v4 offset:264
  ds_read_b64_tr_b16 a[8:9], v4 offset:16
  ds_read_b64_tr_b16 a[10:11], v4 offset:272
  ds_read_b64_tr_b16 a[12:13], v4 offset:24
  ds_read_b64_tr_b16 a[14:15], v4 offset:280
  ds_read_b64_tr_b16 a[16:17], v4 offset:4096
  ds_read_b64_tr_b16 a[18:19], v4 offset:4352
  ds_read_b64_tr_b16 a[20:21], v4 offset:4104
  ds_read_b64_tr_b16 a[22:23], v4 offset:4360
  ds_read_b64_tr_b16 a[24:25], v4 offset:4112
  ds_read_b64_tr_b16 a[26:27], v4 offset:4368
  ds_read_b64_tr_b16 a[28:29], v4 offset:4120
  ds_read_b64_tr_b16 a[30:31], v4 offset:4376
  s_waitcnt vmcnt(0)
  s_waitcnt lgkmcnt(0)
  s_add_u32 s27, s28, 0x28000
  s_add_u32 m0, s34, 16384
  s_nop 0
  buffer_load_dwordx4 v16, s[8:11], s27 offen offset:0 lds
  buffer_load_dwordx4 v17, s[8:11], s27 offen offset:1024 lds
  buffer_load_dwordx4 v18, s[8:11], s27 offen offset:2048 lds
  buffer_load_dwordx4 v19, s[8:11], s27 offen offset:3072 lds
  s_add_u32 m0, s34, 20480
  s_nop 0
  buffer_load_dwordx4 v20, s[8:11], s27 offen offset:0 lds
  buffer_load_dwordx4 v21, s[8:11], s27 offen offset:1024 lds
  buffer_load_dwordx4 v22, s[8:11], s27 offen offset:2048 lds
  buffer_load_dwordx4 v23, s[8:11], s27 offen offset:3072 lds
  ds_read_b64_tr_b16 a[32:33], v4 offset:8192
  ds_read_b64_tr_b16 a[34:35], v4 offset:8448
  ds_read_b64_tr_b16 a[36:37], v4 offset:8200
  ds_read_b64_tr_b16 a[38:39], v4 offset:8456
  ds_read_b64_tr_b16 a[40:41], v4 offset:8208
  ds_read_b64_tr_b16 a[42:43], v4 offset:8464
  ds_read_b64_tr_b16 a[44:45], v4 offset:8216
  ds_read_b64_tr_b16 a[46:47], v4 offset:8472
  ds_read_b64_tr_b16 a[48:49], v4 offset:12288
  ds_read_b64_tr_b16 a[50:51], v4 offset:12544
  ds_read_b64_tr_b16 a[52:53], v4 offset:12296
  ds_read_b64_tr_b16 a[54:55], v4 offset:12552
  ds_read_b64_tr_b16 a[56:57], v4 offset:12304
  ds_read_b64_tr_b16 a[58:59], v4 offset:12560
  ds_read_b64_tr_b16 a[60:61], v4 offset:12312
  ds_read_b64_tr_b16 a[62:63], v4 offset:12568
  s_waitcnt vmcnt(0)
  s_waitcnt lgkmcnt(0)
  s_add_u32 s27, s28, 0x3c000
  s_add_u32 m0, s34, 24576
  s_nop 0
  buffer_load_dwordx4 v16, s[8:11], s27 offen offset:0 lds
  buffer_load_dwordx4 v17, s[8:11], s27 offen offset:1024 lds
  buffer_load_dwordx4 v18, s[8:11], s27 offen offset:2048 lds
  buffer_load_dwordx4 v19, s[8:11], s27 offen offset:3072 lds
  s_add_u32 m0, s34, 28672
  s_nop 0
  buffer_load_dwordx4 v20, s[8:11], s27 offen offset:0 lds
  buffer_load_dwordx4 v21, s[8:11], s27 offen offset:1024 lds
  buffer_load_dwordx4 v22, s[8:11], s27 offen offset:2048 lds
  buffer_load_dwordx4 v23, s[8:11], s27 offen offset:3072 lds
  ds_read_b64_tr_b16 a[64:65], v4 offset:16384
  ds_read_b64_tr_b16 a[66:67], v4 offset:16640
  ds_read_b64_tr_b16 a[68:69], v4 offset:16392
  ds_read_b64_tr_b16 a[70:71], v4 offset:16648
  ds_read_b64_tr_b16 a[72:73], v4 offset:16400
  ds_read_b64_tr_b16 a[74:75], v4 offset:16656
  ds_read_b64_tr_b16 a[76:77], v4 offset:16408
  ds_read_b64_tr_b16 a[78:79], v4 offset:16664
  ds_read_b64_tr_b16 a[80:81], v4 offset:20480
  ds_read_b64_tr_b16 a[82:83], v4 offset:20736
  ds_read_b64_tr_b16 a[84:85], v4 offset:20488
  ds_read_b64_tr_b16 a[86:87], v4 offset:20744
  ds_read_b64_tr_b16 a[88:89], v4 offset:20496
  ds_read_b64_tr_b16 a[90:91], v4 offset:20752
  ds_read_b64_tr_b16 a[92:93], v4 offset:20504
  ds_read_b64_tr_b16 a[94:95], v4 offset:20760
  s_waitcnt vmcnt(0)
  s_waitcnt lgkmcnt(0)
  s_add_u32 s27, s28, 0x50000
  s_add_u32 m0, s34, 0
  s_nop 0
  buffer_load_dwordx4 v16, s[8:11], s27 offen offset:0 lds
  buffer_load_dwordx4 v17, s[8:11], s27 offen offset:1024 lds
  buffer_load_dwordx4 v18, s[8:11], s27 offen offset:2048 lds
  buffer_load_dwordx4 v19, s[8:11], s27 offen offset:3072 lds
  s_add_u32 m0, s34, 4096
  s_nop 0
  buffer_load_dwordx4 v20, s[8:11], s27 offen offset:0 lds
  buffer_load_dwordx4 v21, s[8:11], s27 offen offset:1024 lds
  buffer_load_dwordx4 v22, s[8:11], s27 offen offset:2048 lds
  buffer_load_dwordx4 v23, s[8:11], s27 offen offset:3072 lds
  ds_read_b64_tr_b16 a[96:97], v4 offset:24576
  ds_read_b64_tr_b16 a[98:99], v4 offset:24832
  ds_read_b64_tr_b16 a[100:101], v4 offset:24584
  ds_read_b64_tr_b16 a[102:103], v4 offset:24840
  ds_read_b64_tr_b16 a[104:105], v4 offset:24592
  ds_read_b64_tr_b16 a[106:107], v4 offset:24848
  ds_read_b64_tr_b16 a[108:109], v4 offset:24600
  ds_read_b64_tr_b16 a[110:111], v4 offset:24856
  ds_read_b64_tr_b16 a[112:113], v4 offset:28672
  ds_read_b64_tr_b16 a[114:115], v4 offset:28928
  ds_read_b64_tr_b16 a[116:117], v4 offset:28680
  ds_read_b64_tr_b16 a[118:119], v4 offset:28936
  ds_read_b64_tr_b16 a[120:121], v4 offset:28688
  ds_read_b64_tr_b16 a[122:123], v4 offset:28944
  ds_read_b64_tr_b16 a[124:125], v4 offset:28696
  ds_read_b64_tr_b16 a[126:127], v4 offset:28952
  s_waitcnt vmcnt(0)
  s_waitcnt lgkmcnt(0)
  s_add_u32 s27, s28, 0x64000
  s_add_u32 m0, s34, 8192
  s_nop 0
  buffer_load_dwordx4 v16, s[8:11], s27 offen offset:0 lds
  buffer_load_dwordx4 v17, s[8:11], s27 offen offset:1024 lds
  buffer_load_dwordx4 v18, s[8:11], s27 offen offset:2048 lds
  buffer_load_dwordx4 v19, s[8:11], s27 offen offset:3072 lds
  s_add_u32 m0, s34, 12288
  s_nop 0
  buffer_load_dwordx4 v20, s[8:11], s27 offen offset:0 lds
  buffer_load_dwordx4 v21, s[8:11], s27 offen offset:1024 lds
  buffer_load_dwordx4 v22, s[8:11], s27 offen offset:2048 lds
  buffer_load_dwordx4 v23, s[8:11], s27 offen offset:3072 lds
  ds_read_b64_tr_b16 a[128:129], v4 offset:0
  ds_read_b64_tr_b16 a[130:131], v4 offset:256
  ds_read_b64_tr_b16 a[132:133], v4 offset:8
  ds_read_b64_tr_b16 a[134:135], v4 offset:264
  ds_read_b64_tr_b16 a[136:137], v4 offset:16
  ds_read_b64_tr_b16 a[138:139], v4 offset:272
  ds_read_b64_tr_b16 a[140:141], v4 offset:24
  ds_read_b64_tr_b16 a[142:143], v4 offset:280
  ds_read_b64_tr_b16 a[144:145], v4 offset:4096
  ds_read_b64_tr_b16 a[146:147], v4 offset:4352
  ds_read_b64_tr_b16 a[148:149], v4 offset:4104
  ds_read_b64_tr_b16 a[150:151], v4 offset:4360
  ds_read_b64_tr_b16 a[152:153], v4 offset:4112
  ds_read_b64_tr_b16 a[154:155], v4 offset:4368
  ds_read_b64_tr_b16 a[156:157], v4 offset:4120
  ds_read_b64_tr_b16 a[158:159], v4 offset:4376
  s_waitcnt vmcnt(0)
  ds_read_b64_tr_b16 a[160:161], v4 offset:8192
  ds_read_b64_tr_b16 a[162:163], v4 offset:8448
  ds_read_b64_tr_b16 a[164:165], v4 offset:8200
  ds_read_b64_tr_b16 a[166:167], v4 offset:8456
  ds_read_b64_tr_b16 a[168:169], v4 offset:8208
  ds_read_b64_tr_b16 a[170:171], v4 offset:8464
  ds_read_b64_tr_b16 a[172:173], v4 offset:8216
  ds_read_b64_tr_b16 a[174:175], v4 offset:8472
  ds_read_b64_tr_b16 a[176:177], v4 offset:12288
  ds_read_b64_tr_b16 a[178:179], v4 offset:12544
  ds_read_b64_tr_b16 a[180:181], v4 offset:12296
  ds_read_b64_tr_b16 a[182:183], v4 offset:12552
  ds_read_b64_tr_b16 a[184:185], v4 offset:12304
  ds_read_b64_tr_b16 a[186:187], v4 offset:12560
  ds_read_b64_tr_b16 a[188:189], v4 offset:12312
  ds_read_b64_tr_b16 a[190:191], v4 offset:12568
  s_waitcnt vmcnt(0) lgkmcnt(0)
  v_and_b32 v2, 3, v1
  v_lshlrev_b32 v2, 2, v2
Lcw_244:
  s_add_u32 s24, s24, 1
  s_cmp_gt_u32 s24, 300000
  s_cbranch_scc1 Lfail_243
  buffer_load_dword v3, v2, s[12:15], 0 offen offset:128 sc1
  s_waitcnt vmcnt(0)
  v_cmp_eq_u32 vcc, 0, v3
  s_and_b32 s26, vcc_lo, 2
  s_cmp_eq_u32 s26, 0
  s_cbranch_scc1 Lcok_245
  s_sleep 6
  s_branch Lcw_244
Lcok_245:
  v_readlane_b32 s23, v3, 3
  s_and_b32 s23, s23, 0x2000
  v_lshlrev_b32 v5, 4, v1
  v_mov_b32 v0, 0
  v_min_u32 v2, 5, v1
  v_lshlrev_b32 v6, 2, v2
  s_mul_i32 s29, s21, 24
  s_add_u32 s29, s29, 0x2400
  s_mul_i32 s30, s21, 24576
  s_add_u32 s30, s30, 0xc700000
  s_and_b32 s44, s21, 1
  s_lshr_b32 s45, s21, 1
  s_lshl_b32 s26, s21, 13
  v_add_u32 v8, s26, v5
  s_lshl_b32 s26, s45, 12
  s_lshl_b32 s27, s44, 10
  s_add_u32 s26, s26, s27
  v_add_u32 v9, s26, v5
  s_lshl_b32 s26, s20, 6
  s_lshl_b32 s27, s45, 3
  s_add_u32 s26, s26, s27
  v_lshrrev_b32 v2, 4, v1
  v_lshl_add_u32 v2, v2, 4, s26
  v_and_b32 v3, 15, v1
  s_lshl_b32 s27, s44, 4
  v_add_u32 v3, s27, v3
  v_mul_u32_u24 v3, 1280, v3
  v_lshl_add_u32 v11, v2, 1, v3
  v_lshlrev_b32 v10, 1, v11
  v_lshlrev_b32 v3, 1, v2
  v_lshlrev_b32 v2, 2, v2
  s_mov_b32 s26, 0x283200
  buffer_load_dwordx4 v[208:211], v3, s[16:19], 0 offen
  buffer_load_dwordx4 v[200:203], v2, s[4:7], s26 offen sc1
  buffer_load_dwordx4 v[204:207], v2, s[4:7], s26 offen offset:16 sc1
  s_waitcnt vmcnt(0)
  v_lshlrev_b32 v192, 16, v208
  v_and_b32 v193, 0xffff0000, v208
  v_lshlrev_b32 v194, 16, v209
  v_and_b32 v195, 0xffff0000, v209
  v_lshlrev_b32 v196, 16, v210
  v_and_b32 v197, 0xffff0000, v210
  v_lshlrev_b32 v198, 16, v211
  v_and_b32 v199, 0xffff0000, v211
  s_mov_b32 s16, s60
  s_and_b32 s17, s61, 0xffff
  s_mov_b32 s18, 0x280000
  s_mov_b32 s19, 0x20000
  s_mov_b32 s22, 0
  s_mov_b32 s47, 0
  s_barrier
  s_lshl_b32 s29, s29, 5
  s_add_u32 s29, s29, 0x200000
  v_lshlrev_b32 v6, 5, v6
  s_mov_b32 s25, 0
  s_add_u32 s26, s83, 52
  s_cmp_lg_u32 s83, 0
  s_cselect_b32 s22, s26, 0
  s_lshl_b32 s26, s83, 12
  s_add_u32 s29, s29, s26
Lml_247:
  s_cmp_eq_u32 s25, 1
  s_cbranch_scc1 Lmpre_248
  s_add_u32 s38, s22, 1
Lwf_250:
  s_add_u32 s24, s24, 1
  s_cmp_gt_u32 s24, 300000
  s_cbranch_scc1 Lfail_246
  buffer_load_dword v7, v6, s[4:7], s29 offen sc1
  s_waitcnt vmcnt(0)
  v_cmp_gt_u32 vcc, s38, v7
  s_cbranch_vccz Lrok_251
  s_sleep 2
  s_branch Lwf_250
Lrok_251:
Lwok_249:
  s_mul_i32 s27, s22, 98304
  s_add_u32 s27, s27, s30
  s_mul_i32 s28, s22, 81920
  s_add_u32 s28, s28, 0xbe00000
  buffer_load_dwordx4 v[32:35], v5, s[4:7], s27 offen offset:0 sc1
  buffer_load_dwordx4 v[36:39], v5, s[4:7], s27 offen offset:1024 sc1
  buffer_load_dwordx4 v[40:43], v5, s[4:7], s27 offen offset:2048 sc1
  buffer_load_dwordx4 v[44:47], v5, s[4:7], s27 offen offset:3072 sc1
  s_add_u32 s27, s27, 4096
  buffer_load_dwordx4 v[48:51], v5, s[4:7], s27 offen offset:0 sc1
  buffer_load_dwordx4 v[52:55], v5, s[4:7], s27 offen offset:1024 sc1
  buffer_load_dwordx4 v[56:59], v5, s[4:7], s27 offen offset:2048 sc1
  buffer_load_dwordx4 v[60:63], v5, s[4:7], s27 offen offset:3072 sc1
  s_add_u32 s27, s27, 4096
  buffer_load_dwordx4 v[64:67], v5, s[4:7], s27 offen offset:0 sc1
  buffer_load_dwordx4 v[68:71], v5, s[4:7], s27 offen offset:1024 sc1
  buffer_load_dwordx4 v[72:75], v5, s[4:7], s27 offen offset:2048 sc1
  buffer_load_dwordx4 v[76:79], v5, s[4:7], s27 offen offset:3072 sc1
  s_add_u32 s27, s27, 4096
  buffer_load_dwordx4 v[80:83], v5, s[4:7], s27 offen offset:0 sc1
  buffer_load_dwordx4 v[84:87], v5, s[4:7], s27 offen offset:1024 sc1
  buffer_load_dwordx4 v[88:91], v5, s[4:7], s27 offen offset:2048 sc1
  buffer_load_dwordx4 v[92:95], v5, s[4:7], s27 offen offset:3072 sc1
  s_add_u32 s27, s27, 4096
  buffer_load_dwordx4 v[96:99], v5, s[4:7], s27 offen offset:0 sc1
  buffer_load_dwordx4 v[100:103], v5, s[4:7], s27 offen offset:1024 sc1
  buffer_load_dwordx4 v[104:107], v5, s[4:7], s27 offen offset:2048 sc1
  buffer_load_dwordx4 v[108:111], v5, s[4:7], s27 offen offset:3072 sc1
  s_add_u32 s27, s27, 4096
  buffer_load_dwordx4 v[112:115], v5, s[4:7], s27 offen offset:0 sc1
  buffer_load_dwordx4 v[116:119], v5, s[4:7], s27 offen offset:1024 sc1
  buffer_load_dwordx4 v[120:123], v5, s[4:7], s27 offen offset:2048 sc1
  buffer_load_dwordx4 v[124:127], v5, s[4:7], s27 offen offset:3072 sc1
  buffer_load_dwordx4 v[216:219], v10, s[4:7], s28 offen sc1
  buffer_load_dwordx4 v[220:223], v10, s[4:7], s28 offen offset:16 sc1
  buffer_load_dword v2, v0, s[4:7], s29 offen sc1
Lmpre_248:
  buffer_load_dword v7, v6, s[4:7], s29 offen sc1
  s_cmp_lt_u32 s22, 52
  s_cselect_b32 s40, 1, 4
  s_add_u32 s40, s40, s22
  s_waitcnt vmcnt(27)
  v_mfma_f32_16x16x32_bf16 v[128:131], a[0:3], v[32:35], 0
  v_mfma_f32_16x16x32_bf16 v[136:139], a[4:7], v[32:35], 0
  v_mfma_f32_16x16x32_bf16 v[144:147], a[8:11], v[32:35], 0
  v_mfma_f32_16x16x32_bf16 v[152:155], a[12:15], v[32:35], 0
  s_waitcnt vmcnt(26)
  v_mfma_f32_16x16x32_bf16 v[132:135], a[0:3], v[36:39], 0
  v_mfma_f32_16x16x32_bf16 v[140:143], a[4:7], v[36:39], 0
  v_mfma_f32_16x16x32_bf16 v[148:151], a[8:11], v[36:39], 0
  v_mfma_f32_16x16x32_bf16 v[156:159], a[12:15], v[36:39], 0
  s_waitcnt vmcnt(25)
  v_mfma_f32_16x16x32_bf16 v[128:131], a[16:19], v[40:43], v[128:131]
  v_mfma_f32_16x16x32_bf16 v[136:139], a[20:23], v[40:43], v[136:139]
  v_mfma_f32_16x16x32_bf16 v[144:147], a[24:27], v[40:43], v[144:147]
  v_mfma_f32_16x16x32_bf16 v[152:155], a[28:31], v[40:43], v[152:155]
  s_waitcnt vmcnt(24)
  v_mfma_f32_16x16x32_bf16 v[132:135], a[16:19], v[44:47], v[132:135]
  v_mfma_f32_16x16x32_bf16 v[140:143], a[20:23], v[44:47], v[140:143]
  v_mfma_f32_16x16x32_bf16 v[148:151], a[24:27], v[44:47], v[148:151]
  v_mfma_f32_16x16x32_bf16 v[156:159], a[28:31], v[44:47], v[156:159]
  s_waitcnt vmcnt(23)
  v_mfma_f32_16x16x32_bf16 v[128:131], a[32:35], v[48:51], v[128:131]
  v_mfma_f32_16x16x32_bf16 v[136:139], a[36:39], v[48:51], v[136:139]
  v_mfma_f32_16x16x32_bf16 v[144:147], a[40:43], v[48:51], v[144:147]
  v_mfma_f32_16x16x32_bf16 v[152:155], a[44:47], v[48:51], v[152:155]
  s_waitcnt vmcnt(22)
  v_mfma_f32_16x16x32_bf16 v[132:135], a[32:35], v[52:55], v[132:135]
  v_mfma_f32_16x16x32_bf16 v[140:143], a[36:39], v[52:55], v[140:143]
  v_mfma_f32_16x16x32_bf16 v[148:151], a[40:43], v[52:55], v[148:151]
  v_mfma_f32_16x16x32_bf16 v[156:159], a[44:47], v[52:55], v[156:159]
  s_waitcnt vmcnt(21)
  v_mfma_f32_16x16x32_bf16 v[128:131], a[48:51], v[56:59], v[128:131]
  v_mfma_f32_16x16x32_bf16 v[136:139], a[52:55], v[56:59], v[136:139]
  v_mfma_f32_16x16x32_bf16 v[144:147], a[56:59], v[56:59], v[144:147]
  v_mfma_f32_16x16x32_bf16 v[152:155], a[60:63], v[56:59], v[152:155]
  s_waitcnt vmcnt(20)
  v_mfma_f32_16x16x32_bf16 v[132:135], a[48:51], v[60:63], v[132:135]
  v_mfma_f32_16x16x32_bf16 v[140:143], a[52:55], v[60:63], v[140:143]
  v_mfma_f32_16x16x32_bf16 v[148:151], a[56:59], v[60:63], v[148:151]
  v_mfma_f32_16x16x32_bf16 v[156:159], a[60:63], v[60:63], v[156:159]
  s_waitcnt vmcnt(19)
  v_mfma_f32_16x16x32_bf16 v[128:131], a[64:67], v[64:67], v[128:131]
  v_mfma_f32_16x16x32_bf16 v[136:139], a[68:71], v[64:67], v[136:139]
  v_mfma_f32_16x16x32_bf16 v[144:147], a[72:75], v[64:67], v[144:147]
  v_mfma_f32_16x16x32_bf16 v[152:155], a[76:79], v[64:67], v[152:155]
  s_waitcnt vmcnt(18)
  v_mfma_f32_16x16x32_bf16 v[132:135], a[64:67], v[68:71], v[132:135]
  v_mfma_f32_16x16x32_bf16 v[140:143], a[68:71], v[68:71], v[140:143]
  v_mfma_f32_16x16x32_bf16 v[148:151], a[72:75], v[68:71], v[148:151]
  v_mfma_f32_16x16x32_bf16 v[156:159], a[76:79], v[68:71], v[156:159]
  s_waitcnt vmcnt(17)
  v_mfma_f32_16x16x32_bf16 v[128:131], a[80:83], v[72:75], v[128:131]
  v_mfma_f32_16x16x32_bf16 v[136:139], a[84:87], v[72:75], v[136:139]
  v_mfma_f32_16x16x32_bf16 v[144:147], a[88:91], v[72:75], v[144:147]
  v_mfma_f32_16x16x32_bf16 v[152:155], a[92:95], v[72:75], v[152:155]
  s_waitcnt vmcnt(16)
  v_mfma_f32_16x16x32_bf16 v[132:135], a[80:83], v[76:79], v[132:135]
  v_mfma_f32_16x16x32_bf16 v[140:143], a[84:87], v[76:79], v[140:143]
  v_mfma_f32_16x16x32_bf16 v[148:151], a[88:91], v[76:79], v[148:151]
  v_mfma_f32_16x16x32_bf16 v[156:159], a[92:95], v[76:79], v[156:159]
  s_waitcnt vmcnt(15)
  v_mfma_f32_16x16x32_bf16 v[128:131], a[96:99], v[80:83], v[128:131]
  v_mfma_f32_16x16x32_bf16 v[136:139], a[100:103], v[80:83], v[136:139]
  v_mfma_f32_16x16x32_bf16 v[144:147], a[104:107], v[80:83], v[144:147]
  v_mfma_f32_16x16x32_bf16 v[152:155], a[108:111], v[80:83], v[152:155]
  s_waitcnt vmcnt(14)
  v_mfma_f32_16x16x32_bf16 v[132:135], a[96:99], v[84:87], v[132:135]
  v_mfma_f32_16x16x32_bf16 v[140:143], a[100:103], v[84:87], v[140:143]
  v_mfma_f32_16x16x32_bf16 v[148:151], a[104:107], v[84:87], v[148:151]
  v_mfma_f32_16x16x32_bf16 v[156:159], a[108:111], v[84:87], v[156:159]
  s_waitcnt vmcnt(13)
  v_mfma_f32_16x16x32_bf16 v[128:131], a[112:115], v[88:91], v[128:131]
  v_mfma_f32_16x16x32_bf16 v[136:139], a[116:119], v[88:91], v[136:139]
  v_mfma_f32_16x16x32_bf16 v[144:147], a[120:123], v[88:91], v[144:147]
  v_mfma_f32_16x16x32_bf16 v[152:155], a[124:127], v[88:91], v[152:155]
  s_waitcnt vmcnt(12)
  v_mfma_f32_16x16x32_bf16 v[132:135], a[112:115], v[92:95], v[132:135]
  v_mfma_f32_16x16x32_bf16 v[140:143], a[116:119], v[92:95], v[140:143]
  v_mfma_f32_16x16x32_bf16 v[148:151], a[120:123], v[92:95], v[148:151]
  v_mfma_f32_16x16x32_bf16 v[156:159], a[124:127], v[92:95], v[156:159]
  s_waitcnt vmcnt(11)
  v_mfma_f32_16x16x32_bf16 v[128:131], a[128:131], v[96:99], v[128:131]
  v_mfma_f32_16x16x32_bf16 v[136:139], a[132:135], v[96:99], v[136:139]
  v_mfma_f32_16x16x32_bf16 v[144:147], a[136:139], v[96:99], v[144:147]
  v_mfma_f32_16x16x32_bf16 v[152:155], a[140:143], v[96:99], v[152:155]
  s_waitcnt vmcnt(10)
  v_mfma_f32_16x16x32_bf16 v[132:135], a[128:131], v[100:103], v[132:135]
  v_mfma_f32_16x16x32_bf16 v[140:143], a[132:135], v[100:103], v[140:143]
  v_mfma_f32_16x16x32_bf16 v[148:151], a[136:139], v[100:103], v[148:151]
  v_mfma_f32_16x16x32_bf16 v[156:159], a[140:143], v[100:103], v[156:159]
  s_waitcnt vmcnt(9)
  v_mfma_f32_16x16x32_bf16 v[128:131], a[144:147], v[104:107], v[128:131]
  v_mfma_f32_16x16x32_bf16 v[136:139], a[148:151], v[104:107], v[136:139]
  v_mfma_f32_16x16x32_bf16 v[144:147], a[152:155], v[104:107], v[144:147]
  v_mfma_f32_16x16x32_bf16 v[152:155], a[156:159], v[104:107], v[152:155]
  s_waitcnt vmcnt(8)
  v_mfma_f32_16x16x32_bf16 v[132:135], a[144:147], v[108:111], v[132:135]
  v_mfma_f32_16x16x32_bf16 v[140:143], a[148:151], v[108:111], v[140:143]
  v_mfma_f32_16x16x32_bf16 v[148:151], a[152:155], v[108:111], v[148:151]
  v_mfma_f32_16x16x32_bf16 v[156:159], a[156:159], v[108:111], v[156:159]
  s_waitcnt vmcnt(7)
  v_mfma_f32_16x16x32_bf16 v[128:131], a[160:163], v[112:115], v[128:131]
  v_mfma_f32_16x16x32_bf16 v[136:139], a[164:167], v[112:115], v[136:139]
  v_mfma_f32_16x16x32_bf16 v[144:147], a[168:171], v[112:115], v[144:147]
  v_mfma_f32_16x16x32_bf16 v[152:155], a[172:175], v[112:115], v[152:155]
  s_waitcnt vmcnt(6)
  v_mfma_f32_16x16x32_bf16 v[132:135], a[160:163], v[116:119], v[132:135]
  v_mfma_f32_16x16x32_bf16 v[140:143], a[164:167], v[116:119], v[140:143]
  v_mfma_f32_16x16x32_bf16 v[148:151], a[168:171], v[116:119], v[148:151]
  v_mfma_f32_16x16x32_bf16 v[156:159], a[172:175], v[116:119], v[156:159]
  s_waitcnt vmcnt(5)
  v_mfma_f32_16x16x32_bf16 v[128:131], a[176:179], v[120:123], v[128:131]
  v_mfma_f32_16x16x32_bf16 v[136:139], a[180:183], v[120:123], v[136:139]
  v_mfma_f32_16x16x32_bf16 v[144:147], a[184:187], v[120:123], v[144:147]
  v_mfma_f32_16x16x32_bf16 v[152:155], a[188:191], v[120:123], v[152:155]
  s_waitcnt vmcnt(4)
  v_mfma_f32_16x16x32_bf16 v[132:135], a[176:179], v[124:127], v[132:135]
  v_mfma_f32_16x16x32_bf16 v[140:143], a[180:183], v[124:127], v[140:143]
  v_mfma_f32_16x16x32_bf16 v[148:151], a[184:187], v[124:127], v[148:151]
  v_mfma_f32_16x16x32_bf16 v[156:159], a[188:191], v[124:127], v[156:159]
  s_waitcnt vmcnt(0)
  s_add_u32 s38, s40, 1
  v_mov_b32 v208, v216
  v_mov_b32 v209, v217
  v_mov_b32 v210, v218
  v_mov_b32 v211, v219
  v_mov_b32 v212, v220
  v_mov_b32 v213, v221
  v_mov_b32 v214, v222
  v_mov_b32 v215, v223
  v_cmp_gt_u32 vcc, s38, v7
  v_add_u32 v2, s47, v8
  v_add_u32 v3, s47, v9
  s_xor_b32 s47, s47, 0x8000
  s_cmp_eq_u64 vcc, 0
  s_cselect_b32 s25, 1, 0
  ds_write_b128 v2, v[128:131] offset:0
  ds_write_b128 v2, v[132:135] offset:1024
  ds_write_b128 v2, v[136:139] offset:2048
  ds_write_b128 v2, v[140:143] offset:3072
  ds_write_b128 v2, v[144:147] offset:4096
  ds_write_b128 v2, v[148:151] offset:5120
  ds_write_b128 v2, v[152:155] offset:6144
  ds_write_b128 v2, v[156:159] offset:7168
  s_cmp_eq_u32 s25, 0
  s_cbranch_scc1 Lmnl_252
  s_mul_i32 s27, s40, 98304
  s_add_u32 s27, s27, s30
  s_mul_i32 s28, s40, 81920
  s_add_u32 s28, s28, 0xbe00000
  buffer_load_dwordx4 v[32:35], v5, s[4:7], s27 offen offset:0 sc1
  buffer_load_dwordx4 v[36:39], v5, s[4:7], s27 offen offset:1024 sc1
  buffer_load_dwordx4 v[40:43], v5, s[4:7], s27 offen offset:2048 sc1
  buffer_load_dwordx4 v[44:47], v5, s[4:7], s27 offen offset:3072 sc1
  s_add_u32 s27, s27, 4096
  buffer_load_dwordx4 v[48:51], v5, s[4:7], s27 offen offset:0 sc1
  buffer_load_dwordx4 v[52:55], v5, s[4:7], s27 offen offset:1024 sc1
  buffer_load_dwordx4 v[56:59], v5, s[4:7], s27 offen offset:2048 sc1
  buffer_load_dwordx4 v[60:63], v5, s[4:7], s27 offen offset:3072 sc1
  s_add_u32 s27, s27, 4096
  buffer_load_dwordx4 v[64:67], v5, s[4:7], s27 offen offset:0 sc1
  buffer_load_dwordx4 v[68:71], v5, s[4:7], s27 offen offset:1024 sc1
  buffer_load_dwordx4 v[72:75], v5, s[4:7], s27 offen offset:2048 sc1
  buffer_load_dwordx4 v[76:79], v5, s[4:7], s27 offen offset:3072 sc1
  s_add_u32 s27, s27, 4096
  buffer_load_dwordx4 v[80:83], v5, s[4:7], s27 offen offset:0 sc1
  buffer_load_dwordx4 v[84:87], v5, s[4:7], s27 offen offset:1024 sc1
  buffer_load_dwordx4 v[88:91], v5, s[4:7], s27 offen offset:2048 sc1
  buffer_load_dwordx4 v[92:95], v5, s[4:7], s27 offen offset:3072 sc1
  s_add_u32 s27, s27, 4096
  buffer_load_dwordx4 v[96:99], v5, s[4:7], s27 offen offset:0 sc1
  buffer_load_dwordx4 v[100:103], v5, s[4:7], s27 offen offset:1024 sc1
  buffer_load_dwordx4 v[104:107], v5, s[4:7], s27 offen offset:2048 sc1
  buffer_load_dwordx4 v[108:111], v5, s[4:7], s27 offen offset:3072 sc1
  s_add_u32 s27, s27, 4096
  buffer_load_dwordx4 v[112:115], v5, s[4:7], s27 offen offset:0 sc1
  buffer_load_dwordx4 v[116:119], v5, s[4:7], s27 offen offset:1024 sc1
  buffer_load_dwordx4 v[120:123], v5, s[4:7], s27 offen offset:2048 sc1
  buffer_load_dwordx4 v[124:127], v5, s[4:7], s27 offen offset:3072 sc1
  buffer_load_dwordx4 v[216:219], v10, s[4:7], s28 offen sc1
  buffer_load_dwordx4 v[220:223], v10, s[4:7], s28 offen offset:16 sc1
Lmnl_252:
  s_waitcnt lgkmcnt(0)
  s_barrier
  ds_read_b128 v[160:163], v3 offset:0
  ds_read_b128 v[164:167], v3 offset:2048
  ds_read_b128 v[168:171], v3 offset:8192
  ds_read_b128 v[172:175], v3 offset:10240
  ds_read_b128 v[176:179], v3 offset:16384
  ds_read_b128 v[180:183], v3 offset:18432
  ds_read_b128 v[184:187], v3 offset:24576
  ds_read_b128 v[188:191], v3 offset:26624
  s_mul_i32 s27, s22, 40960
  s_waitcnt lgkmcnt(0)
  v_add_f32 v160, v160, v168
  v_add_f32 v176, v176, v184
  v_add_f32 v160, v160, v176
  v_add_f32 v160, v160, v192
  v_fma_f32 v160, v160, v200, v208
  v_add_f32 v161, v161, v169
  v_add_f32 v177, v177, v185
  v_add_f32 v161, v161, v177
  v_add_f32 v161, v161, v193
  v_fma_f32 v161, v161, v201, v209
  v_add_f32 v162, v162, v170
  v_add_f32 v178, v178, v186
  v_add_f32 v162, v162, v178
  v_add_f32 v162, v162, v194
  v_fma_f32 v162, v162, v202, v210
  v_add_f32 v163, v163, v171
  v_add_f32 v179, v179, v187
  v_add_f32 v163, v163, v179
  v_add_f32 v163, v163, v195
  v_fma_f32 v163, v163, v203, v211
  v_add_f32 v164, v164, v172
  v_add_f32 v180, v180, v188
  v_add_f32 v164, v164, v180
  v_add_f32 v164, v164, v196
  v_fma_f32 v164, v164, v204, v212
  v_add_f32 v165, v165, v173
  v_add_f32 v181, v181, v189
  v_add_f32 v165, v165, v181
  v_add_f32 v165, v165, v197
  v_fma_f32 v165, v165, v205, v213
  v_add_f32 v166, v166, v174
  v_add_f32 v182, v182, v190
  v_add_f32 v166, v166, v182
  v_add_f32 v166, v166, v198
  v_fma_f32 v166, v166, v206, v214
  v_add_f32 v167, v167, v175
  v_add_f32 v183, v183, v191
  v_add_f32 v167, v167, v183
  v_add_f32 v167, v167, v199
  v_fma_f32 v167, v167, v207, v215
  v_cvt_pk_bf16_f32 v168, v160, v161
  v_cvt_pk_bf16_f32 v169, v162, v163
  v_cvt_pk_bf16_f32 v170, v164, v165
  v_cvt_pk_bf16_f32 v171, v166, v167
  buffer_store_dwordx4 v[168:171], v11, s[16:19], s27 offen
  s_mov_b32 s22, s40
  s_cmp_lt_u32 s22, 64
  s_cbranch_scc1 Lml_247
  s_branch Lmain_end
Lfail_44:
  s_mov_b64 exec, -1
  v_mov_b32 v2, 116
  v_mov_b32 v3, s22
  v_add_u32 v3, 1, v3
  buffer_store_dword v3, v2, s[12:15], 0 offen
  s_branch Lmain_end
Lfail_48:
  s_mov_b64 exec, -1
  v_mov_b32 v2, 112
  v_mov_b32 v3, s22
  v_add_u32 v3, 1, v3
  buffer_store_dword v3, v2, s[12:15], 0 offen
  s_branch Lmain_end
Lfail_56:
  s_mov_b64 exec, -1
  v_mov_b32 v2, 120
  v_mov_b32 v3, s22
  v_add_u32 v3, 1, v3
  buffer_store_dword v3, v2, s[12:15], 0 offen
  s_branch Lmain_end
Lfail_59:
  s_mov_b64 exec, -1
  v_mov_b32 v2, 112
  v_mov_b32 v3, s22
  v_add_u32 v3, 1, v3
  buffer_store_dword v3, v2, s[12:15], 0 offen
  s_branch Lmain_end
Lfail_67:
  s_mov_b64 exec, -1
  v_mov_b32 v2, 92
  v_mov_b32 v3, s22
  v_add_u32 v3, 1, v3
  buffer_store_dword v3, v2, s[12:15], 0 offen
  s_branch Lmain_end
Lfail_71:
  s_mov_b64 exec, -1
  v_mov_b32 v2, 112
  v_mov_b32 v3, s22
  v_add_u32 v3, 1, v3
  buffer_store_dword v3, v2, s[12:15], 0 offen
  s_branch Lmain_end
Lfail_74:
  s_mov_b64 exec, -1
  v_mov_b32 v2, 60
  v_mov_b32 v3, s22
  v_add_u32 v3, 1, v3
  buffer_store_dword v3, v2, s[12:15], 0 offen
  s_branch Lmain_end
Lfail_87:
  s_mov_b64 exec, -1
  v_mov_b32 v2, 112
  v_mov_b32 v3, s22
  v_add_u32 v3, 1, v3
  buffer_store_dword v3, v2, s[12:15], 0 offen
  s_branch Lmain_end
Lfail_90:
  s_mov_b64 exec, -1
  v_mov_b32 v2, 68
  v_mov_b32 v3, s22
  v_add_u32 v3, 1, v3
  buffer_store_dword v3, v2, s[12:15], 0 offen
  s_branch Lmain_end
Lfail_100:
  s_mov_b64 exec, -1
  v_mov_b32 v2, 64
  v_mov_b32 v3, s22
  v_add_u32 v3, 1, v3
  buffer_store_dword v3, v2, s[12:15], 0 offen
  s_branch Lmain_end
Lfail_116:
  s_mov_b64 exec, -1
  v_mov_b32 v2, 112
  v_mov_b32 v3, s22
  v_add_u32 v3, 1, v3
  buffer_store_dword v3, v2, s[12:15], 0 offen
  s_branch Lmain_end
Lfail_120:
  s_mov_b64 exec, -1
  v_mov_b32 v2, 72
  v_mov_b32 v3, s22
  v_add_u32 v3, 1, v3
  buffer_store_dword v3, v2, s[12:15], 0 offen
  s_branch Lmain_end
Lfail_130:
  s_mov_b64 exec, -1
  v_mov_b32 v2, 80
  v_mov_b32 v3, s22
  v_add_u32 v3, 1, v3
  buffer_store_dword v3, v2, s[12:15], 0 offen
  s_branch Lmain_end
Lfail_131:
  s_mov_b64 exec, -1
  v_mov_b32 v2, 76
  v_mov_b32 v3, s22
  v_add_u32 v3, 1, v3
  buffer_store_dword v3, v2, s[12:15], 0 offen
  s_branch Lmain_end
Lfail_170:
  s_mov_b64 exec, -1
  v_mov_b32 v2, 84
  v_mov_b32 v3, s22
  v_add_u32 v3, 1, v3
  buffer_store_dword v3, v2, s[12:15], 0 offen
  s_branch Lmain_end
Lfail_171:
  s_mov_b64 exec, -1
  v_mov_b32 v2, 88
  v_mov_b32 v3, s22
  v_add_u32 v3, 1, v3
  buffer_store_dword v3, v2, s[12:15], 0 offen
  s_branch Lmain_end
Lfail_189:
  s_mov_b64 exec, -1
  v_mov_b32 v2, 96
  v_mov_b32 v3, s22
  v_add_u32 v3, 1, v3
  buffer_store_dword v3, v2, s[12:15], 0 offen
  s_branch Lmain_end
Lfail_190:
  s_mov_b64 exec, -1
  v_mov_b32 v2, 100
  v_mov_b32 v3, s22
  v_add_u32 v3, 1, v3
  buffer_store_dword v3, v2, s[12:15], 0 offen
  s_branch Lmain_end
Lfail_218:
  s_mov_b64 exec, -1
  v_mov_b32 v2, 104
  v_mov_b32 v3, s22
  v_add_u32 v3, 1, v3
  buffer_store_dword v3, v2, s[12:15], 0 offen
  s_branch Lmain_end
Lfail_224:
  s_mov_b64 exec, -1
  v_mov_b32 v2, 120
  v_mov_b32 v3, s22
  v_add_u32 v3, 1, v3
  buffer_store_dword v3, v2, s[12:15], 0 offen
  s_branch Lmain_end
Lfail_227:
  s_mov_b64 exec, -1
  v_mov_b32 v2, 112
  v_mov_b32 v3, s22
  v_add_u32 v3, 1, v3
  buffer_store_dword v3, v2, s[12:15], 0 offen
  s_branch Lmain_end
Lfail_236:
  s_mov_b64 exec, -1
  v_mov_b32 v2, 92
  v_mov_b32 v3, s22
  v_add_u32 v3, 1, v3
  buffer_store_dword v3, v2, s[12:15], 0 offen
  s_branch Lmain_end
Lfail_240:
  s_mov_b64 exec, -1
  v_mov_b32 v2, 120
  v_mov_b32 v3, s22
  v_add_u32 v3, 1, v3
  buffer_store_dword v3, v2, s[12:15], 0 offen
  s_branch Lmain_end
Lfail_243:
  s_mov_b64 exec, -1
  v_mov_b32 v2, 112
  v_mov_b32 v3, s22
  v_add_u32 v3, 1, v3
  buffer_store_dword v3, v2, s[12:15], 0 offen
  s_branch Lmain_end
Lfail_246:
  s_mov_b64 exec, -1
  v_mov_b32 v2, 108
  v_mov_b32 v3, s22
  v_add_u32 v3, 1, v3
  buffer_store_dword v3, v2, s[12:15], 0 offen
  s_branch Lmain_end
Lmain_end:
  s_endpgm
.section .rodata,"a"
.p2align 6
.amdhsa_kernel adaLN_cond__memory_aug_recurrent_mem_tr__mixer_channel_mlp__prompt_kernel
  .amdhsa_next_free_vgpr 512
  .amdhsa_next_free_sgpr 102
  .amdhsa_accum_offset 256
  .amdhsa_group_segment_fixed_size 0
  .amdhsa_kernarg_size 136
  .amdhsa_user_sgpr_count 2
  .amdhsa_user_sgpr_kernarg_segment_ptr 1
  .amdhsa_system_sgpr_workgroup_id_x 1
.end_amdhsa_kernel
```
